```python
import torch

def _softmax(x, axis=-1):
    return torch.softmax(x, dim=axis)
def _gelu(x):
    return torch.nn.functional.gelu(x, approximate="tanh")
def _silu(x):
    return torch.nn.functional.silu(x)
def _sigmoid(x):
    return torch.sigmoid(x)
def _layernorm(x, axis=-1, eps=1e-5):
    m = x.mean(dim=axis, keepdim=True)
    v = x.var(dim=axis, keepdim=True, unbiased=False)
    return (x - m) / torch.sqrt(v + eps)
def _scatter_add(tgt, idx, src, axis=0):
    return tgt.clone().index_add_(axis, idx, src)
def _segment_sum(src, seg, n):
    out = torch.zeros((n,) + src.shape[1:], dtype=src.dtype)
    return out.index_add_(0, seg, src)
def _pad(x, pw):
    flat = tuple(v for pair in reversed(pw) for v in pair)
    return torch.nn.functional.pad(x, flat)

kernel_name = 'recurrent_scan__sliding_local_dilated__dense_activation_gelu__prompt'

def setup_inputs():

    _w = (lambda a: (lambda t: t.to(torch.bfloat16) if t.is_floating_point() else t)(torch.as_tensor(a)))
    def _A_setup():
        B, S, D = 1, 2048, 576
        return {
            "x": _w((lambda *s: torch.randn(*s, dtype=torch.bfloat16) * 0.05)(B, S, D)),
            "wqkv": _w((lambda *s: torch.randn(*s, dtype=torch.bfloat16) * 0.2)(D, 3 * D)),
            "wo": _w((lambda *s: torch.randn(*s, dtype=torch.bfloat16) * 0.2)(D, D)),
        }
    _A_in = _A_setup()

    def _B_setup():
        B, S, D, F = 1, 2048, 576, 4608
        return {
            "x": _w((lambda *s: torch.randn(*s, dtype=torch.bfloat16) * 0.05)(B, S, D)),
            "w1": _w((lambda *s: torch.randn(*s, dtype=torch.bfloat16) * 0.8)(D, F) * (D ** -0.5)),
            "b1": _w((lambda *s: torch.randn(*s, dtype=torch.bfloat16) * 0.8)(F) * 0.01),
            "w2": _w((lambda *s: torch.randn(*s, dtype=torch.bfloat16) * 0.1)(F, D) * (F ** -0.5)),
            "b2": _w((lambda *s: torch.randn(*s, dtype=torch.bfloat16) * 0.1)(D) * 0.01),
        }
    _B_in = _B_setup()

    return {
        "A_x": _A_in["x"],
        "A_wqkv": _A_in["wqkv"],
        "A_wo": _A_in["wo"],
        "B_x": _B_in["x"],
        "B_w1": _B_in["w1"],
        "B_b1": _B_in["b1"],
        "B_w2": _B_in["w2"],
        "B_b2": _B_in["b2"],
    }

def reference(A_x, A_wqkv, A_wo, B_x, B_w1, B_b1, B_w2, B_b2):
    def _A_ref(x, wqkv, wo):
        B, S, D = x.shape
        H = 32; Dh = D // H
        W, dil = 8, 2
        qkv = (lambda x, *d: x.permute(*d))((x @ wqkv).reshape(B, S, 3, H, Dh), 2, 0, 3, 1, 4)
        q, k, v = qkv[0], qkv[1], qkv[2]
        scale = Dh ** -0.5
        pos = torch.arange(S)
        off = torch.arange(W) * dil
        idx = pos[:, None] - off[None, :]
        mask = idx >= 0
        idx_c = torch.where(mask, idx, 0).reshape(-1)
        kg = k[:, :, idx_c, :].reshape(B, H, S, W, Dh)
        vg = v[:, :, idx_c, :].reshape(B, H, S, W, Dh)
        logits = torch.einsum("bhsd,bhswd->bhsw", q, kg) * scale
        logits = torch.where(mask[None, None, :, :], logits, -1e9)
        attn = _softmax(logits, axis=-1)
        o = torch.einsum("bhsw,bhswd->bhsd", attn, vg)
        return (lambda x, *d: x.permute(*d))(o, 0, 2, 1, 3).reshape(B, S, D) @ wo

    def _B_ref(x, w1, b1, w2, b2):
        h = torch.einsum("bsd,df->bsf", x, w1) + b1
        h = _gelu(h)
        return torch.einsum("bsf,fd->bsd", h, w2) + b2

    x = A_x
    xn = _layernorm(x, axis=-1)
    s = _A_ref(xn, A_wqkv, A_wo)
    g = _silu(_B_ref(xn, B_w1, B_b1, B_w2, B_b2))
    return x + s * g
```

```asm
; @launch kernel=g1_kernel grid=(256,1,1) block=(256,1,1) lds=155904
; @launch kernel=g3_kernel grid=(256,1,1) block=(256,1,1) lds=155904
.amdgcn_target "amdgcn-amd-amdhsa--gfx950"
.text
.globl g1_kernel
.p2align 8
.type g1_kernel,@function
g1_kernel:
    s_cmp_ge_u32 s2, 256
    s_cbranch_scc1 end_g1_kernel_1
    s_load_dwordx2 s[72:73], s[0:1], 0
    s_load_dwordx2 s[40:41], s[0:1], 80
    s_load_dwordx2 s[42:43], s[0:1], 8
    s_load_dwordx2 s[44:45], s[0:1], 32
    s_load_dwordx2 s[46:47], s[0:1], 40
    s_load_dwordx2 s[68:69], s[0:1], 48
    s_load_dwordx2 s[80:81], s[0:1], 16
    s_getpc_b64 s[88:89]
pc_g1_kernel_2:
    s_sub_u32 s88, s88, pc_g1_kernel_2-g1_kernel
    s_subb_u32 s89, s89, 0
    s_bfe_u32 s90, s2, 0x30003
    s_lshl_b32 s90, s90, 14
    v_lshlrev_b32 v63, 6, v0
    v_add_u32 v63, s90, v63
    v_min_u32 v63, text_end-g1_kernel-4, v63
    global_load_dword v63, v63, s[88:89]
    s_bfe_u32 s37, s2, 0x20001
    s_lshr_b32 s38, s2, 6
    s_bfe_u32 s33, s2, 0x30003
    s_and_b32 s36, s2, 1
    s_lshl_b32 s36, s36, 3
    s_add_u32 s94, s36, s33
    s_lshl_b32 s36, s94, 7
    s_mov_b32 s95, s37
    s_mul_i32 s28, s36, 1152
    v_lshrrev_b32 v17, 6, v0
    v_and_b32 v1, 63, v0
    v_readfirstlane_b32 s26, v17
    v_lshrrev_b32 v2, 3, v1
    v_mul_u32_u24 v52, 1152, v2
    v_and_b32 v3, 7, v1
    v_lshl_add_u32 v52, v3, 4, v52
    s_lshr_b32 s84, s26, 1
    s_mul_i32 s84, s84, 73728
    s_add_u32 s84, s84, s28
    s_and_b32 s85, s26, 1
    s_mul_i32 s85, s85, 18432
    s_add_u32 s84, s84, s85
    s_add_u32 s85, s84, 9216
    s_add_u32 s86, s84, 36864
    s_add_u32 s87, s84, 46080
    s_mov_b32 s74, 0x240000
    s_mov_b32 s75, 0x00020000
    s_waitcnt lgkmcnt(0)
    s_mov_b32 s72, s72
    s_mov_b32 s73, s73
    buffer_load_dwordx4 v[64:67], v52, s[72:75], s84 offen offset:0
    buffer_load_dwordx4 v[80:83], v52, s[72:75], s84 offen offset:128
    buffer_load_dwordx4 v[96:99], v52, s[72:75], s84 offen offset:256
    buffer_load_dwordx4 v[112:115], v52, s[72:75], s84 offen offset:384
    buffer_load_dwordx4 v[128:131], v52, s[72:75], s84 offen offset:512
    buffer_load_dwordx4 v[144:147], v52, s[72:75], s84 offen offset:640
    buffer_load_dwordx4 v[160:163], v52, s[72:75], s84 offen offset:768
    buffer_load_dwordx4 v[176:179], v52, s[72:75], s84 offen offset:896
    buffer_load_dwordx4 v[192:195], v52, s[72:75], s84 offen offset:1024
    buffer_load_dwordx4 v[68:71], v52, s[72:75], s85 offen offset:0
    buffer_load_dwordx4 v[84:87], v52, s[72:75], s85 offen offset:128
    buffer_load_dwordx4 v[100:103], v52, s[72:75], s85 offen offset:256
    buffer_load_dwordx4 v[116:119], v52, s[72:75], s85 offen offset:384
    buffer_load_dwordx4 v[132:135], v52, s[72:75], s85 offen offset:512
    buffer_load_dwordx4 v[148:151], v52, s[72:75], s85 offen offset:640
    buffer_load_dwordx4 v[164:167], v52, s[72:75], s85 offen offset:768
    buffer_load_dwordx4 v[180:183], v52, s[72:75], s85 offen offset:896
    buffer_load_dwordx4 v[196:199], v52, s[72:75], s85 offen offset:1024
    s_mov_b32 s64, s68
    s_mov_b32 s65, s69
    s_mov_b32 s66, 0x510000
    s_mov_b32 s67, 0x00020000
    s_lshl_b32 s70, s2, 15
    v_lshl_add_u32 v62, v0, 7, s70
    s_mov_b32 s70, 0
    s_cmp_ge_u32 s38, 1
    s_cbranch_scc1 hpart_g1_kernel_3
    s_mov_b32 s8, s42
    s_mov_b32 s9, s43
    s_mov_b32 s10, 0x1e6000
    s_mov_b32 s11, 0x00020000
    s_mov_b32 s16, s10
    s_add_u32 s12, s40, 0x400000
    s_addc_u32 s13, s41, 0
    s_mov_b32 s14, 0x6c0000
    s_mov_b32 s15, 0x00020000
    s_mul_i32 s20, s37, 896
    s_cmp_eq_u32 s37, 3
    s_cselect_b32 s17, 2, 3
    s_mul_i32 s29, s36, 3456
    s_add_u32 s29, s29, s20
    v_mul_u32_u24 v58, 911, v0
    v_lshrrev_b32 v58, 16, v58
    v_mul_u32_u24 v59, 72, v58
    v_sub_u32 v59, v0, v59
    s_movk_i32 s71, 3456
    v_mul_lo_u32 v59, v59, s71
    v_lshl_add_u32 v59, v58, 7, v59
    s_mul_i32 s71, s33, 248832
    s_add_u32 s71, s71, s20
    v_lshrrev_b32 v17, 6, v0
    v_and_b32 v1, 63, v0
    v_readfirstlane_b32 s26, v17
    v_lshrrev_b32 v18, 5, v1
    v_and_b32 v19, 31, v1
    s_lshr_b32 s35, s26, 1
    s_and_b32 s36, s26, 1
    s_mul_i32 s23, s26, 9216
    s_movk_i32 s27, 3456
    s_mul_i32 s25, s36, 72
    v_bfe_u32 v17, v1, 2, 3
    v_add_u32 v17, s25, v17
    v_mul_lo_u32 v17, v17, s27
    s_lshl_b32 s25, s35, 7
    v_add_u32 v17, s25, v17
    v_lshl_add_u32 v17, v18, 6, v17
    v_and_b32 v4, 3, v1
    v_lshl_add_u32 v4, v4, 4, v17
    v_add_u32 v5, 0x6c00, v4
    v_add_u32 v6, 0x6c00, v5
    v_add_u32 v7, 0x6c00, v6
    v_add_u32 v8, 0x6c00, v7
    v_add_u32 v9, 0x6c00, v8
    v_add_u32 v10, 0x6c00, v9
    v_add_u32 v11, 0x6c00, v10
    v_add_u32 v12, 0x6c00, v11
    s_mul_i32 s92, s35, 4224
    s_add_u32 s92, s92, 76800
    v_mul_u32_u24 v17, 528, v18
    v_lshl_add_u32 v17, v19, 4, v17
    v_add_u32 v17, s92, v17
    v_add_u32 v58, 0x8400, v17
    s_lshl_b32 s91, s36, 8
    s_add_u32 s92, s92, s91
    v_mul_u32_u24 v3, 528, v3
    v_lshl_add_u32 v224, v2, 4, v3
    v_add_u32 v224, s92, v224
    v_add_u32 v225, 0x8400, v224
    v_and_b32 v38, 3, v1
    v_lshlrev_b32 v38, 4, v38
    v_mov_b32 v36, 0xffff
    v_mov_b32 v37, 0
    v_lshlrev_b64 v[36:37], v38, v[36:37]
    v_mov_b32 v38, 0x3f803f80
    v_mov_b32 v39, 0x3f803f80
    v_and_b32 v56, v36, v38
    v_and_b32 v57, v37, v38
    s_nop 1
    s_waitcnt vmcnt(17)
    v_mfma_f32_4x4x4_16b_bf16 v[208:211], v[38:39], v[64:65], 0
    v_mfma_f32_4x4x4_16b_bf16 v[212:215], v[64:65], v[64:65], 0
    v_mfma_f32_4x4x4_16b_bf16 v[216:219], v[38:39], v[66:67], 0
    v_mfma_f32_4x4x4_16b_bf16 v[220:223], v[66:67], v[66:67], 0
    s_waitcnt vmcnt(16)
    v_mfma_f32_4x4x4_16b_bf16 v[208:211], v[38:39], v[80:81], v[208:211]
    v_mfma_f32_4x4x4_16b_bf16 v[212:215], v[80:81], v[80:81], v[212:215]
    v_mfma_f32_4x4x4_16b_bf16 v[216:219], v[38:39], v[82:83], v[216:219]
    v_mfma_f32_4x4x4_16b_bf16 v[220:223], v[82:83], v[82:83], v[220:223]
    s_waitcnt vmcnt(15)
    v_mfma_f32_4x4x4_16b_bf16 v[208:211], v[38:39], v[96:97], v[208:211]
    v_mfma_f32_4x4x4_16b_bf16 v[212:215], v[96:97], v[96:97], v[212:215]
    v_mfma_f32_4x4x4_16b_bf16 v[216:219], v[38:39], v[98:99], v[216:219]
    v_mfma_f32_4x4x4_16b_bf16 v[220:223], v[98:99], v[98:99], v[220:223]
    s_waitcnt vmcnt(14)
    v_mfma_f32_4x4x4_16b_bf16 v[208:211], v[38:39], v[112:113], v[208:211]
    v_mfma_f32_4x4x4_16b_bf16 v[212:215], v[112:113], v[112:113], v[212:215]
    buffer_load_dwordx4 v[72:75], v52, s[72:75], s86 offen offset:0
    v_mfma_f32_4x4x4_16b_bf16 v[216:219], v[38:39], v[114:115], v[216:219]
    v_mfma_f32_4x4x4_16b_bf16 v[220:223], v[114:115], v[114:115], v[220:223]
    s_waitcnt vmcnt(14)
    v_mfma_f32_4x4x4_16b_bf16 v[208:211], v[38:39], v[128:129], v[208:211]
    v_mfma_f32_4x4x4_16b_bf16 v[212:215], v[128:129], v[128:129], v[212:215]
    v_mfma_f32_4x4x4_16b_bf16 v[216:219], v[38:39], v[130:131], v[216:219]
    v_mfma_f32_4x4x4_16b_bf16 v[220:223], v[130:131], v[130:131], v[220:223]
    s_waitcnt vmcnt(13)
    v_mfma_f32_4x4x4_16b_bf16 v[208:211], v[38:39], v[144:145], v[208:211]
    v_mfma_f32_4x4x4_16b_bf16 v[212:215], v[144:145], v[144:145], v[212:215]
    v_mfma_f32_4x4x4_16b_bf16 v[216:219], v[38:39], v[146:147], v[216:219]
    v_mfma_f32_4x4x4_16b_bf16 v[220:223], v[146:147], v[146:147], v[220:223]
    s_waitcnt vmcnt(12)
    v_mfma_f32_4x4x4_16b_bf16 v[208:211], v[38:39], v[160:161], v[208:211]
    v_mfma_f32_4x4x4_16b_bf16 v[212:215], v[160:161], v[160:161], v[212:215]
    v_mfma_f32_4x4x4_16b_bf16 v[216:219], v[38:39], v[162:163], v[216:219]
    v_mfma_f32_4x4x4_16b_bf16 v[220:223], v[162:163], v[162:163], v[220:223]
    s_waitcnt vmcnt(11)
    v_mfma_f32_4x4x4_16b_bf16 v[208:211], v[38:39], v[176:177], v[208:211]
    buffer_load_dwordx4 v[88:91], v52, s[72:75], s86 offen offset:128
    v_mfma_f32_4x4x4_16b_bf16 v[212:215], v[176:177], v[176:177], v[212:215]
    v_mfma_f32_4x4x4_16b_bf16 v[216:219], v[38:39], v[178:179], v[216:219]
    v_mfma_f32_4x4x4_16b_bf16 v[220:223], v[178:179], v[178:179], v[220:223]
    s_waitcnt vmcnt(11)
    v_mfma_f32_4x4x4_16b_bf16 v[208:211], v[38:39], v[192:193], v[208:211]
    v_mfma_f32_4x4x4_16b_bf16 v[212:215], v[192:193], v[192:193], v[212:215]
    v_mfma_f32_4x4x4_16b_bf16 v[216:219], v[38:39], v[194:195], v[216:219]
    v_mfma_f32_4x4x4_16b_bf16 v[220:223], v[194:195], v[194:195], v[220:223]
    s_nop 3
    v_add_f32 v2, v208, v216
    v_mov_b32_dpp v13, v212 quad_perm:[0,0,0,0] row_mask:0xf bank_mask:0xf
    s_nop 0
    v_add_f32_dpp v3, v2, v2 quad_perm:[1,0,3,2] row_mask:0xf bank_mask:0xf
    v_mov_b32_dpp v14, v220 quad_perm:[0,0,0,0] row_mask:0xf bank_mask:0xf
    s_nop 0
    v_add_f32_dpp v2, v3, v3 quad_perm:[2,3,0,1] row_mask:0xf bank_mask:0xf
    buffer_load_dwordx4 v[104:107], v52, s[72:75], s86 offen offset:256
    v_add_f32_dpp v13, v213, v13 quad_perm:[1,1,1,1] row_mask:0xf bank_mask:0xf
    v_add_f32_dpp v3, v2, v2 row_half_mirror row_mask:0xf bank_mask:0xf
    v_add_f32_dpp v14, v221, v14 quad_perm:[1,1,1,1] row_mask:0xf bank_mask:0xf
    v_mul_f32 v2, 0xbae38e39, v3
    v_add_f32_dpp v13, v214, v13 quad_perm:[2,2,2,2] row_mask:0xf bank_mask:0xf
    v_cvt_pk_bf16_f32 v44, 0, v2
    v_add_f32_dpp v14, v222, v14 quad_perm:[2,2,2,2] row_mask:0xf bank_mask:0xf
    v_cvt_pk_bf16_f32 v45, 0, v2
    v_add_f32_dpp v13, v215, v13 quad_perm:[3,3,3,3] row_mask:0xf bank_mask:0xf
    v_cvt_pk_bf16_f32 v46, 0, v2
    v_add_f32_dpp v14, v223, v14 quad_perm:[3,3,3,3] row_mask:0xf bank_mask:0xf
    v_cvt_pk_bf16_f32 v47, 0, v2
    s_nop 1
    v_mfma_f32_4x4x4_16b_bf16 v[20:23], v[56:57], v[64:65], v[44:47]
    v_add_f32 v13, v13, v14
    v_mfma_f32_4x4x4_16b_bf16 v[24:27], v[56:57], v[66:67], v[44:47]
    s_nop 0
    v_add_f32_dpp v14, v13, v13 row_half_mirror row_mask:0xf bank_mask:0xf
    buffer_load_dwordx4 v[120:123], v52, s[72:75], s86 offen offset:384
    v_mul_f32 v14, 0x3ae38e39, v14
    v_cvt_pk_bf16_f32 v64, v20, v21
    v_cvt_pk_bf16_f32 v65, v22, v23
    v_mfma_f32_4x4x4_16b_bf16 v[28:31], v[56:57], v[80:81], v[44:47]
    v_fma_f32 v13, -v2, v2, v14
    v_max_f32 v13, 0, v13
    v_cvt_pk_bf16_f32 v66, v24, v25
    v_cvt_pk_bf16_f32 v67, v26, v27
    v_mfma_f32_4x4x4_16b_bf16 v[20:23], v[56:57], v[82:83], v[44:47]
    v_cvt_pk_bf16_f32 v13, 0, v13
    v_add_f32 v13, 0x3727c5ac, v13
    v_cvt_pk_bf16_f32 v80, v28, v29
    v_cvt_pk_bf16_f32 v81, v30, v31
    v_mfma_f32_4x4x4_16b_bf16 v[24:27], v[56:57], v[96:97], v[44:47]
    v_cvt_pk_bf16_f32 v13, 0, v13
    v_cvt_pk_bf16_f32 v82, v20, v21
    v_cvt_pk_bf16_f32 v83, v22, v23
    v_mfma_f32_4x4x4_16b_bf16 v[28:31], v[56:57], v[98:99], v[44:47]
    buffer_load_dwordx4 v[136:139], v52, s[72:75], s86 offen offset:512
    v_sqrt_f32 v13, v13
    v_cvt_pk_bf16_f32 v96, v24, v25
    v_cvt_pk_bf16_f32 v97, v26, v27
    v_mfma_f32_4x4x4_16b_bf16 v[20:23], v[56:57], v[112:113], v[44:47]
    v_cvt_pk_bf16_f32 v13, 0, v13
    v_cvt_pk_bf16_f32 v98, v28, v29
    v_cvt_pk_bf16_f32 v99, v30, v31
    v_mfma_f32_4x4x4_16b_bf16 v[24:27], v[56:57], v[114:115], v[44:47]
    v_rcp_f32 v15, v13
    v_cvt_pk_bf16_f32 v112, v20, v21
    v_cvt_pk_bf16_f32 v113, v22, v23
    v_mfma_f32_4x4x4_16b_bf16 v[28:31], v[56:57], v[128:129], v[44:47]
    v_cvt_pk_bf16_f32 v54, v15, v15
    v_cvt_pk_bf16_f32 v114, v24, v25
    v_cvt_pk_bf16_f32 v115, v26, v27
    v_mfma_f32_4x4x4_16b_bf16 v[20:23], v[56:57], v[130:131], v[44:47]
    v_and_b32 v48, v54, v36
    v_cvt_pk_bf16_f32 v128, v28, v29
    buffer_load_dwordx4 v[152:155], v52, s[72:75], s86 offen offset:640
    v_cvt_pk_bf16_f32 v129, v30, v31
    v_mfma_f32_4x4x4_16b_bf16 v[24:27], v[56:57], v[144:145], v[44:47]
    v_and_b32 v49, v54, v37
    v_cvt_pk_bf16_f32 v130, v20, v21
    v_cvt_pk_bf16_f32 v131, v22, v23
    v_mfma_f32_4x4x4_16b_bf16 v[28:31], v[56:57], v[146:147], v[44:47]
    v_and_b32 v16, 0xffff0000, v54
    v_cvt_pk_bf16_f32 v144, v24, v25
    v_cvt_pk_bf16_f32 v145, v26, v27
    v_mfma_f32_4x4x4_16b_bf16 v[20:23], v[56:57], v[160:161], v[44:47]
    v_sub_f32 v15, v15, v16
    v_cvt_pk_bf16_f32 v146, v28, v29
    v_cvt_pk_bf16_f32 v147, v30, v31
    v_mfma_f32_4x4x4_16b_bf16 v[24:27], v[56:57], v[162:163], v[44:47]
    v_cvt_pk_bf16_f32 v54, v15, v15
    v_cvt_pk_bf16_f32 v160, v20, v21
    v_cvt_pk_bf16_f32 v161, v22, v23
    v_mfma_f32_4x4x4_16b_bf16 v[28:31], v[56:57], v[176:177], v[44:47]
    buffer_load_dwordx4 v[168:171], v52, s[72:75], s86 offen offset:768
    v_and_b32 v50, v54, v36
    v_cvt_pk_bf16_f32 v162, v24, v25
    v_cvt_pk_bf16_f32 v163, v26, v27
    v_mfma_f32_4x4x4_16b_bf16 v[20:23], v[56:57], v[178:179], v[44:47]
    v_and_b32 v51, v54, v37
    v_cvt_pk_bf16_f32 v176, v28, v29
    v_cvt_pk_bf16_f32 v177, v30, v31
    v_mfma_f32_4x4x4_16b_bf16 v[24:27], v[56:57], v[192:193], v[44:47]
    s_nop 0
    v_cvt_pk_bf16_f32 v178, v20, v21
    v_cvt_pk_bf16_f32 v179, v22, v23
    v_mfma_f32_4x4x4_16b_bf16 v[28:31], v[56:57], v[194:195], v[44:47]
    s_nop 0
    v_cvt_pk_bf16_f32 v192, v24, v25
    v_cvt_pk_bf16_f32 v193, v26, v27
    s_nop 1
    v_cvt_pk_bf16_f32 v194, v28, v29
    buffer_load_dwordx4 v[184:187], v52, s[72:75], s86 offen offset:896
    v_cvt_pk_bf16_f32 v195, v30, v31
    v_mfma_f32_4x4x4_16b_bf16 v[32:35], v[50:51], v[64:65], 0
    v_mfma_f32_4x4x4_16b_bf16 v[40:43], v[50:51], v[66:67], 0
    v_mfma_f32_4x4x4_16b_bf16 v[208:211], v[50:51], v[80:81], 0
    v_mfma_f32_4x4x4_16b_bf16 v[32:35], v[48:49], v[64:65], v[32:35]
    v_mfma_f32_4x4x4_16b_bf16 v[40:43], v[48:49], v[66:67], v[40:43]
    v_mfma_f32_4x4x4_16b_bf16 v[208:211], v[48:49], v[80:81], v[208:211]
    v_mfma_f32_4x4x4_16b_bf16 v[20:23], v[50:51], v[82:83], 0
    s_nop 1
    v_cvt_pk_bf16_f32 v64, v32, v33
    v_mfma_f32_4x4x4_16b_bf16 v[24:27], v[50:51], v[96:97], 0
    v_cvt_pk_bf16_f32 v65, v34, v35
    v_mfma_f32_4x4x4_16b_bf16 v[28:31], v[50:51], v[98:99], 0
    v_cvt_pk_bf16_f32 v66, v40, v41
    v_mfma_f32_4x4x4_16b_bf16 v[20:23], v[48:49], v[82:83], v[20:23]
    v_cvt_pk_bf16_f32 v67, v42, v43
    v_mfma_f32_4x4x4_16b_bf16 v[24:27], v[48:49], v[96:97], v[24:27]
    buffer_load_dwordx4 v[200:203], v52, s[72:75], s86 offen offset:1024
    v_cvt_pk_bf16_f32 v80, v208, v209
    v_mfma_f32_4x4x4_16b_bf16 v[28:31], v[48:49], v[98:99], v[28:31]
    v_cvt_pk_bf16_f32 v81, v210, v211
    v_mfma_f32_4x4x4_16b_bf16 v[32:35], v[50:51], v[112:113], 0
    v_cvt_pk_bf16_f32 v82, v20, v21
    v_mfma_f32_4x4x4_16b_bf16 v[40:43], v[50:51], v[114:115], 0
    v_cvt_pk_bf16_f32 v83, v22, v23
    ds_write_b128 v224, v[64:67] offset:0
    v_mfma_f32_4x4x4_16b_bf16 v[208:211], v[50:51], v[128:129], 0
    v_cvt_pk_bf16_f32 v96, v24, v25
    v_mfma_f32_4x4x4_16b_bf16 v[32:35], v[48:49], v[112:113], v[32:35]
    v_cvt_pk_bf16_f32 v97, v26, v27
    v_mfma_f32_4x4x4_16b_bf16 v[40:43], v[48:49], v[114:115], v[40:43]
    v_cvt_pk_bf16_f32 v98, v28, v29
    v_mfma_f32_4x4x4_16b_bf16 v[208:211], v[48:49], v[128:129], v[208:211]
    v_cvt_pk_bf16_f32 v99, v30, v31
    v_mfma_f32_4x4x4_16b_bf16 v[20:23], v[50:51], v[130:131], 0
    v_cvt_pk_bf16_f32 v112, v32, v33
    buffer_load_dwordx4 v[76:79], v52, s[72:75], s87 offen offset:0
    v_mfma_f32_4x4x4_16b_bf16 v[24:27], v[50:51], v[144:145], 0
    v_cvt_pk_bf16_f32 v113, v34, v35
    ds_write_b128 v224, v[80:83] offset:8448
    v_mfma_f32_4x4x4_16b_bf16 v[28:31], v[50:51], v[146:147], 0
    v_cvt_pk_bf16_f32 v114, v40, v41
    v_mfma_f32_4x4x4_16b_bf16 v[20:23], v[48:49], v[130:131], v[20:23]
    v_cvt_pk_bf16_f32 v115, v42, v43
    ds_write_b128 v224, v[96:99] offset:16896
    v_mfma_f32_4x4x4_16b_bf16 v[24:27], v[48:49], v[144:145], v[24:27]
    v_cvt_pk_bf16_f32 v128, v208, v209
    v_mfma_f32_4x4x4_16b_bf16 v[28:31], v[48:49], v[146:147], v[28:31]
    v_cvt_pk_bf16_f32 v129, v210, v211
    v_mfma_f32_4x4x4_16b_bf16 v[32:35], v[50:51], v[160:161], 0
    v_cvt_pk_bf16_f32 v130, v20, v21
    v_mfma_f32_4x4x4_16b_bf16 v[40:43], v[50:51], v[162:163], 0
    v_cvt_pk_bf16_f32 v131, v22, v23
    ds_write_b128 v224, v[112:115] offset:25344
    v_mfma_f32_4x4x4_16b_bf16 v[208:211], v[50:51], v[176:177], 0
    buffer_load_dwordx4 v[92:95], v52, s[72:75], s87 offen offset:128
    v_cvt_pk_bf16_f32 v144, v24, v25
    v_mfma_f32_4x4x4_16b_bf16 v[32:35], v[48:49], v[160:161], v[32:35]
    v_cvt_pk_bf16_f32 v145, v26, v27
    v_mfma_f32_4x4x4_16b_bf16 v[40:43], v[48:49], v[162:163], v[40:43]
    v_cvt_pk_bf16_f32 v146, v28, v29
    v_mfma_f32_4x4x4_16b_bf16 v[208:211], v[48:49], v[176:177], v[208:211]
    v_cvt_pk_bf16_f32 v147, v30, v31
    v_mfma_f32_4x4x4_16b_bf16 v[20:23], v[50:51], v[178:179], 0
    v_cvt_pk_bf16_f32 v160, v32, v33
    v_mfma_f32_4x4x4_16b_bf16 v[24:27], v[50:51], v[192:193], 0
    v_cvt_pk_bf16_f32 v161, v34, v35
    ds_write_b128 v225, v[128:131] offset:0
    v_mfma_f32_4x4x4_16b_bf16 v[28:31], v[50:51], v[194:195], 0
    v_cvt_pk_bf16_f32 v162, v40, v41
    v_mfma_f32_4x4x4_16b_bf16 v[20:23], v[48:49], v[178:179], v[20:23]
    v_cvt_pk_bf16_f32 v163, v42, v43
    ds_write_b128 v225, v[144:147] offset:8448
    v_mfma_f32_4x4x4_16b_bf16 v[24:27], v[48:49], v[192:193], v[24:27]
    buffer_load_dwordx4 v[108:111], v52, s[72:75], s87 offen offset:256
    v_cvt_pk_bf16_f32 v176, v208, v209
    v_mfma_f32_4x4x4_16b_bf16 v[28:31], v[48:49], v[194:195], v[28:31]
    v_cvt_pk_bf16_f32 v177, v210, v211
    v_cvt_pk_bf16_f32 v178, v20, v21
    v_cvt_pk_bf16_f32 v179, v22, v23
    ds_write_b128 v225, v[160:163] offset:16896
    v_cvt_pk_bf16_f32 v192, v24, v25
    v_cvt_pk_bf16_f32 v193, v26, v27
    v_cvt_pk_bf16_f32 v194, v28, v29
    v_cvt_pk_bf16_f32 v195, v30, v31
    s_waitcnt vmcnt(20)
    v_mfma_f32_4x4x4_16b_bf16 v[208:211], v[38:39], v[68:69], 0
    v_mfma_f32_4x4x4_16b_bf16 v[212:215], v[68:69], v[68:69], 0
    ds_write_b128 v225, v[176:179] offset:25344
    v_mfma_f32_4x4x4_16b_bf16 v[216:219], v[38:39], v[70:71], 0
    v_mfma_f32_4x4x4_16b_bf16 v[220:223], v[70:71], v[70:71], 0
    ds_write_b128 v225, v[192:195] offset:33792
    s_waitcnt vmcnt(19)
    v_mfma_f32_4x4x4_16b_bf16 v[208:211], v[38:39], v[84:85], v[208:211]
    buffer_load_dwordx4 v[124:127], v52, s[72:75], s87 offen offset:384
    v_mfma_f32_4x4x4_16b_bf16 v[212:215], v[84:85], v[84:85], v[212:215]
    v_mfma_f32_4x4x4_16b_bf16 v[216:219], v[38:39], v[86:87], v[216:219]
    v_mfma_f32_4x4x4_16b_bf16 v[220:223], v[86:87], v[86:87], v[220:223]
    s_waitcnt vmcnt(19)
    v_mfma_f32_4x4x4_16b_bf16 v[208:211], v[38:39], v[100:101], v[208:211]
    v_mfma_f32_4x4x4_16b_bf16 v[212:215], v[100:101], v[100:101], v[212:215]
    v_mfma_f32_4x4x4_16b_bf16 v[216:219], v[38:39], v[102:103], v[216:219]
    v_mfma_f32_4x4x4_16b_bf16 v[220:223], v[102:103], v[102:103], v[220:223]
    s_waitcnt vmcnt(18)
    v_mfma_f32_4x4x4_16b_bf16 v[208:211], v[38:39], v[116:117], v[208:211]
    v_mfma_f32_4x4x4_16b_bf16 v[212:215], v[116:117], v[116:117], v[212:215]
    v_mfma_f32_4x4x4_16b_bf16 v[216:219], v[38:39], v[118:119], v[216:219]
    v_mfma_f32_4x4x4_16b_bf16 v[220:223], v[118:119], v[118:119], v[220:223]
    s_waitcnt vmcnt(17)
    v_mfma_f32_4x4x4_16b_bf16 v[208:211], v[38:39], v[132:133], v[208:211]
    v_mfma_f32_4x4x4_16b_bf16 v[212:215], v[132:133], v[132:133], v[212:215]
    v_mfma_f32_4x4x4_16b_bf16 v[216:219], v[38:39], v[134:135], v[216:219]
    v_mfma_f32_4x4x4_16b_bf16 v[220:223], v[134:135], v[134:135], v[220:223]
    buffer_load_dwordx4 v[140:143], v52, s[72:75], s87 offen offset:512
    s_waitcnt vmcnt(17)
    v_mfma_f32_4x4x4_16b_bf16 v[208:211], v[38:39], v[148:149], v[208:211]
    v_mfma_f32_4x4x4_16b_bf16 v[212:215], v[148:149], v[148:149], v[212:215]
    v_mfma_f32_4x4x4_16b_bf16 v[216:219], v[38:39], v[150:151], v[216:219]
    v_mfma_f32_4x4x4_16b_bf16 v[220:223], v[150:151], v[150:151], v[220:223]
    s_waitcnt vmcnt(16)
    v_mfma_f32_4x4x4_16b_bf16 v[208:211], v[38:39], v[164:165], v[208:211]
    v_mfma_f32_4x4x4_16b_bf16 v[212:215], v[164:165], v[164:165], v[212:215]
    v_mfma_f32_4x4x4_16b_bf16 v[216:219], v[38:39], v[166:167], v[216:219]
    v_mfma_f32_4x4x4_16b_bf16 v[220:223], v[166:167], v[166:167], v[220:223]
    s_waitcnt vmcnt(15)
    v_mfma_f32_4x4x4_16b_bf16 v[208:211], v[38:39], v[180:181], v[208:211]
    v_mfma_f32_4x4x4_16b_bf16 v[212:215], v[180:181], v[180:181], v[212:215]
    v_mfma_f32_4x4x4_16b_bf16 v[216:219], v[38:39], v[182:183], v[216:219]
    v_mfma_f32_4x4x4_16b_bf16 v[220:223], v[182:183], v[182:183], v[220:223]
    s_waitcnt vmcnt(14)
    v_mfma_f32_4x4x4_16b_bf16 v[208:211], v[38:39], v[196:197], v[208:211]
    v_mfma_f32_4x4x4_16b_bf16 v[212:215], v[196:197], v[196:197], v[212:215]
    buffer_load_dwordx4 v[156:159], v52, s[72:75], s87 offen offset:640
    v_mfma_f32_4x4x4_16b_bf16 v[216:219], v[38:39], v[198:199], v[216:219]
    v_mfma_f32_4x4x4_16b_bf16 v[220:223], v[198:199], v[198:199], v[220:223]
    s_nop 3
    v_add_f32 v2, v208, v216
    v_mov_b32_dpp v13, v212 quad_perm:[0,0,0,0] row_mask:0xf bank_mask:0xf
    s_nop 0
    v_add_f32_dpp v3, v2, v2 quad_perm:[1,0,3,2] row_mask:0xf bank_mask:0xf
    v_mov_b32_dpp v14, v220 quad_perm:[0,0,0,0] row_mask:0xf bank_mask:0xf
    s_nop 0
    v_add_f32_dpp v2, v3, v3 quad_perm:[2,3,0,1] row_mask:0xf bank_mask:0xf
    v_add_f32_dpp v13, v213, v13 quad_perm:[1,1,1,1] row_mask:0xf bank_mask:0xf
    s_nop 0
    v_add_f32_dpp v3, v2, v2 row_half_mirror row_mask:0xf bank_mask:0xf
    v_add_f32_dpp v14, v221, v14 quad_perm:[1,1,1,1] row_mask:0xf bank_mask:0xf
    v_mul_f32 v2, 0xbae38e39, v3
    buffer_load_dwordx4 v[172:175], v52, s[72:75], s87 offen offset:768
    v_add_f32_dpp v13, v214, v13 quad_perm:[2,2,2,2] row_mask:0xf bank_mask:0xf
    v_cvt_pk_bf16_f32 v44, 0, v2
    v_add_f32_dpp v14, v222, v14 quad_perm:[2,2,2,2] row_mask:0xf bank_mask:0xf
    v_cvt_pk_bf16_f32 v45, 0, v2
    v_add_f32_dpp v13, v215, v13 quad_perm:[3,3,3,3] row_mask:0xf bank_mask:0xf
    v_cvt_pk_bf16_f32 v46, 0, v2
    v_add_f32_dpp v14, v223, v14 quad_perm:[3,3,3,3] row_mask:0xf bank_mask:0xf
    v_cvt_pk_bf16_f32 v47, 0, v2
    s_nop 1
    v_mfma_f32_4x4x4_16b_bf16 v[20:23], v[56:57], v[68:69], v[44:47]
    v_add_f32 v13, v13, v14
    v_mfma_f32_4x4x4_16b_bf16 v[24:27], v[56:57], v[70:71], v[44:47]
    s_nop 0
    v_add_f32_dpp v14, v13, v13 row_half_mirror row_mask:0xf bank_mask:0xf
    v_mul_f32 v14, 0x3ae38e39, v14
    v_cvt_pk_bf16_f32 v68, v20, v21
    v_cvt_pk_bf16_f32 v69, v22, v23
    buffer_load_dwordx4 v[188:191], v52, s[72:75], s87 offen offset:896
    v_mfma_f32_4x4x4_16b_bf16 v[28:31], v[56:57], v[84:85], v[44:47]
    v_fma_f32 v13, -v2, v2, v14
    v_max_f32 v13, 0, v13
    v_cvt_pk_bf16_f32 v70, v24, v25
    v_cvt_pk_bf16_f32 v71, v26, v27
    v_mfma_f32_4x4x4_16b_bf16 v[20:23], v[56:57], v[86:87], v[44:47]
    v_cvt_pk_bf16_f32 v13, 0, v13
    v_add_f32 v13, 0x3727c5ac, v13
    v_cvt_pk_bf16_f32 v84, v28, v29
    v_cvt_pk_bf16_f32 v85, v30, v31
    v_mfma_f32_4x4x4_16b_bf16 v[24:27], v[56:57], v[100:101], v[44:47]
    v_cvt_pk_bf16_f32 v13, 0, v13
    v_cvt_pk_bf16_f32 v86, v20, v21
    v_cvt_pk_bf16_f32 v87, v22, v23
    v_mfma_f32_4x4x4_16b_bf16 v[28:31], v[56:57], v[102:103], v[44:47]
    v_sqrt_f32 v13, v13
    v_cvt_pk_bf16_f32 v100, v24, v25
    v_cvt_pk_bf16_f32 v101, v26, v27
    buffer_load_dwordx4 v[204:207], v52, s[72:75], s87 offen offset:1024
    v_mfma_f32_4x4x4_16b_bf16 v[20:23], v[56:57], v[116:117], v[44:47]
    v_cvt_pk_bf16_f32 v13, 0, v13
    v_cvt_pk_bf16_f32 v102, v28, v29
    v_cvt_pk_bf16_f32 v103, v30, v31
    v_mfma_f32_4x4x4_16b_bf16 v[24:27], v[56:57], v[118:119], v[44:47]
    v_rcp_f32 v15, v13
    v_cvt_pk_bf16_f32 v116, v20, v21
    v_cvt_pk_bf16_f32 v117, v22, v23
    v_mfma_f32_4x4x4_16b_bf16 v[28:31], v[56:57], v[132:133], v[44:47]
    v_cvt_pk_bf16_f32 v54, v15, v15
    v_cvt_pk_bf16_f32 v118, v24, v25
    v_cvt_pk_bf16_f32 v119, v26, v27
    v_mfma_f32_4x4x4_16b_bf16 v[20:23], v[56:57], v[134:135], v[44:47]
    v_and_b32 v48, v54, v36
    v_cvt_pk_bf16_f32 v132, v28, v29
    v_cvt_pk_bf16_f32 v133, v30, v31
    v_mfma_f32_4x4x4_16b_bf16 v[24:27], v[56:57], v[148:149], v[44:47]
    v_and_b32 v49, v54, v37
    buffer_load_dword v63, v59, s[8:11], s71 offen
    v_cvt_pk_bf16_f32 v134, v20, v21
    v_cvt_pk_bf16_f32 v135, v22, v23
    v_mfma_f32_4x4x4_16b_bf16 v[28:31], v[56:57], v[150:151], v[44:47]
    v_and_b32 v16, 0xffff0000, v54
    v_cvt_pk_bf16_f32 v148, v24, v25
    v_cvt_pk_bf16_f32 v149, v26, v27
    v_mfma_f32_4x4x4_16b_bf16 v[20:23], v[56:57], v[164:165], v[44:47]
    v_sub_f32 v15, v15, v16
    v_cvt_pk_bf16_f32 v150, v28, v29
    v_cvt_pk_bf16_f32 v151, v30, v31
    v_mfma_f32_4x4x4_16b_bf16 v[24:27], v[56:57], v[166:167], v[44:47]
    v_cvt_pk_bf16_f32 v54, v15, v15
    v_cvt_pk_bf16_f32 v164, v20, v21
    v_cvt_pk_bf16_f32 v165, v22, v23
    v_mfma_f32_4x4x4_16b_bf16 v[28:31], v[56:57], v[180:181], v[44:47]
    v_and_b32 v50, v54, v36
    v_cvt_pk_bf16_f32 v166, v24, v25
    v_cvt_pk_bf16_f32 v167, v26, v27
    s_cmp_ge_u32 s17, 0
    s_cselect_b32 s10, s16, 0
    s_add_u32 s27, s20, 0
    s_add_u32 m0, s23, 0
    s_nop 0
    buffer_load_dwordx4 v4, s[8:11], s27 offen lds
    v_mfma_f32_4x4x4_16b_bf16 v[20:23], v[56:57], v[182:183], v[44:47]
    v_and_b32 v51, v54, v37
    v_cvt_pk_bf16_f32 v180, v28, v29
    v_cvt_pk_bf16_f32 v181, v30, v31
    v_mfma_f32_4x4x4_16b_bf16 v[24:27], v[56:57], v[196:197], v[44:47]
    s_nop 0
    v_cvt_pk_bf16_f32 v182, v20, v21
    v_cvt_pk_bf16_f32 v183, v22, v23
    v_mfma_f32_4x4x4_16b_bf16 v[28:31], v[56:57], v[198:199], v[44:47]
    s_nop 0
    v_cvt_pk_bf16_f32 v196, v24, v25
    v_cvt_pk_bf16_f32 v197, v26, v27
    s_nop 1
    v_cvt_pk_bf16_f32 v198, v28, v29
    v_cvt_pk_bf16_f32 v199, v30, v31
    v_mfma_f32_4x4x4_16b_bf16 v[32:35], v[50:51], v[68:69], 0
    v_mfma_f32_4x4x4_16b_bf16 v[40:43], v[50:51], v[70:71], 0
    s_cmp_ge_u32 s17, 0
    s_cselect_b32 s10, s16, 0
    s_add_u32 s27, s20, 0
    s_add_u32 m0, s23, 1024
    s_nop 0
    buffer_load_dwordx4 v5, s[8:11], s27 offen lds
    v_mfma_f32_4x4x4_16b_bf16 v[208:211], v[50:51], v[84:85], 0
    v_mfma_f32_4x4x4_16b_bf16 v[32:35], v[48:49], v[68:69], v[32:35]
    v_mfma_f32_4x4x4_16b_bf16 v[40:43], v[48:49], v[70:71], v[40:43]
    v_mfma_f32_4x4x4_16b_bf16 v[208:211], v[48:49], v[84:85], v[208:211]
    v_mfma_f32_4x4x4_16b_bf16 v[20:23], v[50:51], v[86:87], 0
    s_nop 1
    v_cvt_pk_bf16_f32 v68, v32, v33
    v_mfma_f32_4x4x4_16b_bf16 v[24:27], v[50:51], v[100:101], 0
    v_cvt_pk_bf16_f32 v69, v34, v35
    v_mfma_f32_4x4x4_16b_bf16 v[28:31], v[50:51], v[102:103], 0
    v_cvt_pk_bf16_f32 v70, v40, v41
    v_mfma_f32_4x4x4_16b_bf16 v[20:23], v[48:49], v[86:87], v[20:23]
    v_cvt_pk_bf16_f32 v71, v42, v43
    v_mfma_f32_4x4x4_16b_bf16 v[24:27], v[48:49], v[100:101], v[24:27]
    v_cvt_pk_bf16_f32 v84, v208, v209
    v_mfma_f32_4x4x4_16b_bf16 v[28:31], v[48:49], v[102:103], v[28:31]
    v_cvt_pk_bf16_f32 v85, v210, v211
    s_cmp_ge_u32 s17, 0
    s_cselect_b32 s10, s16, 0
    s_add_u32 s27, s20, 0
    s_add_u32 m0, s23, 2048
    s_nop 0
    buffer_load_dwordx4 v6, s[8:11], s27 offen lds
    v_mfma_f32_4x4x4_16b_bf16 v[32:35], v[50:51], v[116:117], 0
    v_cvt_pk_bf16_f32 v86, v20, v21
    v_mfma_f32_4x4x4_16b_bf16 v[40:43], v[50:51], v[118:119], 0
    v_cvt_pk_bf16_f32 v87, v22, v23
    ds_write_b128 v224, v[68:71] offset:128
    v_mfma_f32_4x4x4_16b_bf16 v[208:211], v[50:51], v[132:133], 0
    v_cvt_pk_bf16_f32 v100, v24, v25
    v_mfma_f32_4x4x4_16b_bf16 v[32:35], v[48:49], v[116:117], v[32:35]
    v_cvt_pk_bf16_f32 v101, v26, v27
    v_mfma_f32_4x4x4_16b_bf16 v[40:43], v[48:49], v[118:119], v[40:43]
    v_cvt_pk_bf16_f32 v102, v28, v29
    v_mfma_f32_4x4x4_16b_bf16 v[208:211], v[48:49], v[132:133], v[208:211]
    v_cvt_pk_bf16_f32 v103, v30, v31
    v_mfma_f32_4x4x4_16b_bf16 v[20:23], v[50:51], v[134:135], 0
    v_cvt_pk_bf16_f32 v116, v32, v33
    v_mfma_f32_4x4x4_16b_bf16 v[24:27], v[50:51], v[148:149], 0
    v_cvt_pk_bf16_f32 v117, v34, v35
    ds_write_b128 v224, v[84:87] offset:8576
    s_cmp_ge_u32 s17, 0
    s_cselect_b32 s10, s16, 0
    s_add_u32 s27, s20, 0
    s_add_u32 m0, s23, 3072
    s_nop 0
    buffer_load_dwordx4 v7, s[8:11], s27 offen lds
    v_mfma_f32_4x4x4_16b_bf16 v[28:31], v[50:51], v[150:151], 0
    v_cvt_pk_bf16_f32 v118, v40, v41
    v_mfma_f32_4x4x4_16b_bf16 v[20:23], v[48:49], v[134:135], v[20:23]
    v_cvt_pk_bf16_f32 v119, v42, v43
    ds_write_b128 v224, v[100:103] offset:17024
    v_mfma_f32_4x4x4_16b_bf16 v[24:27], v[48:49], v[148:149], v[24:27]
    v_cvt_pk_bf16_f32 v132, v208, v209
    v_mfma_f32_4x4x4_16b_bf16 v[28:31], v[48:49], v[150:151], v[28:31]
    v_cvt_pk_bf16_f32 v133, v210, v211
    v_mfma_f32_4x4x4_16b_bf16 v[32:35], v[50:51], v[164:165], 0
    v_cvt_pk_bf16_f32 v134, v20, v21
    v_mfma_f32_4x4x4_16b_bf16 v[40:43], v[50:51], v[166:167], 0
    v_cvt_pk_bf16_f32 v135, v22, v23
    ds_write_b128 v224, v[116:119] offset:25472
    v_mfma_f32_4x4x4_16b_bf16 v[208:211], v[50:51], v[180:181], 0
    v_cvt_pk_bf16_f32 v148, v24, v25
    v_mfma_f32_4x4x4_16b_bf16 v[32:35], v[48:49], v[164:165], v[32:35]
    v_cvt_pk_bf16_f32 v149, v26, v27
    s_cmp_ge_u32 s17, 0
    s_cselect_b32 s10, s16, 0
    s_add_u32 s27, s20, 0
    s_add_u32 m0, s23, 4096
    s_nop 0
    buffer_load_dwordx4 v8, s[8:11], s27 offen lds
    v_mfma_f32_4x4x4_16b_bf16 v[40:43], v[48:49], v[166:167], v[40:43]
    v_cvt_pk_bf16_f32 v150, v28, v29
    v_mfma_f32_4x4x4_16b_bf16 v[208:211], v[48:49], v[180:181], v[208:211]
    v_cvt_pk_bf16_f32 v151, v30, v31
    v_mfma_f32_4x4x4_16b_bf16 v[20:23], v[50:51], v[182:183], 0
    v_cvt_pk_bf16_f32 v164, v32, v33
    v_mfma_f32_4x4x4_16b_bf16 v[24:27], v[50:51], v[196:197], 0
    v_cvt_pk_bf16_f32 v165, v34, v35
    ds_write_b128 v225, v[132:135] offset:128
    v_mfma_f32_4x4x4_16b_bf16 v[28:31], v[50:51], v[198:199], 0
    v_cvt_pk_bf16_f32 v166, v40, v41
    v_mfma_f32_4x4x4_16b_bf16 v[20:23], v[48:49], v[182:183], v[20:23]
    v_cvt_pk_bf16_f32 v167, v42, v43
    ds_write_b128 v225, v[148:151] offset:8576
    v_mfma_f32_4x4x4_16b_bf16 v[24:27], v[48:49], v[196:197], v[24:27]
    v_cvt_pk_bf16_f32 v180, v208, v209
    v_mfma_f32_4x4x4_16b_bf16 v[28:31], v[48:49], v[198:199], v[28:31]
    v_cvt_pk_bf16_f32 v181, v210, v211
    s_cmp_ge_u32 s17, 0
    s_cselect_b32 s10, s16, 0
    s_add_u32 s27, s20, 0
    s_add_u32 m0, s23, 5120
    s_nop 0
    buffer_load_dwordx4 v9, s[8:11], s27 offen lds
    v_cvt_pk_bf16_f32 v182, v20, v21
    v_cvt_pk_bf16_f32 v183, v22, v23
    ds_write_b128 v225, v[164:167] offset:17024
    v_cvt_pk_bf16_f32 v196, v24, v25
    v_cvt_pk_bf16_f32 v197, v26, v27
    v_cvt_pk_bf16_f32 v198, v28, v29
    v_cvt_pk_bf16_f32 v199, v30, v31
    s_waitcnt vmcnt(24)
    v_mfma_f32_4x4x4_16b_bf16 v[208:211], v[38:39], v[72:73], 0
    v_mfma_f32_4x4x4_16b_bf16 v[212:215], v[72:73], v[72:73], 0
    ds_write_b128 v225, v[180:183] offset:25472
    v_mfma_f32_4x4x4_16b_bf16 v[216:219], v[38:39], v[74:75], 0
    v_mfma_f32_4x4x4_16b_bf16 v[220:223], v[74:75], v[74:75], 0
    ds_write_b128 v225, v[196:199] offset:33920
    s_waitcnt vmcnt(23)
    v_mfma_f32_4x4x4_16b_bf16 v[208:211], v[38:39], v[88:89], v[208:211]
    v_mfma_f32_4x4x4_16b_bf16 v[212:215], v[88:89], v[88:89], v[212:215]
    v_mfma_f32_4x4x4_16b_bf16 v[216:219], v[38:39], v[90:91], v[216:219]
    s_cmp_ge_u32 s17, 0
    s_cselect_b32 s10, s16, 0
    s_add_u32 s27, s20, 0
    s_add_u32 m0, s23, 6144
    s_nop 0
    buffer_load_dwordx4 v10, s[8:11], s27 offen lds
    v_mfma_f32_4x4x4_16b_bf16 v[220:223], v[90:91], v[90:91], v[220:223]
    s_waitcnt vmcnt(23)
    v_mfma_f32_4x4x4_16b_bf16 v[208:211], v[38:39], v[104:105], v[208:211]
    v_mfma_f32_4x4x4_16b_bf16 v[212:215], v[104:105], v[104:105], v[212:215]
    v_mfma_f32_4x4x4_16b_bf16 v[216:219], v[38:39], v[106:107], v[216:219]
    v_mfma_f32_4x4x4_16b_bf16 v[220:223], v[106:107], v[106:107], v[220:223]
    s_waitcnt vmcnt(22)
    v_mfma_f32_4x4x4_16b_bf16 v[208:211], v[38:39], v[120:121], v[208:211]
    v_mfma_f32_4x4x4_16b_bf16 v[212:215], v[120:121], v[120:121], v[212:215]
    v_mfma_f32_4x4x4_16b_bf16 v[216:219], v[38:39], v[122:123], v[216:219]
    v_mfma_f32_4x4x4_16b_bf16 v[220:223], v[122:123], v[122:123], v[220:223]
    s_waitcnt vmcnt(21)
    v_mfma_f32_4x4x4_16b_bf16 v[208:211], v[38:39], v[136:137], v[208:211]
    v_mfma_f32_4x4x4_16b_bf16 v[212:215], v[136:137], v[136:137], v[212:215]
    v_mfma_f32_4x4x4_16b_bf16 v[216:219], v[38:39], v[138:139], v[216:219]
    v_mfma_f32_4x4x4_16b_bf16 v[220:223], v[138:139], v[138:139], v[220:223]
    s_waitcnt vmcnt(20)
    v_mfma_f32_4x4x4_16b_bf16 v[208:211], v[38:39], v[152:153], v[208:211]
    s_cmp_ge_u32 s17, 0
    s_cselect_b32 s10, s16, 0
    s_add_u32 s27, s20, 0
    s_add_u32 m0, s23, 7168
    s_nop 0
    buffer_load_dwordx4 v11, s[8:11], s27 offen lds
    v_mfma_f32_4x4x4_16b_bf16 v[212:215], v[152:153], v[152:153], v[212:215]
    v_mfma_f32_4x4x4_16b_bf16 v[216:219], v[38:39], v[154:155], v[216:219]
    v_mfma_f32_4x4x4_16b_bf16 v[220:223], v[154:155], v[154:155], v[220:223]
    s_waitcnt vmcnt(20)
    v_mfma_f32_4x4x4_16b_bf16 v[208:211], v[38:39], v[168:169], v[208:211]
    v_mfma_f32_4x4x4_16b_bf16 v[212:215], v[168:169], v[168:169], v[212:215]
    v_mfma_f32_4x4x4_16b_bf16 v[216:219], v[38:39], v[170:171], v[216:219]
    v_mfma_f32_4x4x4_16b_bf16 v[220:223], v[170:171], v[170:171], v[220:223]
    s_waitcnt vmcnt(19)
    v_mfma_f32_4x4x4_16b_bf16 v[208:211], v[38:39], v[184:185], v[208:211]
    v_mfma_f32_4x4x4_16b_bf16 v[212:215], v[184:185], v[184:185], v[212:215]
    v_mfma_f32_4x4x4_16b_bf16 v[216:219], v[38:39], v[186:187], v[216:219]
    v_mfma_f32_4x4x4_16b_bf16 v[220:223], v[186:187], v[186:187], v[220:223]
    s_waitcnt vmcnt(18)
    v_mfma_f32_4x4x4_16b_bf16 v[208:211], v[38:39], v[200:201], v[208:211]
    v_mfma_f32_4x4x4_16b_bf16 v[212:215], v[200:201], v[200:201], v[212:215]
    v_mfma_f32_4x4x4_16b_bf16 v[216:219], v[38:39], v[202:203], v[216:219]
    v_mfma_f32_4x4x4_16b_bf16 v[220:223], v[202:203], v[202:203], v[220:223]
    s_cmp_ge_u32 s17, 0
    s_cselect_b32 s10, s16, 0
    s_add_u32 s27, s20, 0
    s_add_u32 m0, s23, 8192
    s_nop 0
    buffer_load_dwordx4 v12, s[8:11], s27 offen lds
    s_waitcnt lgkmcnt(0)
    s_barrier
    ds_read_b128 a[0:3], v17 offset:0
    ds_read_b128 a[4:7], v17 offset:1056
    ds_read_b128 a[8:11], v17 offset:2112
    v_add_f32 v2, v208, v216
    v_mov_b32_dpp v13, v212 quad_perm:[0,0,0,0] row_mask:0xf bank_mask:0xf
    ds_read_b128 a[12:15], v17 offset:3168
    v_add_f32_dpp v3, v2, v2 quad_perm:[1,0,3,2] row_mask:0xf bank_mask:0xf
    v_mov_b32_dpp v14, v220 quad_perm:[0,0,0,0] row_mask:0xf bank_mask:0xf
    ds_read_b128 a[16:19], v17 offset:8448
    v_add_f32_dpp v2, v3, v3 quad_perm:[2,3,0,1] row_mask:0xf bank_mask:0xf
    v_add_f32_dpp v13, v213, v13 quad_perm:[1,1,1,1] row_mask:0xf bank_mask:0xf
    ds_read_b128 a[20:23], v17 offset:9504
    v_add_f32_dpp v3, v2, v2 row_half_mirror row_mask:0xf bank_mask:0xf
    v_add_f32_dpp v14, v221, v14 quad_perm:[1,1,1,1] row_mask:0xf bank_mask:0xf
    ds_read_b128 a[24:27], v17 offset:10560
    v_mul_f32 v2, 0xbae38e39, v3
    s_cmp_ge_u32 s17, 0
    s_cselect_b32 s10, s16, 0
    s_add_u32 s27, s20, 497664
    s_add_u32 m0, s23, 36864
    s_nop 0
    buffer_load_dwordx4 v4, s[8:11], s27 offen lds
    v_add_f32_dpp v13, v214, v13 quad_perm:[2,2,2,2] row_mask:0xf bank_mask:0xf
    v_cvt_pk_bf16_f32 v44, 0, v2
    v_add_f32_dpp v14, v222, v14 quad_perm:[2,2,2,2] row_mask:0xf bank_mask:0xf
    v_cvt_pk_bf16_f32 v45, 0, v2
    v_add_f32_dpp v13, v215, v13 quad_perm:[3,3,3,3] row_mask:0xf bank_mask:0xf
    v_cvt_pk_bf16_f32 v46, 0, v2
    v_add_f32_dpp v14, v223, v14 quad_perm:[3,3,3,3] row_mask:0xf bank_mask:0xf
    v_cvt_pk_bf16_f32 v47, 0, v2
    s_nop 1
    v_mfma_f32_4x4x4_16b_bf16 v[20:23], v[56:57], v[72:73], v[44:47]
    v_add_f32 v13, v13, v14
    ds_read_b128 a[28:31], v17 offset:11616
    ds_read_b128 a[32:35], v17 offset:16896
    v_mfma_f32_4x4x4_16b_bf16 v[24:27], v[56:57], v[74:75], v[44:47]
    v_add_f32_dpp v14, v13, v13 row_half_mirror row_mask:0xf bank_mask:0xf
    v_mul_f32 v14, 0x3ae38e39, v14
    ds_read_b128 a[36:39], v17 offset:17952
    s_cmp_ge_u32 s17, 0
    s_cselect_b32 s10, s16, 0
    s_add_u32 s27, s20, 497664
    s_add_u32 m0, s23, 37888
    s_nop 0
    buffer_load_dwordx4 v5, s[8:11], s27 offen lds
    v_cvt_pk_bf16_f32 v72, v20, v21
    v_cvt_pk_bf16_f32 v73, v22, v23
    v_mfma_f32_4x4x4_16b_bf16 v[28:31], v[56:57], v[88:89], v[44:47]
    v_fma_f32 v13, -v2, v2, v14
    v_max_f32 v13, 0, v13
    v_cvt_pk_bf16_f32 v74, v24, v25
    v_cvt_pk_bf16_f32 v75, v26, v27
    v_mfma_f32_4x4x4_16b_bf16 v[20:23], v[56:57], v[90:91], v[44:47]
    v_cvt_pk_bf16_f32 v13, 0, v13
    v_add_f32 v13, 0x3727c5ac, v13
    ds_read_b128 a[40:43], v17 offset:19008
    v_cvt_pk_bf16_f32 v88, v28, v29
    v_cvt_pk_bf16_f32 v89, v30, v31
    v_mfma_f32_4x4x4_16b_bf16 v[24:27], v[56:57], v[104:105], v[44:47]
    v_cvt_pk_bf16_f32 v13, 0, v13
    v_cvt_pk_bf16_f32 v90, v20, v21
    v_cvt_pk_bf16_f32 v91, v22, v23
    v_mfma_f32_4x4x4_16b_bf16 v[28:31], v[56:57], v[106:107], v[44:47]
    s_cmp_ge_u32 s17, 0
    s_cselect_b32 s10, s16, 0
    s_add_u32 s27, s20, 497664
    s_add_u32 m0, s23, 38912
    s_nop 0
    buffer_load_dwordx4 v6, s[8:11], s27 offen lds
    v_sqrt_f32 v13, v13
    ds_read_b128 a[44:47], v17 offset:20064
    v_cvt_pk_bf16_f32 v104, v24, v25
    v_cvt_pk_bf16_f32 v105, v26, v27
    v_mfma_f32_4x4x4_16b_bf16 v[20:23], v[56:57], v[120:121], v[44:47]
    v_cvt_pk_bf16_f32 v13, 0, v13
    v_cvt_pk_bf16_f32 v106, v28, v29
    v_cvt_pk_bf16_f32 v107, v30, v31
    v_mfma_f32_4x4x4_16b_bf16 v[24:27], v[56:57], v[122:123], v[44:47]
    v_rcp_f32 v15, v13
    ds_read_b128 a[48:51], v17 offset:25344
    v_cvt_pk_bf16_f32 v120, v20, v21
    v_cvt_pk_bf16_f32 v121, v22, v23
    v_mfma_f32_4x4x4_16b_bf16 v[28:31], v[56:57], v[136:137], v[44:47]
    v_cvt_pk_bf16_f32 v54, v15, v15
    v_cvt_pk_bf16_f32 v122, v24, v25
    v_cvt_pk_bf16_f32 v123, v26, v27
    v_mfma_f32_4x4x4_16b_bf16 v[20:23], v[56:57], v[138:139], v[44:47]
    s_cmp_ge_u32 s17, 0
    s_cselect_b32 s10, s16, 0
    s_add_u32 s27, s20, 497664
    s_add_u32 m0, s23, 39936
    s_nop 0
    buffer_load_dwordx4 v7, s[8:11], s27 offen lds
    v_and_b32 v48, v54, v36
    ds_read_b128 a[52:55], v17 offset:26400
    v_cvt_pk_bf16_f32 v136, v28, v29
    v_cvt_pk_bf16_f32 v137, v30, v31
    v_mfma_f32_4x4x4_16b_bf16 v[24:27], v[56:57], v[152:153], v[44:47]
    v_and_b32 v49, v54, v37
    v_cvt_pk_bf16_f32 v138, v20, v21
    v_cvt_pk_bf16_f32 v139, v22, v23
    v_mfma_f32_4x4x4_16b_bf16 v[28:31], v[56:57], v[154:155], v[44:47]
    v_and_b32 v16, 0xffff0000, v54
    ds_read_b128 a[56:59], v17 offset:27456
    v_cvt_pk_bf16_f32 v152, v24, v25
    v_cvt_pk_bf16_f32 v153, v26, v27
    v_mfma_f32_4x4x4_16b_bf16 v[20:23], v[56:57], v[168:169], v[44:47]
    v_sub_f32 v15, v15, v16
    v_cvt_pk_bf16_f32 v154, v28, v29
    v_cvt_pk_bf16_f32 v155, v30, v31
    v_mfma_f32_4x4x4_16b_bf16 v[24:27], v[56:57], v[170:171], v[44:47]
    s_cmp_ge_u32 s17, 0
    s_cselect_b32 s10, s16, 0
    s_add_u32 s27, s20, 497664
    s_add_u32 m0, s23, 40960
    s_nop 0
    buffer_load_dwordx4 v8, s[8:11], s27 offen lds
    v_cvt_pk_bf16_f32 v54, v15, v15
    ds_read_b128 a[60:63], v17 offset:28512
    v_cvt_pk_bf16_f32 v168, v20, v21
    v_cvt_pk_bf16_f32 v169, v22, v23
    v_mfma_f32_4x4x4_16b_bf16 v[28:31], v[56:57], v[184:185], v[44:47]
    v_and_b32 v50, v54, v36
    v_cvt_pk_bf16_f32 v170, v24, v25
    v_cvt_pk_bf16_f32 v171, v26, v27
    v_mfma_f32_4x4x4_16b_bf16 v[20:23], v[56:57], v[186:187], v[44:47]
    v_and_b32 v51, v54, v37
    ds_read_b128 a[64:67], v58 offset:0
    v_cvt_pk_bf16_f32 v184, v28, v29
    v_cvt_pk_bf16_f32 v185, v30, v31
    v_mfma_f32_4x4x4_16b_bf16 v[24:27], v[56:57], v[200:201], v[44:47]
    v_cvt_pk_bf16_f32 v186, v20, v21
    v_cvt_pk_bf16_f32 v187, v22, v23
    v_mfma_f32_4x4x4_16b_bf16 v[28:31], v[56:57], v[202:203], v[44:47]
    ds_read_b128 a[68:71], v58 offset:1056
    s_cmp_ge_u32 s17, 0
    s_cselect_b32 s10, s16, 0
    s_add_u32 s27, s20, 497664
    s_add_u32 m0, s23, 41984
    s_nop 0
    buffer_load_dwordx4 v9, s[8:11], s27 offen lds
    v_cvt_pk_bf16_f32 v200, v24, v25
    v_cvt_pk_bf16_f32 v201, v26, v27
    v_cvt_pk_bf16_f32 v202, v28, v29
    v_cvt_pk_bf16_f32 v203, v30, v31
    ds_read_b128 a[72:75], v58 offset:2112
    v_mfma_f32_4x4x4_16b_bf16 v[32:35], v[50:51], v[72:73], 0
    v_mfma_f32_4x4x4_16b_bf16 v[40:43], v[50:51], v[74:75], 0
    ds_read_b128 a[76:79], v58 offset:3168
    v_mfma_f32_4x4x4_16b_bf16 v[208:211], v[50:51], v[88:89], 0
    v_mfma_f32_4x4x4_16b_bf16 v[32:35], v[48:49], v[72:73], v[32:35]
    ds_read_b128 a[80:83], v58 offset:8448
    v_mfma_f32_4x4x4_16b_bf16 v[40:43], v[48:49], v[74:75], v[40:43]
    v_mfma_f32_4x4x4_16b_bf16 v[208:211], v[48:49], v[88:89], v[208:211]
    ds_read_b128 a[84:87], v58 offset:9504
    v_mfma_f32_4x4x4_16b_bf16 v[20:23], v[50:51], v[90:91], 0
    v_cvt_pk_bf16_f32 v72, v32, v33
    v_mfma_f32_4x4x4_16b_bf16 v[24:27], v[50:51], v[104:105], 0
    v_cvt_pk_bf16_f32 v73, v34, v35
    s_cmp_ge_u32 s17, 0
    s_cselect_b32 s10, s16, 0
    s_add_u32 s27, s20, 497664
    s_add_u32 m0, s23, 43008
    s_nop 0
    buffer_load_dwordx4 v10, s[8:11], s27 offen lds
    ds_read_b128 a[88:91], v58 offset:10560
    v_mfma_f32_4x4x4_16b_bf16 v[28:31], v[50:51], v[106:107], 0
    v_cvt_pk_bf16_f32 v74, v40, v41
    v_mfma_f32_4x4x4_16b_bf16 v[20:23], v[48:49], v[90:91], v[20:23]
    v_cvt_pk_bf16_f32 v75, v42, v43
    ds_read_b128 a[92:95], v58 offset:11616
    v_mfma_f32_4x4x4_16b_bf16 v[24:27], v[48:49], v[104:105], v[24:27]
    v_cvt_pk_bf16_f32 v88, v208, v209
    v_mfma_f32_4x4x4_16b_bf16 v[28:31], v[48:49], v[106:107], v[28:31]
    v_cvt_pk_bf16_f32 v89, v210, v211
    ds_read_b128 a[96:99], v58 offset:16896
    v_mfma_f32_4x4x4_16b_bf16 v[32:35], v[50:51], v[120:121], 0
    v_cvt_pk_bf16_f32 v90, v20, v21
    v_mfma_f32_4x4x4_16b_bf16 v[40:43], v[50:51], v[122:123], 0
    v_cvt_pk_bf16_f32 v91, v22, v23
    ds_read_b128 a[100:103], v58 offset:17952
    v_mfma_f32_4x4x4_16b_bf16 v[208:211], v[50:51], v[136:137], 0
    v_cvt_pk_bf16_f32 v104, v24, v25
    s_cmp_ge_u32 s17, 0
    s_cselect_b32 s10, s16, 0
    s_add_u32 s27, s20, 497664
    s_add_u32 m0, s23, 44032
    s_nop 0
    buffer_load_dwordx4 v11, s[8:11], s27 offen lds
    v_mfma_f32_4x4x4_16b_bf16 v[32:35], v[48:49], v[120:121], v[32:35]
    v_cvt_pk_bf16_f32 v105, v26, v27
    ds_read_b128 a[104:107], v58 offset:19008
    v_mfma_f32_4x4x4_16b_bf16 v[40:43], v[48:49], v[122:123], v[40:43]
    v_cvt_pk_bf16_f32 v106, v28, v29
    v_mfma_f32_4x4x4_16b_bf16 v[208:211], v[48:49], v[136:137], v[208:211]
    v_cvt_pk_bf16_f32 v107, v30, v31
    ds_read_b128 a[108:111], v58 offset:20064
    v_mfma_f32_4x4x4_16b_bf16 v[20:23], v[50:51], v[138:139], 0
    v_cvt_pk_bf16_f32 v120, v32, v33
    v_mfma_f32_4x4x4_16b_bf16 v[24:27], v[50:51], v[152:153], 0
    v_cvt_pk_bf16_f32 v121, v34, v35
    ds_read_b128 a[112:115], v58 offset:25344
    v_mfma_f32_4x4x4_16b_bf16 v[28:31], v[50:51], v[154:155], 0
    v_cvt_pk_bf16_f32 v122, v40, v41
    v_mfma_f32_4x4x4_16b_bf16 v[20:23], v[48:49], v[138:139], v[20:23]
    v_cvt_pk_bf16_f32 v123, v42, v43
    ds_read_b128 a[116:119], v58 offset:26400
    s_cmp_ge_u32 s17, 0
    s_cselect_b32 s10, s16, 0
    s_add_u32 s27, s20, 497664
    s_add_u32 m0, s23, 45056
    s_nop 0
    buffer_load_dwordx4 v12, s[8:11], s27 offen lds
    v_mfma_f32_4x4x4_16b_bf16 v[24:27], v[48:49], v[152:153], v[24:27]
    v_cvt_pk_bf16_f32 v136, v208, v209
    v_mfma_f32_4x4x4_16b_bf16 v[28:31], v[48:49], v[154:155], v[28:31]
    v_cvt_pk_bf16_f32 v137, v210, v211
    ds_read_b128 a[120:123], v58 offset:27456
    v_mfma_f32_4x4x4_16b_bf16 v[32:35], v[50:51], v[168:169], 0
    v_cvt_pk_bf16_f32 v138, v20, v21
    v_mfma_f32_4x4x4_16b_bf16 v[40:43], v[50:51], v[170:171], 0
    v_cvt_pk_bf16_f32 v139, v22, v23
    ds_read_b128 a[124:127], v58 offset:28512
    v_mfma_f32_4x4x4_16b_bf16 v[208:211], v[50:51], v[184:185], 0
    v_cvt_pk_bf16_f32 v152, v24, v25
    v_mfma_f32_4x4x4_16b_bf16 v[32:35], v[48:49], v[168:169], v[32:35]
    v_cvt_pk_bf16_f32 v153, v26, v27
    ds_read_b128 a[128:131], v58 offset:33792
    v_mfma_f32_4x4x4_16b_bf16 v[40:43], v[48:49], v[170:171], v[40:43]
    v_cvt_pk_bf16_f32 v154, v28, v29
    v_mfma_f32_4x4x4_16b_bf16 v[208:211], v[48:49], v[184:185], v[208:211]
    buffer_load_dword v63, v59, s[8:11], s71 offen offset:384
    buffer_load_dword v63, v59, s[8:11], s71 offen offset:768
    v_cvt_pk_bf16_f32 v155, v30, v31
    ds_read_b128 a[132:135], v58 offset:34848
    v_mfma_f32_4x4x4_16b_bf16 v[20:23], v[50:51], v[186:187], 0
    v_cvt_pk_bf16_f32 v168, v32, v33
    v_mfma_f32_4x4x4_16b_bf16 v[24:27], v[50:51], v[200:201], 0
    v_cvt_pk_bf16_f32 v169, v34, v35
    ds_read_b128 a[136:139], v58 offset:35904
    v_mfma_f32_4x4x4_16b_bf16 v[28:31], v[50:51], v[202:203], 0
    v_cvt_pk_bf16_f32 v170, v40, v41
    v_mfma_f32_4x4x4_16b_bf16 v[20:23], v[48:49], v[186:187], v[20:23]
    v_cvt_pk_bf16_f32 v171, v42, v43
    ds_read_b128 a[140:143], v58 offset:36960
    v_mfma_f32_4x4x4_16b_bf16 v[24:27], v[48:49], v[200:201], v[24:27]
    v_cvt_pk_bf16_f32 v184, v208, v209
    v_mfma_f32_4x4x4_16b_bf16 v[28:31], v[48:49], v[202:203], v[28:31]
    v_cvt_pk_bf16_f32 v185, v210, v211
    v_cvt_pk_bf16_f32 v186, v20, v21
    v_cvt_pk_bf16_f32 v187, v22, v23
    v_cvt_pk_bf16_f32 v200, v24, v25
    v_cvt_pk_bf16_f32 v201, v26, v27
    v_cvt_pk_bf16_f32 v202, v28, v29
    v_cvt_pk_bf16_f32 v203, v30, v31
    s_waitcnt vmcnt(29)
    v_mfma_f32_4x4x4_16b_bf16 v[208:211], v[38:39], v[76:77], 0
    v_mfma_f32_4x4x4_16b_bf16 v[212:215], v[76:77], v[76:77], 0
    v_mfma_f32_4x4x4_16b_bf16 v[216:219], v[38:39], v[78:79], 0
    v_mfma_f32_4x4x4_16b_bf16 v[220:223], v[78:79], v[78:79], 0
    s_waitcnt vmcnt(28)
    v_mfma_f32_4x4x4_16b_bf16 v[208:211], v[38:39], v[92:93], v[208:211]
    v_mfma_f32_4x4x4_16b_bf16 v[212:215], v[92:93], v[92:93], v[212:215]
    v_mfma_f32_4x4x4_16b_bf16 v[216:219], v[38:39], v[94:95], v[216:219]
    v_mfma_f32_4x4x4_16b_bf16 v[220:223], v[94:95], v[94:95], v[220:223]
    s_waitcnt vmcnt(27)
    v_mfma_f32_4x4x4_16b_bf16 v[208:211], v[38:39], v[108:109], v[208:211]
    v_mfma_f32_4x4x4_16b_bf16 v[212:215], v[108:109], v[108:109], v[212:215]
    v_mfma_f32_4x4x4_16b_bf16 v[216:219], v[38:39], v[110:111], v[216:219]
    v_mfma_f32_4x4x4_16b_bf16 v[220:223], v[110:111], v[110:111], v[220:223]
    s_waitcnt vmcnt(26)
    v_mfma_f32_4x4x4_16b_bf16 v[208:211], v[38:39], v[124:125], v[208:211]
    v_mfma_f32_4x4x4_16b_bf16 v[212:215], v[124:125], v[124:125], v[212:215]
    v_mfma_f32_4x4x4_16b_bf16 v[216:219], v[38:39], v[126:127], v[216:219]
    v_mfma_f32_4x4x4_16b_bf16 v[220:223], v[126:127], v[126:127], v[220:223]
    s_waitcnt vmcnt(25)
    v_mfma_f32_4x4x4_16b_bf16 v[208:211], v[38:39], v[140:141], v[208:211]
    v_mfma_f32_4x4x4_16b_bf16 v[212:215], v[140:141], v[140:141], v[212:215]
    v_mfma_f32_4x4x4_16b_bf16 v[216:219], v[38:39], v[142:143], v[216:219]
    v_mfma_f32_4x4x4_16b_bf16 v[220:223], v[142:143], v[142:143], v[220:223]
    s_waitcnt vmcnt(24)
    v_mfma_f32_4x4x4_16b_bf16 v[208:211], v[38:39], v[156:157], v[208:211]
    v_mfma_f32_4x4x4_16b_bf16 v[212:215], v[156:157], v[156:157], v[212:215]
    v_mfma_f32_4x4x4_16b_bf16 v[216:219], v[38:39], v[158:159], v[216:219]
    v_mfma_f32_4x4x4_16b_bf16 v[220:223], v[158:159], v[158:159], v[220:223]
    s_waitcnt vmcnt(23)
    v_mfma_f32_4x4x4_16b_bf16 v[208:211], v[38:39], v[172:173], v[208:211]
    v_mfma_f32_4x4x4_16b_bf16 v[212:215], v[172:173], v[172:173], v[212:215]
    v_mfma_f32_4x4x4_16b_bf16 v[216:219], v[38:39], v[174:175], v[216:219]
    v_mfma_f32_4x4x4_16b_bf16 v[220:223], v[174:175], v[174:175], v[220:223]
    s_waitcnt vmcnt(22)
    v_mfma_f32_4x4x4_16b_bf16 v[208:211], v[38:39], v[188:189], v[208:211]
    v_mfma_f32_4x4x4_16b_bf16 v[212:215], v[188:189], v[188:189], v[212:215]
    v_mfma_f32_4x4x4_16b_bf16 v[216:219], v[38:39], v[190:191], v[216:219]
    v_mfma_f32_4x4x4_16b_bf16 v[220:223], v[190:191], v[190:191], v[220:223]
    s_waitcnt vmcnt(21)
    v_mfma_f32_4x4x4_16b_bf16 v[208:211], v[38:39], v[204:205], v[208:211]
    v_mfma_f32_4x4x4_16b_bf16 v[212:215], v[204:205], v[204:205], v[212:215]
    v_mfma_f32_4x4x4_16b_bf16 v[216:219], v[38:39], v[206:207], v[216:219]
    v_mfma_f32_4x4x4_16b_bf16 v[220:223], v[206:207], v[206:207], v[220:223]
    s_waitcnt lgkmcnt(0)
    s_barrier
    ds_write_b128 v224, v[72:75] offset:0
    ds_write_b128 v224, v[88:91] offset:8448
    ds_write_b128 v224, v[104:107] offset:16896
    v_add_f32 v2, v208, v216
    v_mov_b32_dpp v13, v212 quad_perm:[0,0,0,0] row_mask:0xf bank_mask:0xf
    ds_write_b128 v224, v[120:123] offset:25344
    v_add_f32_dpp v3, v2, v2 quad_perm:[1,0,3,2] row_mask:0xf bank_mask:0xf
    v_mov_b32_dpp v14, v220 quad_perm:[0,0,0,0] row_mask:0xf bank_mask:0xf
    ds_write_b128 v225, v[136:139] offset:0
    v_add_f32_dpp v2, v3, v3 quad_perm:[2,3,0,1] row_mask:0xf bank_mask:0xf
    v_add_f32_dpp v13, v213, v13 quad_perm:[1,1,1,1] row_mask:0xf bank_mask:0xf
    ds_write_b128 v225, v[152:155] offset:8448
    v_add_f32_dpp v3, v2, v2 row_half_mirror row_mask:0xf bank_mask:0xf
    v_add_f32_dpp v14, v221, v14 quad_perm:[1,1,1,1] row_mask:0xf bank_mask:0xf
    ds_write_b128 v225, v[168:171] offset:16896
    v_mul_f32 v2, 0xbae38e39, v3
    v_add_f32_dpp v13, v214, v13 quad_perm:[2,2,2,2] row_mask:0xf bank_mask:0xf
    v_cvt_pk_bf16_f32 v44, 0, v2
    v_add_f32_dpp v14, v222, v14 quad_perm:[2,2,2,2] row_mask:0xf bank_mask:0xf
    v_cvt_pk_bf16_f32 v45, 0, v2
    v_add_f32_dpp v13, v215, v13 quad_perm:[3,3,3,3] row_mask:0xf bank_mask:0xf
    v_cvt_pk_bf16_f32 v46, 0, v2
    v_add_f32_dpp v14, v223, v14 quad_perm:[3,3,3,3] row_mask:0xf bank_mask:0xf
    v_cvt_pk_bf16_f32 v47, 0, v2
    s_nop 1
    v_mfma_f32_4x4x4_16b_bf16 v[20:23], v[56:57], v[76:77], v[44:47]
    v_add_f32 v13, v13, v14
    ds_write_b128 v225, v[184:187] offset:25344
    ds_write_b128 v225, v[200:203] offset:33792
    v_mfma_f32_4x4x4_16b_bf16 v[24:27], v[56:57], v[78:79], v[44:47]
    v_add_f32_dpp v14, v13, v13 row_half_mirror row_mask:0xf bank_mask:0xf
    v_mul_f32 v14, 0x3ae38e39, v14
    v_cvt_pk_bf16_f32 v76, v20, v21
    v_cvt_pk_bf16_f32 v77, v22, v23
    v_mfma_f32_4x4x4_16b_bf16 v[28:31], v[56:57], v[92:93], v[44:47]
    v_fma_f32 v13, -v2, v2, v14
    v_max_f32 v13, 0, v13
    v_cvt_pk_bf16_f32 v78, v24, v25
    v_cvt_pk_bf16_f32 v79, v26, v27
    v_mfma_f32_4x4x4_16b_bf16 v[20:23], v[56:57], v[94:95], v[44:47]
    v_cvt_pk_bf16_f32 v13, 0, v13
    v_add_f32 v13, 0x3727c5ac, v13
    v_cvt_pk_bf16_f32 v92, v28, v29
    v_cvt_pk_bf16_f32 v93, v30, v31
    v_mfma_f32_4x4x4_16b_bf16 v[24:27], v[56:57], v[108:109], v[44:47]
    v_cvt_pk_bf16_f32 v13, 0, v13
    v_cvt_pk_bf16_f32 v94, v20, v21
    v_cvt_pk_bf16_f32 v95, v22, v23
    v_mfma_f32_4x4x4_16b_bf16 v[28:31], v[56:57], v[110:111], v[44:47]
    v_sqrt_f32 v13, v13
    v_cvt_pk_bf16_f32 v108, v24, v25
    v_cvt_pk_bf16_f32 v109, v26, v27
    v_mfma_f32_4x4x4_16b_bf16 v[20:23], v[56:57], v[124:125], v[44:47]
    v_cvt_pk_bf16_f32 v13, 0, v13
    v_cvt_pk_bf16_f32 v110, v28, v29
    v_cvt_pk_bf16_f32 v111, v30, v31
    v_mfma_f32_4x4x4_16b_bf16 v[24:27], v[56:57], v[126:127], v[44:47]
    v_rcp_f32 v15, v13
    v_cvt_pk_bf16_f32 v124, v20, v21
    v_cvt_pk_bf16_f32 v125, v22, v23
    v_mfma_f32_4x4x4_16b_bf16 v[28:31], v[56:57], v[140:141], v[44:47]
    v_cvt_pk_bf16_f32 v54, v15, v15
    v_cvt_pk_bf16_f32 v126, v24, v25
    v_cvt_pk_bf16_f32 v127, v26, v27
    v_mfma_f32_4x4x4_16b_bf16 v[20:23], v[56:57], v[142:143], v[44:47]
    v_and_b32 v48, v54, v36
    v_cvt_pk_bf16_f32 v140, v28, v29
    v_cvt_pk_bf16_f32 v141, v30, v31
    v_mfma_f32_4x4x4_16b_bf16 v[24:27], v[56:57], v[156:157], v[44:47]
    v_and_b32 v49, v54, v37
    v_cvt_pk_bf16_f32 v142, v20, v21
    v_cvt_pk_bf16_f32 v143, v22, v23
    v_mfma_f32_4x4x4_16b_bf16 v[28:31], v[56:57], v[158:159], v[44:47]
    v_and_b32 v16, 0xffff0000, v54
    v_cvt_pk_bf16_f32 v156, v24, v25
    v_cvt_pk_bf16_f32 v157, v26, v27
    v_mfma_f32_4x4x4_16b_bf16 v[20:23], v[56:57], v[172:173], v[44:47]
    v_sub_f32 v15, v15, v16
    v_cvt_pk_bf16_f32 v158, v28, v29
    v_cvt_pk_bf16_f32 v159, v30, v31
    v_mfma_f32_4x4x4_16b_bf16 v[24:27], v[56:57], v[174:175], v[44:47]
    v_cvt_pk_bf16_f32 v54, v15, v15
    v_cvt_pk_bf16_f32 v172, v20, v21
    v_cvt_pk_bf16_f32 v173, v22, v23
    v_mfma_f32_4x4x4_16b_bf16 v[28:31], v[56:57], v[188:189], v[44:47]
    v_and_b32 v50, v54, v36
    v_cvt_pk_bf16_f32 v174, v24, v25
    v_cvt_pk_bf16_f32 v175, v26, v27
    v_mfma_f32_4x4x4_16b_bf16 v[20:23], v[56:57], v[190:191], v[44:47]
    v_and_b32 v51, v54, v37
    v_cvt_pk_bf16_f32 v188, v28, v29
    v_cvt_pk_bf16_f32 v189, v30, v31
    v_mfma_f32_4x4x4_16b_bf16 v[24:27], v[56:57], v[204:205], v[44:47]
    s_nop 0
    v_cvt_pk_bf16_f32 v190, v20, v21
    v_cvt_pk_bf16_f32 v191, v22, v23
    v_mfma_f32_4x4x4_16b_bf16 v[28:31], v[56:57], v[206:207], v[44:47]
    s_nop 0
    v_cvt_pk_bf16_f32 v204, v24, v25
    v_cvt_pk_bf16_f32 v205, v26, v27
    s_nop 1
    v_cvt_pk_bf16_f32 v206, v28, v29
    v_cvt_pk_bf16_f32 v207, v30, v31
    v_mfma_f32_4x4x4_16b_bf16 v[32:35], v[50:51], v[76:77], 0
    v_mfma_f32_4x4x4_16b_bf16 v[40:43], v[50:51], v[78:79], 0
    v_mfma_f32_4x4x4_16b_bf16 v[208:211], v[50:51], v[92:93], 0
    v_mfma_f32_4x4x4_16b_bf16 v[32:35], v[48:49], v[76:77], v[32:35]
    v_mfma_f32_4x4x4_16b_bf16 v[40:43], v[48:49], v[78:79], v[40:43]
    v_mfma_f32_4x4x4_16b_bf16 v[208:211], v[48:49], v[92:93], v[208:211]
    v_mfma_f32_4x4x4_16b_bf16 v[20:23], v[50:51], v[94:95], 0
    s_nop 1
    v_cvt_pk_bf16_f32 v76, v32, v33
    v_mfma_f32_4x4x4_16b_bf16 v[24:27], v[50:51], v[108:109], 0
    v_cvt_pk_bf16_f32 v77, v34, v35
    v_mfma_f32_4x4x4_16b_bf16 v[28:31], v[50:51], v[110:111], 0
    v_cvt_pk_bf16_f32 v78, v40, v41
    v_mfma_f32_4x4x4_16b_bf16 v[20:23], v[48:49], v[94:95], v[20:23]
    v_cvt_pk_bf16_f32 v79, v42, v43
    v_mfma_f32_4x4x4_16b_bf16 v[24:27], v[48:49], v[108:109], v[24:27]
    v_cvt_pk_bf16_f32 v92, v208, v209
    v_mfma_f32_4x4x4_16b_bf16 v[28:31], v[48:49], v[110:111], v[28:31]
    v_cvt_pk_bf16_f32 v93, v210, v211
    v_mfma_f32_4x4x4_16b_bf16 v[32:35], v[50:51], v[124:125], 0
    v_cvt_pk_bf16_f32 v94, v20, v21
    v_mfma_f32_4x4x4_16b_bf16 v[40:43], v[50:51], v[126:127], 0
    v_cvt_pk_bf16_f32 v95, v22, v23
    ds_write_b128 v224, v[76:79] offset:128
    v_mfma_f32_4x4x4_16b_bf16 v[208:211], v[50:51], v[140:141], 0
    v_cvt_pk_bf16_f32 v108, v24, v25
    v_mfma_f32_4x4x4_16b_bf16 v[32:35], v[48:49], v[124:125], v[32:35]
    v_cvt_pk_bf16_f32 v109, v26, v27
    v_mfma_f32_4x4x4_16b_bf16 v[40:43], v[48:49], v[126:127], v[40:43]
    v_cvt_pk_bf16_f32 v110, v28, v29
    v_mfma_f32_4x4x4_16b_bf16 v[208:211], v[48:49], v[140:141], v[208:211]
    v_cvt_pk_bf16_f32 v111, v30, v31
    v_mfma_f32_4x4x4_16b_bf16 v[20:23], v[50:51], v[142:143], 0
    v_cvt_pk_bf16_f32 v124, v32, v33
    v_mfma_f32_4x4x4_16b_bf16 v[24:27], v[50:51], v[156:157], 0
    v_cvt_pk_bf16_f32 v125, v34, v35
    ds_write_b128 v224, v[92:95] offset:8576
    v_mfma_f32_4x4x4_16b_bf16 v[28:31], v[50:51], v[158:159], 0
    v_cvt_pk_bf16_f32 v126, v40, v41
    v_mfma_f32_4x4x4_16b_bf16 v[20:23], v[48:49], v[142:143], v[20:23]
    v_cvt_pk_bf16_f32 v127, v42, v43
    ds_write_b128 v224, v[108:111] offset:17024
    v_mfma_f32_4x4x4_16b_bf16 v[24:27], v[48:49], v[156:157], v[24:27]
    v_cvt_pk_bf16_f32 v140, v208, v209
    v_mfma_f32_4x4x4_16b_bf16 v[28:31], v[48:49], v[158:159], v[28:31]
    v_cvt_pk_bf16_f32 v141, v210, v211
    v_mfma_f32_4x4x4_16b_bf16 v[32:35], v[50:51], v[172:173], 0
    v_cvt_pk_bf16_f32 v142, v20, v21
    v_mfma_f32_4x4x4_16b_bf16 v[40:43], v[50:51], v[174:175], 0
    v_cvt_pk_bf16_f32 v143, v22, v23
    ds_write_b128 v224, v[124:127] offset:25472
    v_mfma_f32_4x4x4_16b_bf16 v[208:211], v[50:51], v[188:189], 0
    v_cvt_pk_bf16_f32 v156, v24, v25
    v_mfma_f32_4x4x4_16b_bf16 v[32:35], v[48:49], v[172:173], v[32:35]
    v_cvt_pk_bf16_f32 v157, v26, v27
    v_mfma_f32_4x4x4_16b_bf16 v[40:43], v[48:49], v[174:175], v[40:43]
    v_cvt_pk_bf16_f32 v158, v28, v29
    v_mfma_f32_4x4x4_16b_bf16 v[208:211], v[48:49], v[188:189], v[208:211]
    v_cvt_pk_bf16_f32 v159, v30, v31
    v_mfma_f32_4x4x4_16b_bf16 v[20:23], v[50:51], v[190:191], 0
    v_cvt_pk_bf16_f32 v172, v32, v33
    v_mfma_f32_4x4x4_16b_bf16 v[24:27], v[50:51], v[204:205], 0
    v_cvt_pk_bf16_f32 v173, v34, v35
    ds_write_b128 v225, v[140:143] offset:128
    v_mfma_f32_4x4x4_16b_bf16 v[28:31], v[50:51], v[206:207], 0
    v_cvt_pk_bf16_f32 v174, v40, v41
    v_mfma_f32_4x4x4_16b_bf16 v[20:23], v[48:49], v[190:191], v[20:23]
    v_cvt_pk_bf16_f32 v175, v42, v43
    ds_write_b128 v225, v[156:159] offset:8576
    v_mfma_f32_4x4x4_16b_bf16 v[24:27], v[48:49], v[204:205], v[24:27]
    v_cvt_pk_bf16_f32 v188, v208, v209
    v_mfma_f32_4x4x4_16b_bf16 v[28:31], v[48:49], v[206:207], v[28:31]
    v_cvt_pk_bf16_f32 v189, v210, v211
    v_cvt_pk_bf16_f32 v190, v20, v21
    v_cvt_pk_bf16_f32 v191, v22, v23
    ds_write_b128 v225, v[172:175] offset:17024
    v_cvt_pk_bf16_f32 v204, v24, v25
    v_cvt_pk_bf16_f32 v205, v26, v27
    v_cvt_pk_bf16_f32 v206, v28, v29
    v_cvt_pk_bf16_f32 v207, v30, v31
    ds_write_b128 v225, v[188:191] offset:25472
    ds_write_b128 v225, v[204:207] offset:33920
    s_mov_b32 s19, 110592
    v_bfe_u32 v54, v1, 2, 2
    v_lshlrev_b32 v16, 6, v54
    v_lshl_add_u32 v16, v18, 10, v16
    v_bfe_u32 v54, v1, 4, 1
    v_lshl_add_u32 v16, v54, 5, v16
    v_and_b32 v54, 3, v1
    v_lshl_add_u32 v16, v54, 3, v16
    s_mul_i32 s27, s36, 18432
    v_add_u32 v16, s27, v16
    v_mov_b32 v2, v16
    s_mov_b32 s18, 0
    s_lshl_b32 s27, s35, 6
    v_add_u32 v13, s27, v19
    s_movk_i32 s27, 3456
    v_mul_lo_u32 v13, v13, s27
    v_lshl_add_u32 v13, v18, 5, v13
    s_lshl_b32 s27, s36, 7
    s_add_u32 s21, s29, s27
    s_add_u32 s22, s21, 110592
    v_lshlrev_b32 v19, 2, v1
    v_add_u32 v19, 0x26000, v19
    v_mov_b32 v18, 0
    ds_write_b32 v19, v18
    s_mov_b32 s57, 0
    s_waitcnt vmcnt(11)
    s_waitcnt lgkmcnt(0)
    s_barrier
    ds_read_b128 a[144:147], v17 offset:0
    ds_read_b128 a[148:151], v17 offset:1056
    ds_read_b128 a[152:155], v17 offset:2112
    ds_read_b128 a[156:159], v17 offset:3168
    ds_read_b64_tr_b16 v[128:129], v2 offset:0
    ds_read_b64_tr_b16 v[130:131], v2 offset:256
    ds_read_b64_tr_b16 v[132:133], v2 offset:512
    ds_read_b64_tr_b16 v[134:135], v2 offset:768
    ds_read_b64_tr_b16 v[136:137], v2 offset:2048
    ds_read_b64_tr_b16 v[138:139], v2 offset:2304
    ds_read_b64_tr_b16 v[140:141], v2 offset:2560
    ds_read_b64_tr_b16 v[142:143], v2 offset:2816
    ds_read_b64_tr_b16 v[144:145], v2 offset:4096
    ds_read_b64_tr_b16 v[146:147], v2 offset:4352
    ds_read_b64_tr_b16 v[148:149], v2 offset:4608
    ds_read_b64_tr_b16 v[150:151], v2 offset:4864
    ds_read_b64_tr_b16 v[152:153], v2 offset:6144
    ds_read_b64_tr_b16 v[154:155], v2 offset:6400
    ds_read_b64_tr_b16 v[156:157], v2 offset:6656
    ds_read_b64_tr_b16 v[158:159], v2 offset:6912
    s_lshl_b32 s58, s35, 6
    s_lshl_b32 s59, s36, 6
    s_waitcnt lgkmcnt(14)
    v_mfma_f32_32x32x16_bf16 v[64:79], v[128:131], a[0:3], 0
    ds_read_b64_tr_b16 v[20:21], v2 offset:8192
    ds_read_b64_tr_b16 v[22:23], v2 offset:8448
    ds_read_b128 a[160:163], v17 offset:8448
    ds_read_b128 a[164:167], v17 offset:9504
    v_mfma_f32_32x32x16_bf16 v[80:95], v[128:131], a[144:147], 0
    ds_read_b128 a[168:171], v17 offset:10560
    ds_read_b128 a[172:175], v17 offset:11616
    s_waitcnt lgkmcnt(15)
    v_mfma_f32_32x32x16_bf16 v[96:111], v[132:135], a[0:3], 0
    ds_read_b64_tr_b16 v[24:25], v2 offset:8704
    ds_read_b64_tr_b16 v[26:27], v2 offset:8960
    ds_read_b128 a[176:179], v17 offset:16896
    ds_read_b128 a[180:183], v17 offset:17952
    v_mfma_f32_32x32x16_bf16 v[112:127], v[132:135], a[144:147], 0
    ds_read_b128 a[184:187], v17 offset:19008
    ds_read_b128 a[188:191], v17 offset:20064
    v_mfma_f32_32x32x16_bf16 v[64:79], v[136:139], a[4:7], v[64:79]
    ds_read_b64_tr_b16 v[28:29], v2 offset:10240
    ds_read_b64_tr_b16 v[30:31], v2 offset:10496
    ds_read_b128 a[192:195], v17 offset:25344
    ds_read_b128 a[196:199], v17 offset:26400
    v_mfma_f32_32x32x16_bf16 v[80:95], v[136:139], a[148:151], v[80:95]
    ds_read_b128 a[200:203], v17 offset:27456
    ds_read_b128 a[204:207], v17 offset:28512
    s_waitcnt lgkmcnt(15)
    v_mfma_f32_32x32x16_bf16 v[96:111], v[140:143], a[4:7], v[96:111]
    ds_read_b64_tr_b16 v[32:33], v2 offset:10752
    ds_read_b64_tr_b16 v[34:35], v2 offset:11008
    ds_read_b128 a[208:211], v58 offset:0
    ds_read_b128 a[212:215], v58 offset:1056
    v_mfma_f32_32x32x16_bf16 v[112:127], v[140:143], a[148:151], v[112:127]
    ds_read_b128 a[216:219], v58 offset:2112
    ds_read_b128 a[220:223], v58 offset:3168
    v_mfma_f32_32x32x16_bf16 v[64:79], v[144:147], a[8:11], v[64:79]
    ds_read_b64_tr_b16 v[128:129], v2 offset:12288
    ds_read_b64_tr_b16 v[130:131], v2 offset:12544
    ds_read_b128 a[224:227], v58 offset:8448
    ds_read_b128 a[228:231], v58 offset:9504
    v_mfma_f32_32x32x16_bf16 v[80:95], v[144:147], a[152:155], v[80:95]
    ds_read_b128 a[232:235], v58 offset:10560
    ds_read_b128 a[236:239], v58 offset:11616
    v_mfma_f32_32x32x16_bf16 v[96:111], v[148:151], a[8:11], v[96:111]
    ds_read_b64_tr_b16 v[132:133], v2 offset:12800
    ds_read_b64_tr_b16 v[134:135], v2 offset:13056
    ds_read_b128 a[240:243], v58 offset:16896
    ds_read_b128 a[244:247], v58 offset:17952
    v_mfma_f32_32x32x16_bf16 v[112:127], v[148:151], a[152:155], v[112:127]
    ds_read_b128 a[248:251], v58 offset:19008
    ds_read_b128 a[252:255], v58 offset:20064
    v_mfma_f32_32x32x16_bf16 v[64:79], v[152:155], a[12:15], v[64:79]
    ds_read_b64_tr_b16 v[136:137], v2 offset:14336
    ds_read_b64_tr_b16 v[138:139], v2 offset:14592
    ds_read_b128 v[224:227], v58 offset:25344
    ds_read_b128 v[228:231], v58 offset:26400
    v_mfma_f32_32x32x16_bf16 v[80:95], v[152:155], a[156:159], v[80:95]
    ds_read_b128 v[232:235], v58 offset:27456
    ds_read_b128 v[236:239], v58 offset:28512
    v_mfma_f32_32x32x16_bf16 v[96:111], v[156:159], a[12:15], v[96:111]
    ds_read_b64_tr_b16 v[140:141], v2 offset:14848
    ds_read_b64_tr_b16 v[142:143], v2 offset:15104
    ds_read_b128 v[240:243], v58 offset:33792
    ds_read_b128 v[244:247], v58 offset:34848
    v_mfma_f32_32x32x16_bf16 v[112:127], v[156:159], a[156:159], v[112:127]
    ds_read_b128 v[248:251], v58 offset:35904
    ds_read_b128 v[252:255], v58 offset:36960
    v_mfma_f32_32x32x16_bf16 v[64:79], v[20:23], a[16:19], v[64:79]
    s_waitcnt lgkmcnt(0)
    s_waitcnt vmcnt(2)
    s_barrier
    s_add_u32 s18, s18, 36864
    s_cmp_eq_u32 s18, 147456
    s_cselect_b32 s18, 0, s18
    v_add_u32 v3, s18, v16
    ds_read_b64_tr_b16 v[144:145], v2 offset:16384
    ds_read_b64_tr_b16 v[146:147], v2 offset:16640
    v_mfma_f32_32x32x16_bf16 v[80:95], v[20:23], a[160:163], v[80:95]
    s_cmp_ge_u32 s17, 0
    s_cselect_b32 s10, s16, 0
    s_add_u32 s27, s20, 995328
    s_add_u32 m0, s23, 73728
    s_nop 0
    buffer_load_dwordx4 v4, s[8:11], s27 offen lds
    v_mfma_f32_32x32x16_bf16 v[96:111], v[24:27], a[16:19], v[96:111]
    ds_read_b64_tr_b16 v[148:149], v2 offset:16896
    ds_read_b64_tr_b16 v[150:151], v2 offset:17152
    s_cmp_ge_u32 s17, 0
    s_cselect_b32 s10, s16, 0
    s_add_u32 s27, s20, 995328
    s_add_u32 m0, s23, 74752
    s_nop 0
    buffer_load_dwordx4 v5, s[8:11], s27 offen lds
    v_mfma_f32_32x32x16_bf16 v[112:127], v[24:27], a[160:163], v[112:127]
    s_cmp_ge_u32 s17, 0
    s_cselect_b32 s10, s16, 0
    s_add_u32 s27, s20, 995328
    s_add_u32 m0, s23, 75776
    s_nop 0
    buffer_load_dwordx4 v6, s[8:11], s27 offen lds
    v_mfma_f32_32x32x16_bf16 v[64:79], v[28:31], a[20:23], v[64:79]
    ds_read_b64_tr_b16 v[152:153], v3 offset:0
    ds_read_b64_tr_b16 v[154:155], v3 offset:256
    s_cmp_ge_u32 s17, 0
    s_cselect_b32 s10, s16, 0
    s_add_u32 s27, s20, 995328
    s_add_u32 m0, s23, 76800
    s_nop 0
    buffer_load_dwordx4 v7, s[8:11], s27 offen lds
    v_mfma_f32_32x32x16_bf16 v[80:95], v[28:31], a[164:167], v[80:95]
    s_cmp_ge_u32 s17, 0
    s_cselect_b32 s10, s16, 0
    s_add_u32 s27, s20, 995328
    s_add_u32 m0, s23, 77824
    s_nop 0
    buffer_load_dwordx4 v8, s[8:11], s27 offen lds
    v_mfma_f32_32x32x16_bf16 v[96:111], v[32:35], a[20:23], v[96:111]
    ds_read_b64_tr_b16 v[156:157], v3 offset:512
    ds_read_b64_tr_b16 v[158:159], v3 offset:768
    s_cmp_ge_u32 s17, 0
    s_cselect_b32 s10, s16, 0
    s_add_u32 s27, s20, 995328
    s_add_u32 m0, s23, 78848
    s_nop 0
    buffer_load_dwordx4 v9, s[8:11], s27 offen lds
    v_mfma_f32_32x32x16_bf16 v[112:127], v[32:35], a[164:167], v[112:127]
    s_cmp_ge_u32 s17, 0
    s_cselect_b32 s10, s16, 0
    s_add_u32 s27, s20, 995328
    s_add_u32 m0, s23, 79872
    s_nop 0
    buffer_load_dwordx4 v10, s[8:11], s27 offen lds
    v_mfma_f32_32x32x16_bf16 v[64:79], v[128:131], a[24:27], v[64:79]
    ds_read_b64_tr_b16 v[20:21], v3 offset:2048
    ds_read_b64_tr_b16 v[22:23], v3 offset:2304
    s_cmp_ge_u32 s17, 0
    s_cselect_b32 s10, s16, 0
    s_add_u32 s27, s20, 995328
    s_add_u32 m0, s23, 80896
    s_nop 0
    buffer_load_dwordx4 v11, s[8:11], s27 offen lds
    v_mfma_f32_32x32x16_bf16 v[80:95], v[128:131], a[168:171], v[80:95]
    s_cmp_ge_u32 s17, 0
    s_cselect_b32 s10, s16, 0
    s_add_u32 s27, s20, 995328
    s_add_u32 m0, s23, 81920
    s_nop 0
    buffer_load_dwordx4 v12, s[8:11], s27 offen lds
    v_mfma_f32_32x32x16_bf16 v[96:111], v[132:135], a[24:27], v[96:111]
    ds_read_b64_tr_b16 v[24:25], v3 offset:2560
    ds_read_b64_tr_b16 v[26:27], v3 offset:2816
    s_cmp_ge_u32 s17, 0
    s_cselect_b32 s10, s16, 0
    s_add_u32 s25, s19, s23
    s_add_u32 s27, s20, 1492992
    s_add_u32 s19, s19, 36864
    s_cmp_eq_u32 s19, 147456
    s_cselect_b32 s19, 0, s19
    v_mfma_f32_32x32x16_bf16 v[112:127], v[132:135], a[168:171], v[112:127]
    s_add_u32 m0, s25, 0
    s_nop 0
    buffer_load_dwordx4 v4, s[8:11], s27 offen lds
    v_mfma_f32_32x32x16_bf16 v[64:79], v[136:139], a[28:31], v[64:79]
    ds_read_b64_tr_b16 v[28:29], v3 offset:4096
    ds_read_b64_tr_b16 v[30:31], v3 offset:4352
    s_add_u32 m0, s25, 1024
    s_nop 0
    buffer_load_dwordx4 v5, s[8:11], s27 offen lds
    v_mfma_f32_32x32x16_bf16 v[80:95], v[136:139], a[172:175], v[80:95]
    s_add_u32 m0, s25, 2048
    s_nop 0
    buffer_load_dwordx4 v6, s[8:11], s27 offen lds
    v_mfma_f32_32x32x16_bf16 v[96:111], v[140:143], a[28:31], v[96:111]
    ds_read_b64_tr_b16 v[32:33], v3 offset:4608
    ds_read_b64_tr_b16 v[34:35], v3 offset:4864
    s_add_u32 m0, s25, 3072
    s_nop 0
    buffer_load_dwordx4 v7, s[8:11], s27 offen lds
    v_mfma_f32_32x32x16_bf16 v[112:127], v[140:143], a[172:175], v[112:127]
    s_add_u32 m0, s25, 4096
    s_nop 0
    buffer_load_dwordx4 v8, s[8:11], s27 offen lds
    s_waitcnt lgkmcnt(14)
    v_mfma_f32_32x32x16_bf16 v[64:79], v[144:147], a[32:35], v[64:79]
    ds_read_b64_tr_b16 v[128:129], v3 offset:6144
    ds_read_b64_tr_b16 v[130:131], v3 offset:6400
    s_add_u32 m0, s25, 5120
    s_nop 0
    buffer_load_dwordx4 v9, s[8:11], s27 offen lds
    v_mfma_f32_32x32x16_bf16 v[80:95], v[144:147], a[176:179], v[80:95]
    s_add_u32 m0, s25, 6144
    s_nop 0
    buffer_load_dwordx4 v10, s[8:11], s27 offen lds
    s_waitcnt lgkmcnt(14)
    v_mfma_f32_32x32x16_bf16 v[96:111], v[148:151], a[32:35], v[96:111]
    ds_read_b64_tr_b16 v[132:133], v3 offset:6656
    ds_read_b64_tr_b16 v[134:135], v3 offset:6912
    s_add_u32 m0, s25, 7168
    s_nop 0
    buffer_load_dwordx4 v11, s[8:11], s27 offen lds
    v_mfma_f32_32x32x16_bf16 v[112:127], v[148:151], a[176:179], v[112:127]
    s_add_u32 m0, s25, 8192
    s_nop 0
    buffer_load_dwordx4 v12, s[8:11], s27 offen lds
    s_waitcnt lgkmcnt(14)
    v_mfma_f32_32x32x16_bf16 v[64:79], v[152:155], a[36:39], v[64:79]
    ds_read_b64_tr_b16 v[136:137], v3 offset:8192
    ds_read_b64_tr_b16 v[138:139], v3 offset:8448
    v_mfma_f32_32x32x16_bf16 v[80:95], v[152:155], a[180:183], v[80:95]
    s_waitcnt lgkmcnt(14)
    v_mfma_f32_32x32x16_bf16 v[96:111], v[156:159], a[36:39], v[96:111]
    ds_read_b64_tr_b16 v[140:141], v3 offset:8704
    ds_read_b64_tr_b16 v[142:143], v3 offset:8960
    v_mfma_f32_32x32x16_bf16 v[112:127], v[156:159], a[180:183], v[112:127]
    s_waitcnt lgkmcnt(14)
    v_mfma_f32_32x32x16_bf16 v[64:79], v[20:23], a[40:43], v[64:79]
    ds_read_b64_tr_b16 v[144:145], v3 offset:10240
    ds_read_b64_tr_b16 v[146:147], v3 offset:10496
    v_mfma_f32_32x32x16_bf16 v[80:95], v[20:23], a[184:187], v[80:95]
    buffer_load_dword v63, v62, s[64:67], s70 offen
    s_waitcnt lgkmcnt(14)
    v_mfma_f32_32x32x16_bf16 v[96:111], v[24:27], a[40:43], v[96:111]
    ds_read_b64_tr_b16 v[148:149], v3 offset:10752
    ds_read_b64_tr_b16 v[150:151], v3 offset:11008
    v_mfma_f32_32x32x16_bf16 v[112:127], v[24:27], a[184:187], v[112:127]
    s_waitcnt lgkmcnt(14)
    v_mfma_f32_32x32x16_bf16 v[64:79], v[28:31], a[44:47], v[64:79]
    ds_read_b64_tr_b16 v[152:153], v3 offset:12288
    ds_read_b64_tr_b16 v[154:155], v3 offset:12544
    v_mfma_f32_32x32x16_bf16 v[80:95], v[28:31], a[188:191], v[80:95]
    s_waitcnt lgkmcnt(14)
    v_mfma_f32_32x32x16_bf16 v[96:111], v[32:35], a[44:47], v[96:111]
    ds_read_b64_tr_b16 v[156:157], v3 offset:12800
    ds_read_b64_tr_b16 v[158:159], v3 offset:13056
    v_mfma_f32_32x32x16_bf16 v[112:127], v[32:35], a[188:191], v[112:127]
    s_waitcnt lgkmcnt(14)
    v_mfma_f32_32x32x16_bf16 v[64:79], v[128:131], a[48:51], v[64:79]
    s_waitcnt vmcnt(10)
    ds_add_u32 v19, v19
    s_add_u32 s57, s57, 0x98000
    ds_read_b64_tr_b16 v[20:21], v3 offset:14336
    ds_read_b64_tr_b16 v[22:23], v3 offset:14592
    v_mfma_f32_32x32x16_bf16 v[80:95], v[128:131], a[192:195], v[80:95]
    s_waitcnt lgkmcnt(15)
    v_mfma_f32_32x32x16_bf16 v[96:111], v[132:135], a[48:51], v[96:111]
    ds_read_b32 v18, v19
    ds_read_b64_tr_b16 v[24:25], v3 offset:14848
    ds_read_b64_tr_b16 v[26:27], v3 offset:15104
    v_mfma_f32_32x32x16_bf16 v[112:127], v[132:135], a[192:195], v[112:127]
    s_waitcnt lgkmcnt(15)
    v_mfma_f32_32x32x16_bf16 v[64:79], v[136:139], a[52:55], v[64:79]
    s_waitcnt lgkmcnt(2)
    v_readfirstlane_b32 s56, v18
    s_cmp_ge_u32 s56, s57
    s_cbranch_scc0 spin_g1_kernel_6
back_g1_kernel_7:
    s_add_u32 s18, s18, 36864
    s_cmp_eq_u32 s18, 147456
    s_cselect_b32 s18, 0, s18
    v_add_u32 v2, s18, v16
    s_cmp_ge_u32 s17, 1
    s_cselect_b32 s10, s16, 0
    s_add_u32 s25, s19, s23
    s_add_u32 s27, s20, 256
    s_add_u32 s19, s19, 36864
    s_cmp_eq_u32 s19, 147456
    s_cselect_b32 s19, 0, s19
    ds_read_b64_tr_b16 v[28:29], v3 offset:16384
    ds_read_b64_tr_b16 v[30:31], v3 offset:16640
    v_mfma_f32_32x32x16_bf16 v[80:95], v[136:139], a[196:199], v[80:95]
    s_add_u32 m0, s25, 0
    s_nop 0
    buffer_load_dwordx4 v4, s[8:11], s27 offen lds
    v_mfma_f32_32x32x16_bf16 v[96:111], v[140:143], a[52:55], v[96:111]
    ds_read_b64_tr_b16 v[32:33], v3 offset:16896
    ds_read_b64_tr_b16 v[34:35], v3 offset:17152
    v_mfma_f32_32x32x16_bf16 v[112:127], v[140:143], a[196:199], v[112:127]
    v_mfma_f32_32x32x16_bf16 v[64:79], v[144:147], a[56:59], v[64:79]
    ds_read_b64_tr_b16 v[128:129], v2 offset:0
    ds_read_b64_tr_b16 v[130:131], v2 offset:256
    s_add_u32 m0, s25, 1024
    s_nop 0
    buffer_load_dwordx4 v5, s[8:11], s27 offen lds
    v_mfma_f32_32x32x16_bf16 v[80:95], v[144:147], a[200:203], v[80:95]
    v_mfma_f32_32x32x16_bf16 v[96:111], v[148:151], a[56:59], v[96:111]
    ds_read_b64_tr_b16 v[132:133], v2 offset:512
    ds_read_b64_tr_b16 v[134:135], v2 offset:768
    v_mfma_f32_32x32x16_bf16 v[112:127], v[148:151], a[200:203], v[112:127]
    s_add_u32 m0, s25, 2048
    s_nop 0
    buffer_load_dwordx4 v6, s[8:11], s27 offen lds
    v_mfma_f32_32x32x16_bf16 v[64:79], v[152:155], a[60:63], v[64:79]
    ds_read_b64_tr_b16 v[136:137], v2 offset:2048
    ds_read_b64_tr_b16 v[138:139], v2 offset:2304
    v_mfma_f32_32x32x16_bf16 v[80:95], v[152:155], a[204:207], v[80:95]
    v_mfma_f32_32x32x16_bf16 v[96:111], v[156:159], a[60:63], v[96:111]
    ds_read_b64_tr_b16 v[140:141], v2 offset:2560
    ds_read_b64_tr_b16 v[142:143], v2 offset:2816
    s_add_u32 m0, s25, 3072
    s_nop 0
    buffer_load_dwordx4 v7, s[8:11], s27 offen lds
    v_mfma_f32_32x32x16_bf16 v[112:127], v[156:159], a[204:207], v[112:127]
    v_mfma_f32_32x32x16_bf16 v[64:79], v[20:23], a[64:67], v[64:79]
    ds_read_b64_tr_b16 v[144:145], v2 offset:4096
    ds_read_b64_tr_b16 v[146:147], v2 offset:4352
    v_mfma_f32_32x32x16_bf16 v[80:95], v[20:23], a[208:211], v[80:95]
    s_add_u32 m0, s25, 4096
    s_nop 0
    buffer_load_dwordx4 v8, s[8:11], s27 offen lds
    s_waitcnt lgkmcnt(14)
    v_mfma_f32_32x32x16_bf16 v[96:111], v[24:27], a[64:67], v[96:111]
    ds_read_b64_tr_b16 v[148:149], v2 offset:4608
    ds_read_b64_tr_b16 v[150:151], v2 offset:4864
    v_mfma_f32_32x32x16_bf16 v[112:127], v[24:27], a[208:211], v[112:127]
    s_waitcnt lgkmcnt(14)
    v_mfma_f32_32x32x16_bf16 v[64:79], v[28:31], a[68:71], v[64:79]
    ds_read_b64_tr_b16 v[152:153], v2 offset:6144
    ds_read_b64_tr_b16 v[154:155], v2 offset:6400
    s_add_u32 m0, s25, 5120
    s_nop 0
    buffer_load_dwordx4 v9, s[8:11], s27 offen lds
    v_mfma_f32_32x32x16_bf16 v[80:95], v[28:31], a[212:215], v[80:95]
    s_waitcnt lgkmcnt(14)
    v_mfma_f32_32x32x16_bf16 v[96:111], v[32:35], a[68:71], v[96:111]
    ds_read_b64_tr_b16 v[156:157], v2 offset:6656
    ds_read_b64_tr_b16 v[158:159], v2 offset:6912
    v_mfma_f32_32x32x16_bf16 v[112:127], v[32:35], a[212:215], v[112:127]
    s_add_u32 m0, s25, 6144
    s_nop 0
    buffer_load_dwordx4 v10, s[8:11], s27 offen lds
    s_waitcnt lgkmcnt(14)
    v_mfma_f32_32x32x16_bf16 v[64:79], v[128:131], a[72:75], v[64:79]
    s_waitcnt vmcnt(8)
    ds_add_u32 v19, v19
    s_add_u32 s57, s57, 0x98000
    ds_read_b64_tr_b16 v[20:21], v2 offset:8192
    ds_read_b64_tr_b16 v[22:23], v2 offset:8448
    v_mfma_f32_32x32x16_bf16 v[80:95], v[128:131], a[216:219], v[80:95]
    s_waitcnt lgkmcnt(15)
    v_mfma_f32_32x32x16_bf16 v[96:111], v[132:135], a[72:75], v[96:111]
    ds_read_b64_tr_b16 v[24:25], v2 offset:8704
    ds_read_b64_tr_b16 v[26:27], v2 offset:8960
    s_add_u32 m0, s25, 7168
    s_nop 0
    buffer_load_dwordx4 v11, s[8:11], s27 offen lds
    v_mfma_f32_32x32x16_bf16 v[112:127], v[132:135], a[216:219], v[112:127]
    s_waitcnt lgkmcnt(15)
    v_mfma_f32_32x32x16_bf16 v[64:79], v[136:139], a[76:79], v[64:79]
    ds_read_b64_tr_b16 v[28:29], v2 offset:10240
    ds_read_b64_tr_b16 v[30:31], v2 offset:10496
    v_mfma_f32_32x32x16_bf16 v[80:95], v[136:139], a[220:223], v[80:95]
    s_add_u32 m0, s25, 8192
    s_nop 0
    buffer_load_dwordx4 v12, s[8:11], s27 offen lds
    s_waitcnt lgkmcnt(15)
    v_mfma_f32_32x32x16_bf16 v[96:111], v[140:143], a[76:79], v[96:111]
    ds_read_b64_tr_b16 v[32:33], v2 offset:10752
    ds_read_b64_tr_b16 v[34:35], v2 offset:11008
    v_mfma_f32_32x32x16_bf16 v[112:127], v[140:143], a[220:223], v[112:127]
    s_waitcnt lgkmcnt(15)
    v_mfma_f32_32x32x16_bf16 v[64:79], v[144:147], a[80:83], v[64:79]
    ds_read_b64_tr_b16 v[128:129], v2 offset:12288
    ds_read_b64_tr_b16 v[130:131], v2 offset:12544
    v_mfma_f32_32x32x16_bf16 v[80:95], v[144:147], a[224:227], v[80:95]
    s_waitcnt lgkmcnt(15)
    v_mfma_f32_32x32x16_bf16 v[96:111], v[148:151], a[80:83], v[96:111]
    ds_read_b64_tr_b16 v[132:133], v2 offset:12800
    ds_read_b64_tr_b16 v[134:135], v2 offset:13056
    v_mfma_f32_32x32x16_bf16 v[112:127], v[148:151], a[224:227], v[112:127]
    s_waitcnt lgkmcnt(15)
    v_mfma_f32_32x32x16_bf16 v[64:79], v[152:155], a[84:87], v[64:79]
    ds_read_b64_tr_b16 v[136:137], v2 offset:14336
    ds_read_b64_tr_b16 v[138:139], v2 offset:14592
    v_mfma_f32_32x32x16_bf16 v[80:95], v[152:155], a[228:231], v[80:95]
    s_waitcnt lgkmcnt(15)
    v_mfma_f32_32x32x16_bf16 v[96:111], v[156:159], a[84:87], v[96:111]
    ds_read_b32 v18, v19
    ds_read_b64_tr_b16 v[140:141], v2 offset:14848
    ds_read_b64_tr_b16 v[142:143], v2 offset:15104
    v_mfma_f32_32x32x16_bf16 v[112:127], v[156:159], a[228:231], v[112:127]
    s_waitcnt lgkmcnt(15)
    v_mfma_f32_32x32x16_bf16 v[64:79], v[20:23], a[88:91], v[64:79]
    s_waitcnt lgkmcnt(2)
    v_readfirstlane_b32 s56, v18
    s_cmp_ge_u32 s56, s57
    s_cbranch_scc0 spin_g1_kernel_8
back_g1_kernel_9:
    s_add_u32 s18, s18, 36864
    s_cmp_eq_u32 s18, 147456
    s_cselect_b32 s18, 0, s18
    v_add_u32 v3, s18, v16
    s_cmp_ge_u32 s17, 1
    s_cselect_b32 s10, s16, 0
    s_add_u32 s25, s19, s23
    s_add_u32 s27, s20, 497920
    s_add_u32 s19, s19, 36864
    s_cmp_eq_u32 s19, 147456
    s_cselect_b32 s19, 0, s19
    ds_read_b64_tr_b16 v[144:145], v2 offset:16384
    ds_read_b64_tr_b16 v[146:147], v2 offset:16640
    v_mfma_f32_32x32x16_bf16 v[80:95], v[20:23], a[232:235], v[80:95]
    s_add_u32 m0, s25, 0
    s_nop 0
    buffer_load_dwordx4 v4, s[8:11], s27 offen lds
    v_mfma_f32_32x32x16_bf16 v[96:111], v[24:27], a[88:91], v[96:111]
    ds_read_b64_tr_b16 v[148:149], v2 offset:16896
    ds_read_b64_tr_b16 v[150:151], v2 offset:17152
    v_mfma_f32_32x32x16_bf16 v[112:127], v[24:27], a[232:235], v[112:127]
    v_mfma_f32_32x32x16_bf16 v[64:79], v[28:31], a[92:95], v[64:79]
    ds_read_b64_tr_b16 v[152:153], v3 offset:0
    ds_read_b64_tr_b16 v[154:155], v3 offset:256
    s_add_u32 m0, s25, 1024
    s_nop 0
    buffer_load_dwordx4 v5, s[8:11], s27 offen lds
    v_mfma_f32_32x32x16_bf16 v[80:95], v[28:31], a[236:239], v[80:95]
    v_mfma_f32_32x32x16_bf16 v[96:111], v[32:35], a[92:95], v[96:111]
    ds_read_b64_tr_b16 v[156:157], v3 offset:512
    ds_read_b64_tr_b16 v[158:159], v3 offset:768
    v_mfma_f32_32x32x16_bf16 v[112:127], v[32:35], a[236:239], v[112:127]
    s_add_u32 m0, s25, 2048
    s_nop 0
    buffer_load_dwordx4 v6, s[8:11], s27 offen lds
    v_mfma_f32_32x32x16_bf16 v[64:79], v[128:131], a[96:99], v[64:79]
    ds_read_b64_tr_b16 v[20:21], v3 offset:2048
    ds_read_b64_tr_b16 v[22:23], v3 offset:2304
    v_mfma_f32_32x32x16_bf16 v[80:95], v[128:131], a[240:243], v[80:95]
    v_mfma_f32_32x32x16_bf16 v[96:111], v[132:135], a[96:99], v[96:111]
    ds_read_b64_tr_b16 v[24:25], v3 offset:2560
    ds_read_b64_tr_b16 v[26:27], v3 offset:2816
    s_add_u32 m0, s25, 3072
    s_nop 0
    buffer_load_dwordx4 v7, s[8:11], s27 offen lds
    v_mfma_f32_32x32x16_bf16 v[112:127], v[132:135], a[240:243], v[112:127]
    v_mfma_f32_32x32x16_bf16 v[64:79], v[136:139], a[100:103], v[64:79]
    ds_read_b64_tr_b16 v[28:29], v3 offset:4096
    ds_read_b64_tr_b16 v[30:31], v3 offset:4352
    v_mfma_f32_32x32x16_bf16 v[80:95], v[136:139], a[244:247], v[80:95]
    s_add_u32 m0, s25, 4096
    s_nop 0
    buffer_load_dwordx4 v8, s[8:11], s27 offen lds
    s_waitcnt lgkmcnt(14)
    v_mfma_f32_32x32x16_bf16 v[96:111], v[140:143], a[100:103], v[96:111]
    ds_read_b64_tr_b16 v[32:33], v3 offset:4608
    ds_read_b64_tr_b16 v[34:35], v3 offset:4864
    v_mfma_f32_32x32x16_bf16 v[112:127], v[140:143], a[244:247], v[112:127]
    s_waitcnt lgkmcnt(14)
    v_mfma_f32_32x32x16_bf16 v[64:79], v[144:147], a[104:107], v[64:79]
    ds_read_b64_tr_b16 v[128:129], v3 offset:6144
    ds_read_b64_tr_b16 v[130:131], v3 offset:6400
    s_add_u32 m0, s25, 5120
    s_nop 0
    buffer_load_dwordx4 v9, s[8:11], s27 offen lds
    v_mfma_f32_32x32x16_bf16 v[80:95], v[144:147], a[248:251], v[80:95]
    s_waitcnt lgkmcnt(14)
    v_mfma_f32_32x32x16_bf16 v[96:111], v[148:151], a[104:107], v[96:111]
    ds_read_b64_tr_b16 v[132:133], v3 offset:6656
    ds_read_b64_tr_b16 v[134:135], v3 offset:6912
    v_mfma_f32_32x32x16_bf16 v[112:127], v[148:151], a[248:251], v[112:127]
    s_add_u32 m0, s25, 6144
    s_nop 0
    buffer_load_dwordx4 v10, s[8:11], s27 offen lds
    s_waitcnt lgkmcnt(14)
    v_mfma_f32_32x32x16_bf16 v[64:79], v[152:155], a[108:111], v[64:79]
    s_waitcnt vmcnt(7)
    ds_add_u32 v19, v19
    s_add_u32 s57, s57, 0x98000
    ds_read_b64_tr_b16 v[136:137], v3 offset:8192
    ds_read_b64_tr_b16 v[138:139], v3 offset:8448
    v_mfma_f32_32x32x16_bf16 v[80:95], v[152:155], a[252:255], v[80:95]
    s_waitcnt lgkmcnt(15)
    v_mfma_f32_32x32x16_bf16 v[96:111], v[156:159], a[108:111], v[96:111]
    ds_read_b64_tr_b16 v[140:141], v3 offset:8704
    ds_read_b64_tr_b16 v[142:143], v3 offset:8960
    s_add_u32 m0, s25, 7168
    s_nop 0
    buffer_load_dwordx4 v11, s[8:11], s27 offen lds
    v_mfma_f32_32x32x16_bf16 v[112:127], v[156:159], a[252:255], v[112:127]
    s_waitcnt lgkmcnt(15)
    v_mfma_f32_32x32x16_bf16 v[64:79], v[20:23], a[112:115], v[64:79]
    ds_read_b64_tr_b16 v[144:145], v3 offset:10240
    ds_read_b64_tr_b16 v[146:147], v3 offset:10496
    v_mfma_f32_32x32x16_bf16 v[80:95], v[20:23], v[224:227], v[80:95]
    s_add_u32 m0, s25, 8192
    s_nop 0
    buffer_load_dwordx4 v12, s[8:11], s27 offen lds
    s_waitcnt lgkmcnt(15)
    v_mfma_f32_32x32x16_bf16 v[96:111], v[24:27], a[112:115], v[96:111]
    ds_read_b64_tr_b16 v[148:149], v3 offset:10752
    ds_read_b64_tr_b16 v[150:151], v3 offset:11008
    v_mfma_f32_32x32x16_bf16 v[112:127], v[24:27], v[224:227], v[112:127]
    s_waitcnt lgkmcnt(15)
    v_mfma_f32_32x32x16_bf16 v[64:79], v[28:31], a[116:119], v[64:79]
    ds_read_b64_tr_b16 v[152:153], v3 offset:12288
    ds_read_b64_tr_b16 v[154:155], v3 offset:12544
    v_mfma_f32_32x32x16_bf16 v[80:95], v[28:31], v[228:231], v[80:95]
    s_waitcnt lgkmcnt(15)
    v_mfma_f32_32x32x16_bf16 v[96:111], v[32:35], a[116:119], v[96:111]
    ds_read_b64_tr_b16 v[156:157], v3 offset:12800
    ds_read_b64_tr_b16 v[158:159], v3 offset:13056
    v_mfma_f32_32x32x16_bf16 v[112:127], v[32:35], v[228:231], v[112:127]
    s_waitcnt lgkmcnt(15)
    v_mfma_f32_32x32x16_bf16 v[64:79], v[128:131], a[120:123], v[64:79]
    ds_read_b64_tr_b16 v[20:21], v3 offset:14336
    ds_read_b64_tr_b16 v[22:23], v3 offset:14592
    v_mfma_f32_32x32x16_bf16 v[80:95], v[128:131], v[232:235], v[80:95]
    s_waitcnt lgkmcnt(15)
    v_mfma_f32_32x32x16_bf16 v[96:111], v[132:135], a[120:123], v[96:111]
    ds_read_b32 v18, v19
    ds_read_b64_tr_b16 v[24:25], v3 offset:14848
    ds_read_b64_tr_b16 v[26:27], v3 offset:15104
    v_mfma_f32_32x32x16_bf16 v[112:127], v[132:135], v[232:235], v[112:127]
    s_waitcnt lgkmcnt(15)
    v_mfma_f32_32x32x16_bf16 v[64:79], v[136:139], a[124:127], v[64:79]
    s_waitcnt lgkmcnt(2)
    v_readfirstlane_b32 s56, v18
    s_cmp_ge_u32 s56, s57
    s_cbranch_scc0 spin_g1_kernel_10
back_g1_kernel_11:
    s_add_u32 s18, s18, 36864
    s_cmp_eq_u32 s18, 147456
    s_cselect_b32 s18, 0, s18
    v_add_u32 v2, s18, v16
    s_cmp_ge_u32 s17, 1
    s_cselect_b32 s10, s16, 0
    s_add_u32 s25, s19, s23
    s_add_u32 s27, s20, 995584
    s_add_u32 s19, s19, 36864
    s_cmp_eq_u32 s19, 147456
    s_cselect_b32 s19, 0, s19
    ds_read_b64_tr_b16 v[28:29], v3 offset:16384
    ds_read_b64_tr_b16 v[30:31], v3 offset:16640
    v_mfma_f32_32x32x16_bf16 v[80:95], v[136:139], v[236:239], v[80:95]
    s_add_u32 m0, s25, 0
    s_nop 0
    buffer_load_dwordx4 v4, s[8:11], s27 offen lds
    v_mfma_f32_32x32x16_bf16 v[96:111], v[140:143], a[124:127], v[96:111]
    ds_read_b64_tr_b16 v[32:33], v3 offset:16896
    ds_read_b64_tr_b16 v[34:35], v3 offset:17152
    v_mfma_f32_32x32x16_bf16 v[112:127], v[140:143], v[236:239], v[112:127]
    v_mfma_f32_32x32x16_bf16 v[64:79], v[144:147], a[128:131], v[64:79]
    ds_read_b64_tr_b16 v[128:129], v2 offset:0
    ds_read_b64_tr_b16 v[130:131], v2 offset:256
    s_add_u32 m0, s25, 1024
    s_nop 0
    buffer_load_dwordx4 v5, s[8:11], s27 offen lds
    v_mfma_f32_32x32x16_bf16 v[80:95], v[144:147], v[240:243], v[80:95]
    v_mfma_f32_32x32x16_bf16 v[96:111], v[148:151], a[128:131], v[96:111]
    ds_read_b64_tr_b16 v[132:133], v2 offset:512
    ds_read_b64_tr_b16 v[134:135], v2 offset:768
    v_mfma_f32_32x32x16_bf16 v[112:127], v[148:151], v[240:243], v[112:127]
    s_add_u32 m0, s25, 2048
    s_nop 0
    buffer_load_dwordx4 v6, s[8:11], s27 offen lds
    v_mfma_f32_32x32x16_bf16 v[64:79], v[152:155], a[132:135], v[64:79]
    ds_read_b64_tr_b16 v[136:137], v2 offset:2048
    ds_read_b64_tr_b16 v[138:139], v2 offset:2304
    v_mfma_f32_32x32x16_bf16 v[80:95], v[152:155], v[244:247], v[80:95]
    v_mfma_f32_32x32x16_bf16 v[96:111], v[156:159], a[132:135], v[96:111]
    ds_read_b64_tr_b16 v[140:141], v2 offset:2560
    ds_read_b64_tr_b16 v[142:143], v2 offset:2816
    s_add_u32 m0, s25, 3072
    s_nop 0
    buffer_load_dwordx4 v7, s[8:11], s27 offen lds
    v_mfma_f32_32x32x16_bf16 v[112:127], v[156:159], v[244:247], v[112:127]
    v_mfma_f32_32x32x16_bf16 v[64:79], v[20:23], a[136:139], v[64:79]
    ds_read_b64_tr_b16 v[144:145], v2 offset:4096
    ds_read_b64_tr_b16 v[146:147], v2 offset:4352
    v_mfma_f32_32x32x16_bf16 v[80:95], v[20:23], v[248:251], v[80:95]
    s_add_u32 m0, s25, 4096
    s_nop 0
    buffer_load_dwordx4 v8, s[8:11], s27 offen lds
    s_waitcnt lgkmcnt(14)
    v_mfma_f32_32x32x16_bf16 v[96:111], v[24:27], a[136:139], v[96:111]
    ds_read_b64_tr_b16 v[148:149], v2 offset:4608
    ds_read_b64_tr_b16 v[150:151], v2 offset:4864
    v_mfma_f32_32x32x16_bf16 v[112:127], v[24:27], v[248:251], v[112:127]
    s_waitcnt lgkmcnt(14)
    v_mfma_f32_32x32x16_bf16 v[64:79], v[28:31], a[140:143], v[64:79]
    ds_read_b64_tr_b16 v[152:153], v2 offset:6144
    ds_read_b64_tr_b16 v[154:155], v2 offset:6400
    s_add_u32 m0, s25, 5120
    s_nop 0
    buffer_load_dwordx4 v9, s[8:11], s27 offen lds
    v_mfma_f32_32x32x16_bf16 v[80:95], v[28:31], v[252:255], v[80:95]
    s_waitcnt lgkmcnt(14)
    v_mfma_f32_32x32x16_bf16 v[96:111], v[32:35], a[140:143], v[96:111]
    ds_read_b64_tr_b16 v[156:157], v2 offset:6656
    ds_read_b64_tr_b16 v[158:159], v2 offset:6912
    v_mfma_f32_32x32x16_bf16 v[112:127], v[32:35], v[252:255], v[112:127]
    s_add_u32 m0, s25, 6144
    s_nop 0
    buffer_load_dwordx4 v10, s[8:11], s27 offen lds
    s_add_u32 s20, s20, 256
    s_sub_u32 s17, s17, 1
    s_waitcnt lgkmcnt(14)
    v_mfma_f32_32x32x16_bf16 v[160:175], v[128:131], a[0:3], 0
    s_waitcnt vmcnt(7)
    ds_add_u32 v19, v19
    s_add_u32 s57, s57, 0x98000
    ds_read_b64_tr_b16 v[20:21], v2 offset:8192
    ds_read_b64_tr_b16 v[22:23], v2 offset:8448
    v_mfma_f32_32x32x16_bf16 v[176:191], v[128:131], a[144:147], 0
    s_waitcnt lgkmcnt(15)
    v_mfma_f32_32x32x16_bf16 v[192:207], v[132:135], a[0:3], 0
    ds_read_b64_tr_b16 v[24:25], v2 offset:8704
    ds_read_b64_tr_b16 v[26:27], v2 offset:8960
    s_add_u32 m0, s25, 7168
    s_nop 0
    buffer_load_dwordx4 v11, s[8:11], s27 offen lds
    v_cvt_pk_bf16_f32 v36, v64, v65
    v_mfma_f32_32x32x16_bf16 v[208:223], v[132:135], a[144:147], 0
    s_waitcnt lgkmcnt(15)
    v_mfma_f32_32x32x16_bf16 v[160:175], v[136:139], a[4:7], v[160:175]
    ds_read_b64_tr_b16 v[28:29], v2 offset:10240
    ds_read_b64_tr_b16 v[30:31], v2 offset:10496
    v_cvt_pk_bf16_f32 v37, v66, v67
    v_mfma_f32_32x32x16_bf16 v[176:191], v[136:139], a[148:151], v[176:191]
    s_add_u32 m0, s25, 8192
    s_nop 0
    buffer_load_dwordx4 v12, s[8:11], s27 offen lds
    s_waitcnt lgkmcnt(15)
    v_mfma_f32_32x32x16_bf16 v[192:207], v[140:143], a[4:7], v[192:207]
    ds_read_b64_tr_b16 v[32:33], v2 offset:10752
    ds_read_b64_tr_b16 v[34:35], v2 offset:11008
    v_cvt_pk_bf16_f32 v40, v68, v69
    v_mfma_f32_32x32x16_bf16 v[208:223], v[140:143], a[148:151], v[208:223]
    s_waitcnt lgkmcnt(15)
    v_mfma_f32_32x32x16_bf16 v[160:175], v[144:147], a[8:11], v[160:175]
    ds_read_b64_tr_b16 v[128:129], v2 offset:12288
    ds_read_b64_tr_b16 v[130:131], v2 offset:12544
    v_cvt_pk_bf16_f32 v41, v70, v71
    v_mfma_f32_32x32x16_bf16 v[176:191], v[144:147], a[152:155], v[176:191]
    s_waitcnt lgkmcnt(15)
    v_mfma_f32_32x32x16_bf16 v[192:207], v[148:151], a[8:11], v[192:207]
    ds_read_b64_tr_b16 v[132:133], v2 offset:12800
    ds_read_b64_tr_b16 v[134:135], v2 offset:13056
    v_cvt_pk_bf16_f32 v38, v72, v73
    v_mfma_f32_32x32x16_bf16 v[208:223], v[148:151], a[152:155], v[208:223]
    s_waitcnt lgkmcnt(15)
    v_mfma_f32_32x32x16_bf16 v[160:175], v[152:155], a[12:15], v[160:175]
    ds_read_b64_tr_b16 v[136:137], v2 offset:14336
    ds_read_b64_tr_b16 v[138:139], v2 offset:14592
    v_cvt_pk_bf16_f32 v39, v74, v75
    v_mfma_f32_32x32x16_bf16 v[176:191], v[152:155], a[156:159], v[176:191]
    s_waitcnt lgkmcnt(15)
    v_mfma_f32_32x32x16_bf16 v[192:207], v[156:159], a[12:15], v[192:207]
    ds_read_b32 v18, v19
    ds_read_b64_tr_b16 v[140:141], v2 offset:14848
    ds_read_b64_tr_b16 v[142:143], v2 offset:15104
    v_cvt_pk_bf16_f32 v42, v76, v77
    v_mfma_f32_32x32x16_bf16 v[208:223], v[156:159], a[156:159], v[208:223]
    s_waitcnt lgkmcnt(15)
    v_mfma_f32_32x32x16_bf16 v[160:175], v[20:23], a[16:19], v[160:175]
    s_waitcnt lgkmcnt(2)
    v_readfirstlane_b32 s56, v18
    s_cmp_ge_u32 s56, s57
    s_cbranch_scc0 spin_g1_kernel_12
back_g1_kernel_13:
    s_add_u32 s18, s18, 36864
    s_cmp_eq_u32 s18, 147456
    s_cselect_b32 s18, 0, s18
    v_add_u32 v3, s18, v16
    s_cmp_ge_u32 s17, 0
    s_cselect_b32 s10, s16, 0
    s_add_u32 s25, s19, s23
    s_add_u32 s27, s20, 1492992
    s_add_u32 s19, s19, 36864
    s_cmp_eq_u32 s19, 147456
    s_cselect_b32 s19, 0, s19
    ds_read_b64_tr_b16 v[144:145], v2 offset:16384
    ds_read_b64_tr_b16 v[146:147], v2 offset:16640
    v_cvt_pk_bf16_f32 v43, v78, v79
    v_mfma_f32_32x32x16_bf16 v[176:191], v[20:23], a[160:163], v[176:191]
    s_add_u32 m0, s25, 0
    s_nop 0
    buffer_load_dwordx4 v4, s[8:11], s27 offen lds
    v_mfma_f32_32x32x16_bf16 v[192:207], v[24:27], a[16:19], v[192:207]
    ds_read_b64_tr_b16 v[148:149], v2 offset:16896
    ds_read_b64_tr_b16 v[150:151], v2 offset:17152
    s_nop 1
    v_mfma_f32_32x32x16_bf16 v[208:223], v[24:27], a[160:163], v[208:223]
    v_mfma_f32_32x32x16_bf16 v[160:175], v[28:31], a[20:23], v[160:175]
    ds_read_b64_tr_b16 v[152:153], v3 offset:0
    ds_read_b64_tr_b16 v[154:155], v3 offset:256
    s_add_u32 m0, s25, 1024
    s_nop 0
    buffer_load_dwordx4 v5, s[8:11], s27 offen lds
    v_permlane32_swap_b32 v36, v38
    v_mfma_f32_32x32x16_bf16 v[176:191], v[28:31], a[164:167], v[176:191]
    v_mfma_f32_32x32x16_bf16 v[192:207], v[32:35], a[20:23], v[192:207]
    ds_read_b64_tr_b16 v[156:157], v3 offset:512
    ds_read_b64_tr_b16 v[158:159], v3 offset:768
    v_permlane32_swap_b32 v40, v42
    v_mfma_f32_32x32x16_bf16 v[208:223], v[32:35], a[164:167], v[208:223]
    s_add_u32 m0, s25, 2048
    s_nop 0
    buffer_load_dwordx4 v6, s[8:11], s27 offen lds
    v_mfma_f32_32x32x16_bf16 v[160:175], v[128:131], a[24:27], v[160:175]
    ds_read_b64_tr_b16 v[20:21], v3 offset:2048
    ds_read_b64_tr_b16 v[22:23], v3 offset:2304
    v_permlane32_swap_b32 v37, v39
    v_mfma_f32_32x32x16_bf16 v[176:191], v[128:131], a[168:171], v[176:191]
    v_mfma_f32_32x32x16_bf16 v[192:207], v[132:135], a[24:27], v[192:207]
    ds_read_b64_tr_b16 v[24:25], v3 offset:2560
    ds_read_b64_tr_b16 v[26:27], v3 offset:2816
    s_add_u32 m0, s25, 3072
    s_nop 0
    buffer_load_dwordx4 v7, s[8:11], s27 offen lds
    v_permlane32_swap_b32 v41, v43
    v_mfma_f32_32x32x16_bf16 v[208:223], v[132:135], a[168:171], v[208:223]
    v_mfma_f32_32x32x16_bf16 v[160:175], v[136:139], a[28:31], v[160:175]
    ds_read_b64_tr_b16 v[28:29], v3 offset:4096
    ds_read_b64_tr_b16 v[30:31], v3 offset:4352
    buffer_store_dwordx4 v[36:39], v13, s[12:15], s21 offen offset:0
    v_mfma_f32_32x32x16_bf16 v[176:191], v[136:139], a[172:175], v[176:191]
    s_add_u32 m0, s25, 4096
    s_nop 0
    buffer_load_dwordx4 v8, s[8:11], s27 offen lds
    s_waitcnt lgkmcnt(14)
    v_mfma_f32_32x32x16_bf16 v[192:207], v[140:143], a[28:31], v[192:207]
    ds_read_b64_tr_b16 v[32:33], v3 offset:4608
    ds_read_b64_tr_b16 v[34:35], v3 offset:4864
    v_mfma_f32_32x32x16_bf16 v[208:223], v[140:143], a[172:175], v[208:223]
    s_waitcnt lgkmcnt(14)
    v_mfma_f32_32x32x16_bf16 v[160:175], v[144:147], a[32:35], v[160:175]
    ds_read_b64_tr_b16 v[128:129], v3 offset:6144
    ds_read_b64_tr_b16 v[130:131], v3 offset:6400
    s_add_u32 m0, s25, 5120
    s_nop 0
    buffer_load_dwordx4 v9, s[8:11], s27 offen lds
    buffer_store_dwordx4 v[40:43], v13, s[12:15], s21 offen offset:16
    v_mfma_f32_32x32x16_bf16 v[176:191], v[144:147], a[176:179], v[176:191]
    s_waitcnt lgkmcnt(14)
    v_mfma_f32_32x32x16_bf16 v[192:207], v[148:151], a[32:35], v[192:207]
    ds_read_b64_tr_b16 v[132:133], v3 offset:6656
    ds_read_b64_tr_b16 v[134:135], v3 offset:6912
    v_mfma_f32_32x32x16_bf16 v[208:223], v[148:151], a[176:179], v[208:223]
    s_add_u32 m0, s25, 6144
    s_nop 0
    buffer_load_dwordx4 v10, s[8:11], s27 offen lds
    s_waitcnt lgkmcnt(14)
    v_mfma_f32_32x32x16_bf16 v[160:175], v[152:155], a[36:39], v[160:175]
    s_waitcnt vmcnt(9)
    ds_add_u32 v19, v19
    s_add_u32 s57, s57, 0x98000
    ds_read_b64_tr_b16 v[136:137], v3 offset:8192
    ds_read_b64_tr_b16 v[138:139], v3 offset:8448
    v_cvt_pk_bf16_f32 v44, v80, v81
    v_mfma_f32_32x32x16_bf16 v[176:191], v[152:155], a[180:183], v[176:191]
    s_waitcnt lgkmcnt(15)
    v_mfma_f32_32x32x16_bf16 v[192:207], v[156:159], a[36:39], v[192:207]
    ds_read_b64_tr_b16 v[140:141], v3 offset:8704
    ds_read_b64_tr_b16 v[142:143], v3 offset:8960
    s_add_u32 m0, s25, 7168
    s_nop 0
    buffer_load_dwordx4 v11, s[8:11], s27 offen lds
    v_cvt_pk_bf16_f32 v45, v82, v83
    v_mfma_f32_32x32x16_bf16 v[208:223], v[156:159], a[180:183], v[208:223]
    s_waitcnt lgkmcnt(15)
    v_mfma_f32_32x32x16_bf16 v[160:175], v[20:23], a[40:43], v[160:175]
    ds_read_b64_tr_b16 v[144:145], v3 offset:10240
    ds_read_b64_tr_b16 v[146:147], v3 offset:10496
    v_cvt_pk_bf16_f32 v48, v84, v85
    v_mfma_f32_32x32x16_bf16 v[176:191], v[20:23], a[184:187], v[176:191]
    s_add_u32 m0, s25, 8192
    s_nop 0
    buffer_load_dwordx4 v12, s[8:11], s27 offen lds
    s_waitcnt lgkmcnt(15)
    v_mfma_f32_32x32x16_bf16 v[192:207], v[24:27], a[40:43], v[192:207]
    ds_read_b64_tr_b16 v[148:149], v3 offset:10752
    ds_read_b64_tr_b16 v[150:151], v3 offset:11008
    v_cvt_pk_bf16_f32 v49, v86, v87
    v_mfma_f32_32x32x16_bf16 v[208:223], v[24:27], a[184:187], v[208:223]
    s_waitcnt lgkmcnt(15)
    v_mfma_f32_32x32x16_bf16 v[160:175], v[28:31], a[44:47], v[160:175]
    ds_read_b64_tr_b16 v[152:153], v3 offset:12288
    ds_read_b64_tr_b16 v[154:155], v3 offset:12544
    v_cvt_pk_bf16_f32 v46, v88, v89
    v_mfma_f32_32x32x16_bf16 v[176:191], v[28:31], a[188:191], v[176:191]
    s_waitcnt lgkmcnt(15)
    v_mfma_f32_32x32x16_bf16 v[192:207], v[32:35], a[44:47], v[192:207]
    ds_read_b64_tr_b16 v[156:157], v3 offset:12800
    ds_read_b64_tr_b16 v[158:159], v3 offset:13056
    v_cvt_pk_bf16_f32 v47, v90, v91
    v_mfma_f32_32x32x16_bf16 v[208:223], v[32:35], a[188:191], v[208:223]
    s_waitcnt lgkmcnt(15)
    v_mfma_f32_32x32x16_bf16 v[160:175], v[128:131], a[48:51], v[160:175]
    ds_read_b64_tr_b16 v[20:21], v3 offset:14336
    ds_read_b64_tr_b16 v[22:23], v3 offset:14592
    v_cvt_pk_bf16_f32 v50, v92, v93
    v_mfma_f32_32x32x16_bf16 v[176:191], v[128:131], a[192:195], v[176:191]
    s_waitcnt lgkmcnt(15)
    v_mfma_f32_32x32x16_bf16 v[192:207], v[132:135], a[48:51], v[192:207]
    ds_read_b32 v18, v19
    ds_read_b64_tr_b16 v[24:25], v3 offset:14848
    ds_read_b64_tr_b16 v[26:27], v3 offset:15104
    v_cvt_pk_bf16_f32 v51, v94, v95
    v_mfma_f32_32x32x16_bf16 v[208:223], v[132:135], a[192:195], v[208:223]
    s_waitcnt lgkmcnt(15)
    v_mfma_f32_32x32x16_bf16 v[160:175], v[136:139], a[52:55], v[160:175]
    s_waitcnt lgkmcnt(2)
    v_readfirstlane_b32 s56, v18
    s_cmp_ge_u32 s56, s57
    s_cbranch_scc0 spin_g1_kernel_14
back_g1_kernel_15:
    s_add_u32 s18, s18, 36864
    s_cmp_eq_u32 s18, 147456
    s_cselect_b32 s18, 0, s18
    v_add_u32 v2, s18, v16
    s_cmp_ge_u32 s17, 1
    s_cselect_b32 s10, s16, 0
    s_add_u32 s25, s19, s23
    s_add_u32 s27, s20, 256
    s_add_u32 s19, s19, 36864
    s_cmp_eq_u32 s19, 147456
    s_cselect_b32 s19, 0, s19
    ds_read_b64_tr_b16 v[28:29], v3 offset:16384
    ds_read_b64_tr_b16 v[30:31], v3 offset:16640
    s_nop 1
    v_mfma_f32_32x32x16_bf16 v[176:191], v[136:139], a[196:199], v[176:191]
    s_add_u32 m0, s25, 0
    s_nop 0
    buffer_load_dwordx4 v4, s[8:11], s27 offen lds
    v_mfma_f32_32x32x16_bf16 v[192:207], v[140:143], a[52:55], v[192:207]
    ds_read_b64_tr_b16 v[32:33], v3 offset:16896
    ds_read_b64_tr_b16 v[34:35], v3 offset:17152
    v_permlane32_swap_b32 v44, v46
    v_mfma_f32_32x32x16_bf16 v[208:223], v[140:143], a[196:199], v[208:223]
    v_mfma_f32_32x32x16_bf16 v[160:175], v[144:147], a[56:59], v[160:175]
    ds_read_b64_tr_b16 v[128:129], v2 offset:0
    ds_read_b64_tr_b16 v[130:131], v2 offset:256
    s_add_u32 m0, s25, 1024
    s_nop 0
    buffer_load_dwordx4 v5, s[8:11], s27 offen lds
    v_permlane32_swap_b32 v48, v50
    v_mfma_f32_32x32x16_bf16 v[176:191], v[144:147], a[200:203], v[176:191]
    v_mfma_f32_32x32x16_bf16 v[192:207], v[148:151], a[56:59], v[192:207]
    ds_read_b64_tr_b16 v[132:133], v2 offset:512
    ds_read_b64_tr_b16 v[134:135], v2 offset:768
    v_permlane32_swap_b32 v45, v47
    v_mfma_f32_32x32x16_bf16 v[208:223], v[148:151], a[200:203], v[208:223]
    s_add_u32 m0, s25, 2048
    s_nop 0
    buffer_load_dwordx4 v6, s[8:11], s27 offen lds
    v_mfma_f32_32x32x16_bf16 v[160:175], v[152:155], a[60:63], v[160:175]
    ds_read_b64_tr_b16 v[136:137], v2 offset:2048
    ds_read_b64_tr_b16 v[138:139], v2 offset:2304
    v_permlane32_swap_b32 v49, v51
    v_mfma_f32_32x32x16_bf16 v[176:191], v[152:155], a[204:207], v[176:191]
    v_mfma_f32_32x32x16_bf16 v[192:207], v[156:159], a[60:63], v[192:207]
    ds_read_b64_tr_b16 v[140:141], v2 offset:2560
    ds_read_b64_tr_b16 v[142:143], v2 offset:2816
    s_add_u32 m0, s25, 3072
    s_nop 0
    buffer_load_dwordx4 v7, s[8:11], s27 offen lds
    buffer_store_dwordx4 v[44:47], v13, s[12:15], s22 offen offset:0
    v_mfma_f32_32x32x16_bf16 v[208:223], v[156:159], a[204:207], v[208:223]
    v_mfma_f32_32x32x16_bf16 v[160:175], v[20:23], a[64:67], v[160:175]
    ds_read_b64_tr_b16 v[144:145], v2 offset:4096
    ds_read_b64_tr_b16 v[146:147], v2 offset:4352
    v_mfma_f32_32x32x16_bf16 v[176:191], v[20:23], a[208:211], v[176:191]
    s_add_u32 m0, s25, 4096
    s_nop 0
    buffer_load_dwordx4 v8, s[8:11], s27 offen lds
    s_waitcnt lgkmcnt(14)
    v_mfma_f32_32x32x16_bf16 v[192:207], v[24:27], a[64:67], v[192:207]
    ds_read_b64_tr_b16 v[148:149], v2 offset:4608
    ds_read_b64_tr_b16 v[150:151], v2 offset:4864
    buffer_store_dwordx4 v[48:51], v13, s[12:15], s22 offen offset:16
    v_mfma_f32_32x32x16_bf16 v[208:223], v[24:27], a[208:211], v[208:223]
    s_waitcnt lgkmcnt(14)
    v_mfma_f32_32x32x16_bf16 v[160:175], v[28:31], a[68:71], v[160:175]
    ds_read_b64_tr_b16 v[152:153], v2 offset:6144
    ds_read_b64_tr_b16 v[154:155], v2 offset:6400
    s_add_u32 m0, s25, 5120
    s_nop 0
    buffer_load_dwordx4 v9, s[8:11], s27 offen lds
    v_mfma_f32_32x32x16_bf16 v[176:191], v[28:31], a[212:215], v[176:191]
    s_waitcnt lgkmcnt(14)
    v_mfma_f32_32x32x16_bf16 v[192:207], v[32:35], a[68:71], v[192:207]
    ds_read_b64_tr_b16 v[156:157], v2 offset:6656
    ds_read_b64_tr_b16 v[158:159], v2 offset:6912
    v_cvt_pk_bf16_f32 v36, v96, v97
    v_mfma_f32_32x32x16_bf16 v[208:223], v[32:35], a[212:215], v[208:223]
    s_add_u32 m0, s25, 6144
    s_nop 0
    buffer_load_dwordx4 v10, s[8:11], s27 offen lds
    s_waitcnt lgkmcnt(14)
    v_mfma_f32_32x32x16_bf16 v[160:175], v[128:131], a[72:75], v[160:175]
    s_waitcnt vmcnt(9)
    ds_add_u32 v19, v19
    s_add_u32 s57, s57, 0x98000
    ds_read_b64_tr_b16 v[20:21], v2 offset:8192
    ds_read_b64_tr_b16 v[22:23], v2 offset:8448
    v_cvt_pk_bf16_f32 v37, v98, v99
    v_mfma_f32_32x32x16_bf16 v[176:191], v[128:131], a[216:219], v[176:191]
    s_waitcnt lgkmcnt(15)
    v_mfma_f32_32x32x16_bf16 v[192:207], v[132:135], a[72:75], v[192:207]
    ds_read_b64_tr_b16 v[24:25], v2 offset:8704
    ds_read_b64_tr_b16 v[26:27], v2 offset:8960
    s_add_u32 m0, s25, 7168
    s_nop 0
    buffer_load_dwordx4 v11, s[8:11], s27 offen lds
    v_cvt_pk_bf16_f32 v40, v100, v101
    v_mfma_f32_32x32x16_bf16 v[208:223], v[132:135], a[216:219], v[208:223]
    s_waitcnt lgkmcnt(15)
    v_mfma_f32_32x32x16_bf16 v[160:175], v[136:139], a[76:79], v[160:175]
    ds_read_b64_tr_b16 v[28:29], v2 offset:10240
    ds_read_b64_tr_b16 v[30:31], v2 offset:10496
    v_cvt_pk_bf16_f32 v41, v102, v103
    v_mfma_f32_32x32x16_bf16 v[176:191], v[136:139], a[220:223], v[176:191]
    s_add_u32 m0, s25, 8192
    s_nop 0
    buffer_load_dwordx4 v12, s[8:11], s27 offen lds
    s_waitcnt lgkmcnt(15)
    v_mfma_f32_32x32x16_bf16 v[192:207], v[140:143], a[76:79], v[192:207]
    ds_read_b64_tr_b16 v[32:33], v2 offset:10752
    ds_read_b64_tr_b16 v[34:35], v2 offset:11008
    v_cvt_pk_bf16_f32 v38, v104, v105
    v_mfma_f32_32x32x16_bf16 v[208:223], v[140:143], a[220:223], v[208:223]
    s_waitcnt lgkmcnt(15)
    v_mfma_f32_32x32x16_bf16 v[160:175], v[144:147], a[80:83], v[160:175]
    ds_read_b64_tr_b16 v[128:129], v2 offset:12288
    ds_read_b64_tr_b16 v[130:131], v2 offset:12544
    v_cvt_pk_bf16_f32 v39, v106, v107
    v_mfma_f32_32x32x16_bf16 v[176:191], v[144:147], a[224:227], v[176:191]
    s_waitcnt lgkmcnt(15)
    v_mfma_f32_32x32x16_bf16 v[192:207], v[148:151], a[80:83], v[192:207]
    ds_read_b64_tr_b16 v[132:133], v2 offset:12800
    ds_read_b64_tr_b16 v[134:135], v2 offset:13056
    v_cvt_pk_bf16_f32 v42, v108, v109
    v_mfma_f32_32x32x16_bf16 v[208:223], v[148:151], a[224:227], v[208:223]
    s_waitcnt lgkmcnt(15)
    v_mfma_f32_32x32x16_bf16 v[160:175], v[152:155], a[84:87], v[160:175]
    ds_read_b64_tr_b16 v[136:137], v2 offset:14336
    ds_read_b64_tr_b16 v[138:139], v2 offset:14592
    v_cvt_pk_bf16_f32 v43, v110, v111
    v_mfma_f32_32x32x16_bf16 v[176:191], v[152:155], a[228:231], v[176:191]
    s_waitcnt lgkmcnt(15)
    v_mfma_f32_32x32x16_bf16 v[192:207], v[156:159], a[84:87], v[192:207]
    ds_read_b32 v18, v19
    ds_read_b64_tr_b16 v[140:141], v2 offset:14848
    ds_read_b64_tr_b16 v[142:143], v2 offset:15104
    s_nop 1
    v_mfma_f32_32x32x16_bf16 v[208:223], v[156:159], a[228:231], v[208:223]
    s_waitcnt lgkmcnt(15)
    v_mfma_f32_32x32x16_bf16 v[160:175], v[20:23], a[88:91], v[160:175]
    s_waitcnt lgkmcnt(2)
    v_readfirstlane_b32 s56, v18
    s_cmp_ge_u32 s56, s57
    s_cbranch_scc0 spin_g1_kernel_16
back_g1_kernel_17:
    s_add_u32 s18, s18, 36864
    s_cmp_eq_u32 s18, 147456
    s_cselect_b32 s18, 0, s18
    v_add_u32 v3, s18, v16
    s_cmp_ge_u32 s17, 1
    s_cselect_b32 s10, s16, 0
    s_add_u32 s25, s19, s23
    s_add_u32 s27, s20, 497920
    s_add_u32 s19, s19, 36864
    s_cmp_eq_u32 s19, 147456
    s_cselect_b32 s19, 0, s19
    ds_read_b64_tr_b16 v[144:145], v2 offset:16384
    ds_read_b64_tr_b16 v[146:147], v2 offset:16640
    v_permlane32_swap_b32 v36, v38
    v_mfma_f32_32x32x16_bf16 v[176:191], v[20:23], a[232:235], v[176:191]
    s_add_u32 m0, s25, 0
    s_nop 0
    buffer_load_dwordx4 v4, s[8:11], s27 offen lds
    v_mfma_f32_32x32x16_bf16 v[192:207], v[24:27], a[88:91], v[192:207]
    ds_read_b64_tr_b16 v[148:149], v2 offset:16896
    ds_read_b64_tr_b16 v[150:151], v2 offset:17152
    v_permlane32_swap_b32 v40, v42
    v_mfma_f32_32x32x16_bf16 v[208:223], v[24:27], a[232:235], v[208:223]
    v_mfma_f32_32x32x16_bf16 v[160:175], v[28:31], a[92:95], v[160:175]
    ds_read_b64_tr_b16 v[152:153], v3 offset:0
    ds_read_b64_tr_b16 v[154:155], v3 offset:256
    s_add_u32 m0, s25, 1024
    s_nop 0
    buffer_load_dwordx4 v5, s[8:11], s27 offen lds
    v_permlane32_swap_b32 v37, v39
    v_mfma_f32_32x32x16_bf16 v[176:191], v[28:31], a[236:239], v[176:191]
    v_mfma_f32_32x32x16_bf16 v[192:207], v[32:35], a[92:95], v[192:207]
    ds_read_b64_tr_b16 v[156:157], v3 offset:512
    ds_read_b64_tr_b16 v[158:159], v3 offset:768
    v_permlane32_swap_b32 v41, v43
    v_mfma_f32_32x32x16_bf16 v[208:223], v[32:35], a[236:239], v[208:223]
    s_add_u32 m0, s25, 2048
    s_nop 0
    buffer_load_dwordx4 v6, s[8:11], s27 offen lds
    v_mfma_f32_32x32x16_bf16 v[160:175], v[128:131], a[96:99], v[160:175]
    ds_read_b64_tr_b16 v[20:21], v3 offset:2048
    ds_read_b64_tr_b16 v[22:23], v3 offset:2304
    buffer_store_dwordx4 v[36:39], v13, s[12:15], s21 offen offset:64
    v_mfma_f32_32x32x16_bf16 v[176:191], v[128:131], a[240:243], v[176:191]
    v_mfma_f32_32x32x16_bf16 v[192:207], v[132:135], a[96:99], v[192:207]
    ds_read_b64_tr_b16 v[24:25], v3 offset:2560
    ds_read_b64_tr_b16 v[26:27], v3 offset:2816
    s_add_u32 m0, s25, 3072
    s_nop 0
    buffer_load_dwordx4 v7, s[8:11], s27 offen lds
    v_mfma_f32_32x32x16_bf16 v[208:223], v[132:135], a[240:243], v[208:223]
    v_mfma_f32_32x32x16_bf16 v[160:175], v[136:139], a[100:103], v[160:175]
    ds_read_b64_tr_b16 v[28:29], v3 offset:4096
    ds_read_b64_tr_b16 v[30:31], v3 offset:4352
    buffer_store_dwordx4 v[40:43], v13, s[12:15], s21 offen offset:80
    v_mfma_f32_32x32x16_bf16 v[176:191], v[136:139], a[244:247], v[176:191]
    s_add_u32 m0, s25, 4096
    s_nop 0
    buffer_load_dwordx4 v8, s[8:11], s27 offen lds
    s_waitcnt lgkmcnt(14)
    v_mfma_f32_32x32x16_bf16 v[192:207], v[140:143], a[100:103], v[192:207]
    ds_read_b64_tr_b16 v[32:33], v3 offset:4608
    ds_read_b64_tr_b16 v[34:35], v3 offset:4864
    v_mfma_f32_32x32x16_bf16 v[208:223], v[140:143], a[244:247], v[208:223]
    s_waitcnt lgkmcnt(14)
    v_mfma_f32_32x32x16_bf16 v[160:175], v[144:147], a[104:107], v[160:175]
    ds_read_b64_tr_b16 v[128:129], v3 offset:6144
    ds_read_b64_tr_b16 v[130:131], v3 offset:6400
    s_add_u32 m0, s25, 5120
    s_nop 0
    buffer_load_dwordx4 v9, s[8:11], s27 offen lds
    v_cvt_pk_bf16_f32 v44, v112, v113
    v_mfma_f32_32x32x16_bf16 v[176:191], v[144:147], a[248:251], v[176:191]
    s_waitcnt lgkmcnt(14)
    v_mfma_f32_32x32x16_bf16 v[192:207], v[148:151], a[104:107], v[192:207]
    ds_read_b64_tr_b16 v[132:133], v3 offset:6656
    ds_read_b64_tr_b16 v[134:135], v3 offset:6912
    v_cvt_pk_bf16_f32 v45, v114, v115
    v_mfma_f32_32x32x16_bf16 v[208:223], v[148:151], a[248:251], v[208:223]
    s_add_u32 m0, s25, 6144
    s_nop 0
    buffer_load_dwordx4 v10, s[8:11], s27 offen lds
    s_waitcnt lgkmcnt(14)
    v_mfma_f32_32x32x16_bf16 v[160:175], v[152:155], a[108:111], v[160:175]
    s_waitcnt vmcnt(9)
    ds_add_u32 v19, v19
    s_add_u32 s57, s57, 0x98000
    ds_read_b64_tr_b16 v[136:137], v3 offset:8192
    ds_read_b64_tr_b16 v[138:139], v3 offset:8448
    v_cvt_pk_bf16_f32 v48, v116, v117
    v_mfma_f32_32x32x16_bf16 v[176:191], v[152:155], a[252:255], v[176:191]
    s_waitcnt lgkmcnt(15)
    v_mfma_f32_32x32x16_bf16 v[192:207], v[156:159], a[108:111], v[192:207]
    ds_read_b64_tr_b16 v[140:141], v3 offset:8704
    ds_read_b64_tr_b16 v[142:143], v3 offset:8960
    s_add_u32 m0, s25, 7168
    s_nop 0
    buffer_load_dwordx4 v11, s[8:11], s27 offen lds
    v_cvt_pk_bf16_f32 v49, v118, v119
    v_mfma_f32_32x32x16_bf16 v[208:223], v[156:159], a[252:255], v[208:223]
    s_waitcnt lgkmcnt(15)
    v_mfma_f32_32x32x16_bf16 v[160:175], v[20:23], a[112:115], v[160:175]
    ds_read_b64_tr_b16 v[144:145], v3 offset:10240
    ds_read_b64_tr_b16 v[146:147], v3 offset:10496
    v_cvt_pk_bf16_f32 v46, v120, v121
    v_mfma_f32_32x32x16_bf16 v[176:191], v[20:23], v[224:227], v[176:191]
    s_add_u32 m0, s25, 8192
    s_nop 0
    buffer_load_dwordx4 v12, s[8:11], s27 offen lds
    s_waitcnt lgkmcnt(15)
    v_mfma_f32_32x32x16_bf16 v[192:207], v[24:27], a[112:115], v[192:207]
    ds_read_b64_tr_b16 v[148:149], v3 offset:10752
    ds_read_b64_tr_b16 v[150:151], v3 offset:11008
    v_cvt_pk_bf16_f32 v47, v122, v123
    v_mfma_f32_32x32x16_bf16 v[208:223], v[24:27], v[224:227], v[208:223]
    s_waitcnt lgkmcnt(15)
    v_mfma_f32_32x32x16_bf16 v[160:175], v[28:31], a[116:119], v[160:175]
    ds_read_b64_tr_b16 v[152:153], v3 offset:12288
    ds_read_b64_tr_b16 v[154:155], v3 offset:12544
    v_cvt_pk_bf16_f32 v50, v124, v125
    v_mfma_f32_32x32x16_bf16 v[176:191], v[28:31], v[228:231], v[176:191]
    s_waitcnt lgkmcnt(15)
    v_mfma_f32_32x32x16_bf16 v[192:207], v[32:35], a[116:119], v[192:207]
    ds_read_b64_tr_b16 v[156:157], v3 offset:12800
    ds_read_b64_tr_b16 v[158:159], v3 offset:13056
    v_cvt_pk_bf16_f32 v51, v126, v127
    v_mfma_f32_32x32x16_bf16 v[208:223], v[32:35], v[228:231], v[208:223]
    s_waitcnt lgkmcnt(15)
    v_mfma_f32_32x32x16_bf16 v[160:175], v[128:131], a[120:123], v[160:175]
    ds_read_b64_tr_b16 v[20:21], v3 offset:14336
    ds_read_b64_tr_b16 v[22:23], v3 offset:14592
    s_nop 1
    v_mfma_f32_32x32x16_bf16 v[176:191], v[128:131], v[232:235], v[176:191]
    s_waitcnt lgkmcnt(15)
    v_mfma_f32_32x32x16_bf16 v[192:207], v[132:135], a[120:123], v[192:207]
    ds_read_b32 v18, v19
    ds_read_b64_tr_b16 v[24:25], v3 offset:14848
    ds_read_b64_tr_b16 v[26:27], v3 offset:15104
    v_permlane32_swap_b32 v44, v46
    v_mfma_f32_32x32x16_bf16 v[208:223], v[132:135], v[232:235], v[208:223]
    s_waitcnt lgkmcnt(15)
    v_mfma_f32_32x32x16_bf16 v[160:175], v[136:139], a[124:127], v[160:175]
    s_waitcnt lgkmcnt(2)
    v_readfirstlane_b32 s56, v18
    s_cmp_ge_u32 s56, s57
    s_cbranch_scc0 spin_g1_kernel_18
back_g1_kernel_19:
    s_add_u32 s18, s18, 36864
    s_cmp_eq_u32 s18, 147456
    s_cselect_b32 s18, 0, s18
    v_add_u32 v2, s18, v16
    s_cmp_ge_u32 s17, 1
    s_cselect_b32 s10, s16, 0
    s_add_u32 s25, s19, s23
    s_add_u32 s27, s20, 995584
    s_add_u32 s19, s19, 36864
    s_cmp_eq_u32 s19, 147456
    s_cselect_b32 s19, 0, s19
    ds_read_b64_tr_b16 v[28:29], v3 offset:16384
    ds_read_b64_tr_b16 v[30:31], v3 offset:16640
    v_permlane32_swap_b32 v48, v50
    v_mfma_f32_32x32x16_bf16 v[176:191], v[136:139], v[236:239], v[176:191]
    s_add_u32 m0, s25, 0
    s_nop 0
    buffer_load_dwordx4 v4, s[8:11], s27 offen lds
    v_mfma_f32_32x32x16_bf16 v[192:207], v[140:143], a[124:127], v[192:207]
    ds_read_b64_tr_b16 v[32:33], v3 offset:16896
    ds_read_b64_tr_b16 v[34:35], v3 offset:17152
    v_permlane32_swap_b32 v45, v47
    v_mfma_f32_32x32x16_bf16 v[208:223], v[140:143], v[236:239], v[208:223]
    v_mfma_f32_32x32x16_bf16 v[160:175], v[144:147], a[128:131], v[160:175]
    ds_read_b64_tr_b16 v[128:129], v2 offset:0
    ds_read_b64_tr_b16 v[130:131], v2 offset:256
    s_add_u32 m0, s25, 1024
    s_nop 0
    buffer_load_dwordx4 v5, s[8:11], s27 offen lds
    v_permlane32_swap_b32 v49, v51
    v_mfma_f32_32x32x16_bf16 v[176:191], v[144:147], v[240:243], v[176:191]
    v_mfma_f32_32x32x16_bf16 v[192:207], v[148:151], a[128:131], v[192:207]
    ds_read_b64_tr_b16 v[132:133], v2 offset:512
    ds_read_b64_tr_b16 v[134:135], v2 offset:768
    buffer_store_dwordx4 v[44:47], v13, s[12:15], s22 offen offset:64
    v_mfma_f32_32x32x16_bf16 v[208:223], v[148:151], v[240:243], v[208:223]
    s_add_u32 m0, s25, 2048
    s_nop 0
    buffer_load_dwordx4 v6, s[8:11], s27 offen lds
    v_mfma_f32_32x32x16_bf16 v[160:175], v[152:155], a[132:135], v[160:175]
    ds_read_b64_tr_b16 v[136:137], v2 offset:2048
    ds_read_b64_tr_b16 v[138:139], v2 offset:2304
    v_mfma_f32_32x32x16_bf16 v[176:191], v[152:155], v[244:247], v[176:191]
    v_mfma_f32_32x32x16_bf16 v[192:207], v[156:159], a[132:135], v[192:207]
    ds_read_b64_tr_b16 v[140:141], v2 offset:2560
    ds_read_b64_tr_b16 v[142:143], v2 offset:2816
    s_add_u32 m0, s25, 3072
    s_nop 0
    buffer_load_dwordx4 v7, s[8:11], s27 offen lds
    buffer_store_dwordx4 v[48:51], v13, s[12:15], s22 offen offset:80
    v_mfma_f32_32x32x16_bf16 v[208:223], v[156:159], v[244:247], v[208:223]
    v_mfma_f32_32x32x16_bf16 v[160:175], v[20:23], a[136:139], v[160:175]
    ds_read_b64_tr_b16 v[144:145], v2 offset:4096
    ds_read_b64_tr_b16 v[146:147], v2 offset:4352
    v_mfma_f32_32x32x16_bf16 v[176:191], v[20:23], v[248:251], v[176:191]
    s_add_u32 m0, s25, 4096
    s_nop 0
    buffer_load_dwordx4 v8, s[8:11], s27 offen lds
    s_waitcnt lgkmcnt(14)
    v_mfma_f32_32x32x16_bf16 v[192:207], v[24:27], a[136:139], v[192:207]
    ds_read_b64_tr_b16 v[148:149], v2 offset:4608
    ds_read_b64_tr_b16 v[150:151], v2 offset:4864
    s_add_u32 s21, s21, 256
    v_mfma_f32_32x32x16_bf16 v[208:223], v[24:27], v[248:251], v[208:223]
    s_waitcnt lgkmcnt(14)
    v_mfma_f32_32x32x16_bf16 v[160:175], v[28:31], a[140:143], v[160:175]
    ds_read_b64_tr_b16 v[152:153], v2 offset:6144
    ds_read_b64_tr_b16 v[154:155], v2 offset:6400
    s_add_u32 m0, s25, 5120
    s_nop 0
    buffer_load_dwordx4 v9, s[8:11], s27 offen lds
    s_add_u32 s22, s22, 256
    v_mfma_f32_32x32x16_bf16 v[176:191], v[28:31], v[252:255], v[176:191]
    s_waitcnt lgkmcnt(14)
    v_mfma_f32_32x32x16_bf16 v[192:207], v[32:35], a[140:143], v[192:207]
    ds_read_b64_tr_b16 v[156:157], v2 offset:6656
    ds_read_b64_tr_b16 v[158:159], v2 offset:6912
    v_mfma_f32_32x32x16_bf16 v[208:223], v[32:35], v[252:255], v[208:223]
    s_add_u32 m0, s25, 6144
    s_nop 0
    buffer_load_dwordx4 v10, s[8:11], s27 offen lds
    s_add_u32 s20, s20, 256
    s_sub_u32 s17, s17, 1
    s_waitcnt lgkmcnt(14)
    v_mfma_f32_32x32x16_bf16 v[64:79], v[128:131], a[0:3], 0
    s_waitcnt vmcnt(9)
    ds_add_u32 v19, v19
    s_add_u32 s57, s57, 0x98000
    ds_read_b64_tr_b16 v[20:21], v2 offset:8192
    ds_read_b64_tr_b16 v[22:23], v2 offset:8448
    v_mfma_f32_32x32x16_bf16 v[80:95], v[128:131], a[144:147], 0
    s_waitcnt lgkmcnt(15)
    v_mfma_f32_32x32x16_bf16 v[96:111], v[132:135], a[0:3], 0
    ds_read_b64_tr_b16 v[24:25], v2 offset:8704
    ds_read_b64_tr_b16 v[26:27], v2 offset:8960
    s_add_u32 m0, s25, 7168
    s_nop 0
    buffer_load_dwordx4 v11, s[8:11], s27 offen lds
    v_cvt_pk_bf16_f32 v36, v160, v161
    v_mfma_f32_32x32x16_bf16 v[112:127], v[132:135], a[144:147], 0
    s_waitcnt lgkmcnt(15)
    v_mfma_f32_32x32x16_bf16 v[64:79], v[136:139], a[4:7], v[64:79]
    ds_read_b64_tr_b16 v[28:29], v2 offset:10240
    ds_read_b64_tr_b16 v[30:31], v2 offset:10496
    v_cvt_pk_bf16_f32 v37, v162, v163
    v_mfma_f32_32x32x16_bf16 v[80:95], v[136:139], a[148:151], v[80:95]
    s_add_u32 m0, s25, 8192
    s_nop 0
    buffer_load_dwordx4 v12, s[8:11], s27 offen lds
    s_waitcnt lgkmcnt(15)
    v_mfma_f32_32x32x16_bf16 v[96:111], v[140:143], a[4:7], v[96:111]
    ds_read_b64_tr_b16 v[32:33], v2 offset:10752
    ds_read_b64_tr_b16 v[34:35], v2 offset:11008
    v_cvt_pk_bf16_f32 v40, v164, v165
    v_mfma_f32_32x32x16_bf16 v[112:127], v[140:143], a[148:151], v[112:127]
    s_waitcnt lgkmcnt(15)
    v_mfma_f32_32x32x16_bf16 v[64:79], v[144:147], a[8:11], v[64:79]
    ds_read_b64_tr_b16 v[128:129], v2 offset:12288
    ds_read_b64_tr_b16 v[130:131], v2 offset:12544
    v_cvt_pk_bf16_f32 v41, v166, v167
    v_mfma_f32_32x32x16_bf16 v[80:95], v[144:147], a[152:155], v[80:95]
    s_waitcnt lgkmcnt(15)
    v_mfma_f32_32x32x16_bf16 v[96:111], v[148:151], a[8:11], v[96:111]
    ds_read_b64_tr_b16 v[132:133], v2 offset:12800
    ds_read_b64_tr_b16 v[134:135], v2 offset:13056
    v_cvt_pk_bf16_f32 v38, v168, v169
    v_mfma_f32_32x32x16_bf16 v[112:127], v[148:151], a[152:155], v[112:127]
    s_waitcnt lgkmcnt(15)
    v_mfma_f32_32x32x16_bf16 v[64:79], v[152:155], a[12:15], v[64:79]
    ds_read_b64_tr_b16 v[136:137], v2 offset:14336
    ds_read_b64_tr_b16 v[138:139], v2 offset:14592
    v_cvt_pk_bf16_f32 v39, v170, v171
    v_mfma_f32_32x32x16_bf16 v[80:95], v[152:155], a[156:159], v[80:95]
    s_waitcnt lgkmcnt(15)
    v_mfma_f32_32x32x16_bf16 v[96:111], v[156:159], a[12:15], v[96:111]
    ds_read_b32 v18, v19
    ds_read_b64_tr_b16 v[140:141], v2 offset:14848
    ds_read_b64_tr_b16 v[142:143], v2 offset:15104
    v_cvt_pk_bf16_f32 v42, v172, v173
    v_mfma_f32_32x32x16_bf16 v[112:127], v[156:159], a[156:159], v[112:127]
    s_waitcnt lgkmcnt(15)
    v_mfma_f32_32x32x16_bf16 v[64:79], v[20:23], a[16:19], v[64:79]
    s_waitcnt lgkmcnt(2)
    v_readfirstlane_b32 s56, v18
    s_cmp_ge_u32 s56, s57
    s_cbranch_scc0 spin_g1_kernel_20
back_g1_kernel_21:
    s_add_u32 s18, s18, 36864
    s_cmp_eq_u32 s18, 147456
    s_cselect_b32 s18, 0, s18
    v_add_u32 v3, s18, v16
    s_cmp_ge_u32 s17, 0
    s_cselect_b32 s10, s16, 0
    s_add_u32 s25, s19, s23
    s_add_u32 s27, s20, 1492992
    s_add_u32 s19, s19, 36864
    s_cmp_eq_u32 s19, 147456
    s_cselect_b32 s19, 0, s19
    ds_read_b64_tr_b16 v[144:145], v2 offset:16384
    ds_read_b64_tr_b16 v[146:147], v2 offset:16640
    v_cvt_pk_bf16_f32 v43, v174, v175
    v_mfma_f32_32x32x16_bf16 v[80:95], v[20:23], a[160:163], v[80:95]
    s_add_u32 m0, s25, 0
    s_nop 0
    buffer_load_dwordx4 v4, s[8:11], s27 offen lds
    v_mfma_f32_32x32x16_bf16 v[96:111], v[24:27], a[16:19], v[96:111]
    ds_read_b64_tr_b16 v[148:149], v2 offset:16896
    ds_read_b64_tr_b16 v[150:151], v2 offset:17152
    s_nop 1
    v_mfma_f32_32x32x16_bf16 v[112:127], v[24:27], a[160:163], v[112:127]
    v_mfma_f32_32x32x16_bf16 v[64:79], v[28:31], a[20:23], v[64:79]
    ds_read_b64_tr_b16 v[152:153], v3 offset:0
    ds_read_b64_tr_b16 v[154:155], v3 offset:256
    s_add_u32 m0, s25, 1024
    s_nop 0
    buffer_load_dwordx4 v5, s[8:11], s27 offen lds
    v_permlane32_swap_b32 v36, v38
    v_mfma_f32_32x32x16_bf16 v[80:95], v[28:31], a[164:167], v[80:95]
    v_mfma_f32_32x32x16_bf16 v[96:111], v[32:35], a[20:23], v[96:111]
    ds_read_b64_tr_b16 v[156:157], v3 offset:512
    ds_read_b64_tr_b16 v[158:159], v3 offset:768
    v_permlane32_swap_b32 v40, v42
    v_mfma_f32_32x32x16_bf16 v[112:127], v[32:35], a[164:167], v[112:127]
    s_add_u32 m0, s25, 2048
    s_nop 0
    buffer_load_dwordx4 v6, s[8:11], s27 offen lds
    v_mfma_f32_32x32x16_bf16 v[64:79], v[128:131], a[24:27], v[64:79]
    ds_read_b64_tr_b16 v[20:21], v3 offset:2048
    ds_read_b64_tr_b16 v[22:23], v3 offset:2304
    v_permlane32_swap_b32 v37, v39
    v_mfma_f32_32x32x16_bf16 v[80:95], v[128:131], a[168:171], v[80:95]
    v_mfma_f32_32x32x16_bf16 v[96:111], v[132:135], a[24:27], v[96:111]
    ds_read_b64_tr_b16 v[24:25], v3 offset:2560
    ds_read_b64_tr_b16 v[26:27], v3 offset:2816
    s_add_u32 m0, s25, 3072
    s_nop 0
    buffer_load_dwordx4 v7, s[8:11], s27 offen lds
    v_permlane32_swap_b32 v41, v43
    v_mfma_f32_32x32x16_bf16 v[112:127], v[132:135], a[168:171], v[112:127]
    v_mfma_f32_32x32x16_bf16 v[64:79], v[136:139], a[28:31], v[64:79]
    ds_read_b64_tr_b16 v[28:29], v3 offset:4096
    ds_read_b64_tr_b16 v[30:31], v3 offset:4352
    buffer_store_dwordx4 v[36:39], v13, s[12:15], s21 offen offset:0
    v_mfma_f32_32x32x16_bf16 v[80:95], v[136:139], a[172:175], v[80:95]
    s_add_u32 m0, s25, 4096
    s_nop 0
    buffer_load_dwordx4 v8, s[8:11], s27 offen lds
    s_waitcnt lgkmcnt(14)
    v_mfma_f32_32x32x16_bf16 v[96:111], v[140:143], a[28:31], v[96:111]
    ds_read_b64_tr_b16 v[32:33], v3 offset:4608
    ds_read_b64_tr_b16 v[34:35], v3 offset:4864
    v_mfma_f32_32x32x16_bf16 v[112:127], v[140:143], a[172:175], v[112:127]
    s_waitcnt lgkmcnt(14)
    v_mfma_f32_32x32x16_bf16 v[64:79], v[144:147], a[32:35], v[64:79]
    ds_read_b64_tr_b16 v[128:129], v3 offset:6144
    ds_read_b64_tr_b16 v[130:131], v3 offset:6400
    s_add_u32 m0, s25, 5120
    s_nop 0
    buffer_load_dwordx4 v9, s[8:11], s27 offen lds
    buffer_store_dwordx4 v[40:43], v13, s[12:15], s21 offen offset:16
    v_mfma_f32_32x32x16_bf16 v[80:95], v[144:147], a[176:179], v[80:95]
    s_waitcnt lgkmcnt(14)
    v_mfma_f32_32x32x16_bf16 v[96:111], v[148:151], a[32:35], v[96:111]
    ds_read_b64_tr_b16 v[132:133], v3 offset:6656
    ds_read_b64_tr_b16 v[134:135], v3 offset:6912
    v_mfma_f32_32x32x16_bf16 v[112:127], v[148:151], a[176:179], v[112:127]
    s_add_u32 m0, s25, 6144
    s_nop 0
    buffer_load_dwordx4 v10, s[8:11], s27 offen lds
    s_waitcnt lgkmcnt(14)
    v_mfma_f32_32x32x16_bf16 v[64:79], v[152:155], a[36:39], v[64:79]
    s_waitcnt vmcnt(9)
    ds_add_u32 v19, v19
    s_add_u32 s57, s57, 0x98000
    ds_read_b64_tr_b16 v[136:137], v3 offset:8192
    ds_read_b64_tr_b16 v[138:139], v3 offset:8448
    v_cvt_pk_bf16_f32 v44, v176, v177
    v_mfma_f32_32x32x16_bf16 v[80:95], v[152:155], a[180:183], v[80:95]
    s_waitcnt lgkmcnt(15)
    v_mfma_f32_32x32x16_bf16 v[96:111], v[156:159], a[36:39], v[96:111]
    ds_read_b64_tr_b16 v[140:141], v3 offset:8704
    ds_read_b64_tr_b16 v[142:143], v3 offset:8960
    s_add_u32 m0, s25, 7168
    s_nop 0
    buffer_load_dwordx4 v11, s[8:11], s27 offen lds
    v_cvt_pk_bf16_f32 v45, v178, v179
    v_mfma_f32_32x32x16_bf16 v[112:127], v[156:159], a[180:183], v[112:127]
    s_waitcnt lgkmcnt(15)
    v_mfma_f32_32x32x16_bf16 v[64:79], v[20:23], a[40:43], v[64:79]
    ds_read_b64_tr_b16 v[144:145], v3 offset:10240
    ds_read_b64_tr_b16 v[146:147], v3 offset:10496
    v_cvt_pk_bf16_f32 v48, v180, v181
    v_mfma_f32_32x32x16_bf16 v[80:95], v[20:23], a[184:187], v[80:95]
    s_add_u32 m0, s25, 8192
    s_nop 0
    buffer_load_dwordx4 v12, s[8:11], s27 offen lds
    s_waitcnt lgkmcnt(15)
    v_mfma_f32_32x32x16_bf16 v[96:111], v[24:27], a[40:43], v[96:111]
    ds_read_b64_tr_b16 v[148:149], v3 offset:10752
    ds_read_b64_tr_b16 v[150:151], v3 offset:11008
    v_cvt_pk_bf16_f32 v49, v182, v183
    v_mfma_f32_32x32x16_bf16 v[112:127], v[24:27], a[184:187], v[112:127]
    s_waitcnt lgkmcnt(15)
    v_mfma_f32_32x32x16_bf16 v[64:79], v[28:31], a[44:47], v[64:79]
    ds_read_b64_tr_b16 v[152:153], v3 offset:12288
    ds_read_b64_tr_b16 v[154:155], v3 offset:12544
    v_cvt_pk_bf16_f32 v46, v184, v185
    v_mfma_f32_32x32x16_bf16 v[80:95], v[28:31], a[188:191], v[80:95]
    s_waitcnt lgkmcnt(15)
    v_mfma_f32_32x32x16_bf16 v[96:111], v[32:35], a[44:47], v[96:111]
    ds_read_b64_tr_b16 v[156:157], v3 offset:12800
    ds_read_b64_tr_b16 v[158:159], v3 offset:13056
    v_cvt_pk_bf16_f32 v47, v186, v187
    v_mfma_f32_32x32x16_bf16 v[112:127], v[32:35], a[188:191], v[112:127]
    s_waitcnt lgkmcnt(15)
    v_mfma_f32_32x32x16_bf16 v[64:79], v[128:131], a[48:51], v[64:79]
    ds_read_b64_tr_b16 v[20:21], v3 offset:14336
    ds_read_b64_tr_b16 v[22:23], v3 offset:14592
    v_cvt_pk_bf16_f32 v50, v188, v189
    v_mfma_f32_32x32x16_bf16 v[80:95], v[128:131], a[192:195], v[80:95]
    s_waitcnt lgkmcnt(15)
    v_mfma_f32_32x32x16_bf16 v[96:111], v[132:135], a[48:51], v[96:111]
    ds_read_b32 v18, v19
    ds_read_b64_tr_b16 v[24:25], v3 offset:14848
    ds_read_b64_tr_b16 v[26:27], v3 offset:15104
    v_cvt_pk_bf16_f32 v51, v190, v191
    v_mfma_f32_32x32x16_bf16 v[112:127], v[132:135], a[192:195], v[112:127]
    s_waitcnt lgkmcnt(15)
    v_mfma_f32_32x32x16_bf16 v[64:79], v[136:139], a[52:55], v[64:79]
    s_waitcnt lgkmcnt(2)
    v_readfirstlane_b32 s56, v18
    s_cmp_ge_u32 s56, s57
    s_cbranch_scc0 spin_g1_kernel_22
back_g1_kernel_23:
    s_add_u32 s18, s18, 36864
    s_cmp_eq_u32 s18, 147456
    s_cselect_b32 s18, 0, s18
    v_add_u32 v2, s18, v16
    s_cmp_ge_u32 s17, 1
    s_cselect_b32 s10, s16, 0
    s_add_u32 s25, s19, s23
    s_add_u32 s27, s20, 256
    s_sub_u32 s27, s27, s58
    s_add_u32 s19, s19, 36864
    s_cmp_eq_u32 s19, 147456
    s_cselect_b32 s19, 0, s19
    ds_read_b64_tr_b16 v[28:29], v3 offset:16384
    ds_read_b64_tr_b16 v[30:31], v3 offset:16640
    s_nop 1
    v_mfma_f32_32x32x16_bf16 v[80:95], v[136:139], a[196:199], v[80:95]
    s_add_u32 m0, s25, 0
    s_nop 0
    buffer_load_dwordx4 v4, s[8:11], s27 offen lds
    v_mfma_f32_32x32x16_bf16 v[96:111], v[140:143], a[52:55], v[96:111]
    ds_read_b64_tr_b16 v[32:33], v3 offset:16896
    ds_read_b64_tr_b16 v[34:35], v3 offset:17152
    v_permlane32_swap_b32 v44, v46
    v_mfma_f32_32x32x16_bf16 v[112:127], v[140:143], a[196:199], v[112:127]
    v_mfma_f32_32x32x16_bf16 v[64:79], v[144:147], a[56:59], v[64:79]
    ds_read_b64_tr_b16 v[128:129], v2 offset:0
    ds_read_b64_tr_b16 v[130:131], v2 offset:256
    s_add_u32 m0, s25, 1024
    s_nop 0
    buffer_load_dwordx4 v5, s[8:11], s27 offen lds
    v_permlane32_swap_b32 v48, v50
    v_mfma_f32_32x32x16_bf16 v[80:95], v[144:147], a[200:203], v[80:95]
    v_mfma_f32_32x32x16_bf16 v[96:111], v[148:151], a[56:59], v[96:111]
    ds_read_b64_tr_b16 v[132:133], v2 offset:512
    ds_read_b64_tr_b16 v[134:135], v2 offset:768
    v_permlane32_swap_b32 v45, v47
    v_mfma_f32_32x32x16_bf16 v[112:127], v[148:151], a[200:203], v[112:127]
    s_add_u32 m0, s25, 2048
    s_nop 0
    buffer_load_dwordx4 v6, s[8:11], s27 offen lds
    v_mfma_f32_32x32x16_bf16 v[64:79], v[152:155], a[60:63], v[64:79]
    ds_read_b64_tr_b16 v[136:137], v2 offset:2048
    ds_read_b64_tr_b16 v[138:139], v2 offset:2304
    v_permlane32_swap_b32 v49, v51
    v_mfma_f32_32x32x16_bf16 v[80:95], v[152:155], a[204:207], v[80:95]
    v_mfma_f32_32x32x16_bf16 v[96:111], v[156:159], a[60:63], v[96:111]
    ds_read_b64_tr_b16 v[140:141], v2 offset:2560
    ds_read_b64_tr_b16 v[142:143], v2 offset:2816
    s_add_u32 m0, s25, 3072
    s_nop 0
    buffer_load_dwordx4 v7, s[8:11], s27 offen lds
    buffer_store_dwordx4 v[44:47], v13, s[12:15], s22 offen offset:0
    v_mfma_f32_32x32x16_bf16 v[112:127], v[156:159], a[204:207], v[112:127]
    v_mfma_f32_32x32x16_bf16 v[64:79], v[20:23], a[64:67], v[64:79]
    ds_read_b64_tr_b16 v[144:145], v2 offset:4096
    ds_read_b64_tr_b16 v[146:147], v2 offset:4352
    v_mfma_f32_32x32x16_bf16 v[80:95], v[20:23], a[208:211], v[80:95]
    s_add_u32 m0, s25, 4096
    s_nop 0
    buffer_load_dwordx4 v8, s[8:11], s27 offen lds
    s_waitcnt lgkmcnt(14)
    v_mfma_f32_32x32x16_bf16 v[96:111], v[24:27], a[64:67], v[96:111]
    ds_read_b64_tr_b16 v[148:149], v2 offset:4608
    ds_read_b64_tr_b16 v[150:151], v2 offset:4864
    buffer_store_dwordx4 v[48:51], v13, s[12:15], s22 offen offset:16
    v_mfma_f32_32x32x16_bf16 v[112:127], v[24:27], a[208:211], v[112:127]
    s_waitcnt lgkmcnt(14)
    v_mfma_f32_32x32x16_bf16 v[64:79], v[28:31], a[68:71], v[64:79]
    ds_read_b64_tr_b16 v[152:153], v2 offset:6144
    ds_read_b64_tr_b16 v[154:155], v2 offset:6400
    s_add_u32 m0, s25, 5120
    s_nop 0
    buffer_load_dwordx4 v9, s[8:11], s27 offen lds
    v_mfma_f32_32x32x16_bf16 v[80:95], v[28:31], a[212:215], v[80:95]
    s_waitcnt lgkmcnt(14)
    v_mfma_f32_32x32x16_bf16 v[96:111], v[32:35], a[68:71], v[96:111]
    ds_read_b64_tr_b16 v[156:157], v2 offset:6656
    ds_read_b64_tr_b16 v[158:159], v2 offset:6912
    v_cvt_pk_bf16_f32 v36, v192, v193
    v_mfma_f32_32x32x16_bf16 v[112:127], v[32:35], a[212:215], v[112:127]
    s_add_u32 m0, s25, 6144
    s_nop 0
    buffer_load_dwordx4 v10, s[8:11], s27 offen lds
    s_waitcnt lgkmcnt(14)
    v_mfma_f32_32x32x16_bf16 v[64:79], v[128:131], a[72:75], v[64:79]
    s_waitcnt vmcnt(9)
    ds_add_u32 v19, v19
    s_add_u32 s57, s57, 0x98000
    ds_read_b64_tr_b16 v[20:21], v2 offset:8192
    ds_read_b64_tr_b16 v[22:23], v2 offset:8448
    v_cvt_pk_bf16_f32 v37, v194, v195
    v_mfma_f32_32x32x16_bf16 v[80:95], v[128:131], a[216:219], v[80:95]
    s_waitcnt lgkmcnt(15)
    v_mfma_f32_32x32x16_bf16 v[96:111], v[132:135], a[72:75], v[96:111]
    ds_read_b64_tr_b16 v[24:25], v2 offset:8704
    ds_read_b64_tr_b16 v[26:27], v2 offset:8960
    s_add_u32 m0, s25, 7168
    s_nop 0
    buffer_load_dwordx4 v11, s[8:11], s27 offen lds
    v_cvt_pk_bf16_f32 v40, v196, v197
    v_mfma_f32_32x32x16_bf16 v[112:127], v[132:135], a[216:219], v[112:127]
    s_waitcnt lgkmcnt(15)
    v_mfma_f32_32x32x16_bf16 v[64:79], v[136:139], a[76:79], v[64:79]
    ds_read_b64_tr_b16 v[28:29], v2 offset:10240
    ds_read_b64_tr_b16 v[30:31], v2 offset:10496
    v_cvt_pk_bf16_f32 v41, v198, v199
    v_mfma_f32_32x32x16_bf16 v[80:95], v[136:139], a[220:223], v[80:95]
    s_add_u32 m0, s25, 8192
    s_nop 0
    buffer_load_dwordx4 v12, s[8:11], s27 offen lds
    s_waitcnt lgkmcnt(15)
    v_mfma_f32_32x32x16_bf16 v[96:111], v[140:143], a[76:79], v[96:111]
    ds_read_b64_tr_b16 v[32:33], v2 offset:10752
    ds_read_b64_tr_b16 v[34:35], v2 offset:11008
    v_cvt_pk_bf16_f32 v38, v200, v201
    v_mfma_f32_32x32x16_bf16 v[112:127], v[140:143], a[220:223], v[112:127]
    s_waitcnt lgkmcnt(15)
    v_mfma_f32_32x32x16_bf16 v[64:79], v[144:147], a[80:83], v[64:79]
    ds_read_b64_tr_b16 v[128:129], v2 offset:12288
    ds_read_b64_tr_b16 v[130:131], v2 offset:12544
    v_cvt_pk_bf16_f32 v39, v202, v203
    v_mfma_f32_32x32x16_bf16 v[80:95], v[144:147], a[224:227], v[80:95]
    s_waitcnt lgkmcnt(15)
    v_mfma_f32_32x32x16_bf16 v[96:111], v[148:151], a[80:83], v[96:111]
    ds_read_b64_tr_b16 v[132:133], v2 offset:12800
    ds_read_b64_tr_b16 v[134:135], v2 offset:13056
    v_cvt_pk_bf16_f32 v42, v204, v205
    v_mfma_f32_32x32x16_bf16 v[112:127], v[148:151], a[224:227], v[112:127]
    s_waitcnt lgkmcnt(15)
    v_mfma_f32_32x32x16_bf16 v[64:79], v[152:155], a[84:87], v[64:79]
    ds_read_b64_tr_b16 v[136:137], v2 offset:14336
    ds_read_b64_tr_b16 v[138:139], v2 offset:14592
    v_cvt_pk_bf16_f32 v43, v206, v207
    v_mfma_f32_32x32x16_bf16 v[80:95], v[152:155], a[228:231], v[80:95]
    s_waitcnt lgkmcnt(15)
    v_mfma_f32_32x32x16_bf16 v[96:111], v[156:159], a[84:87], v[96:111]
    ds_read_b32 v18, v19
    ds_read_b64_tr_b16 v[140:141], v2 offset:14848
    ds_read_b64_tr_b16 v[142:143], v2 offset:15104
    s_nop 1
    v_mfma_f32_32x32x16_bf16 v[112:127], v[156:159], a[228:231], v[112:127]
    s_waitcnt lgkmcnt(15)
    v_mfma_f32_32x32x16_bf16 v[64:79], v[20:23], a[88:91], v[64:79]
    s_waitcnt lgkmcnt(2)
    v_readfirstlane_b32 s56, v18
    s_cmp_ge_u32 s56, s57
    s_cbranch_scc0 spin_g1_kernel_24
back_g1_kernel_25:
    s_add_u32 s18, s18, 36864
    s_cmp_eq_u32 s18, 147456
    s_cselect_b32 s18, 0, s18
    v_add_u32 v3, s18, v16
    s_cmp_ge_u32 s17, 1
    s_cselect_b32 s10, s16, 0
    s_add_u32 s25, s19, s23
    s_add_u32 s27, s20, 497920
    s_sub_u32 s27, s27, s58
    s_add_u32 s19, s19, 36864
    s_cmp_eq_u32 s19, 147456
    s_cselect_b32 s19, 0, s19
    ds_read_b64_tr_b16 v[144:145], v2 offset:16384
    ds_read_b64_tr_b16 v[146:147], v2 offset:16640
    v_permlane32_swap_b32 v36, v38
    v_mfma_f32_32x32x16_bf16 v[80:95], v[20:23], a[232:235], v[80:95]
    s_add_u32 m0, s25, 0
    s_nop 0
    buffer_load_dwordx4 v4, s[8:11], s27 offen lds
    v_mfma_f32_32x32x16_bf16 v[96:111], v[24:27], a[88:91], v[96:111]
    ds_read_b64_tr_b16 v[148:149], v2 offset:16896
    ds_read_b64_tr_b16 v[150:151], v2 offset:17152
    v_permlane32_swap_b32 v40, v42
    v_mfma_f32_32x32x16_bf16 v[112:127], v[24:27], a[232:235], v[112:127]
    v_mfma_f32_32x32x16_bf16 v[64:79], v[28:31], a[92:95], v[64:79]
    ds_read_b64_tr_b16 v[152:153], v3 offset:0
    ds_read_b64_tr_b16 v[154:155], v3 offset:256
    s_add_u32 m0, s25, 1024
    s_nop 0
    buffer_load_dwordx4 v5, s[8:11], s27 offen lds
    v_permlane32_swap_b32 v37, v39
    v_mfma_f32_32x32x16_bf16 v[80:95], v[28:31], a[236:239], v[80:95]
    v_mfma_f32_32x32x16_bf16 v[96:111], v[32:35], a[92:95], v[96:111]
    ds_read_b64_tr_b16 v[156:157], v3 offset:512
    ds_read_b64_tr_b16 v[158:159], v3 offset:768
    v_permlane32_swap_b32 v41, v43
    v_mfma_f32_32x32x16_bf16 v[112:127], v[32:35], a[236:239], v[112:127]
    s_add_u32 m0, s25, 2048
    s_nop 0
    buffer_load_dwordx4 v6, s[8:11], s27 offen lds
    v_mfma_f32_32x32x16_bf16 v[64:79], v[128:131], a[96:99], v[64:79]
    ds_read_b64_tr_b16 v[20:21], v3 offset:2048
    ds_read_b64_tr_b16 v[22:23], v3 offset:2304
    buffer_store_dwordx4 v[36:39], v13, s[12:15], s21 offen offset:64
    v_mfma_f32_32x32x16_bf16 v[80:95], v[128:131], a[240:243], v[80:95]
    v_mfma_f32_32x32x16_bf16 v[96:111], v[132:135], a[96:99], v[96:111]
    ds_read_b64_tr_b16 v[24:25], v3 offset:2560
    ds_read_b64_tr_b16 v[26:27], v3 offset:2816
    s_add_u32 m0, s25, 3072
    s_nop 0
    buffer_load_dwordx4 v7, s[8:11], s27 offen lds
    v_mfma_f32_32x32x16_bf16 v[112:127], v[132:135], a[240:243], v[112:127]
    v_mfma_f32_32x32x16_bf16 v[64:79], v[136:139], a[100:103], v[64:79]
    ds_read_b64_tr_b16 v[28:29], v3 offset:4096
    ds_read_b64_tr_b16 v[30:31], v3 offset:4352
    buffer_store_dwordx4 v[40:43], v13, s[12:15], s21 offen offset:80
    v_mfma_f32_32x32x16_bf16 v[80:95], v[136:139], a[244:247], v[80:95]
    s_add_u32 m0, s25, 4096
    s_nop 0
    buffer_load_dwordx4 v8, s[8:11], s27 offen lds
    s_waitcnt lgkmcnt(14)
    v_mfma_f32_32x32x16_bf16 v[96:111], v[140:143], a[100:103], v[96:111]
    ds_read_b64_tr_b16 v[32:33], v3 offset:4608
    ds_read_b64_tr_b16 v[34:35], v3 offset:4864
    v_mfma_f32_32x32x16_bf16 v[112:127], v[140:143], a[244:247], v[112:127]
    s_waitcnt lgkmcnt(14)
    v_mfma_f32_32x32x16_bf16 v[64:79], v[144:147], a[104:107], v[64:79]
    ds_read_b64_tr_b16 v[128:129], v3 offset:6144
    ds_read_b64_tr_b16 v[130:131], v3 offset:6400
    s_add_u32 m0, s25, 5120
    s_nop 0
    buffer_load_dwordx4 v9, s[8:11], s27 offen lds
    v_cvt_pk_bf16_f32 v44, v208, v209
    v_mfma_f32_32x32x16_bf16 v[80:95], v[144:147], a[248:251], v[80:95]
    s_waitcnt lgkmcnt(14)
    v_mfma_f32_32x32x16_bf16 v[96:111], v[148:151], a[104:107], v[96:111]
    ds_read_b64_tr_b16 v[132:133], v3 offset:6656
    ds_read_b64_tr_b16 v[134:135], v3 offset:6912
    v_cvt_pk_bf16_f32 v45, v210, v211
    v_mfma_f32_32x32x16_bf16 v[112:127], v[148:151], a[248:251], v[112:127]
    s_add_u32 m0, s25, 6144
    s_nop 0
    buffer_load_dwordx4 v10, s[8:11], s27 offen lds
    s_waitcnt lgkmcnt(14)
    v_mfma_f32_32x32x16_bf16 v[64:79], v[152:155], a[108:111], v[64:79]
    s_waitcnt vmcnt(9)
    ds_add_u32 v19, v19
    s_add_u32 s57, s57, 0x98000
    ds_read_b64_tr_b16 v[136:137], v3 offset:8192
    ds_read_b64_tr_b16 v[138:139], v3 offset:8448
    v_cvt_pk_bf16_f32 v48, v212, v213
    v_mfma_f32_32x32x16_bf16 v[80:95], v[152:155], a[252:255], v[80:95]
    s_waitcnt lgkmcnt(15)
    v_mfma_f32_32x32x16_bf16 v[96:111], v[156:159], a[108:111], v[96:111]
    ds_read_b64_tr_b16 v[140:141], v3 offset:8704
    ds_read_b64_tr_b16 v[142:143], v3 offset:8960
    s_add_u32 m0, s25, 7168
    s_nop 0
    buffer_load_dwordx4 v11, s[8:11], s27 offen lds
    v_cvt_pk_bf16_f32 v49, v214, v215
    v_mfma_f32_32x32x16_bf16 v[112:127], v[156:159], a[252:255], v[112:127]
    s_waitcnt lgkmcnt(15)
    v_mfma_f32_32x32x16_bf16 v[64:79], v[20:23], a[112:115], v[64:79]
    ds_read_b64_tr_b16 v[144:145], v3 offset:10240
    ds_read_b64_tr_b16 v[146:147], v3 offset:10496
    v_cvt_pk_bf16_f32 v46, v216, v217
    v_mfma_f32_32x32x16_bf16 v[80:95], v[20:23], v[224:227], v[80:95]
    s_add_u32 m0, s25, 8192
    s_nop 0
    buffer_load_dwordx4 v12, s[8:11], s27 offen lds
    s_waitcnt lgkmcnt(15)
    v_mfma_f32_32x32x16_bf16 v[96:111], v[24:27], a[112:115], v[96:111]
    ds_read_b64_tr_b16 v[148:149], v3 offset:10752
    ds_read_b64_tr_b16 v[150:151], v3 offset:11008
    v_cvt_pk_bf16_f32 v47, v218, v219
    v_mfma_f32_32x32x16_bf16 v[112:127], v[24:27], v[224:227], v[112:127]
    s_waitcnt lgkmcnt(15)
    v_mfma_f32_32x32x16_bf16 v[64:79], v[28:31], a[116:119], v[64:79]
    ds_read_b64_tr_b16 v[152:153], v3 offset:12288
    ds_read_b64_tr_b16 v[154:155], v3 offset:12544
    v_cvt_pk_bf16_f32 v50, v220, v221
    v_mfma_f32_32x32x16_bf16 v[80:95], v[28:31], v[228:231], v[80:95]
    s_waitcnt lgkmcnt(15)
    v_mfma_f32_32x32x16_bf16 v[96:111], v[32:35], a[116:119], v[96:111]
    ds_read_b64_tr_b16 v[156:157], v3 offset:12800
    ds_read_b64_tr_b16 v[158:159], v3 offset:13056
    v_cvt_pk_bf16_f32 v51, v222, v223
    v_mfma_f32_32x32x16_bf16 v[112:127], v[32:35], v[228:231], v[112:127]
    s_waitcnt lgkmcnt(15)
    v_mfma_f32_32x32x16_bf16 v[64:79], v[128:131], a[120:123], v[64:79]
    ds_read_b64_tr_b16 v[20:21], v3 offset:14336
    ds_read_b64_tr_b16 v[22:23], v3 offset:14592
    s_nop 1
    v_mfma_f32_32x32x16_bf16 v[80:95], v[128:131], v[232:235], v[80:95]
    s_waitcnt lgkmcnt(15)
    v_mfma_f32_32x32x16_bf16 v[96:111], v[132:135], a[120:123], v[96:111]
    ds_read_b32 v18, v19
    ds_read_b64_tr_b16 v[24:25], v3 offset:14848
    ds_read_b64_tr_b16 v[26:27], v3 offset:15104
    v_permlane32_swap_b32 v44, v46
    v_mfma_f32_32x32x16_bf16 v[112:127], v[132:135], v[232:235], v[112:127]
    s_waitcnt lgkmcnt(15)
    v_mfma_f32_32x32x16_bf16 v[64:79], v[136:139], a[124:127], v[64:79]
    s_waitcnt lgkmcnt(2)
    v_readfirstlane_b32 s56, v18
    s_cmp_ge_u32 s56, s57
    s_cbranch_scc0 spin_g1_kernel_26
back_g1_kernel_27:
    s_add_u32 s18, s18, 36864
    s_cmp_eq_u32 s18, 147456
    s_cselect_b32 s18, 0, s18
    v_add_u32 v2, s18, v16
    s_cmp_ge_u32 s17, 1
    s_cselect_b32 s10, s16, 0
    s_add_u32 s25, s19, s23
    s_add_u32 s27, s20, 995584
    s_sub_u32 s27, s27, s58
    s_add_u32 s19, s19, 36864
    s_cmp_eq_u32 s19, 147456
    s_cselect_b32 s19, 0, s19
    ds_read_b64_tr_b16 v[28:29], v3 offset:16384
    ds_read_b64_tr_b16 v[30:31], v3 offset:16640
    v_permlane32_swap_b32 v48, v50
    v_mfma_f32_32x32x16_bf16 v[80:95], v[136:139], v[236:239], v[80:95]
    s_add_u32 m0, s25, 0
    s_nop 0
    buffer_load_dwordx4 v4, s[8:11], s27 offen lds
    v_mfma_f32_32x32x16_bf16 v[96:111], v[140:143], a[124:127], v[96:111]
    ds_read_b64_tr_b16 v[32:33], v3 offset:16896
    ds_read_b64_tr_b16 v[34:35], v3 offset:17152
    v_permlane32_swap_b32 v45, v47
    v_mfma_f32_32x32x16_bf16 v[112:127], v[140:143], v[236:239], v[112:127]
    s_add_u32 m0, s25, 1024
    s_nop 0
    buffer_load_dwordx4 v5, s[8:11], s27 offen lds
    v_mfma_f32_32x32x16_bf16 v[64:79], v[144:147], a[128:131], v[64:79]
    ds_read_b64_tr_b16 v[128:129], v2 offset:0
    ds_read_b64_tr_b16 v[130:131], v2 offset:256
    v_permlane32_swap_b32 v49, v51
    v_mfma_f32_32x32x16_bf16 v[80:95], v[144:147], v[240:243], v[80:95]
    s_add_u32 m0, s25, 2048
    s_nop 0
    buffer_load_dwordx4 v6, s[8:11], s27 offen lds
    v_mfma_f32_32x32x16_bf16 v[96:111], v[148:151], a[128:131], v[96:111]
    ds_read_b64_tr_b16 v[132:133], v2 offset:512
    ds_read_b64_tr_b16 v[134:135], v2 offset:768
    buffer_store_dwordx4 v[44:47], v13, s[12:15], s22 offen offset:64
    v_mfma_f32_32x32x16_bf16 v[112:127], v[148:151], v[240:243], v[112:127]
    s_add_u32 m0, s25, 3072
    s_nop 0
    buffer_load_dwordx4 v7, s[8:11], s27 offen lds
    v_mfma_f32_32x32x16_bf16 v[64:79], v[152:155], a[132:135], v[64:79]
    ds_read_b64_tr_b16 v[136:137], v2 offset:2048
    ds_read_b64_tr_b16 v[138:139], v2 offset:2304
    v_mfma_f32_32x32x16_bf16 v[80:95], v[152:155], v[244:247], v[80:95]
    s_add_u32 m0, s25, 4096
    s_nop 0
    buffer_load_dwordx4 v8, s[8:11], s27 offen lds
    v_mfma_f32_32x32x16_bf16 v[96:111], v[156:159], a[132:135], v[96:111]
    ds_read_b64_tr_b16 v[140:141], v2 offset:2560
    ds_read_b64_tr_b16 v[142:143], v2 offset:2816
    buffer_store_dwordx4 v[48:51], v13, s[12:15], s22 offen offset:80
    v_mfma_f32_32x32x16_bf16 v[112:127], v[156:159], v[244:247], v[112:127]
    s_add_u32 m0, s25, 5120
    s_nop 0
    buffer_load_dwordx4 v9, s[8:11], s27 offen lds
    v_mfma_f32_32x32x16_bf16 v[64:79], v[20:23], a[136:139], v[64:79]
    ds_read_b64_tr_b16 v[144:145], v2 offset:4096
    ds_read_b64_tr_b16 v[146:147], v2 offset:4352
    v_mfma_f32_32x32x16_bf16 v[80:95], v[20:23], v[248:251], v[80:95]
    s_add_u32 m0, s25, 6144
    s_nop 0
    buffer_load_dwordx4 v10, s[8:11], s27 offen lds
    s_waitcnt lgkmcnt(14)
    v_mfma_f32_32x32x16_bf16 v[96:111], v[24:27], a[136:139], v[96:111]
    ds_read_b64_tr_b16 v[148:149], v2 offset:4608
    ds_read_b64_tr_b16 v[150:151], v2 offset:4864
    s_add_u32 s21, s21, 256
    v_mfma_f32_32x32x16_bf16 v[112:127], v[24:27], v[248:251], v[112:127]
    s_add_u32 m0, s25, 7168
    s_nop 0
    buffer_load_dwordx4 v11, s[8:11], s27 offen lds
    s_waitcnt lgkmcnt(14)
    v_mfma_f32_32x32x16_bf16 v[64:79], v[28:31], a[140:143], v[64:79]
    ds_read_b64_tr_b16 v[152:153], v2 offset:6144
    ds_read_b64_tr_b16 v[154:155], v2 offset:6400
    s_add_u32 s22, s22, 256
    v_mfma_f32_32x32x16_bf16 v[80:95], v[28:31], v[252:255], v[80:95]
    s_add_u32 m0, s25, 8192
    s_nop 0
    buffer_load_dwordx4 v12, s[8:11], s27 offen lds
    s_waitcnt lgkmcnt(14)
    v_mfma_f32_32x32x16_bf16 v[96:111], v[32:35], a[140:143], v[96:111]
    ds_read_b64_tr_b16 v[156:157], v2 offset:6656
    ds_read_b64_tr_b16 v[158:159], v2 offset:6912
    v_mfma_f32_32x32x16_bf16 v[112:127], v[32:35], v[252:255], v[112:127]
    s_add_u32 s20, s20, 256
    s_cmp_eq_u32 s17, 0
    s_cbranch_scc1 drain0q_g1_kernel_4
    s_sub_u32 s17, s17, 1
    s_waitcnt lgkmcnt(14)
    v_mfma_f32_32x32x16_bf16 v[160:175], v[128:131], a[0:3], 0
    s_waitcnt vmcnt(11)
    ds_add_u32 v19, v19
    s_add_u32 s57, s57, 0x98000
    ds_read_b64_tr_b16 v[20:21], v2 offset:8192
    ds_read_b64_tr_b16 v[22:23], v2 offset:8448
    v_mfma_f32_32x32x16_bf16 v[176:191], v[128:131], a[144:147], 0
    s_waitcnt lgkmcnt(13)
    v_mfma_f32_32x32x16_bf16 v[160:175], v[136:139], a[4:7], v[160:175]
    ds_read_b64_tr_b16 v[28:29], v2 offset:10240
    ds_read_b64_tr_b16 v[30:31], v2 offset:10496
    v_cvt_pk_bf16_f32 v36, v64, v65
    v_cvt_pk_bf16_f32 v37, v66, v67
    v_mfma_f32_32x32x16_bf16 v[176:191], v[136:139], a[148:151], v[176:191]
    v_cvt_pk_bf16_f32 v40, v68, v69
    s_waitcnt lgkmcnt(11)
    v_mfma_f32_32x32x16_bf16 v[160:175], v[144:147], a[8:11], v[160:175]
    ds_read_b64_tr_b16 v[128:129], v2 offset:12288
    ds_read_b64_tr_b16 v[130:131], v2 offset:12544
    v_cvt_pk_bf16_f32 v41, v70, v71
    v_mfma_f32_32x32x16_bf16 v[176:191], v[144:147], a[152:155], v[176:191]
    v_cvt_pk_bf16_f32 v38, v72, v73
    s_waitcnt lgkmcnt(9)
    v_mfma_f32_32x32x16_bf16 v[160:175], v[152:155], a[12:15], v[160:175]
    ds_read_b32 v18, v19
    ds_read_b64_tr_b16 v[136:137], v2 offset:14336
    ds_read_b64_tr_b16 v[138:139], v2 offset:14592
    v_cvt_pk_bf16_f32 v39, v74, v75
    v_mfma_f32_32x32x16_bf16 v[176:191], v[152:155], a[156:159], v[176:191]
    v_cvt_pk_bf16_f32 v42, v76, v77
    s_waitcnt lgkmcnt(7)
    v_mfma_f32_32x32x16_bf16 v[160:175], v[20:23], a[16:19], v[160:175]
    s_waitcnt lgkmcnt(2)
    v_readfirstlane_b32 s56, v18
    s_cmp_ge_u32 s56, s57
    s_cbranch_scc0 spin_g1_kernel_28
back_g1_kernel_29:
    s_add_u32 s18, s18, 36864
    s_cmp_eq_u32 s18, 147456
    s_cselect_b32 s18, 0, s18
    v_add_u32 v3, s18, v16
    s_cmp_ge_u32 s17, 0
    s_cselect_b32 s10, s16, 0
    s_add_u32 s25, s19, s23
    s_add_u32 s27, s20, 1492992
    s_sub_u32 s27, s27, s58
    s_add_u32 s19, s19, 36864
    s_cmp_eq_u32 s19, 147456
    s_cselect_b32 s19, 0, s19
    ds_read_b64_tr_b16 v[144:145], v2 offset:16384
    ds_read_b64_tr_b16 v[146:147], v2 offset:16640
    v_cvt_pk_bf16_f32 v43, v78, v79
    v_mfma_f32_32x32x16_bf16 v[176:191], v[20:23], a[160:163], v[176:191]
    s_add_u32 m0, s25, 0
    s_nop 0
    buffer_load_dwordx4 v4, s[8:11], s27 offen lds
    s_nop 1
    v_mfma_f32_32x32x16_bf16 v[160:175], v[28:31], a[20:23], v[160:175]
    ds_read_b64_tr_b16 v[152:153], v3 offset:0
    ds_read_b64_tr_b16 v[154:155], v3 offset:256
    s_add_u32 m0, s25, 1024
    s_nop 0
    buffer_load_dwordx4 v5, s[8:11], s27 offen lds
    v_permlane32_swap_b32 v36, v38
    v_mfma_f32_32x32x16_bf16 v[176:191], v[28:31], a[164:167], v[176:191]
    s_add_u32 m0, s25, 2048
    s_nop 0
    buffer_load_dwordx4 v6, s[8:11], s27 offen lds
    v_permlane32_swap_b32 v40, v42
    v_mfma_f32_32x32x16_bf16 v[160:175], v[128:131], a[24:27], v[160:175]
    ds_read_b64_tr_b16 v[20:21], v3 offset:2048
    ds_read_b64_tr_b16 v[22:23], v3 offset:2304
    s_add_u32 m0, s25, 3072
    s_nop 0
    buffer_load_dwordx4 v7, s[8:11], s27 offen lds
    v_permlane32_swap_b32 v37, v39
    v_mfma_f32_32x32x16_bf16 v[176:191], v[128:131], a[168:171], v[176:191]
    s_add_u32 m0, s25, 4096
    s_nop 0
    buffer_load_dwordx4 v8, s[8:11], s27 offen lds
    v_permlane32_swap_b32 v41, v43
    s_waitcnt lgkmcnt(6)
    v_mfma_f32_32x32x16_bf16 v[160:175], v[136:139], a[28:31], v[160:175]
    ds_read_b64_tr_b16 v[28:29], v3 offset:4096
    ds_read_b64_tr_b16 v[30:31], v3 offset:4352
    s_add_u32 m0, s25, 5120
    s_nop 0
    buffer_load_dwordx4 v9, s[8:11], s27 offen lds
    buffer_store_dwordx4 v[36:39], v13, s[12:15], s21 offen offset:0
    v_mfma_f32_32x32x16_bf16 v[176:191], v[136:139], a[172:175], v[176:191]
    s_add_u32 m0, s25, 6144
    s_nop 0
    buffer_load_dwordx4 v10, s[8:11], s27 offen lds
    s_waitcnt lgkmcnt(6)
    v_mfma_f32_32x32x16_bf16 v[160:175], v[144:147], a[32:35], v[160:175]
    ds_read_b64_tr_b16 v[128:129], v3 offset:6144
    ds_read_b64_tr_b16 v[130:131], v3 offset:6400
    s_add_u32 m0, s25, 7168
    s_nop 0
    buffer_load_dwordx4 v11, s[8:11], s27 offen lds
    buffer_store_dwordx4 v[40:43], v13, s[12:15], s21 offen offset:16
    v_mfma_f32_32x32x16_bf16 v[176:191], v[144:147], a[176:179], v[176:191]
    s_add_u32 m0, s25, 8192
    s_nop 0
    buffer_load_dwordx4 v12, s[8:11], s27 offen lds
    s_waitcnt lgkmcnt(6)
    v_mfma_f32_32x32x16_bf16 v[160:175], v[152:155], a[36:39], v[160:175]
    s_waitcnt vmcnt(11)
    ds_add_u32 v19, v19
    s_add_u32 s57, s57, 0x98000
    ds_read_b64_tr_b16 v[136:137], v3 offset:8192
    ds_read_b64_tr_b16 v[138:139], v3 offset:8448
    v_cvt_pk_bf16_f32 v44, v80, v81
    v_mfma_f32_32x32x16_bf16 v[176:191], v[152:155], a[180:183], v[176:191]
    v_cvt_pk_bf16_f32 v45, v82, v83
    s_waitcnt lgkmcnt(7)
    v_mfma_f32_32x32x16_bf16 v[160:175], v[20:23], a[40:43], v[160:175]
    ds_read_b64_tr_b16 v[144:145], v3 offset:10240
    ds_read_b64_tr_b16 v[146:147], v3 offset:10496
    v_cvt_pk_bf16_f32 v48, v84, v85
    v_mfma_f32_32x32x16_bf16 v[176:191], v[20:23], a[184:187], v[176:191]
    v_cvt_pk_bf16_f32 v49, v86, v87
    s_waitcnt lgkmcnt(7)
    v_mfma_f32_32x32x16_bf16 v[160:175], v[28:31], a[44:47], v[160:175]
    ds_read_b64_tr_b16 v[152:153], v3 offset:12288
    ds_read_b64_tr_b16 v[154:155], v3 offset:12544
    v_cvt_pk_bf16_f32 v46, v88, v89
    v_mfma_f32_32x32x16_bf16 v[176:191], v[28:31], a[188:191], v[176:191]
    v_cvt_pk_bf16_f32 v47, v90, v91
    s_waitcnt lgkmcnt(7)
    v_mfma_f32_32x32x16_bf16 v[160:175], v[128:131], a[48:51], v[160:175]
    ds_read_b32 v18, v19
    ds_read_b64_tr_b16 v[20:21], v3 offset:14336
    ds_read_b64_tr_b16 v[22:23], v3 offset:14592
    v_cvt_pk_bf16_f32 v50, v92, v93
    v_mfma_f32_32x32x16_bf16 v[176:191], v[128:131], a[192:195], v[176:191]
    v_cvt_pk_bf16_f32 v51, v94, v95
    s_waitcnt lgkmcnt(7)
    v_mfma_f32_32x32x16_bf16 v[160:175], v[136:139], a[52:55], v[160:175]
    s_waitcnt lgkmcnt(2)
    v_readfirstlane_b32 s56, v18
    s_cmp_ge_u32 s56, s57
    s_cbranch_scc0 spin_g1_kernel_30
back_g1_kernel_31:
    s_add_u32 s18, s18, 36864
    s_cmp_eq_u32 s18, 147456
    s_cselect_b32 s18, 0, s18
    v_add_u32 v2, s18, v16
    ds_read_b64_tr_b16 v[28:29], v3 offset:16384
    ds_read_b64_tr_b16 v[30:31], v3 offset:16640
    s_nop 1
    v_mfma_f32_32x32x16_bf16 v[176:191], v[136:139], a[196:199], v[176:191]
    v_permlane32_swap_b32 v44, v46
    v_mfma_f32_32x32x16_bf16 v[160:175], v[144:147], a[56:59], v[160:175]
    ds_read_b64_tr_b16 v[128:129], v2 offset:0
    ds_read_b64_tr_b16 v[130:131], v2 offset:256
    v_permlane32_swap_b32 v48, v50
    v_mfma_f32_32x32x16_bf16 v[176:191], v[144:147], a[200:203], v[176:191]
    v_permlane32_swap_b32 v45, v47
    v_mfma_f32_32x32x16_bf16 v[160:175], v[152:155], a[60:63], v[160:175]
    ds_read_b64_tr_b16 v[136:137], v2 offset:2048
    ds_read_b64_tr_b16 v[138:139], v2 offset:2304
    v_permlane32_swap_b32 v49, v51
    v_mfma_f32_32x32x16_bf16 v[176:191], v[152:155], a[204:207], v[176:191]
    buffer_store_dwordx4 v[44:47], v13, s[12:15], s22 offen offset:0
    s_waitcnt lgkmcnt(6)
    v_mfma_f32_32x32x16_bf16 v[160:175], v[20:23], a[64:67], v[160:175]
    ds_read_b64_tr_b16 v[144:145], v2 offset:4096
    ds_read_b64_tr_b16 v[146:147], v2 offset:4352
    v_mfma_f32_32x32x16_bf16 v[176:191], v[20:23], a[208:211], v[176:191]
    buffer_store_dwordx4 v[48:51], v13, s[12:15], s22 offen offset:16
    s_waitcnt lgkmcnt(6)
    v_mfma_f32_32x32x16_bf16 v[160:175], v[28:31], a[68:71], v[160:175]
    ds_read_b64_tr_b16 v[152:153], v2 offset:6144
    ds_read_b64_tr_b16 v[154:155], v2 offset:6400
    v_mfma_f32_32x32x16_bf16 v[176:191], v[28:31], a[212:215], v[176:191]
    v_cvt_pk_bf16_f32 v36, v96, v97
    s_waitcnt lgkmcnt(6)
    v_mfma_f32_32x32x16_bf16 v[160:175], v[128:131], a[72:75], v[160:175]
    s_waitcnt vmcnt(2)
    ds_add_u32 v19, v19
    s_add_u32 s57, s57, 0x98000
    ds_read_b64_tr_b16 v[20:21], v2 offset:8192
    ds_read_b64_tr_b16 v[22:23], v2 offset:8448
    v_cvt_pk_bf16_f32 v37, v98, v99
    v_cvt_pk_bf16_f32 v40, v100, v101
    v_mfma_f32_32x32x16_bf16 v[176:191], v[128:131], a[216:219], v[176:191]
    v_cvt_pk_bf16_f32 v41, v102, v103
    s_waitcnt lgkmcnt(7)
    v_mfma_f32_32x32x16_bf16 v[160:175], v[136:139], a[76:79], v[160:175]
    ds_read_b64_tr_b16 v[28:29], v2 offset:10240
    ds_read_b64_tr_b16 v[30:31], v2 offset:10496
    v_cvt_pk_bf16_f32 v38, v104, v105
    v_mfma_f32_32x32x16_bf16 v[176:191], v[136:139], a[220:223], v[176:191]
    v_cvt_pk_bf16_f32 v39, v106, v107
    s_waitcnt lgkmcnt(7)
    v_mfma_f32_32x32x16_bf16 v[160:175], v[144:147], a[80:83], v[160:175]
    ds_read_b64_tr_b16 v[128:129], v2 offset:12288
    ds_read_b64_tr_b16 v[130:131], v2 offset:12544
    v_cvt_pk_bf16_f32 v42, v108, v109
    v_mfma_f32_32x32x16_bf16 v[176:191], v[144:147], a[224:227], v[176:191]
    v_cvt_pk_bf16_f32 v43, v110, v111
    s_waitcnt lgkmcnt(7)
    v_mfma_f32_32x32x16_bf16 v[160:175], v[152:155], a[84:87], v[160:175]
    ds_read_b32 v18, v19
    ds_read_b64_tr_b16 v[136:137], v2 offset:14336
    ds_read_b64_tr_b16 v[138:139], v2 offset:14592
    s_nop 1
    v_mfma_f32_32x32x16_bf16 v[176:191], v[152:155], a[228:231], v[176:191]
    v_permlane32_swap_b32 v36, v38
    s_waitcnt lgkmcnt(7)
    v_mfma_f32_32x32x16_bf16 v[160:175], v[20:23], a[88:91], v[160:175]
    s_waitcnt lgkmcnt(2)
    v_readfirstlane_b32 s56, v18
    s_cmp_ge_u32 s56, s57
    s_cbranch_scc0 spin_g1_kernel_32
back_g1_kernel_33:
    s_add_u32 s18, s18, 36864
    s_cmp_eq_u32 s18, 147456
    s_cselect_b32 s18, 0, s18
    v_add_u32 v3, s18, v16
    ds_read_b64_tr_b16 v[144:145], v2 offset:16384
    ds_read_b64_tr_b16 v[146:147], v2 offset:16640
    v_permlane32_swap_b32 v40, v42
    v_mfma_f32_32x32x16_bf16 v[176:191], v[20:23], a[232:235], v[176:191]
    v_permlane32_swap_b32 v37, v39
    v_mfma_f32_32x32x16_bf16 v[160:175], v[28:31], a[92:95], v[160:175]
    ds_read_b64_tr_b16 v[152:153], v3 offset:0
    ds_read_b64_tr_b16 v[154:155], v3 offset:256
    v_permlane32_swap_b32 v41, v43
    v_mfma_f32_32x32x16_bf16 v[176:191], v[28:31], a[236:239], v[176:191]
    buffer_store_dwordx4 v[36:39], v13, s[12:15], s21 offen offset:64
    v_mfma_f32_32x32x16_bf16 v[160:175], v[128:131], a[96:99], v[160:175]
    ds_read_b64_tr_b16 v[20:21], v3 offset:2048
    ds_read_b64_tr_b16 v[22:23], v3 offset:2304
    v_mfma_f32_32x32x16_bf16 v[176:191], v[128:131], a[240:243], v[176:191]
    buffer_store_dwordx4 v[40:43], v13, s[12:15], s21 offen offset:80
    s_waitcnt lgkmcnt(6)
    v_mfma_f32_32x32x16_bf16 v[160:175], v[136:139], a[100:103], v[160:175]
    ds_read_b64_tr_b16 v[28:29], v3 offset:4096
    ds_read_b64_tr_b16 v[30:31], v3 offset:4352
    v_mfma_f32_32x32x16_bf16 v[176:191], v[136:139], a[244:247], v[176:191]
    v_cvt_pk_bf16_f32 v44, v112, v113
    s_waitcnt lgkmcnt(6)
    v_mfma_f32_32x32x16_bf16 v[160:175], v[144:147], a[104:107], v[160:175]
    ds_read_b64_tr_b16 v[128:129], v3 offset:6144
    ds_read_b64_tr_b16 v[130:131], v3 offset:6400
    v_cvt_pk_bf16_f32 v45, v114, v115
    v_mfma_f32_32x32x16_bf16 v[176:191], v[144:147], a[248:251], v[176:191]
    v_cvt_pk_bf16_f32 v48, v116, v117
    s_waitcnt lgkmcnt(6)
    v_mfma_f32_32x32x16_bf16 v[160:175], v[152:155], a[108:111], v[160:175]
    ds_read_b64_tr_b16 v[136:137], v3 offset:8192
    ds_read_b64_tr_b16 v[138:139], v3 offset:8448
    v_cvt_pk_bf16_f32 v49, v118, v119
    v_mfma_f32_32x32x16_bf16 v[176:191], v[152:155], a[252:255], v[176:191]
    v_cvt_pk_bf16_f32 v46, v120, v121
    s_waitcnt lgkmcnt(6)
    v_mfma_f32_32x32x16_bf16 v[160:175], v[20:23], a[112:115], v[160:175]
    ds_read_b64_tr_b16 v[144:145], v3 offset:10240
    ds_read_b64_tr_b16 v[146:147], v3 offset:10496
    v_cvt_pk_bf16_f32 v47, v122, v123
    v_mfma_f32_32x32x16_bf16 v[176:191], v[20:23], v[224:227], v[176:191]
    v_cvt_pk_bf16_f32 v50, v124, v125
    s_waitcnt lgkmcnt(6)
    v_mfma_f32_32x32x16_bf16 v[160:175], v[28:31], a[116:119], v[160:175]
    ds_read_b64_tr_b16 v[152:153], v3 offset:12288
    ds_read_b64_tr_b16 v[154:155], v3 offset:12544
    v_cvt_pk_bf16_f32 v51, v126, v127
    v_mfma_f32_32x32x16_bf16 v[176:191], v[28:31], v[228:231], v[176:191]
    s_nop 1
    s_waitcnt lgkmcnt(6)
    v_mfma_f32_32x32x16_bf16 v[160:175], v[128:131], a[120:123], v[160:175]
    ds_read_b64_tr_b16 v[20:21], v3 offset:14336
    ds_read_b64_tr_b16 v[22:23], v3 offset:14592
    v_permlane32_swap_b32 v44, v46
    v_mfma_f32_32x32x16_bf16 v[176:191], v[128:131], v[232:235], v[176:191]
    v_permlane32_swap_b32 v48, v50
    s_waitcnt lgkmcnt(6)
    v_mfma_f32_32x32x16_bf16 v[160:175], v[136:139], a[124:127], v[160:175]
    ds_read_b64_tr_b16 v[28:29], v3 offset:16384
    ds_read_b64_tr_b16 v[30:31], v3 offset:16640
    v_permlane32_swap_b32 v45, v47
    v_mfma_f32_32x32x16_bf16 v[176:191], v[136:139], v[236:239], v[176:191]
    v_permlane32_swap_b32 v49, v51
    s_waitcnt lgkmcnt(6)
    v_mfma_f32_32x32x16_bf16 v[160:175], v[144:147], a[128:131], v[160:175]
    buffer_store_dwordx4 v[44:47], v13, s[12:15], s22 offen offset:64
    v_mfma_f32_32x32x16_bf16 v[176:191], v[144:147], v[240:243], v[176:191]
    s_waitcnt lgkmcnt(4)
    v_mfma_f32_32x32x16_bf16 v[160:175], v[152:155], a[132:135], v[160:175]
    buffer_store_dwordx4 v[48:51], v13, s[12:15], s22 offen offset:80
    v_mfma_f32_32x32x16_bf16 v[176:191], v[152:155], v[244:247], v[176:191]
    s_waitcnt lgkmcnt(2)
    v_mfma_f32_32x32x16_bf16 v[160:175], v[20:23], a[136:139], v[160:175]
    s_add_u32 s21, s21, 256
    v_mfma_f32_32x32x16_bf16 v[176:191], v[20:23], v[248:251], v[176:191]
    s_add_u32 s22, s22, 256
    s_waitcnt lgkmcnt(0)
    v_mfma_f32_32x32x16_bf16 v[160:175], v[28:31], a[140:143], v[160:175]
    v_mfma_f32_32x32x16_bf16 v[176:191], v[28:31], v[252:255], v[176:191]
    s_add_u32 s20, s20, 256
    s_sub_u32 s21, s21, s59
    s_sub_u32 s22, s22, s59
    s_nop 15
    v_cvt_pk_bf16_f32 v36, v160, v161
    v_cvt_pk_bf16_f32 v37, v162, v163
    v_cvt_pk_bf16_f32 v40, v164, v165
    v_cvt_pk_bf16_f32 v41, v166, v167
    v_cvt_pk_bf16_f32 v38, v168, v169
    v_cvt_pk_bf16_f32 v39, v170, v171
    v_cvt_pk_bf16_f32 v42, v172, v173
    v_cvt_pk_bf16_f32 v43, v174, v175
    s_nop 1
    v_permlane32_swap_b32 v36, v38
    v_permlane32_swap_b32 v40, v42
    v_permlane32_swap_b32 v37, v39
    v_permlane32_swap_b32 v41, v43
    buffer_store_dwordx4 v[36:39], v13, s[12:15], s21 offen offset:0
    buffer_store_dwordx4 v[40:43], v13, s[12:15], s21 offen offset:16
    v_cvt_pk_bf16_f32 v44, v176, v177
    v_cvt_pk_bf16_f32 v45, v178, v179
    v_cvt_pk_bf16_f32 v48, v180, v181
    v_cvt_pk_bf16_f32 v49, v182, v183
    v_cvt_pk_bf16_f32 v46, v184, v185
    v_cvt_pk_bf16_f32 v47, v186, v187
    v_cvt_pk_bf16_f32 v50, v188, v189
    v_cvt_pk_bf16_f32 v51, v190, v191
    s_nop 1
    v_permlane32_swap_b32 v44, v46
    v_permlane32_swap_b32 v48, v50
    v_permlane32_swap_b32 v45, v47
    v_permlane32_swap_b32 v49, v51
    buffer_store_dwordx4 v[44:47], v13, s[12:15], s22 offen offset:0
    buffer_store_dwordx4 v[48:51], v13, s[12:15], s22 offen offset:16
    s_add_u32 s21, s21, 256
    s_add_u32 s22, s22, 256
    s_branch finq_g1_kernel_5
spin_g1_kernel_6:
    ds_read_b32 v18, v19
    s_waitcnt lgkmcnt(0)
    v_readfirstlane_b32 s56, v18
    s_cmp_ge_u32 s56, s57
    s_cbranch_scc0 spin_g1_kernel_6
    s_branch back_g1_kernel_7
spin_g1_kernel_8:
    ds_read_b32 v18, v19
    s_waitcnt lgkmcnt(0)
    v_readfirstlane_b32 s56, v18
    s_cmp_ge_u32 s56, s57
    s_cbranch_scc0 spin_g1_kernel_8
    s_branch back_g1_kernel_9
spin_g1_kernel_10:
    ds_read_b32 v18, v19
    s_waitcnt lgkmcnt(0)
    v_readfirstlane_b32 s56, v18
    s_cmp_ge_u32 s56, s57
    s_cbranch_scc0 spin_g1_kernel_10
    s_branch back_g1_kernel_11
spin_g1_kernel_12:
    ds_read_b32 v18, v19
    s_waitcnt lgkmcnt(0)
    v_readfirstlane_b32 s56, v18
    s_cmp_ge_u32 s56, s57
    s_cbranch_scc0 spin_g1_kernel_12
    s_branch back_g1_kernel_13
spin_g1_kernel_14:
    ds_read_b32 v18, v19
    s_waitcnt lgkmcnt(0)
    v_readfirstlane_b32 s56, v18
    s_cmp_ge_u32 s56, s57
    s_cbranch_scc0 spin_g1_kernel_14
    s_branch back_g1_kernel_15
spin_g1_kernel_16:
    ds_read_b32 v18, v19
    s_waitcnt lgkmcnt(0)
    v_readfirstlane_b32 s56, v18
    s_cmp_ge_u32 s56, s57
    s_cbranch_scc0 spin_g1_kernel_16
    s_branch back_g1_kernel_17
spin_g1_kernel_18:
    ds_read_b32 v18, v19
    s_waitcnt lgkmcnt(0)
    v_readfirstlane_b32 s56, v18
    s_cmp_ge_u32 s56, s57
    s_cbranch_scc0 spin_g1_kernel_18
    s_branch back_g1_kernel_19
spin_g1_kernel_20:
    ds_read_b32 v18, v19
    s_waitcnt lgkmcnt(0)
    v_readfirstlane_b32 s56, v18
    s_cmp_ge_u32 s56, s57
    s_cbranch_scc0 spin_g1_kernel_20
    s_branch back_g1_kernel_21
spin_g1_kernel_22:
    ds_read_b32 v18, v19
    s_waitcnt lgkmcnt(0)
    v_readfirstlane_b32 s56, v18
    s_cmp_ge_u32 s56, s57
    s_cbranch_scc0 spin_g1_kernel_22
    s_branch back_g1_kernel_23
spin_g1_kernel_24:
    ds_read_b32 v18, v19
    s_waitcnt lgkmcnt(0)
    v_readfirstlane_b32 s56, v18
    s_cmp_ge_u32 s56, s57
    s_cbranch_scc0 spin_g1_kernel_24
    s_branch back_g1_kernel_25
spin_g1_kernel_26:
    ds_read_b32 v18, v19
    s_waitcnt lgkmcnt(0)
    v_readfirstlane_b32 s56, v18
    s_cmp_ge_u32 s56, s57
    s_cbranch_scc0 spin_g1_kernel_26
    s_branch back_g1_kernel_27
spin_g1_kernel_28:
    ds_read_b32 v18, v19
    s_waitcnt lgkmcnt(0)
    v_readfirstlane_b32 s56, v18
    s_cmp_ge_u32 s56, s57
    s_cbranch_scc0 spin_g1_kernel_28
    s_branch back_g1_kernel_29
spin_g1_kernel_30:
    ds_read_b32 v18, v19
    s_waitcnt lgkmcnt(0)
    v_readfirstlane_b32 s56, v18
    s_cmp_ge_u32 s56, s57
    s_cbranch_scc0 spin_g1_kernel_30
    s_branch back_g1_kernel_31
spin_g1_kernel_32:
    ds_read_b32 v18, v19
    s_waitcnt lgkmcnt(0)
    v_readfirstlane_b32 s56, v18
    s_cmp_ge_u32 s56, s57
    s_cbranch_scc0 spin_g1_kernel_32
    s_branch back_g1_kernel_33
drain0q_g1_kernel_4:
    s_nop 15
    v_cvt_pk_bf16_f32 v36, v64, v65
    v_cvt_pk_bf16_f32 v37, v66, v67
    v_cvt_pk_bf16_f32 v40, v68, v69
    v_cvt_pk_bf16_f32 v41, v70, v71
    v_cvt_pk_bf16_f32 v38, v72, v73
    v_cvt_pk_bf16_f32 v39, v74, v75
    v_cvt_pk_bf16_f32 v42, v76, v77
    v_cvt_pk_bf16_f32 v43, v78, v79
    s_nop 1
    v_permlane32_swap_b32 v36, v38
    v_permlane32_swap_b32 v40, v42
    v_permlane32_swap_b32 v37, v39
    v_permlane32_swap_b32 v41, v43
    buffer_store_dwordx4 v[36:39], v13, s[12:15], s21 offen offset:0
    buffer_store_dwordx4 v[40:43], v13, s[12:15], s21 offen offset:16
    v_cvt_pk_bf16_f32 v44, v80, v81
    v_cvt_pk_bf16_f32 v45, v82, v83
    v_cvt_pk_bf16_f32 v48, v84, v85
    v_cvt_pk_bf16_f32 v49, v86, v87
    v_cvt_pk_bf16_f32 v46, v88, v89
    v_cvt_pk_bf16_f32 v47, v90, v91
    v_cvt_pk_bf16_f32 v50, v92, v93
    v_cvt_pk_bf16_f32 v51, v94, v95
    s_nop 1
    v_permlane32_swap_b32 v44, v46
    v_permlane32_swap_b32 v48, v50
    v_permlane32_swap_b32 v45, v47
    v_permlane32_swap_b32 v49, v51
    buffer_store_dwordx4 v[44:47], v13, s[12:15], s22 offen offset:0
    buffer_store_dwordx4 v[48:51], v13, s[12:15], s22 offen offset:16
    v_cvt_pk_bf16_f32 v36, v96, v97
    v_cvt_pk_bf16_f32 v37, v98, v99
    v_cvt_pk_bf16_f32 v40, v100, v101
    v_cvt_pk_bf16_f32 v41, v102, v103
    v_cvt_pk_bf16_f32 v38, v104, v105
    v_cvt_pk_bf16_f32 v39, v106, v107
    v_cvt_pk_bf16_f32 v42, v108, v109
    v_cvt_pk_bf16_f32 v43, v110, v111
    s_nop 1
    v_permlane32_swap_b32 v36, v38
    v_permlane32_swap_b32 v40, v42
    v_permlane32_swap_b32 v37, v39
    v_permlane32_swap_b32 v41, v43
    buffer_store_dwordx4 v[36:39], v13, s[12:15], s21 offen offset:64
    buffer_store_dwordx4 v[40:43], v13, s[12:15], s21 offen offset:80
    v_cvt_pk_bf16_f32 v44, v112, v113
    v_cvt_pk_bf16_f32 v45, v114, v115
    v_cvt_pk_bf16_f32 v48, v116, v117
    v_cvt_pk_bf16_f32 v49, v118, v119
    v_cvt_pk_bf16_f32 v46, v120, v121
    v_cvt_pk_bf16_f32 v47, v122, v123
    v_cvt_pk_bf16_f32 v50, v124, v125
    v_cvt_pk_bf16_f32 v51, v126, v127
    s_nop 1
    v_permlane32_swap_b32 v44, v46
    v_permlane32_swap_b32 v48, v50
    v_permlane32_swap_b32 v45, v47
    v_permlane32_swap_b32 v49, v51
    buffer_store_dwordx4 v[44:47], v13, s[12:15], s22 offen offset:64
    buffer_store_dwordx4 v[48:51], v13, s[12:15], s22 offen offset:80
    s_add_u32 s21, s21, 256
    s_add_u32 s22, s22, 256
finq_g1_kernel_5:
    s_branch end_g1_kernel_1
hpart_g1_kernel_3:
    s_mov_b32 s8, s44
    s_mov_b32 s9, s45
    s_mov_b32 s10, 0x510000
    s_mov_b32 s11, 0x00020000
    s_mov_b32 s16, s10
    s_add_u32 s12, s40, 0x1000000
    s_addc_u32 s13, s41, 0
    s_mov_b32 s14, 0x1200000
    s_mov_b32 s15, 0x00020000
    s_mov_b32 s48, s46
    s_mov_b32 s49, s47
    s_mov_b32 s50, 0x2400
    s_mov_b32 s51, 0x00020000
    s_mul_i32 s35, s37, 3
    s_add_u32 s35, s35, s38
    s_sub_u32 s35, s35, 1
    s_mul_i32 s20, s35, 768
    s_mov_b32 s34, s20
    s_mov_b32 s17, 2
    s_mul_i32 s29, s36, 9216
    s_lshl_b32 s37, s20, 5
    s_add_u32 s29, s29, s37
    v_mul_u32_u24 v58, 911, v0
    v_lshrrev_b32 v58, 16, v58
    v_mul_u32_u24 v59, 72, v58
    v_sub_u32 v59, v0, v59
    s_movk_i32 s71, 9216
    v_mul_lo_u32 v59, v59, s71
    v_lshl_add_u32 v59, v58, 7, v59
    s_mul_i32 s71, s33, 663552
    s_add_u32 s71, s71, s20
    s_mov_b32 s80, s80
    s_mov_b32 s81, s81
    s_mov_b32 s82, 0xa2000
    s_mov_b32 s83, 0x00020000
    s_add_u32 s76, s40, 0x2800000
    s_addc_u32 s77, s41, 0
    s_mov_b32 s78, 0xa5000
    s_mov_b32 s79, 0x00020000
    v_lshrrev_b32 v17, 6, v0
    v_and_b32 v1, 63, v0
    v_readfirstlane_b32 s26, v17
    v_lshrrev_b32 v18, 5, v1
    v_and_b32 v19, 31, v1
    s_lshr_b32 s35, s26, 1
    s_and_b32 s36, s26, 1
    v_lshlrev_b32 v54, 1, v0
    buffer_load_ushort v53, v54, s[48:51], s34 offen
    buffer_load_ushort v55, v54, s[48:51], s34 offen offset:512
    s_mul_i32 s23, s26, 9216
    s_movk_i32 s27, 9216
    s_mul_i32 s25, s36, 72
    v_bfe_u32 v17, v1, 2, 3
    v_add_u32 v17, s25, v17
    v_mul_lo_u32 v17, v17, s27
    s_lshl_b32 s25, s35, 7
    v_add_u32 v17, s25, v17
    v_lshl_add_u32 v17, v18, 6, v17
    v_and_b32 v4, 3, v1
    v_lshl_add_u32 v4, v4, 4, v17
    v_add_u32 v5, 0x12000, v4
    v_add_u32 v6, 0x12000, v5
    v_add_u32 v7, 0x12000, v6
    v_add_u32 v8, 0x12000, v7
    v_add_u32 v9, 0x12000, v8
    v_add_u32 v10, 0x12000, v9
    v_add_u32 v11, 0x12000, v10
    v_add_u32 v12, 0x12000, v11
    s_mul_i32 s92, s35, 4224
    s_add_u32 s92, s92, 76800
    v_mul_u32_u24 v17, 528, v18
    v_lshl_add_u32 v17, v19, 4, v17
    v_add_u32 v17, s92, v17
    v_add_u32 v58, 0x8400, v17
    s_lshl_b32 s91, s36, 8
    s_add_u32 s92, s92, s91
    v_mul_u32_u24 v3, 528, v3
    v_lshl_add_u32 v224, v2, 4, v3
    v_add_u32 v224, s92, v224
    v_add_u32 v225, 0x8400, v224
    v_and_b32 v38, 3, v1
    v_lshlrev_b32 v38, 4, v38
    v_mov_b32 v36, 0xffff
    v_mov_b32 v37, 0
    v_lshlrev_b64 v[36:37], v38, v[36:37]
    v_mov_b32 v38, 0x3f803f80
    v_mov_b32 v39, 0x3f803f80
    v_and_b32 v56, v36, v38
    v_and_b32 v57, v37, v38
    s_nop 1
    s_waitcnt vmcnt(19)
    v_mfma_f32_4x4x4_16b_bf16 v[208:211], v[38:39], v[64:65], 0
    v_mfma_f32_4x4x4_16b_bf16 v[212:215], v[64:65], v[64:65], 0
    v_mfma_f32_4x4x4_16b_bf16 v[216:219], v[38:39], v[66:67], 0
    v_mfma_f32_4x4x4_16b_bf16 v[220:223], v[66:67], v[66:67], 0
    s_waitcnt vmcnt(18)
    v_mfma_f32_4x4x4_16b_bf16 v[208:211], v[38:39], v[80:81], v[208:211]
    v_mfma_f32_4x4x4_16b_bf16 v[212:215], v[80:81], v[80:81], v[212:215]
    v_mfma_f32_4x4x4_16b_bf16 v[216:219], v[38:39], v[82:83], v[216:219]
    v_mfma_f32_4x4x4_16b_bf16 v[220:223], v[82:83], v[82:83], v[220:223]
    s_waitcnt vmcnt(17)
    v_mfma_f32_4x4x4_16b_bf16 v[208:211], v[38:39], v[96:97], v[208:211]
    v_mfma_f32_4x4x4_16b_bf16 v[212:215], v[96:97], v[96:97], v[212:215]
    v_mfma_f32_4x4x4_16b_bf16 v[216:219], v[38:39], v[98:99], v[216:219]
    v_mfma_f32_4x4x4_16b_bf16 v[220:223], v[98:99], v[98:99], v[220:223]
    s_waitcnt vmcnt(16)
    v_mfma_f32_4x4x4_16b_bf16 v[208:211], v[38:39], v[112:113], v[208:211]
    v_mfma_f32_4x4x4_16b_bf16 v[212:215], v[112:113], v[112:113], v[212:215]
    buffer_load_dwordx4 v[72:75], v52, s[72:75], s86 offen offset:0
    v_mfma_f32_4x4x4_16b_bf16 v[216:219], v[38:39], v[114:115], v[216:219]
    v_mfma_f32_4x4x4_16b_bf16 v[220:223], v[114:115], v[114:115], v[220:223]
    s_waitcnt vmcnt(16)
    v_mfma_f32_4x4x4_16b_bf16 v[208:211], v[38:39], v[128:129], v[208:211]
    v_mfma_f32_4x4x4_16b_bf16 v[212:215], v[128:129], v[128:129], v[212:215]
    v_mfma_f32_4x4x4_16b_bf16 v[216:219], v[38:39], v[130:131], v[216:219]
    v_mfma_f32_4x4x4_16b_bf16 v[220:223], v[130:131], v[130:131], v[220:223]
    s_waitcnt vmcnt(15)
    v_mfma_f32_4x4x4_16b_bf16 v[208:211], v[38:39], v[144:145], v[208:211]
    v_mfma_f32_4x4x4_16b_bf16 v[212:215], v[144:145], v[144:145], v[212:215]
    v_mfma_f32_4x4x4_16b_bf16 v[216:219], v[38:39], v[146:147], v[216:219]
    v_mfma_f32_4x4x4_16b_bf16 v[220:223], v[146:147], v[146:147], v[220:223]
    s_waitcnt vmcnt(14)
    v_mfma_f32_4x4x4_16b_bf16 v[208:211], v[38:39], v[160:161], v[208:211]
    v_mfma_f32_4x4x4_16b_bf16 v[212:215], v[160:161], v[160:161], v[212:215]
    v_mfma_f32_4x4x4_16b_bf16 v[216:219], v[38:39], v[162:163], v[216:219]
    v_mfma_f32_4x4x4_16b_bf16 v[220:223], v[162:163], v[162:163], v[220:223]
    s_waitcnt vmcnt(13)
    v_mfma_f32_4x4x4_16b_bf16 v[208:211], v[38:39], v[176:177], v[208:211]
    buffer_load_dwordx4 v[88:91], v52, s[72:75], s86 offen offset:128
    v_mfma_f32_4x4x4_16b_bf16 v[212:215], v[176:177], v[176:177], v[212:215]
    v_mfma_f32_4x4x4_16b_bf16 v[216:219], v[38:39], v[178:179], v[216:219]
    v_mfma_f32_4x4x4_16b_bf16 v[220:223], v[178:179], v[178:179], v[220:223]
    s_waitcnt vmcnt(13)
    v_mfma_f32_4x4x4_16b_bf16 v[208:211], v[38:39], v[192:193], v[208:211]
    v_mfma_f32_4x4x4_16b_bf16 v[212:215], v[192:193], v[192:193], v[212:215]
    v_mfma_f32_4x4x4_16b_bf16 v[216:219], v[38:39], v[194:195], v[216:219]
    v_mfma_f32_4x4x4_16b_bf16 v[220:223], v[194:195], v[194:195], v[220:223]
    s_nop 3
    v_add_f32 v2, v208, v216
    v_mov_b32_dpp v13, v212 quad_perm:[0,0,0,0] row_mask:0xf bank_mask:0xf
    s_nop 0
    v_add_f32_dpp v3, v2, v2 quad_perm:[1,0,3,2] row_mask:0xf bank_mask:0xf
    v_mov_b32_dpp v14, v220 quad_perm:[0,0,0,0] row_mask:0xf bank_mask:0xf
    s_nop 0
    v_add_f32_dpp v2, v3, v3 quad_perm:[2,3,0,1] row_mask:0xf bank_mask:0xf
    buffer_load_dwordx4 v[104:107], v52, s[72:75], s86 offen offset:256
    v_add_f32_dpp v13, v213, v13 quad_perm:[1,1,1,1] row_mask:0xf bank_mask:0xf
    v_add_f32_dpp v3, v2, v2 row_half_mirror row_mask:0xf bank_mask:0xf
    v_add_f32_dpp v14, v221, v14 quad_perm:[1,1,1,1] row_mask:0xf bank_mask:0xf
    v_mul_f32 v2, 0xbae38e39, v3
    v_add_f32_dpp v13, v214, v13 quad_perm:[2,2,2,2] row_mask:0xf bank_mask:0xf
    v_cvt_pk_bf16_f32 v44, 0, v2
    v_add_f32_dpp v14, v222, v14 quad_perm:[2,2,2,2] row_mask:0xf bank_mask:0xf
    v_cvt_pk_bf16_f32 v45, 0, v2
    v_add_f32_dpp v13, v215, v13 quad_perm:[3,3,3,3] row_mask:0xf bank_mask:0xf
    v_cvt_pk_bf16_f32 v46, 0, v2
    v_add_f32_dpp v14, v223, v14 quad_perm:[3,3,3,3] row_mask:0xf bank_mask:0xf
    v_cvt_pk_bf16_f32 v47, 0, v2
    s_nop 1
    v_mfma_f32_4x4x4_16b_bf16 v[20:23], v[56:57], v[64:65], v[44:47]
    v_add_f32 v13, v13, v14
    v_mfma_f32_4x4x4_16b_bf16 v[24:27], v[56:57], v[66:67], v[44:47]
    s_nop 0
    v_add_f32_dpp v14, v13, v13 row_half_mirror row_mask:0xf bank_mask:0xf
    buffer_load_dwordx4 v[120:123], v52, s[72:75], s86 offen offset:384
    v_mul_f32 v14, 0x3ae38e39, v14
    v_cvt_pk_bf16_f32 v64, v20, v21
    v_cvt_pk_bf16_f32 v65, v22, v23
    v_mfma_f32_4x4x4_16b_bf16 v[28:31], v[56:57], v[80:81], v[44:47]
    v_fma_f32 v13, -v2, v2, v14
    v_max_f32 v13, 0, v13
    v_cvt_pk_bf16_f32 v66, v24, v25
    v_cvt_pk_bf16_f32 v67, v26, v27
    v_mfma_f32_4x4x4_16b_bf16 v[20:23], v[56:57], v[82:83], v[44:47]
    v_cvt_pk_bf16_f32 v13, 0, v13
    v_add_f32 v13, 0x3727c5ac, v13
    v_cvt_pk_bf16_f32 v80, v28, v29
    v_cvt_pk_bf16_f32 v81, v30, v31
    v_mfma_f32_4x4x4_16b_bf16 v[24:27], v[56:57], v[96:97], v[44:47]
    v_cvt_pk_bf16_f32 v13, 0, v13
    v_cvt_pk_bf16_f32 v82, v20, v21
    v_cvt_pk_bf16_f32 v83, v22, v23
    v_mfma_f32_4x4x4_16b_bf16 v[28:31], v[56:57], v[98:99], v[44:47]
    buffer_load_dwordx4 v[136:139], v52, s[72:75], s86 offen offset:512
    v_sqrt_f32 v13, v13
    v_cvt_pk_bf16_f32 v96, v24, v25
    v_cvt_pk_bf16_f32 v97, v26, v27
    v_mfma_f32_4x4x4_16b_bf16 v[20:23], v[56:57], v[112:113], v[44:47]
    v_cvt_pk_bf16_f32 v13, 0, v13
    v_cvt_pk_bf16_f32 v98, v28, v29
    v_cvt_pk_bf16_f32 v99, v30, v31
    v_mfma_f32_4x4x4_16b_bf16 v[24:27], v[56:57], v[114:115], v[44:47]
    v_rcp_f32 v15, v13
    v_cvt_pk_bf16_f32 v112, v20, v21
    v_cvt_pk_bf16_f32 v113, v22, v23
    v_mfma_f32_4x4x4_16b_bf16 v[28:31], v[56:57], v[128:129], v[44:47]
    v_cvt_pk_bf16_f32 v54, v15, v15
    v_cvt_pk_bf16_f32 v114, v24, v25
    v_cvt_pk_bf16_f32 v115, v26, v27
    v_mfma_f32_4x4x4_16b_bf16 v[20:23], v[56:57], v[130:131], v[44:47]
    v_and_b32 v48, v54, v36
    v_cvt_pk_bf16_f32 v128, v28, v29
    buffer_load_dwordx4 v[152:155], v52, s[72:75], s86 offen offset:640
    v_cvt_pk_bf16_f32 v129, v30, v31
    v_mfma_f32_4x4x4_16b_bf16 v[24:27], v[56:57], v[144:145], v[44:47]
    v_and_b32 v49, v54, v37
    v_cvt_pk_bf16_f32 v130, v20, v21
    v_cvt_pk_bf16_f32 v131, v22, v23
    v_mfma_f32_4x4x4_16b_bf16 v[28:31], v[56:57], v[146:147], v[44:47]
    v_and_b32 v16, 0xffff0000, v54
    v_cvt_pk_bf16_f32 v144, v24, v25
    v_cvt_pk_bf16_f32 v145, v26, v27
    v_mfma_f32_4x4x4_16b_bf16 v[20:23], v[56:57], v[160:161], v[44:47]
    v_sub_f32 v15, v15, v16
    v_cvt_pk_bf16_f32 v146, v28, v29
    v_cvt_pk_bf16_f32 v147, v30, v31
    v_mfma_f32_4x4x4_16b_bf16 v[24:27], v[56:57], v[162:163], v[44:47]
    v_cvt_pk_bf16_f32 v54, v15, v15
    v_cvt_pk_bf16_f32 v160, v20, v21
    v_cvt_pk_bf16_f32 v161, v22, v23
    v_mfma_f32_4x4x4_16b_bf16 v[28:31], v[56:57], v[176:177], v[44:47]
    buffer_load_dwordx4 v[168:171], v52, s[72:75], s86 offen offset:768
    v_and_b32 v50, v54, v36
    v_cvt_pk_bf16_f32 v162, v24, v25
    v_cvt_pk_bf16_f32 v163, v26, v27
    v_mfma_f32_4x4x4_16b_bf16 v[20:23], v[56:57], v[178:179], v[44:47]
    v_and_b32 v51, v54, v37
    v_cvt_pk_bf16_f32 v176, v28, v29
    v_cvt_pk_bf16_f32 v177, v30, v31
    v_mfma_f32_4x4x4_16b_bf16 v[24:27], v[56:57], v[192:193], v[44:47]
    s_nop 0
    v_cvt_pk_bf16_f32 v178, v20, v21
    v_cvt_pk_bf16_f32 v179, v22, v23
    v_mfma_f32_4x4x4_16b_bf16 v[28:31], v[56:57], v[194:195], v[44:47]
    s_nop 0
    v_cvt_pk_bf16_f32 v192, v24, v25
    v_cvt_pk_bf16_f32 v193, v26, v27
    s_nop 1
    v_cvt_pk_bf16_f32 v194, v28, v29
    buffer_load_dwordx4 v[184:187], v52, s[72:75], s86 offen offset:896
    v_cvt_pk_bf16_f32 v195, v30, v31
    v_mfma_f32_4x4x4_16b_bf16 v[32:35], v[50:51], v[64:65], 0
    v_mfma_f32_4x4x4_16b_bf16 v[40:43], v[50:51], v[66:67], 0
    v_mfma_f32_4x4x4_16b_bf16 v[208:211], v[50:51], v[80:81], 0
    v_mfma_f32_4x4x4_16b_bf16 v[32:35], v[48:49], v[64:65], v[32:35]
    v_mfma_f32_4x4x4_16b_bf16 v[40:43], v[48:49], v[66:67], v[40:43]
    v_mfma_f32_4x4x4_16b_bf16 v[208:211], v[48:49], v[80:81], v[208:211]
    v_mfma_f32_4x4x4_16b_bf16 v[20:23], v[50:51], v[82:83], 0
    s_nop 1
    v_cvt_pk_bf16_f32 v64, v32, v33
    v_mfma_f32_4x4x4_16b_bf16 v[24:27], v[50:51], v[96:97], 0
    v_cvt_pk_bf16_f32 v65, v34, v35
    v_mfma_f32_4x4x4_16b_bf16 v[28:31], v[50:51], v[98:99], 0
    v_cvt_pk_bf16_f32 v66, v40, v41
    v_mfma_f32_4x4x4_16b_bf16 v[20:23], v[48:49], v[82:83], v[20:23]
    v_cvt_pk_bf16_f32 v67, v42, v43
    v_mfma_f32_4x4x4_16b_bf16 v[24:27], v[48:49], v[96:97], v[24:27]
    buffer_load_dwordx4 v[200:203], v52, s[72:75], s86 offen offset:1024
    v_cvt_pk_bf16_f32 v80, v208, v209
    v_mfma_f32_4x4x4_16b_bf16 v[28:31], v[48:49], v[98:99], v[28:31]
    v_cvt_pk_bf16_f32 v81, v210, v211
    v_mfma_f32_4x4x4_16b_bf16 v[32:35], v[50:51], v[112:113], 0
    v_cvt_pk_bf16_f32 v82, v20, v21
    v_mfma_f32_4x4x4_16b_bf16 v[40:43], v[50:51], v[114:115], 0
    v_cvt_pk_bf16_f32 v83, v22, v23
    ds_write_b128 v224, v[64:67] offset:0
    v_mfma_f32_4x4x4_16b_bf16 v[208:211], v[50:51], v[128:129], 0
    v_cvt_pk_bf16_f32 v96, v24, v25
    v_mfma_f32_4x4x4_16b_bf16 v[32:35], v[48:49], v[112:113], v[32:35]
    v_cvt_pk_bf16_f32 v97, v26, v27
    v_mfma_f32_4x4x4_16b_bf16 v[40:43], v[48:49], v[114:115], v[40:43]
    v_cvt_pk_bf16_f32 v98, v28, v29
    v_mfma_f32_4x4x4_16b_bf16 v[208:211], v[48:49], v[128:129], v[208:211]
    v_cvt_pk_bf16_f32 v99, v30, v31
    v_mfma_f32_4x4x4_16b_bf16 v[20:23], v[50:51], v[130:131], 0
    v_cvt_pk_bf16_f32 v112, v32, v33
    buffer_load_dwordx4 v[76:79], v52, s[72:75], s87 offen offset:0
    v_mfma_f32_4x4x4_16b_bf16 v[24:27], v[50:51], v[144:145], 0
    v_cvt_pk_bf16_f32 v113, v34, v35
    ds_write_b128 v224, v[80:83] offset:8448
    v_mfma_f32_4x4x4_16b_bf16 v[28:31], v[50:51], v[146:147], 0
    v_cvt_pk_bf16_f32 v114, v40, v41
    v_mfma_f32_4x4x4_16b_bf16 v[20:23], v[48:49], v[130:131], v[20:23]
    v_cvt_pk_bf16_f32 v115, v42, v43
    ds_write_b128 v224, v[96:99] offset:16896
    v_mfma_f32_4x4x4_16b_bf16 v[24:27], v[48:49], v[144:145], v[24:27]
    v_cvt_pk_bf16_f32 v128, v208, v209
    v_mfma_f32_4x4x4_16b_bf16 v[28:31], v[48:49], v[146:147], v[28:31]
    v_cvt_pk_bf16_f32 v129, v210, v211
    v_mfma_f32_4x4x4_16b_bf16 v[32:35], v[50:51], v[160:161], 0
    v_cvt_pk_bf16_f32 v130, v20, v21
    v_mfma_f32_4x4x4_16b_bf16 v[40:43], v[50:51], v[162:163], 0
    v_cvt_pk_bf16_f32 v131, v22, v23
    ds_write_b128 v224, v[112:115] offset:25344
    v_mfma_f32_4x4x4_16b_bf16 v[208:211], v[50:51], v[176:177], 0
    buffer_load_dwordx4 v[92:95], v52, s[72:75], s87 offen offset:128
    v_cvt_pk_bf16_f32 v144, v24, v25
    v_mfma_f32_4x4x4_16b_bf16 v[32:35], v[48:49], v[160:161], v[32:35]
    v_cvt_pk_bf16_f32 v145, v26, v27
    v_mfma_f32_4x4x4_16b_bf16 v[40:43], v[48:49], v[162:163], v[40:43]
    v_cvt_pk_bf16_f32 v146, v28, v29
    v_mfma_f32_4x4x4_16b_bf16 v[208:211], v[48:49], v[176:177], v[208:211]
    v_cvt_pk_bf16_f32 v147, v30, v31
    v_mfma_f32_4x4x4_16b_bf16 v[20:23], v[50:51], v[178:179], 0
    v_cvt_pk_bf16_f32 v160, v32, v33
    v_mfma_f32_4x4x4_16b_bf16 v[24:27], v[50:51], v[192:193], 0
    v_cvt_pk_bf16_f32 v161, v34, v35
    ds_write_b128 v225, v[128:131] offset:0
    v_mfma_f32_4x4x4_16b_bf16 v[28:31], v[50:51], v[194:195], 0
    v_cvt_pk_bf16_f32 v162, v40, v41
    v_mfma_f32_4x4x4_16b_bf16 v[20:23], v[48:49], v[178:179], v[20:23]
    v_cvt_pk_bf16_f32 v163, v42, v43
    ds_write_b128 v225, v[144:147] offset:8448
    v_mfma_f32_4x4x4_16b_bf16 v[24:27], v[48:49], v[192:193], v[24:27]
    buffer_load_dwordx4 v[108:111], v52, s[72:75], s87 offen offset:256
    v_cvt_pk_bf16_f32 v176, v208, v209
    v_mfma_f32_4x4x4_16b_bf16 v[28:31], v[48:49], v[194:195], v[28:31]
    v_cvt_pk_bf16_f32 v177, v210, v211
    v_cvt_pk_bf16_f32 v178, v20, v21
    v_cvt_pk_bf16_f32 v179, v22, v23
    ds_write_b128 v225, v[160:163] offset:16896
    v_cvt_pk_bf16_f32 v192, v24, v25
    v_cvt_pk_bf16_f32 v193, v26, v27
    v_cvt_pk_bf16_f32 v194, v28, v29
    v_cvt_pk_bf16_f32 v195, v30, v31
    s_waitcnt vmcnt(22)
    v_mfma_f32_4x4x4_16b_bf16 v[208:211], v[38:39], v[68:69], 0
    v_mfma_f32_4x4x4_16b_bf16 v[212:215], v[68:69], v[68:69], 0
    ds_write_b128 v225, v[176:179] offset:25344
    v_mfma_f32_4x4x4_16b_bf16 v[216:219], v[38:39], v[70:71], 0
    v_mfma_f32_4x4x4_16b_bf16 v[220:223], v[70:71], v[70:71], 0
    ds_write_b128 v225, v[192:195] offset:33792
    s_waitcnt vmcnt(21)
    v_mfma_f32_4x4x4_16b_bf16 v[208:211], v[38:39], v[84:85], v[208:211]
    buffer_load_dwordx4 v[124:127], v52, s[72:75], s87 offen offset:384
    v_mfma_f32_4x4x4_16b_bf16 v[212:215], v[84:85], v[84:85], v[212:215]
    v_mfma_f32_4x4x4_16b_bf16 v[216:219], v[38:39], v[86:87], v[216:219]
    v_mfma_f32_4x4x4_16b_bf16 v[220:223], v[86:87], v[86:87], v[220:223]
    s_waitcnt vmcnt(21)
    v_mfma_f32_4x4x4_16b_bf16 v[208:211], v[38:39], v[100:101], v[208:211]
    v_mfma_f32_4x4x4_16b_bf16 v[212:215], v[100:101], v[100:101], v[212:215]
    v_mfma_f32_4x4x4_16b_bf16 v[216:219], v[38:39], v[102:103], v[216:219]
    v_mfma_f32_4x4x4_16b_bf16 v[220:223], v[102:103], v[102:103], v[220:223]
    s_waitcnt vmcnt(20)
    v_mfma_f32_4x4x4_16b_bf16 v[208:211], v[38:39], v[116:117], v[208:211]
    v_mfma_f32_4x4x4_16b_bf16 v[212:215], v[116:117], v[116:117], v[212:215]
    v_mfma_f32_4x4x4_16b_bf16 v[216:219], v[38:39], v[118:119], v[216:219]
    v_mfma_f32_4x4x4_16b_bf16 v[220:223], v[118:119], v[118:119], v[220:223]
    s_waitcnt vmcnt(19)
    v_mfma_f32_4x4x4_16b_bf16 v[208:211], v[38:39], v[132:133], v[208:211]
    v_mfma_f32_4x4x4_16b_bf16 v[212:215], v[132:133], v[132:133], v[212:215]
    v_mfma_f32_4x4x4_16b_bf16 v[216:219], v[38:39], v[134:135], v[216:219]
    v_mfma_f32_4x4x4_16b_bf16 v[220:223], v[134:135], v[134:135], v[220:223]
    buffer_load_dwordx4 v[140:143], v52, s[72:75], s87 offen offset:512
    s_waitcnt vmcnt(19)
    v_mfma_f32_4x4x4_16b_bf16 v[208:211], v[38:39], v[148:149], v[208:211]
    v_mfma_f32_4x4x4_16b_bf16 v[212:215], v[148:149], v[148:149], v[212:215]
    v_mfma_f32_4x4x4_16b_bf16 v[216:219], v[38:39], v[150:151], v[216:219]
    v_mfma_f32_4x4x4_16b_bf16 v[220:223], v[150:151], v[150:151], v[220:223]
    s_waitcnt vmcnt(18)
    v_mfma_f32_4x4x4_16b_bf16 v[208:211], v[38:39], v[164:165], v[208:211]
    v_mfma_f32_4x4x4_16b_bf16 v[212:215], v[164:165], v[164:165], v[212:215]
    v_mfma_f32_4x4x4_16b_bf16 v[216:219], v[38:39], v[166:167], v[216:219]
    v_mfma_f32_4x4x4_16b_bf16 v[220:223], v[166:167], v[166:167], v[220:223]
    s_waitcnt vmcnt(17)
    v_mfma_f32_4x4x4_16b_bf16 v[208:211], v[38:39], v[180:181], v[208:211]
    v_mfma_f32_4x4x4_16b_bf16 v[212:215], v[180:181], v[180:181], v[212:215]
    v_mfma_f32_4x4x4_16b_bf16 v[216:219], v[38:39], v[182:183], v[216:219]
    v_mfma_f32_4x4x4_16b_bf16 v[220:223], v[182:183], v[182:183], v[220:223]
    s_waitcnt vmcnt(16)
    v_mfma_f32_4x4x4_16b_bf16 v[208:211], v[38:39], v[196:197], v[208:211]
    v_mfma_f32_4x4x4_16b_bf16 v[212:215], v[196:197], v[196:197], v[212:215]
    buffer_load_dwordx4 v[156:159], v52, s[72:75], s87 offen offset:640
    v_mfma_f32_4x4x4_16b_bf16 v[216:219], v[38:39], v[198:199], v[216:219]
    v_mfma_f32_4x4x4_16b_bf16 v[220:223], v[198:199], v[198:199], v[220:223]
    s_nop 3
    v_add_f32 v2, v208, v216
    v_mov_b32_dpp v13, v212 quad_perm:[0,0,0,0] row_mask:0xf bank_mask:0xf
    s_nop 0
    v_add_f32_dpp v3, v2, v2 quad_perm:[1,0,3,2] row_mask:0xf bank_mask:0xf
    v_mov_b32_dpp v14, v220 quad_perm:[0,0,0,0] row_mask:0xf bank_mask:0xf
    s_nop 0
    v_add_f32_dpp v2, v3, v3 quad_perm:[2,3,0,1] row_mask:0xf bank_mask:0xf
    v_add_f32_dpp v13, v213, v13 quad_perm:[1,1,1,1] row_mask:0xf bank_mask:0xf
    s_nop 0
    v_add_f32_dpp v3, v2, v2 row_half_mirror row_mask:0xf bank_mask:0xf
    v_add_f32_dpp v14, v221, v14 quad_perm:[1,1,1,1] row_mask:0xf bank_mask:0xf
    v_mul_f32 v2, 0xbae38e39, v3
    buffer_load_dwordx4 v[172:175], v52, s[72:75], s87 offen offset:768
    v_add_f32_dpp v13, v214, v13 quad_perm:[2,2,2,2] row_mask:0xf bank_mask:0xf
    v_cvt_pk_bf16_f32 v44, 0, v2
    v_add_f32_dpp v14, v222, v14 quad_perm:[2,2,2,2] row_mask:0xf bank_mask:0xf
    v_cvt_pk_bf16_f32 v45, 0, v2
    v_add_f32_dpp v13, v215, v13 quad_perm:[3,3,3,3] row_mask:0xf bank_mask:0xf
    v_cvt_pk_bf16_f32 v46, 0, v2
    v_add_f32_dpp v14, v223, v14 quad_perm:[3,3,3,3] row_mask:0xf bank_mask:0xf
    v_cvt_pk_bf16_f32 v47, 0, v2
    s_nop 1
    v_mfma_f32_4x4x4_16b_bf16 v[20:23], v[56:57], v[68:69], v[44:47]
    v_add_f32 v13, v13, v14
    v_mfma_f32_4x4x4_16b_bf16 v[24:27], v[56:57], v[70:71], v[44:47]
    s_nop 0
    v_add_f32_dpp v14, v13, v13 row_half_mirror row_mask:0xf bank_mask:0xf
    v_mul_f32 v14, 0x3ae38e39, v14
    v_cvt_pk_bf16_f32 v68, v20, v21
    v_cvt_pk_bf16_f32 v69, v22, v23
    buffer_load_dwordx4 v[188:191], v52, s[72:75], s87 offen offset:896
    v_mfma_f32_4x4x4_16b_bf16 v[28:31], v[56:57], v[84:85], v[44:47]
    v_fma_f32 v13, -v2, v2, v14
    v_max_f32 v13, 0, v13
    v_cvt_pk_bf16_f32 v70, v24, v25
    v_cvt_pk_bf16_f32 v71, v26, v27
    v_mfma_f32_4x4x4_16b_bf16 v[20:23], v[56:57], v[86:87], v[44:47]
    v_cvt_pk_bf16_f32 v13, 0, v13
    v_add_f32 v13, 0x3727c5ac, v13
    v_cvt_pk_bf16_f32 v84, v28, v29
    v_cvt_pk_bf16_f32 v85, v30, v31
    v_mfma_f32_4x4x4_16b_bf16 v[24:27], v[56:57], v[100:101], v[44:47]
    v_cvt_pk_bf16_f32 v13, 0, v13
    v_cvt_pk_bf16_f32 v86, v20, v21
    v_cvt_pk_bf16_f32 v87, v22, v23
    v_mfma_f32_4x4x4_16b_bf16 v[28:31], v[56:57], v[102:103], v[44:47]
    v_sqrt_f32 v13, v13
    v_cvt_pk_bf16_f32 v100, v24, v25
    v_cvt_pk_bf16_f32 v101, v26, v27
    buffer_load_dwordx4 v[204:207], v52, s[72:75], s87 offen offset:1024
    v_mfma_f32_4x4x4_16b_bf16 v[20:23], v[56:57], v[116:117], v[44:47]
    v_cvt_pk_bf16_f32 v13, 0, v13
    v_cvt_pk_bf16_f32 v102, v28, v29
    v_cvt_pk_bf16_f32 v103, v30, v31
    v_mfma_f32_4x4x4_16b_bf16 v[24:27], v[56:57], v[118:119], v[44:47]
    v_rcp_f32 v15, v13
    v_cvt_pk_bf16_f32 v116, v20, v21
    v_cvt_pk_bf16_f32 v117, v22, v23
    v_mfma_f32_4x4x4_16b_bf16 v[28:31], v[56:57], v[132:133], v[44:47]
    v_cvt_pk_bf16_f32 v54, v15, v15
    v_cvt_pk_bf16_f32 v118, v24, v25
    v_cvt_pk_bf16_f32 v119, v26, v27
    v_mfma_f32_4x4x4_16b_bf16 v[20:23], v[56:57], v[134:135], v[44:47]
    v_and_b32 v48, v54, v36
    v_cvt_pk_bf16_f32 v132, v28, v29
    v_cvt_pk_bf16_f32 v133, v30, v31
    v_mfma_f32_4x4x4_16b_bf16 v[24:27], v[56:57], v[148:149], v[44:47]
    v_and_b32 v49, v54, v37
    buffer_load_dword v63, v59, s[8:11], s71 offen
    v_cvt_pk_bf16_f32 v134, v20, v21
    v_cvt_pk_bf16_f32 v135, v22, v23
    v_mfma_f32_4x4x4_16b_bf16 v[28:31], v[56:57], v[150:151], v[44:47]
    v_and_b32 v16, 0xffff0000, v54
    v_cvt_pk_bf16_f32 v148, v24, v25
    v_cvt_pk_bf16_f32 v149, v26, v27
    v_mfma_f32_4x4x4_16b_bf16 v[20:23], v[56:57], v[164:165], v[44:47]
    v_sub_f32 v15, v15, v16
    v_cvt_pk_bf16_f32 v150, v28, v29
    v_cvt_pk_bf16_f32 v151, v30, v31
    v_mfma_f32_4x4x4_16b_bf16 v[24:27], v[56:57], v[166:167], v[44:47]
    v_cvt_pk_bf16_f32 v54, v15, v15
    v_cvt_pk_bf16_f32 v164, v20, v21
    v_cvt_pk_bf16_f32 v165, v22, v23
    v_mfma_f32_4x4x4_16b_bf16 v[28:31], v[56:57], v[180:181], v[44:47]
    v_and_b32 v50, v54, v36
    v_cvt_pk_bf16_f32 v166, v24, v25
    v_cvt_pk_bf16_f32 v167, v26, v27
    s_cmp_ge_u32 s17, 0
    s_cselect_b32 s10, s16, 0
    s_add_u32 s27, s20, 0
    s_add_u32 m0, s23, 0
    s_nop 0
    buffer_load_dwordx4 v4, s[8:11], s27 offen lds
    v_mfma_f32_4x4x4_16b_bf16 v[20:23], v[56:57], v[182:183], v[44:47]
    v_and_b32 v51, v54, v37
    v_cvt_pk_bf16_f32 v180, v28, v29
    v_cvt_pk_bf16_f32 v181, v30, v31
    v_mfma_f32_4x4x4_16b_bf16 v[24:27], v[56:57], v[196:197], v[44:47]
    s_nop 0
    v_cvt_pk_bf16_f32 v182, v20, v21
    v_cvt_pk_bf16_f32 v183, v22, v23
    v_mfma_f32_4x4x4_16b_bf16 v[28:31], v[56:57], v[198:199], v[44:47]
    s_nop 0
    v_cvt_pk_bf16_f32 v196, v24, v25
    v_cvt_pk_bf16_f32 v197, v26, v27
    s_nop 1
    v_cvt_pk_bf16_f32 v198, v28, v29
    v_cvt_pk_bf16_f32 v199, v30, v31
    v_mfma_f32_4x4x4_16b_bf16 v[32:35], v[50:51], v[68:69], 0
    v_mfma_f32_4x4x4_16b_bf16 v[40:43], v[50:51], v[70:71], 0
    s_cmp_ge_u32 s17, 0
    s_cselect_b32 s10, s16, 0
    s_add_u32 s27, s20, 0
    s_add_u32 m0, s23, 1024
    s_nop 0
    buffer_load_dwordx4 v5, s[8:11], s27 offen lds
    v_mfma_f32_4x4x4_16b_bf16 v[208:211], v[50:51], v[84:85], 0
    v_mfma_f32_4x4x4_16b_bf16 v[32:35], v[48:49], v[68:69], v[32:35]
    v_mfma_f32_4x4x4_16b_bf16 v[40:43], v[48:49], v[70:71], v[40:43]
    v_mfma_f32_4x4x4_16b_bf16 v[208:211], v[48:49], v[84:85], v[208:211]
    v_mfma_f32_4x4x4_16b_bf16 v[20:23], v[50:51], v[86:87], 0
    s_nop 1
    v_cvt_pk_bf16_f32 v68, v32, v33
    v_mfma_f32_4x4x4_16b_bf16 v[24:27], v[50:51], v[100:101], 0
    v_cvt_pk_bf16_f32 v69, v34, v35
    v_mfma_f32_4x4x4_16b_bf16 v[28:31], v[50:51], v[102:103], 0
    v_cvt_pk_bf16_f32 v70, v40, v41
    v_mfma_f32_4x4x4_16b_bf16 v[20:23], v[48:49], v[86:87], v[20:23]
    v_cvt_pk_bf16_f32 v71, v42, v43
    v_mfma_f32_4x4x4_16b_bf16 v[24:27], v[48:49], v[100:101], v[24:27]
    v_cvt_pk_bf16_f32 v84, v208, v209
    v_mfma_f32_4x4x4_16b_bf16 v[28:31], v[48:49], v[102:103], v[28:31]
    v_cvt_pk_bf16_f32 v85, v210, v211
    s_cmp_ge_u32 s17, 0
    s_cselect_b32 s10, s16, 0
    s_add_u32 s27, s20, 0
    s_add_u32 m0, s23, 2048
    s_nop 0
    buffer_load_dwordx4 v6, s[8:11], s27 offen lds
    v_mfma_f32_4x4x4_16b_bf16 v[32:35], v[50:51], v[116:117], 0
    v_cvt_pk_bf16_f32 v86, v20, v21
    v_mfma_f32_4x4x4_16b_bf16 v[40:43], v[50:51], v[118:119], 0
    v_cvt_pk_bf16_f32 v87, v22, v23
    ds_write_b128 v224, v[68:71] offset:128
    v_mfma_f32_4x4x4_16b_bf16 v[208:211], v[50:51], v[132:133], 0
    v_cvt_pk_bf16_f32 v100, v24, v25
    v_mfma_f32_4x4x4_16b_bf16 v[32:35], v[48:49], v[116:117], v[32:35]
    v_cvt_pk_bf16_f32 v101, v26, v27
    v_mfma_f32_4x4x4_16b_bf16 v[40:43], v[48:49], v[118:119], v[40:43]
    v_cvt_pk_bf16_f32 v102, v28, v29
    v_mfma_f32_4x4x4_16b_bf16 v[208:211], v[48:49], v[132:133], v[208:211]
    v_cvt_pk_bf16_f32 v103, v30, v31
    v_mfma_f32_4x4x4_16b_bf16 v[20:23], v[50:51], v[134:135], 0
    v_cvt_pk_bf16_f32 v116, v32, v33
    v_mfma_f32_4x4x4_16b_bf16 v[24:27], v[50:51], v[148:149], 0
    v_cvt_pk_bf16_f32 v117, v34, v35
    ds_write_b128 v224, v[84:87] offset:8576
    s_cmp_ge_u32 s17, 0
    s_cselect_b32 s10, s16, 0
    s_add_u32 s27, s20, 0
    s_add_u32 m0, s23, 3072
    s_nop 0
    buffer_load_dwordx4 v7, s[8:11], s27 offen lds
    v_mfma_f32_4x4x4_16b_bf16 v[28:31], v[50:51], v[150:151], 0
    v_cvt_pk_bf16_f32 v118, v40, v41
    v_mfma_f32_4x4x4_16b_bf16 v[20:23], v[48:49], v[134:135], v[20:23]
    v_cvt_pk_bf16_f32 v119, v42, v43
    ds_write_b128 v224, v[100:103] offset:17024
    v_mfma_f32_4x4x4_16b_bf16 v[24:27], v[48:49], v[148:149], v[24:27]
    v_cvt_pk_bf16_f32 v132, v208, v209
    v_mfma_f32_4x4x4_16b_bf16 v[28:31], v[48:49], v[150:151], v[28:31]
    v_cvt_pk_bf16_f32 v133, v210, v211
    v_mfma_f32_4x4x4_16b_bf16 v[32:35], v[50:51], v[164:165], 0
    v_cvt_pk_bf16_f32 v134, v20, v21
    v_mfma_f32_4x4x4_16b_bf16 v[40:43], v[50:51], v[166:167], 0
    v_cvt_pk_bf16_f32 v135, v22, v23
    ds_write_b128 v224, v[116:119] offset:25472
    v_mfma_f32_4x4x4_16b_bf16 v[208:211], v[50:51], v[180:181], 0
    v_cvt_pk_bf16_f32 v148, v24, v25
    v_mfma_f32_4x4x4_16b_bf16 v[32:35], v[48:49], v[164:165], v[32:35]
    v_cvt_pk_bf16_f32 v149, v26, v27
    s_cmp_ge_u32 s17, 0
    s_cselect_b32 s10, s16, 0
    s_add_u32 s27, s20, 0
    s_add_u32 m0, s23, 4096
    s_nop 0
    buffer_load_dwordx4 v8, s[8:11], s27 offen lds
    v_mfma_f32_4x4x4_16b_bf16 v[40:43], v[48:49], v[166:167], v[40:43]
    v_cvt_pk_bf16_f32 v150, v28, v29
    v_mfma_f32_4x4x4_16b_bf16 v[208:211], v[48:49], v[180:181], v[208:211]
    v_cvt_pk_bf16_f32 v151, v30, v31
    v_mfma_f32_4x4x4_16b_bf16 v[20:23], v[50:51], v[182:183], 0
    v_cvt_pk_bf16_f32 v164, v32, v33
    v_mfma_f32_4x4x4_16b_bf16 v[24:27], v[50:51], v[196:197], 0
    v_cvt_pk_bf16_f32 v165, v34, v35
    ds_write_b128 v225, v[132:135] offset:128
    v_mfma_f32_4x4x4_16b_bf16 v[28:31], v[50:51], v[198:199], 0
    v_cvt_pk_bf16_f32 v166, v40, v41
    v_mfma_f32_4x4x4_16b_bf16 v[20:23], v[48:49], v[182:183], v[20:23]
    v_cvt_pk_bf16_f32 v167, v42, v43
    ds_write_b128 v225, v[148:151] offset:8576
    v_mfma_f32_4x4x4_16b_bf16 v[24:27], v[48:49], v[196:197], v[24:27]
    v_cvt_pk_bf16_f32 v180, v208, v209
    v_mfma_f32_4x4x4_16b_bf16 v[28:31], v[48:49], v[198:199], v[28:31]
    v_cvt_pk_bf16_f32 v181, v210, v211
    s_cmp_ge_u32 s17, 0
    s_cselect_b32 s10, s16, 0
    s_add_u32 s27, s20, 0
    s_add_u32 m0, s23, 5120
    s_nop 0
    buffer_load_dwordx4 v9, s[8:11], s27 offen lds
    v_cvt_pk_bf16_f32 v182, v20, v21
    v_cvt_pk_bf16_f32 v183, v22, v23
    ds_write_b128 v225, v[164:167] offset:17024
    v_cvt_pk_bf16_f32 v196, v24, v25
    v_cvt_pk_bf16_f32 v197, v26, v27
    v_cvt_pk_bf16_f32 v198, v28, v29
    v_cvt_pk_bf16_f32 v199, v30, v31
    s_waitcnt vmcnt(24)
    v_mfma_f32_4x4x4_16b_bf16 v[208:211], v[38:39], v[72:73], 0
    v_mfma_f32_4x4x4_16b_bf16 v[212:215], v[72:73], v[72:73], 0
    ds_write_b128 v225, v[180:183] offset:25472
    v_mfma_f32_4x4x4_16b_bf16 v[216:219], v[38:39], v[74:75], 0
    v_mfma_f32_4x4x4_16b_bf16 v[220:223], v[74:75], v[74:75], 0
    ds_write_b128 v225, v[196:199] offset:33920
    s_waitcnt vmcnt(23)
    v_mfma_f32_4x4x4_16b_bf16 v[208:211], v[38:39], v[88:89], v[208:211]
    v_mfma_f32_4x4x4_16b_bf16 v[212:215], v[88:89], v[88:89], v[212:215]
    v_mfma_f32_4x4x4_16b_bf16 v[216:219], v[38:39], v[90:91], v[216:219]
    s_cmp_ge_u32 s17, 0
    s_cselect_b32 s10, s16, 0
    s_add_u32 s27, s20, 0
    s_add_u32 m0, s23, 6144
    s_nop 0
    buffer_load_dwordx4 v10, s[8:11], s27 offen lds
    v_mfma_f32_4x4x4_16b_bf16 v[220:223], v[90:91], v[90:91], v[220:223]
    s_waitcnt vmcnt(23)
    v_mfma_f32_4x4x4_16b_bf16 v[208:211], v[38:39], v[104:105], v[208:211]
    v_mfma_f32_4x4x4_16b_bf16 v[212:215], v[104:105], v[104:105], v[212:215]
    v_mfma_f32_4x4x4_16b_bf16 v[216:219], v[38:39], v[106:107], v[216:219]
    v_mfma_f32_4x4x4_16b_bf16 v[220:223], v[106:107], v[106:107], v[220:223]
    s_waitcnt vmcnt(22)
    v_mfma_f32_4x4x4_16b_bf16 v[208:211], v[38:39], v[120:121], v[208:211]
    v_mfma_f32_4x4x4_16b_bf16 v[212:215], v[120:121], v[120:121], v[212:215]
    v_mfma_f32_4x4x4_16b_bf16 v[216:219], v[38:39], v[122:123], v[216:219]
    v_mfma_f32_4x4x4_16b_bf16 v[220:223], v[122:123], v[122:123], v[220:223]
    s_waitcnt vmcnt(21)
    v_mfma_f32_4x4x4_16b_bf16 v[208:211], v[38:39], v[136:137], v[208:211]
    v_mfma_f32_4x4x4_16b_bf16 v[212:215], v[136:137], v[136:137], v[212:215]
    v_mfma_f32_4x4x4_16b_bf16 v[216:219], v[38:39], v[138:139], v[216:219]
    v_mfma_f32_4x4x4_16b_bf16 v[220:223], v[138:139], v[138:139], v[220:223]
    s_waitcnt vmcnt(20)
    v_mfma_f32_4x4x4_16b_bf16 v[208:211], v[38:39], v[152:153], v[208:211]
    s_cmp_ge_u32 s17, 0
    s_cselect_b32 s10, s16, 0
    s_add_u32 s27, s20, 0
    s_add_u32 m0, s23, 7168
    s_nop 0
    buffer_load_dwordx4 v11, s[8:11], s27 offen lds
    v_mfma_f32_4x4x4_16b_bf16 v[212:215], v[152:153], v[152:153], v[212:215]
    v_mfma_f32_4x4x4_16b_bf16 v[216:219], v[38:39], v[154:155], v[216:219]
    v_mfma_f32_4x4x4_16b_bf16 v[220:223], v[154:155], v[154:155], v[220:223]
    s_waitcnt vmcnt(20)
    v_mfma_f32_4x4x4_16b_bf16 v[208:211], v[38:39], v[168:169], v[208:211]
    v_mfma_f32_4x4x4_16b_bf16 v[212:215], v[168:169], v[168:169], v[212:215]
    v_mfma_f32_4x4x4_16b_bf16 v[216:219], v[38:39], v[170:171], v[216:219]
    v_mfma_f32_4x4x4_16b_bf16 v[220:223], v[170:171], v[170:171], v[220:223]
    s_waitcnt vmcnt(19)
    v_mfma_f32_4x4x4_16b_bf16 v[208:211], v[38:39], v[184:185], v[208:211]
    v_mfma_f32_4x4x4_16b_bf16 v[212:215], v[184:185], v[184:185], v[212:215]
    v_mfma_f32_4x4x4_16b_bf16 v[216:219], v[38:39], v[186:187], v[216:219]
    v_mfma_f32_4x4x4_16b_bf16 v[220:223], v[186:187], v[186:187], v[220:223]
    s_waitcnt vmcnt(18)
    v_mfma_f32_4x4x4_16b_bf16 v[208:211], v[38:39], v[200:201], v[208:211]
    v_mfma_f32_4x4x4_16b_bf16 v[212:215], v[200:201], v[200:201], v[212:215]
    v_mfma_f32_4x4x4_16b_bf16 v[216:219], v[38:39], v[202:203], v[216:219]
    v_mfma_f32_4x4x4_16b_bf16 v[220:223], v[202:203], v[202:203], v[220:223]
    s_cmp_ge_u32 s17, 0
    s_cselect_b32 s10, s16, 0
    s_add_u32 s27, s20, 0
    s_add_u32 m0, s23, 8192
    s_nop 0
    buffer_load_dwordx4 v12, s[8:11], s27 offen lds
    s_waitcnt lgkmcnt(0)
    s_barrier
    ds_read_b128 a[0:3], v17 offset:0
    ds_read_b128 a[4:7], v17 offset:1056
    ds_read_b128 a[8:11], v17 offset:2112
    v_add_f32 v2, v208, v216
    v_mov_b32_dpp v13, v212 quad_perm:[0,0,0,0] row_mask:0xf bank_mask:0xf
    ds_read_b128 a[12:15], v17 offset:3168
    v_add_f32_dpp v3, v2, v2 quad_perm:[1,0,3,2] row_mask:0xf bank_mask:0xf
    v_mov_b32_dpp v14, v220 quad_perm:[0,0,0,0] row_mask:0xf bank_mask:0xf
    ds_read_b128 a[16:19], v17 offset:8448
    v_add_f32_dpp v2, v3, v3 quad_perm:[2,3,0,1] row_mask:0xf bank_mask:0xf
    v_add_f32_dpp v13, v213, v13 quad_perm:[1,1,1,1] row_mask:0xf bank_mask:0xf
    ds_read_b128 a[20:23], v17 offset:9504
    v_add_f32_dpp v3, v2, v2 row_half_mirror row_mask:0xf bank_mask:0xf
    v_add_f32_dpp v14, v221, v14 quad_perm:[1,1,1,1] row_mask:0xf bank_mask:0xf
    ds_read_b128 a[24:27], v17 offset:10560
    v_mul_f32 v2, 0xbae38e39, v3
    s_cmp_ge_u32 s17, 0
    s_cselect_b32 s10, s16, 0
    s_add_u32 s27, s20, 1327104
    s_add_u32 m0, s23, 36864
    s_nop 0
    buffer_load_dwordx4 v4, s[8:11], s27 offen lds
    v_add_f32_dpp v13, v214, v13 quad_perm:[2,2,2,2] row_mask:0xf bank_mask:0xf
    v_cvt_pk_bf16_f32 v44, 0, v2
    v_add_f32_dpp v14, v222, v14 quad_perm:[2,2,2,2] row_mask:0xf bank_mask:0xf
    v_cvt_pk_bf16_f32 v45, 0, v2
    v_add_f32_dpp v13, v215, v13 quad_perm:[3,3,3,3] row_mask:0xf bank_mask:0xf
    v_cvt_pk_bf16_f32 v46, 0, v2
    v_add_f32_dpp v14, v223, v14 quad_perm:[3,3,3,3] row_mask:0xf bank_mask:0xf
    v_cvt_pk_bf16_f32 v47, 0, v2
    s_nop 1
    v_mfma_f32_4x4x4_16b_bf16 v[20:23], v[56:57], v[72:73], v[44:47]
    v_add_f32 v13, v13, v14
    ds_read_b128 a[28:31], v17 offset:11616
    ds_read_b128 a[32:35], v17 offset:16896
    v_mfma_f32_4x4x4_16b_bf16 v[24:27], v[56:57], v[74:75], v[44:47]
    v_add_f32_dpp v14, v13, v13 row_half_mirror row_mask:0xf bank_mask:0xf
    v_mul_f32 v14, 0x3ae38e39, v14
    ds_read_b128 a[36:39], v17 offset:17952
    s_cmp_ge_u32 s17, 0
    s_cselect_b32 s10, s16, 0
    s_add_u32 s27, s20, 1327104
    s_add_u32 m0, s23, 37888
    s_nop 0
    buffer_load_dwordx4 v5, s[8:11], s27 offen lds
    v_cvt_pk_bf16_f32 v72, v20, v21
    v_cvt_pk_bf16_f32 v73, v22, v23
    v_mfma_f32_4x4x4_16b_bf16 v[28:31], v[56:57], v[88:89], v[44:47]
    v_fma_f32 v13, -v2, v2, v14
    v_max_f32 v13, 0, v13
    v_cvt_pk_bf16_f32 v74, v24, v25
    v_cvt_pk_bf16_f32 v75, v26, v27
    v_mfma_f32_4x4x4_16b_bf16 v[20:23], v[56:57], v[90:91], v[44:47]
    v_cvt_pk_bf16_f32 v13, 0, v13
    v_add_f32 v13, 0x3727c5ac, v13
    ds_read_b128 a[40:43], v17 offset:19008
    v_cvt_pk_bf16_f32 v88, v28, v29
    v_cvt_pk_bf16_f32 v89, v30, v31
    v_mfma_f32_4x4x4_16b_bf16 v[24:27], v[56:57], v[104:105], v[44:47]
    v_cvt_pk_bf16_f32 v13, 0, v13
    v_cvt_pk_bf16_f32 v90, v20, v21
    v_cvt_pk_bf16_f32 v91, v22, v23
    v_mfma_f32_4x4x4_16b_bf16 v[28:31], v[56:57], v[106:107], v[44:47]
    s_cmp_ge_u32 s17, 0
    s_cselect_b32 s10, s16, 0
    s_add_u32 s27, s20, 1327104
    s_add_u32 m0, s23, 38912
    s_nop 0
    buffer_load_dwordx4 v6, s[8:11], s27 offen lds
    v_sqrt_f32 v13, v13
    ds_read_b128 a[44:47], v17 offset:20064
    v_cvt_pk_bf16_f32 v104, v24, v25
    v_cvt_pk_bf16_f32 v105, v26, v27
    v_mfma_f32_4x4x4_16b_bf16 v[20:23], v[56:57], v[120:121], v[44:47]
    v_cvt_pk_bf16_f32 v13, 0, v13
    v_cvt_pk_bf16_f32 v106, v28, v29
    v_cvt_pk_bf16_f32 v107, v30, v31
    v_mfma_f32_4x4x4_16b_bf16 v[24:27], v[56:57], v[122:123], v[44:47]
    v_rcp_f32 v15, v13
    ds_read_b128 a[48:51], v17 offset:25344
    v_cvt_pk_bf16_f32 v120, v20, v21
    v_cvt_pk_bf16_f32 v121, v22, v23
    v_mfma_f32_4x4x4_16b_bf16 v[28:31], v[56:57], v[136:137], v[44:47]
    v_cvt_pk_bf16_f32 v54, v15, v15
    v_cvt_pk_bf16_f32 v122, v24, v25
    v_cvt_pk_bf16_f32 v123, v26, v27
    v_mfma_f32_4x4x4_16b_bf16 v[20:23], v[56:57], v[138:139], v[44:47]
    s_cmp_ge_u32 s17, 0
    s_cselect_b32 s10, s16, 0
    s_add_u32 s27, s20, 1327104
    s_add_u32 m0, s23, 39936
    s_nop 0
    buffer_load_dwordx4 v7, s[8:11], s27 offen lds
    v_and_b32 v48, v54, v36
    ds_read_b128 a[52:55], v17 offset:26400
    v_cvt_pk_bf16_f32 v136, v28, v29
    v_cvt_pk_bf16_f32 v137, v30, v31
    v_mfma_f32_4x4x4_16b_bf16 v[24:27], v[56:57], v[152:153], v[44:47]
    v_and_b32 v49, v54, v37
    v_cvt_pk_bf16_f32 v138, v20, v21
    v_cvt_pk_bf16_f32 v139, v22, v23
    v_mfma_f32_4x4x4_16b_bf16 v[28:31], v[56:57], v[154:155], v[44:47]
    v_and_b32 v16, 0xffff0000, v54
    ds_read_b128 a[56:59], v17 offset:27456
    v_cvt_pk_bf16_f32 v152, v24, v25
    v_cvt_pk_bf16_f32 v153, v26, v27
    v_mfma_f32_4x4x4_16b_bf16 v[20:23], v[56:57], v[168:169], v[44:47]
    v_sub_f32 v15, v15, v16
    v_cvt_pk_bf16_f32 v154, v28, v29
    v_cvt_pk_bf16_f32 v155, v30, v31
    v_mfma_f32_4x4x4_16b_bf16 v[24:27], v[56:57], v[170:171], v[44:47]
    s_cmp_ge_u32 s17, 0
    s_cselect_b32 s10, s16, 0
    s_add_u32 s27, s20, 1327104
    s_add_u32 m0, s23, 40960
    s_nop 0
    buffer_load_dwordx4 v8, s[8:11], s27 offen lds
    v_cvt_pk_bf16_f32 v54, v15, v15
    ds_read_b128 a[60:63], v17 offset:28512
    v_cvt_pk_bf16_f32 v168, v20, v21
    v_cvt_pk_bf16_f32 v169, v22, v23
    v_mfma_f32_4x4x4_16b_bf16 v[28:31], v[56:57], v[184:185], v[44:47]
    v_and_b32 v50, v54, v36
    v_cvt_pk_bf16_f32 v170, v24, v25
    v_cvt_pk_bf16_f32 v171, v26, v27
    v_mfma_f32_4x4x4_16b_bf16 v[20:23], v[56:57], v[186:187], v[44:47]
    v_and_b32 v51, v54, v37
    ds_read_b128 a[64:67], v58 offset:0
    v_cvt_pk_bf16_f32 v184, v28, v29
    v_cvt_pk_bf16_f32 v185, v30, v31
    v_mfma_f32_4x4x4_16b_bf16 v[24:27], v[56:57], v[200:201], v[44:47]
    v_cvt_pk_bf16_f32 v186, v20, v21
    v_cvt_pk_bf16_f32 v187, v22, v23
    v_mfma_f32_4x4x4_16b_bf16 v[28:31], v[56:57], v[202:203], v[44:47]
    ds_read_b128 a[68:71], v58 offset:1056
    s_cmp_ge_u32 s17, 0
    s_cselect_b32 s10, s16, 0
    s_add_u32 s27, s20, 1327104
    s_add_u32 m0, s23, 41984
    s_nop 0
    buffer_load_dwordx4 v9, s[8:11], s27 offen lds
    v_cvt_pk_bf16_f32 v200, v24, v25
    v_cvt_pk_bf16_f32 v201, v26, v27
    v_cvt_pk_bf16_f32 v202, v28, v29
    v_cvt_pk_bf16_f32 v203, v30, v31
    ds_read_b128 a[72:75], v58 offset:2112
    v_mfma_f32_4x4x4_16b_bf16 v[32:35], v[50:51], v[72:73], 0
    v_mfma_f32_4x4x4_16b_bf16 v[40:43], v[50:51], v[74:75], 0
    ds_read_b128 a[76:79], v58 offset:3168
    v_mfma_f32_4x4x4_16b_bf16 v[208:211], v[50:51], v[88:89], 0
    v_mfma_f32_4x4x4_16b_bf16 v[32:35], v[48:49], v[72:73], v[32:35]
    ds_read_b128 a[80:83], v58 offset:8448
    v_mfma_f32_4x4x4_16b_bf16 v[40:43], v[48:49], v[74:75], v[40:43]
    v_mfma_f32_4x4x4_16b_bf16 v[208:211], v[48:49], v[88:89], v[208:211]
    ds_read_b128 a[84:87], v58 offset:9504
    v_mfma_f32_4x4x4_16b_bf16 v[20:23], v[50:51], v[90:91], 0
    v_cvt_pk_bf16_f32 v72, v32, v33
    v_mfma_f32_4x4x4_16b_bf16 v[24:27], v[50:51], v[104:105], 0
    v_cvt_pk_bf16_f32 v73, v34, v35
    s_cmp_ge_u32 s17, 0
    s_cselect_b32 s10, s16, 0
    s_add_u32 s27, s20, 1327104
    s_add_u32 m0, s23, 43008
    s_nop 0
    buffer_load_dwordx4 v10, s[8:11], s27 offen lds
    ds_read_b128 a[88:91], v58 offset:10560
    v_mfma_f32_4x4x4_16b_bf16 v[28:31], v[50:51], v[106:107], 0
    v_cvt_pk_bf16_f32 v74, v40, v41
    v_mfma_f32_4x4x4_16b_bf16 v[20:23], v[48:49], v[90:91], v[20:23]
    v_cvt_pk_bf16_f32 v75, v42, v43
    ds_read_b128 a[92:95], v58 offset:11616
    v_mfma_f32_4x4x4_16b_bf16 v[24:27], v[48:49], v[104:105], v[24:27]
    v_cvt_pk_bf16_f32 v88, v208, v209
    v_mfma_f32_4x4x4_16b_bf16 v[28:31], v[48:49], v[106:107], v[28:31]
    v_cvt_pk_bf16_f32 v89, v210, v211
    ds_read_b128 a[96:99], v58 offset:16896
    v_mfma_f32_4x4x4_16b_bf16 v[32:35], v[50:51], v[120:121], 0
    v_cvt_pk_bf16_f32 v90, v20, v21
    v_mfma_f32_4x4x4_16b_bf16 v[40:43], v[50:51], v[122:123], 0
    v_cvt_pk_bf16_f32 v91, v22, v23
    ds_read_b128 a[100:103], v58 offset:17952
    v_mfma_f32_4x4x4_16b_bf16 v[208:211], v[50:51], v[136:137], 0
    v_cvt_pk_bf16_f32 v104, v24, v25
    s_cmp_ge_u32 s17, 0
    s_cselect_b32 s10, s16, 0
    s_add_u32 s27, s20, 1327104
    s_add_u32 m0, s23, 44032
    s_nop 0
    buffer_load_dwordx4 v11, s[8:11], s27 offen lds
    v_mfma_f32_4x4x4_16b_bf16 v[32:35], v[48:49], v[120:121], v[32:35]
    v_cvt_pk_bf16_f32 v105, v26, v27
    ds_read_b128 a[104:107], v58 offset:19008
    v_mfma_f32_4x4x4_16b_bf16 v[40:43], v[48:49], v[122:123], v[40:43]
    v_cvt_pk_bf16_f32 v106, v28, v29
    v_mfma_f32_4x4x4_16b_bf16 v[208:211], v[48:49], v[136:137], v[208:211]
    v_cvt_pk_bf16_f32 v107, v30, v31
    ds_read_b128 a[108:111], v58 offset:20064
    v_mfma_f32_4x4x4_16b_bf16 v[20:23], v[50:51], v[138:139], 0
    v_cvt_pk_bf16_f32 v120, v32, v33
    v_mfma_f32_4x4x4_16b_bf16 v[24:27], v[50:51], v[152:153], 0
    v_cvt_pk_bf16_f32 v121, v34, v35
    ds_read_b128 a[112:115], v58 offset:25344
    v_mfma_f32_4x4x4_16b_bf16 v[28:31], v[50:51], v[154:155], 0
    v_cvt_pk_bf16_f32 v122, v40, v41
    v_mfma_f32_4x4x4_16b_bf16 v[20:23], v[48:49], v[138:139], v[20:23]
    v_cvt_pk_bf16_f32 v123, v42, v43
    ds_read_b128 a[116:119], v58 offset:26400
    s_cmp_ge_u32 s17, 0
    s_cselect_b32 s10, s16, 0
    s_add_u32 s27, s20, 1327104
    s_add_u32 m0, s23, 45056
    s_nop 0
    buffer_load_dwordx4 v12, s[8:11], s27 offen lds
    v_mfma_f32_4x4x4_16b_bf16 v[24:27], v[48:49], v[152:153], v[24:27]
    v_cvt_pk_bf16_f32 v136, v208, v209
    v_mfma_f32_4x4x4_16b_bf16 v[28:31], v[48:49], v[154:155], v[28:31]
    v_cvt_pk_bf16_f32 v137, v210, v211
    ds_read_b128 a[120:123], v58 offset:27456
    v_mfma_f32_4x4x4_16b_bf16 v[32:35], v[50:51], v[168:169], 0
    v_cvt_pk_bf16_f32 v138, v20, v21
    v_mfma_f32_4x4x4_16b_bf16 v[40:43], v[50:51], v[170:171], 0
    v_cvt_pk_bf16_f32 v139, v22, v23
    ds_read_b128 a[124:127], v58 offset:28512
    v_mfma_f32_4x4x4_16b_bf16 v[208:211], v[50:51], v[184:185], 0
    v_cvt_pk_bf16_f32 v152, v24, v25
    v_mfma_f32_4x4x4_16b_bf16 v[32:35], v[48:49], v[168:169], v[32:35]
    v_cvt_pk_bf16_f32 v153, v26, v27
    ds_read_b128 a[128:131], v58 offset:33792
    v_mfma_f32_4x4x4_16b_bf16 v[40:43], v[48:49], v[170:171], v[40:43]
    v_cvt_pk_bf16_f32 v154, v28, v29
    v_mfma_f32_4x4x4_16b_bf16 v[208:211], v[48:49], v[184:185], v[208:211]
    buffer_load_dword v63, v59, s[8:11], s71 offen offset:384
    v_cvt_pk_bf16_f32 v155, v30, v31
    ds_read_b128 a[132:135], v58 offset:34848
    v_mfma_f32_4x4x4_16b_bf16 v[20:23], v[50:51], v[186:187], 0
    v_cvt_pk_bf16_f32 v168, v32, v33
    v_mfma_f32_4x4x4_16b_bf16 v[24:27], v[50:51], v[200:201], 0
    v_cvt_pk_bf16_f32 v169, v34, v35
    ds_read_b128 a[136:139], v58 offset:35904
    v_mfma_f32_4x4x4_16b_bf16 v[28:31], v[50:51], v[202:203], 0
    v_cvt_pk_bf16_f32 v170, v40, v41
    v_mfma_f32_4x4x4_16b_bf16 v[20:23], v[48:49], v[186:187], v[20:23]
    v_cvt_pk_bf16_f32 v171, v42, v43
    ds_read_b128 a[140:143], v58 offset:36960
    v_mfma_f32_4x4x4_16b_bf16 v[24:27], v[48:49], v[200:201], v[24:27]
    v_cvt_pk_bf16_f32 v184, v208, v209
    v_mfma_f32_4x4x4_16b_bf16 v[28:31], v[48:49], v[202:203], v[28:31]
    v_cvt_pk_bf16_f32 v185, v210, v211
    v_cvt_pk_bf16_f32 v186, v20, v21
    v_cvt_pk_bf16_f32 v187, v22, v23
    v_cvt_pk_bf16_f32 v200, v24, v25
    v_cvt_pk_bf16_f32 v201, v26, v27
    v_cvt_pk_bf16_f32 v202, v28, v29
    v_cvt_pk_bf16_f32 v203, v30, v31
    s_waitcnt vmcnt(28)
    v_mfma_f32_4x4x4_16b_bf16 v[208:211], v[38:39], v[76:77], 0
    v_mfma_f32_4x4x4_16b_bf16 v[212:215], v[76:77], v[76:77], 0
    v_mfma_f32_4x4x4_16b_bf16 v[216:219], v[38:39], v[78:79], 0
    v_mfma_f32_4x4x4_16b_bf16 v[220:223], v[78:79], v[78:79], 0
    s_waitcnt vmcnt(27)
    v_mfma_f32_4x4x4_16b_bf16 v[208:211], v[38:39], v[92:93], v[208:211]
    v_mfma_f32_4x4x4_16b_bf16 v[212:215], v[92:93], v[92:93], v[212:215]
    v_mfma_f32_4x4x4_16b_bf16 v[216:219], v[38:39], v[94:95], v[216:219]
    v_mfma_f32_4x4x4_16b_bf16 v[220:223], v[94:95], v[94:95], v[220:223]
    s_waitcnt vmcnt(26)
    v_mfma_f32_4x4x4_16b_bf16 v[208:211], v[38:39], v[108:109], v[208:211]
    v_mfma_f32_4x4x4_16b_bf16 v[212:215], v[108:109], v[108:109], v[212:215]
    v_mfma_f32_4x4x4_16b_bf16 v[216:219], v[38:39], v[110:111], v[216:219]
    v_mfma_f32_4x4x4_16b_bf16 v[220:223], v[110:111], v[110:111], v[220:223]
    s_waitcnt vmcnt(25)
    v_mfma_f32_4x4x4_16b_bf16 v[208:211], v[38:39], v[124:125], v[208:211]
    v_mfma_f32_4x4x4_16b_bf16 v[212:215], v[124:125], v[124:125], v[212:215]
    v_mfma_f32_4x4x4_16b_bf16 v[216:219], v[38:39], v[126:127], v[216:219]
    v_mfma_f32_4x4x4_16b_bf16 v[220:223], v[126:127], v[126:127], v[220:223]
    s_waitcnt vmcnt(24)
    v_mfma_f32_4x4x4_16b_bf16 v[208:211], v[38:39], v[140:141], v[208:211]
    v_mfma_f32_4x4x4_16b_bf16 v[212:215], v[140:141], v[140:141], v[212:215]
    v_mfma_f32_4x4x4_16b_bf16 v[216:219], v[38:39], v[142:143], v[216:219]
    v_mfma_f32_4x4x4_16b_bf16 v[220:223], v[142:143], v[142:143], v[220:223]
    s_waitcnt vmcnt(23)
    v_mfma_f32_4x4x4_16b_bf16 v[208:211], v[38:39], v[156:157], v[208:211]
    v_mfma_f32_4x4x4_16b_bf16 v[212:215], v[156:157], v[156:157], v[212:215]
    v_mfma_f32_4x4x4_16b_bf16 v[216:219], v[38:39], v[158:159], v[216:219]
    v_mfma_f32_4x4x4_16b_bf16 v[220:223], v[158:159], v[158:159], v[220:223]
    s_waitcnt vmcnt(22)
    v_mfma_f32_4x4x4_16b_bf16 v[208:211], v[38:39], v[172:173], v[208:211]
    v_mfma_f32_4x4x4_16b_bf16 v[212:215], v[172:173], v[172:173], v[212:215]
    v_mfma_f32_4x4x4_16b_bf16 v[216:219], v[38:39], v[174:175], v[216:219]
    v_mfma_f32_4x4x4_16b_bf16 v[220:223], v[174:175], v[174:175], v[220:223]
    s_waitcnt vmcnt(21)
    v_mfma_f32_4x4x4_16b_bf16 v[208:211], v[38:39], v[188:189], v[208:211]
    v_mfma_f32_4x4x4_16b_bf16 v[212:215], v[188:189], v[188:189], v[212:215]
    v_mfma_f32_4x4x4_16b_bf16 v[216:219], v[38:39], v[190:191], v[216:219]
    v_mfma_f32_4x4x4_16b_bf16 v[220:223], v[190:191], v[190:191], v[220:223]
    s_waitcnt vmcnt(20)
    v_mfma_f32_4x4x4_16b_bf16 v[208:211], v[38:39], v[204:205], v[208:211]
    v_mfma_f32_4x4x4_16b_bf16 v[212:215], v[204:205], v[204:205], v[212:215]
    v_mfma_f32_4x4x4_16b_bf16 v[216:219], v[38:39], v[206:207], v[216:219]
    v_mfma_f32_4x4x4_16b_bf16 v[220:223], v[206:207], v[206:207], v[220:223]
    s_waitcnt lgkmcnt(0)
    s_barrier
    ds_write_b128 v224, v[72:75] offset:0
    ds_write_b128 v224, v[88:91] offset:8448
    ds_write_b128 v224, v[104:107] offset:16896
    v_add_f32 v2, v208, v216
    v_mov_b32_dpp v13, v212 quad_perm:[0,0,0,0] row_mask:0xf bank_mask:0xf
    ds_write_b128 v224, v[120:123] offset:25344
    v_add_f32_dpp v3, v2, v2 quad_perm:[1,0,3,2] row_mask:0xf bank_mask:0xf
    v_mov_b32_dpp v14, v220 quad_perm:[0,0,0,0] row_mask:0xf bank_mask:0xf
    ds_write_b128 v225, v[136:139] offset:0
    v_add_f32_dpp v2, v3, v3 quad_perm:[2,3,0,1] row_mask:0xf bank_mask:0xf
    v_add_f32_dpp v13, v213, v13 quad_perm:[1,1,1,1] row_mask:0xf bank_mask:0xf
    ds_write_b128 v225, v[152:155] offset:8448
    v_add_f32_dpp v3, v2, v2 row_half_mirror row_mask:0xf bank_mask:0xf
    v_add_f32_dpp v14, v221, v14 quad_perm:[1,1,1,1] row_mask:0xf bank_mask:0xf
    ds_write_b128 v225, v[168:171] offset:16896
    v_mul_f32 v2, 0xbae38e39, v3
    v_add_f32_dpp v13, v214, v13 quad_perm:[2,2,2,2] row_mask:0xf bank_mask:0xf
    v_cvt_pk_bf16_f32 v44, 0, v2
    v_add_f32_dpp v14, v222, v14 quad_perm:[2,2,2,2] row_mask:0xf bank_mask:0xf
    v_cvt_pk_bf16_f32 v45, 0, v2
    v_add_f32_dpp v13, v215, v13 quad_perm:[3,3,3,3] row_mask:0xf bank_mask:0xf
    v_cvt_pk_bf16_f32 v46, 0, v2
    v_add_f32_dpp v14, v223, v14 quad_perm:[3,3,3,3] row_mask:0xf bank_mask:0xf
    v_cvt_pk_bf16_f32 v47, 0, v2
    s_nop 1
    v_mfma_f32_4x4x4_16b_bf16 v[20:23], v[56:57], v[76:77], v[44:47]
    v_add_f32 v13, v13, v14
    ds_write_b128 v225, v[184:187] offset:25344
    ds_write_b128 v225, v[200:203] offset:33792
    v_mfma_f32_4x4x4_16b_bf16 v[24:27], v[56:57], v[78:79], v[44:47]
    v_add_f32_dpp v14, v13, v13 row_half_mirror row_mask:0xf bank_mask:0xf
    v_mul_f32 v14, 0x3ae38e39, v14
    v_cvt_pk_bf16_f32 v76, v20, v21
    v_cvt_pk_bf16_f32 v77, v22, v23
    v_mfma_f32_4x4x4_16b_bf16 v[28:31], v[56:57], v[92:93], v[44:47]
    v_fma_f32 v13, -v2, v2, v14
    v_max_f32 v13, 0, v13
    v_cvt_pk_bf16_f32 v78, v24, v25
    v_cvt_pk_bf16_f32 v79, v26, v27
    v_mfma_f32_4x4x4_16b_bf16 v[20:23], v[56:57], v[94:95], v[44:47]
    v_cvt_pk_bf16_f32 v13, 0, v13
    v_add_f32 v13, 0x3727c5ac, v13
    v_cvt_pk_bf16_f32 v92, v28, v29
    v_cvt_pk_bf16_f32 v93, v30, v31
    v_mfma_f32_4x4x4_16b_bf16 v[24:27], v[56:57], v[108:109], v[44:47]
    v_cvt_pk_bf16_f32 v13, 0, v13
    v_cvt_pk_bf16_f32 v94, v20, v21
    v_cvt_pk_bf16_f32 v95, v22, v23
    v_mfma_f32_4x4x4_16b_bf16 v[28:31], v[56:57], v[110:111], v[44:47]
    v_sqrt_f32 v13, v13
    v_cvt_pk_bf16_f32 v108, v24, v25
    v_cvt_pk_bf16_f32 v109, v26, v27
    v_mfma_f32_4x4x4_16b_bf16 v[20:23], v[56:57], v[124:125], v[44:47]
    v_cvt_pk_bf16_f32 v13, 0, v13
    v_cvt_pk_bf16_f32 v110, v28, v29
    v_cvt_pk_bf16_f32 v111, v30, v31
    v_mfma_f32_4x4x4_16b_bf16 v[24:27], v[56:57], v[126:127], v[44:47]
    v_rcp_f32 v15, v13
    v_cvt_pk_bf16_f32 v124, v20, v21
    v_cvt_pk_bf16_f32 v125, v22, v23
    v_mfma_f32_4x4x4_16b_bf16 v[28:31], v[56:57], v[140:141], v[44:47]
    v_cvt_pk_bf16_f32 v54, v15, v15
    v_cvt_pk_bf16_f32 v126, v24, v25
    v_cvt_pk_bf16_f32 v127, v26, v27
    v_mfma_f32_4x4x4_16b_bf16 v[20:23], v[56:57], v[142:143], v[44:47]
    v_and_b32 v48, v54, v36
    v_cvt_pk_bf16_f32 v140, v28, v29
    v_cvt_pk_bf16_f32 v141, v30, v31
    v_mfma_f32_4x4x4_16b_bf16 v[24:27], v[56:57], v[156:157], v[44:47]
    v_and_b32 v49, v54, v37
    v_cvt_pk_bf16_f32 v142, v20, v21
    v_cvt_pk_bf16_f32 v143, v22, v23
    v_mfma_f32_4x4x4_16b_bf16 v[28:31], v[56:57], v[158:159], v[44:47]
    v_and_b32 v16, 0xffff0000, v54
    v_cvt_pk_bf16_f32 v156, v24, v25
    v_cvt_pk_bf16_f32 v157, v26, v27
    v_mfma_f32_4x4x4_16b_bf16 v[20:23], v[56:57], v[172:173], v[44:47]
    v_sub_f32 v15, v15, v16
    v_cvt_pk_bf16_f32 v158, v28, v29
    v_cvt_pk_bf16_f32 v159, v30, v31
    v_mfma_f32_4x4x4_16b_bf16 v[24:27], v[56:57], v[174:175], v[44:47]
    v_cvt_pk_bf16_f32 v54, v15, v15
    v_cvt_pk_bf16_f32 v172, v20, v21
    v_cvt_pk_bf16_f32 v173, v22, v23
    v_mfma_f32_4x4x4_16b_bf16 v[28:31], v[56:57], v[188:189], v[44:47]
    v_and_b32 v50, v54, v36
    v_cvt_pk_bf16_f32 v174, v24, v25
    v_cvt_pk_bf16_f32 v175, v26, v27
    v_mfma_f32_4x4x4_16b_bf16 v[20:23], v[56:57], v[190:191], v[44:47]
    v_and_b32 v51, v54, v37
    v_cvt_pk_bf16_f32 v188, v28, v29
    v_cvt_pk_bf16_f32 v189, v30, v31
    v_mfma_f32_4x4x4_16b_bf16 v[24:27], v[56:57], v[204:205], v[44:47]
    s_nop 0
    v_cvt_pk_bf16_f32 v190, v20, v21
    v_cvt_pk_bf16_f32 v191, v22, v23
    v_mfma_f32_4x4x4_16b_bf16 v[28:31], v[56:57], v[206:207], v[44:47]
    s_nop 0
    v_cvt_pk_bf16_f32 v204, v24, v25
    v_cvt_pk_bf16_f32 v205, v26, v27
    s_nop 1
    v_cvt_pk_bf16_f32 v206, v28, v29
    v_cvt_pk_bf16_f32 v207, v30, v31
    v_mfma_f32_4x4x4_16b_bf16 v[32:35], v[50:51], v[76:77], 0
    v_mfma_f32_4x4x4_16b_bf16 v[40:43], v[50:51], v[78:79], 0
    v_mfma_f32_4x4x4_16b_bf16 v[208:211], v[50:51], v[92:93], 0
    v_mfma_f32_4x4x4_16b_bf16 v[32:35], v[48:49], v[76:77], v[32:35]
    v_mfma_f32_4x4x4_16b_bf16 v[40:43], v[48:49], v[78:79], v[40:43]
    v_mfma_f32_4x4x4_16b_bf16 v[208:211], v[48:49], v[92:93], v[208:211]
    v_mfma_f32_4x4x4_16b_bf16 v[20:23], v[50:51], v[94:95], 0
    s_nop 1
    v_cvt_pk_bf16_f32 v76, v32, v33
    v_mfma_f32_4x4x4_16b_bf16 v[24:27], v[50:51], v[108:109], 0
    v_cvt_pk_bf16_f32 v77, v34, v35
    v_mfma_f32_4x4x4_16b_bf16 v[28:31], v[50:51], v[110:111], 0
    v_cvt_pk_bf16_f32 v78, v40, v41
    v_mfma_f32_4x4x4_16b_bf16 v[20:23], v[48:49], v[94:95], v[20:23]
    v_cvt_pk_bf16_f32 v79, v42, v43
    v_mfma_f32_4x4x4_16b_bf16 v[24:27], v[48:49], v[108:109], v[24:27]
    v_cvt_pk_bf16_f32 v92, v208, v209
    v_mfma_f32_4x4x4_16b_bf16 v[28:31], v[48:49], v[110:111], v[28:31]
    v_cvt_pk_bf16_f32 v93, v210, v211
    v_mfma_f32_4x4x4_16b_bf16 v[32:35], v[50:51], v[124:125], 0
    v_cvt_pk_bf16_f32 v94, v20, v21
    v_mfma_f32_4x4x4_16b_bf16 v[40:43], v[50:51], v[126:127], 0
    v_cvt_pk_bf16_f32 v95, v22, v23
    ds_write_b128 v224, v[76:79] offset:128
    v_mfma_f32_4x4x4_16b_bf16 v[208:211], v[50:51], v[140:141], 0
    v_cvt_pk_bf16_f32 v108, v24, v25
    v_mfma_f32_4x4x4_16b_bf16 v[32:35], v[48:49], v[124:125], v[32:35]
    v_cvt_pk_bf16_f32 v109, v26, v27
    v_mfma_f32_4x4x4_16b_bf16 v[40:43], v[48:49], v[126:127], v[40:43]
    v_cvt_pk_bf16_f32 v110, v28, v29
    v_mfma_f32_4x4x4_16b_bf16 v[208:211], v[48:49], v[140:141], v[208:211]
    v_cvt_pk_bf16_f32 v111, v30, v31
    v_mfma_f32_4x4x4_16b_bf16 v[20:23], v[50:51], v[142:143], 0
    v_cvt_pk_bf16_f32 v124, v32, v33
    v_mfma_f32_4x4x4_16b_bf16 v[24:27], v[50:51], v[156:157], 0
    v_cvt_pk_bf16_f32 v125, v34, v35
    ds_write_b128 v224, v[92:95] offset:8576
    v_mfma_f32_4x4x4_16b_bf16 v[28:31], v[50:51], v[158:159], 0
    v_cvt_pk_bf16_f32 v126, v40, v41
    v_mfma_f32_4x4x4_16b_bf16 v[20:23], v[48:49], v[142:143], v[20:23]
    v_cvt_pk_bf16_f32 v127, v42, v43
    ds_write_b128 v224, v[108:111] offset:17024
    v_mfma_f32_4x4x4_16b_bf16 v[24:27], v[48:49], v[156:157], v[24:27]
    v_cvt_pk_bf16_f32 v140, v208, v209
    v_mfma_f32_4x4x4_16b_bf16 v[28:31], v[48:49], v[158:159], v[28:31]
    v_cvt_pk_bf16_f32 v141, v210, v211
    v_mfma_f32_4x4x4_16b_bf16 v[32:35], v[50:51], v[172:173], 0
    v_cvt_pk_bf16_f32 v142, v20, v21
    v_mfma_f32_4x4x4_16b_bf16 v[40:43], v[50:51], v[174:175], 0
    v_cvt_pk_bf16_f32 v143, v22, v23
    ds_write_b128 v224, v[124:127] offset:25472
    v_mfma_f32_4x4x4_16b_bf16 v[208:211], v[50:51], v[188:189], 0
    v_cvt_pk_bf16_f32 v156, v24, v25
    v_mfma_f32_4x4x4_16b_bf16 v[32:35], v[48:49], v[172:173], v[32:35]
    v_cvt_pk_bf16_f32 v157, v26, v27
    v_mfma_f32_4x4x4_16b_bf16 v[40:43], v[48:49], v[174:175], v[40:43]
    v_cvt_pk_bf16_f32 v158, v28, v29
    v_mfma_f32_4x4x4_16b_bf16 v[208:211], v[48:49], v[188:189], v[208:211]
    v_cvt_pk_bf16_f32 v159, v30, v31
    v_mfma_f32_4x4x4_16b_bf16 v[20:23], v[50:51], v[190:191], 0
    v_cvt_pk_bf16_f32 v172, v32, v33
    v_mfma_f32_4x4x4_16b_bf16 v[24:27], v[50:51], v[204:205], 0
    v_cvt_pk_bf16_f32 v173, v34, v35
    ds_write_b128 v225, v[140:143] offset:128
    v_mfma_f32_4x4x4_16b_bf16 v[28:31], v[50:51], v[206:207], 0
    v_cvt_pk_bf16_f32 v174, v40, v41
    v_mfma_f32_4x4x4_16b_bf16 v[20:23], v[48:49], v[190:191], v[20:23]
    v_cvt_pk_bf16_f32 v175, v42, v43
    ds_write_b128 v225, v[156:159] offset:8576
    v_mfma_f32_4x4x4_16b_bf16 v[24:27], v[48:49], v[204:205], v[24:27]
    v_cvt_pk_bf16_f32 v188, v208, v209
    v_mfma_f32_4x4x4_16b_bf16 v[28:31], v[48:49], v[206:207], v[28:31]
    v_cvt_pk_bf16_f32 v189, v210, v211
    v_cvt_pk_bf16_f32 v190, v20, v21
    v_cvt_pk_bf16_f32 v191, v22, v23
    ds_write_b128 v225, v[172:175] offset:17024
    v_cvt_pk_bf16_f32 v204, v24, v25
    v_cvt_pk_bf16_f32 v205, v26, v27
    v_cvt_pk_bf16_f32 v206, v28, v29
    v_cvt_pk_bf16_f32 v207, v30, v31
    ds_write_b128 v225, v[188:191] offset:25472
    ds_write_b128 v225, v[204:207] offset:33920
    s_mov_b32 s19, 110592
    v_bfe_u32 v54, v1, 2, 2
    v_lshlrev_b32 v16, 6, v54
    v_lshl_add_u32 v16, v18, 10, v16
    v_bfe_u32 v54, v1, 4, 1
    v_lshl_add_u32 v16, v54, 5, v16
    v_and_b32 v54, 3, v1
    v_lshl_add_u32 v16, v54, 3, v16
    s_mul_i32 s27, s36, 18432
    v_add_u32 v16, s27, v16
    v_mov_b32 v2, v16
    s_mov_b32 s18, 0
    v_lshlrev_b32 v13, 4, v19
    v_lshl_add_u32 v13, v18, 10, v13
    s_mul_i32 s21, s35, 589824
    s_add_u32 s21, s21, s29
    s_lshl_b32 s27, s36, 12
    s_add_u32 s21, s21, s27
    s_add_u32 s22, s21, 294912
    v_lshlrev_b32 v14, 4, v18
    s_lshl_b32 s27, s36, 8
    s_add_u32 s27, s27, 0x25800
    v_add_u32 v14, s27, v14
    v_mov_b32 v15, 0xc0135761
    s_mov_b32 s24, 0xbdd2d3e8
    v_lshlrev_b32 v19, 2, v1
    v_add_u32 v19, 0x26000, v19
    v_mov_b32 v18, 0
    ds_write_b32 v19, v18
    s_mov_b32 s57, 0
    s_waitcnt vmcnt(10)
    v_lshlrev_b32 v53, 16, v53
    v_lshlrev_b32 v52, 2, v0
    v_add_u32 v52, 0x25800, v52
    ds_write_b32 v52, v53
    v_lshlrev_b32 v55, 16, v55
    ds_write_b32 v52, v55 offset:1024
    s_waitcnt lgkmcnt(0)
    s_barrier
    ds_read_b128 v[80:83], v14 offset:0
    ds_read_b128 v[84:87], v14 offset:32
    ds_read_b128 v[88:91], v14 offset:64
    ds_read_b128 v[92:95], v14 offset:96
    ds_read_b64_tr_b16 v[128:129], v2 offset:0
    ds_read_b64_tr_b16 v[130:131], v2 offset:256
    ds_read_b128 a[144:147], v17 offset:0
    ds_read_b128 v[112:115], v14 offset:128
    ds_read_b128 v[116:119], v14 offset:160
    ds_read_b128 v[120:123], v14 offset:192
    ds_read_b128 v[124:127], v14 offset:224
    ds_read_b64_tr_b16 v[132:133], v2 offset:512
    ds_read_b64_tr_b16 v[134:135], v2 offset:768
    ds_read_b128 a[148:151], v17 offset:1056
    ds_read_b128 a[152:155], v17 offset:2112
    ds_read_b128 a[156:159], v17 offset:3168
    ds_read_b64_tr_b16 v[136:137], v2 offset:2048
    ds_read_b64_tr_b16 v[138:139], v2 offset:2304
    ds_read_b64_tr_b16 v[140:141], v2 offset:2560
    ds_read_b64_tr_b16 v[142:143], v2 offset:2816
    ds_read_b64_tr_b16 v[144:145], v2 offset:4096
    ds_read_b64_tr_b16 v[146:147], v2 offset:4352
    ds_read_b64_tr_b16 v[148:149], v2 offset:4608
    ds_read_b64_tr_b16 v[150:151], v2 offset:4864
    ds_read_b64_tr_b16 v[152:153], v2 offset:6144
    ds_read_b64_tr_b16 v[154:155], v2 offset:6400
    ds_read_b64_tr_b16 v[156:157], v2 offset:6656
    ds_read_b64_tr_b16 v[158:159], v2 offset:6912
    s_waitcnt lgkmcnt(15)
    v_mfma_f32_32x32x16_bf16 v[64:79], v[128:131], a[0:3], v[80:95]
    ds_read_b64_tr_b16 v[20:21], v2 offset:8192
    ds_read_b64_tr_b16 v[22:23], v2 offset:8448
    ds_read_b128 a[160:163], v17 offset:8448
    ds_read_b128 a[164:167], v17 offset:9504
    v_mfma_f32_32x32x16_bf16 v[80:95], v[128:131], a[144:147], v[80:95]
    ds_read_b128 a[168:171], v17 offset:10560
    ds_read_b128 a[172:175], v17 offset:11616
    v_mfma_f32_32x32x16_bf16 v[96:111], v[132:135], a[0:3], v[112:127]
    ds_read_b64_tr_b16 v[24:25], v2 offset:8704
    ds_read_b64_tr_b16 v[26:27], v2 offset:8960
    ds_read_b128 a[176:179], v17 offset:16896
    ds_read_b128 a[180:183], v17 offset:17952
    v_mfma_f32_32x32x16_bf16 v[112:127], v[132:135], a[144:147], v[112:127]
    ds_read_b128 a[184:187], v17 offset:19008
    ds_read_b128 a[188:191], v17 offset:20064
    s_waitcnt lgkmcnt(15)
    v_mfma_f32_32x32x16_bf16 v[64:79], v[136:139], a[4:7], v[64:79]
    ds_read_b64_tr_b16 v[28:29], v2 offset:10240
    ds_read_b64_tr_b16 v[30:31], v2 offset:10496
    ds_read_b128 a[192:195], v17 offset:25344
    ds_read_b128 a[196:199], v17 offset:26400
    v_mfma_f32_32x32x16_bf16 v[80:95], v[136:139], a[148:151], v[80:95]
    ds_read_b128 a[200:203], v17 offset:27456
    ds_read_b128 a[204:207], v17 offset:28512
    v_mfma_f32_32x32x16_bf16 v[96:111], v[140:143], a[4:7], v[96:111]
    ds_read_b64_tr_b16 v[32:33], v2 offset:10752
    ds_read_b64_tr_b16 v[34:35], v2 offset:11008
    ds_read_b128 a[208:211], v58 offset:0
    ds_read_b128 a[212:215], v58 offset:1056
    v_mfma_f32_32x32x16_bf16 v[112:127], v[140:143], a[148:151], v[112:127]
    ds_read_b128 a[216:219], v58 offset:2112
    ds_read_b128 a[220:223], v58 offset:3168
    v_mfma_f32_32x32x16_bf16 v[64:79], v[144:147], a[8:11], v[64:79]
    ds_read_b64_tr_b16 v[128:129], v2 offset:12288
    ds_read_b64_tr_b16 v[130:131], v2 offset:12544
    ds_read_b128 a[224:227], v58 offset:8448
    ds_read_b128 a[228:231], v58 offset:9504
    v_mfma_f32_32x32x16_bf16 v[80:95], v[144:147], a[152:155], v[80:95]
    ds_read_b128 a[232:235], v58 offset:10560
    ds_read_b128 a[236:239], v58 offset:11616
    v_mfma_f32_32x32x16_bf16 v[96:111], v[148:151], a[8:11], v[96:111]
    ds_read_b64_tr_b16 v[132:133], v2 offset:12800
    ds_read_b64_tr_b16 v[134:135], v2 offset:13056
    ds_read_b128 a[240:243], v58 offset:16896
    ds_read_b128 a[244:247], v58 offset:17952
    v_mfma_f32_32x32x16_bf16 v[112:127], v[148:151], a[152:155], v[112:127]
    ds_read_b128 a[248:251], v58 offset:19008
    ds_read_b128 a[252:255], v58 offset:20064
    s_waitcnt lgkmcnt(15)
    v_mfma_f32_32x32x16_bf16 v[64:79], v[152:155], a[12:15], v[64:79]
    ds_read_b64_tr_b16 v[136:137], v2 offset:14336
    ds_read_b64_tr_b16 v[138:139], v2 offset:14592
    ds_read_b128 v[224:227], v58 offset:25344
    ds_read_b128 v[228:231], v58 offset:26400
    v_mfma_f32_32x32x16_bf16 v[80:95], v[152:155], a[156:159], v[80:95]
    ds_read_b128 v[232:235], v58 offset:27456
    ds_read_b128 v[236:239], v58 offset:28512
    v_mfma_f32_32x32x16_bf16 v[96:111], v[156:159], a[12:15], v[96:111]
    ds_read_b64_tr_b16 v[140:141], v2 offset:14848
    ds_read_b64_tr_b16 v[142:143], v2 offset:15104
    ds_read_b128 v[240:243], v58 offset:33792
    ds_read_b128 v[244:247], v58 offset:34848
    v_mfma_f32_32x32x16_bf16 v[112:127], v[156:159], a[156:159], v[112:127]
    ds_read_b128 v[248:251], v58 offset:35904
    ds_read_b128 v[252:255], v58 offset:36960
    v_mfma_f32_32x32x16_bf16 v[64:79], v[20:23], a[16:19], v[64:79]
    ds_read_b128 v[176:179], v14 offset:512
    ds_read_b128 v[180:183], v14 offset:544
    ds_read_b128 v[184:187], v14 offset:576
    ds_read_b128 v[188:191], v14 offset:608
    ds_read_b128 v[208:211], v14 offset:640
    ds_read_b128 v[212:215], v14 offset:672
    ds_read_b128 v[216:219], v14 offset:704
    ds_read_b128 v[220:223], v14 offset:736
    s_waitcnt lgkmcnt(8)
    s_waitcnt vmcnt(1)
    s_barrier
    s_add_u32 s18, s18, 36864
    s_cmp_eq_u32 s18, 147456
    s_cselect_b32 s18, 0, s18
    v_add_u32 v3, s18, v16
    ds_read_b64_tr_b16 v[144:145], v2 offset:16384
    ds_read_b64_tr_b16 v[146:147], v2 offset:16640
    v_mfma_f32_32x32x16_bf16 v[80:95], v[20:23], a[160:163], v[80:95]
    s_cmp_ge_u32 s17, 0
    s_cselect_b32 s10, s16, 0
    s_add_u32 s27, s20, 2654208
    s_add_u32 m0, s23, 73728
    s_nop 0
    buffer_load_dwordx4 v4, s[8:11], s27 offen lds
    v_mfma_f32_32x32x16_bf16 v[96:111], v[24:27], a[16:19], v[96:111]
    ds_read_b64_tr_b16 v[148:149], v2 offset:16896
    ds_read_b64_tr_b16 v[150:151], v2 offset:17152
    s_cmp_ge_u32 s17, 0
    s_cselect_b32 s10, s16, 0
    s_add_u32 s27, s20, 2654208
    s_add_u32 m0, s23, 74752
    s_nop 0
    buffer_load_dwordx4 v5, s[8:11], s27 offen lds
    v_mfma_f32_32x32x16_bf16 v[112:127], v[24:27], a[160:163], v[112:127]
    s_cmp_ge_u32 s17, 0
    s_cselect_b32 s10, s16, 0
    s_add_u32 s27, s20, 2654208
    s_add_u32 m0, s23, 75776
    s_nop 0
    buffer_load_dwordx4 v6, s[8:11], s27 offen lds
    v_mfma_f32_32x32x16_bf16 v[64:79], v[28:31], a[20:23], v[64:79]
    ds_read_b64_tr_b16 v[152:153], v3 offset:0
    ds_read_b64_tr_b16 v[154:155], v3 offset:256
    s_cmp_ge_u32 s17, 0
    s_cselect_b32 s10, s16, 0
    s_add_u32 s27, s20, 2654208
    s_add_u32 m0, s23, 76800
    s_nop 0
    buffer_load_dwordx4 v7, s[8:11], s27 offen lds
    v_mfma_f32_32x32x16_bf16 v[80:95], v[28:31], a[164:167], v[80:95]
    s_cmp_ge_u32 s17, 0
    s_cselect_b32 s10, s16, 0
    s_add_u32 s27, s20, 2654208
    s_add_u32 m0, s23, 77824
    s_nop 0
    buffer_load_dwordx4 v8, s[8:11], s27 offen lds
    v_mfma_f32_32x32x16_bf16 v[96:111], v[32:35], a[20:23], v[96:111]
    ds_read_b64_tr_b16 v[156:157], v3 offset:512
    ds_read_b64_tr_b16 v[158:159], v3 offset:768
    s_cmp_ge_u32 s17, 0
    s_cselect_b32 s10, s16, 0
    s_add_u32 s27, s20, 2654208
    s_add_u32 m0, s23, 78848
    s_nop 0
    buffer_load_dwordx4 v9, s[8:11], s27 offen lds
    v_mfma_f32_32x32x16_bf16 v[112:127], v[32:35], a[164:167], v[112:127]
    s_cmp_ge_u32 s17, 0
    s_cselect_b32 s10, s16, 0
    s_add_u32 s27, s20, 2654208
    s_add_u32 m0, s23, 79872
    s_nop 0
    buffer_load_dwordx4 v10, s[8:11], s27 offen lds
    v_mfma_f32_32x32x16_bf16 v[64:79], v[128:131], a[24:27], v[64:79]
    ds_read_b64_tr_b16 v[20:21], v3 offset:2048
    ds_read_b64_tr_b16 v[22:23], v3 offset:2304
    s_cmp_ge_u32 s17, 0
    s_cselect_b32 s10, s16, 0
    s_add_u32 s27, s20, 2654208
    s_add_u32 m0, s23, 80896
    s_nop 0
    buffer_load_dwordx4 v11, s[8:11], s27 offen lds
    v_mfma_f32_32x32x16_bf16 v[80:95], v[128:131], a[168:171], v[80:95]
    s_cmp_ge_u32 s17, 0
    s_cselect_b32 s10, s16, 0
    s_add_u32 s27, s20, 2654208
    s_add_u32 m0, s23, 81920
    s_nop 0
    buffer_load_dwordx4 v12, s[8:11], s27 offen lds
    v_mfma_f32_32x32x16_bf16 v[96:111], v[132:135], a[24:27], v[96:111]
    ds_read_b64_tr_b16 v[24:25], v3 offset:2560
    ds_read_b64_tr_b16 v[26:27], v3 offset:2816
    s_cmp_ge_u32 s17, 0
    s_cselect_b32 s10, s16, 0
    s_add_u32 s25, s19, s23
    s_add_u32 s27, s20, 3981312
    s_add_u32 s19, s19, 36864
    s_cmp_eq_u32 s19, 147456
    s_cselect_b32 s19, 0, s19
    v_mfma_f32_32x32x16_bf16 v[112:127], v[132:135], a[168:171], v[112:127]
    s_add_u32 m0, s25, 0
    s_nop 0
    buffer_load_dwordx4 v4, s[8:11], s27 offen lds
    v_mfma_f32_32x32x16_bf16 v[64:79], v[136:139], a[28:31], v[64:79]
    ds_read_b64_tr_b16 v[28:29], v3 offset:4096
    ds_read_b64_tr_b16 v[30:31], v3 offset:4352
    s_add_u32 m0, s25, 1024
    s_nop 0
    buffer_load_dwordx4 v5, s[8:11], s27 offen lds
    v_mfma_f32_32x32x16_bf16 v[80:95], v[136:139], a[172:175], v[80:95]
    s_add_u32 m0, s25, 2048
    s_nop 0
    buffer_load_dwordx4 v6, s[8:11], s27 offen lds
    v_mfma_f32_32x32x16_bf16 v[96:111], v[140:143], a[28:31], v[96:111]
    ds_read_b64_tr_b16 v[32:33], v3 offset:4608
    ds_read_b64_tr_b16 v[34:35], v3 offset:4864
    s_add_u32 m0, s25, 3072
    s_nop 0
    buffer_load_dwordx4 v7, s[8:11], s27 offen lds
    v_mfma_f32_32x32x16_bf16 v[112:127], v[140:143], a[172:175], v[112:127]
    s_add_u32 m0, s25, 4096
    s_nop 0
    buffer_load_dwordx4 v8, s[8:11], s27 offen lds
    s_waitcnt lgkmcnt(14)
    v_mfma_f32_32x32x16_bf16 v[64:79], v[144:147], a[32:35], v[64:79]
    ds_read_b64_tr_b16 v[128:129], v3 offset:6144
    ds_read_b64_tr_b16 v[130:131], v3 offset:6400
    s_add_u32 m0, s25, 5120
    s_nop 0
    buffer_load_dwordx4 v9, s[8:11], s27 offen lds
    v_mfma_f32_32x32x16_bf16 v[80:95], v[144:147], a[176:179], v[80:95]
    s_add_u32 m0, s25, 6144
    s_nop 0
    buffer_load_dwordx4 v10, s[8:11], s27 offen lds
    s_waitcnt lgkmcnt(14)
    v_mfma_f32_32x32x16_bf16 v[96:111], v[148:151], a[32:35], v[96:111]
    ds_read_b64_tr_b16 v[132:133], v3 offset:6656
    ds_read_b64_tr_b16 v[134:135], v3 offset:6912
    s_add_u32 m0, s25, 7168
    s_nop 0
    buffer_load_dwordx4 v11, s[8:11], s27 offen lds
    v_mfma_f32_32x32x16_bf16 v[112:127], v[148:151], a[176:179], v[112:127]
    s_add_u32 m0, s25, 8192
    s_nop 0
    buffer_load_dwordx4 v12, s[8:11], s27 offen lds
    s_waitcnt lgkmcnt(14)
    v_mfma_f32_32x32x16_bf16 v[64:79], v[152:155], a[36:39], v[64:79]
    ds_read_b64_tr_b16 v[136:137], v3 offset:8192
    ds_read_b64_tr_b16 v[138:139], v3 offset:8448
    v_mfma_f32_32x32x16_bf16 v[80:95], v[152:155], a[180:183], v[80:95]
    s_waitcnt lgkmcnt(14)
    v_mfma_f32_32x32x16_bf16 v[96:111], v[156:159], a[36:39], v[96:111]
    ds_read_b64_tr_b16 v[140:141], v3 offset:8704
    ds_read_b64_tr_b16 v[142:143], v3 offset:8960
    v_mfma_f32_32x32x16_bf16 v[112:127], v[156:159], a[180:183], v[112:127]
    s_waitcnt lgkmcnt(14)
    v_mfma_f32_32x32x16_bf16 v[64:79], v[20:23], a[40:43], v[64:79]
    ds_read_b64_tr_b16 v[144:145], v3 offset:10240
    ds_read_b64_tr_b16 v[146:147], v3 offset:10496
    v_mfma_f32_32x32x16_bf16 v[80:95], v[20:23], a[184:187], v[80:95]
    buffer_load_dword v63, v62, s[64:67], s70 offen
    s_waitcnt lgkmcnt(14)
    v_mfma_f32_32x32x16_bf16 v[96:111], v[24:27], a[40:43], v[96:111]
    ds_read_b64_tr_b16 v[148:149], v3 offset:10752
    ds_read_b64_tr_b16 v[150:151], v3 offset:11008
    v_mfma_f32_32x32x16_bf16 v[112:127], v[24:27], a[184:187], v[112:127]
    s_waitcnt lgkmcnt(14)
    v_mfma_f32_32x32x16_bf16 v[64:79], v[28:31], a[44:47], v[64:79]
    ds_read_b64_tr_b16 v[152:153], v3 offset:12288
    ds_read_b64_tr_b16 v[154:155], v3 offset:12544
    v_mfma_f32_32x32x16_bf16 v[80:95], v[28:31], a[188:191], v[80:95]
    s_waitcnt lgkmcnt(14)
    v_mfma_f32_32x32x16_bf16 v[96:111], v[32:35], a[44:47], v[96:111]
    ds_read_b64_tr_b16 v[156:157], v3 offset:12800
    ds_read_b64_tr_b16 v[158:159], v3 offset:13056
    v_mfma_f32_32x32x16_bf16 v[112:127], v[32:35], a[188:191], v[112:127]
    s_waitcnt lgkmcnt(14)
    v_mfma_f32_32x32x16_bf16 v[64:79], v[128:131], a[48:51], v[64:79]
    s_waitcnt vmcnt(10)
    ds_add_u32 v19, v19
    s_add_u32 s57, s57, 0x98000
    ds_read_b64_tr_b16 v[20:21], v3 offset:14336
    ds_read_b64_tr_b16 v[22:23], v3 offset:14592
    v_mfma_f32_32x32x16_bf16 v[80:95], v[128:131], a[192:195], v[80:95]
    s_waitcnt lgkmcnt(15)
    v_mfma_f32_32x32x16_bf16 v[96:111], v[132:135], a[48:51], v[96:111]
    ds_read_b32 v18, v19
    ds_read_b64_tr_b16 v[24:25], v3 offset:14848
    ds_read_b64_tr_b16 v[26:27], v3 offset:15104
    v_mfma_f32_32x32x16_bf16 v[112:127], v[132:135], a[192:195], v[112:127]
    s_waitcnt lgkmcnt(15)
    v_mfma_f32_32x32x16_bf16 v[64:79], v[136:139], a[52:55], v[64:79]
    s_waitcnt lgkmcnt(2)
    v_readfirstlane_b32 s56, v18
    s_cmp_ge_u32 s56, s57
    s_cbranch_scc0 spin_g1_kernel_38
back_g1_kernel_39:
    s_add_u32 s18, s18, 36864
    s_cmp_eq_u32 s18, 147456
    s_cselect_b32 s18, 0, s18
    v_add_u32 v2, s18, v16
    s_cmp_ge_u32 s17, 1
    s_cselect_b32 s10, s16, 0
    s_add_u32 s25, s19, s23
    s_add_u32 s27, s20, 256
    s_add_u32 s19, s19, 36864
    s_cmp_eq_u32 s19, 147456
    s_cselect_b32 s19, 0, s19
    ds_read_b64_tr_b16 v[28:29], v3 offset:16384
    ds_read_b64_tr_b16 v[30:31], v3 offset:16640
    v_mfma_f32_32x32x16_bf16 v[80:95], v[136:139], a[196:199], v[80:95]
    s_add_u32 m0, s25, 0
    s_nop 0
    buffer_load_dwordx4 v4, s[8:11], s27 offen lds
    v_mfma_f32_32x32x16_bf16 v[96:111], v[140:143], a[52:55], v[96:111]
    ds_read_b64_tr_b16 v[32:33], v3 offset:16896
    ds_read_b64_tr_b16 v[34:35], v3 offset:17152
    v_mfma_f32_32x32x16_bf16 v[112:127], v[140:143], a[196:199], v[112:127]
    v_mfma_f32_32x32x16_bf16 v[64:79], v[144:147], a[56:59], v[64:79]
    ds_read_b64_tr_b16 v[128:129], v2 offset:0
    ds_read_b64_tr_b16 v[130:131], v2 offset:256
    s_add_u32 m0, s25, 1024
    s_nop 0
    buffer_load_dwordx4 v5, s[8:11], s27 offen lds
    v_mfma_f32_32x32x16_bf16 v[80:95], v[144:147], a[200:203], v[80:95]
    v_mfma_f32_32x32x16_bf16 v[96:111], v[148:151], a[56:59], v[96:111]
    ds_read_b64_tr_b16 v[132:133], v2 offset:512
    ds_read_b64_tr_b16 v[134:135], v2 offset:768
    v_mfma_f32_32x32x16_bf16 v[112:127], v[148:151], a[200:203], v[112:127]
    s_add_u32 m0, s25, 2048
    s_nop 0
    buffer_load_dwordx4 v6, s[8:11], s27 offen lds
    v_mfma_f32_32x32x16_bf16 v[64:79], v[152:155], a[60:63], v[64:79]
    ds_read_b64_tr_b16 v[136:137], v2 offset:2048
    ds_read_b64_tr_b16 v[138:139], v2 offset:2304
    v_mfma_f32_32x32x16_bf16 v[80:95], v[152:155], a[204:207], v[80:95]
    v_mfma_f32_32x32x16_bf16 v[96:111], v[156:159], a[60:63], v[96:111]
    ds_read_b64_tr_b16 v[140:141], v2 offset:2560
    ds_read_b64_tr_b16 v[142:143], v2 offset:2816
    s_add_u32 m0, s25, 3072
    s_nop 0
    buffer_load_dwordx4 v7, s[8:11], s27 offen lds
    v_mfma_f32_32x32x16_bf16 v[112:127], v[156:159], a[204:207], v[112:127]
    v_mfma_f32_32x32x16_bf16 v[64:79], v[20:23], a[64:67], v[64:79]
    ds_read_b64_tr_b16 v[144:145], v2 offset:4096
    ds_read_b64_tr_b16 v[146:147], v2 offset:4352
    v_mfma_f32_32x32x16_bf16 v[80:95], v[20:23], a[208:211], v[80:95]
    s_add_u32 m0, s25, 4096
    s_nop 0
    buffer_load_dwordx4 v8, s[8:11], s27 offen lds
    s_waitcnt lgkmcnt(14)
    v_mfma_f32_32x32x16_bf16 v[96:111], v[24:27], a[64:67], v[96:111]
    ds_read_b64_tr_b16 v[148:149], v2 offset:4608
    ds_read_b64_tr_b16 v[150:151], v2 offset:4864
    v_mfma_f32_32x32x16_bf16 v[112:127], v[24:27], a[208:211], v[112:127]
    s_waitcnt lgkmcnt(14)
    v_mfma_f32_32x32x16_bf16 v[64:79], v[28:31], a[68:71], v[64:79]
    ds_read_b64_tr_b16 v[152:153], v2 offset:6144
    ds_read_b64_tr_b16 v[154:155], v2 offset:6400
    s_add_u32 m0, s25, 5120
    s_nop 0
    buffer_load_dwordx4 v9, s[8:11], s27 offen lds
    v_mfma_f32_32x32x16_bf16 v[80:95], v[28:31], a[212:215], v[80:95]
    s_waitcnt lgkmcnt(14)
    v_mfma_f32_32x32x16_bf16 v[96:111], v[32:35], a[68:71], v[96:111]
    ds_read_b64_tr_b16 v[156:157], v2 offset:6656
    ds_read_b64_tr_b16 v[158:159], v2 offset:6912
    v_mfma_f32_32x32x16_bf16 v[112:127], v[32:35], a[212:215], v[112:127]
    s_add_u32 m0, s25, 6144
    s_nop 0
    buffer_load_dwordx4 v10, s[8:11], s27 offen lds
    s_waitcnt lgkmcnt(14)
    v_mfma_f32_32x32x16_bf16 v[64:79], v[128:131], a[72:75], v[64:79]
    s_waitcnt vmcnt(8)
    ds_add_u32 v19, v19
    s_add_u32 s57, s57, 0x98000
    ds_read_b64_tr_b16 v[20:21], v2 offset:8192
    ds_read_b64_tr_b16 v[22:23], v2 offset:8448
    v_mfma_f32_32x32x16_bf16 v[80:95], v[128:131], a[216:219], v[80:95]
    s_waitcnt lgkmcnt(15)
    v_mfma_f32_32x32x16_bf16 v[96:111], v[132:135], a[72:75], v[96:111]
    ds_read_b64_tr_b16 v[24:25], v2 offset:8704
    ds_read_b64_tr_b16 v[26:27], v2 offset:8960
    s_add_u32 m0, s25, 7168
    s_nop 0
    buffer_load_dwordx4 v11, s[8:11], s27 offen lds
    v_mfma_f32_32x32x16_bf16 v[112:127], v[132:135], a[216:219], v[112:127]
    s_waitcnt lgkmcnt(15)
    v_mfma_f32_32x32x16_bf16 v[64:79], v[136:139], a[76:79], v[64:79]
    ds_read_b64_tr_b16 v[28:29], v2 offset:10240
    ds_read_b64_tr_b16 v[30:31], v2 offset:10496
    v_mfma_f32_32x32x16_bf16 v[80:95], v[136:139], a[220:223], v[80:95]
    s_add_u32 m0, s25, 8192
    s_nop 0
    buffer_load_dwordx4 v12, s[8:11], s27 offen lds
    s_waitcnt lgkmcnt(15)
    v_mfma_f32_32x32x16_bf16 v[96:111], v[140:143], a[76:79], v[96:111]
    ds_read_b64_tr_b16 v[32:33], v2 offset:10752
    ds_read_b64_tr_b16 v[34:35], v2 offset:11008
    v_mfma_f32_32x32x16_bf16 v[112:127], v[140:143], a[220:223], v[112:127]
    s_waitcnt lgkmcnt(15)
    v_mfma_f32_32x32x16_bf16 v[64:79], v[144:147], a[80:83], v[64:79]
    ds_read_b64_tr_b16 v[128:129], v2 offset:12288
    ds_read_b64_tr_b16 v[130:131], v2 offset:12544
    v_mfma_f32_32x32x16_bf16 v[80:95], v[144:147], a[224:227], v[80:95]
    s_waitcnt lgkmcnt(15)
    v_mfma_f32_32x32x16_bf16 v[96:111], v[148:151], a[80:83], v[96:111]
    ds_read_b64_tr_b16 v[132:133], v2 offset:12800
    ds_read_b64_tr_b16 v[134:135], v2 offset:13056
    v_mfma_f32_32x32x16_bf16 v[112:127], v[148:151], a[224:227], v[112:127]
    s_waitcnt lgkmcnt(15)
    v_mfma_f32_32x32x16_bf16 v[64:79], v[152:155], a[84:87], v[64:79]
    ds_read_b64_tr_b16 v[136:137], v2 offset:14336
    ds_read_b64_tr_b16 v[138:139], v2 offset:14592
    v_mfma_f32_32x32x16_bf16 v[80:95], v[152:155], a[228:231], v[80:95]
    s_waitcnt lgkmcnt(15)
    v_mfma_f32_32x32x16_bf16 v[96:111], v[156:159], a[84:87], v[96:111]
    ds_read_b32 v18, v19
    ds_read_b64_tr_b16 v[140:141], v2 offset:14848
    ds_read_b64_tr_b16 v[142:143], v2 offset:15104
    v_mfma_f32_32x32x16_bf16 v[112:127], v[156:159], a[228:231], v[112:127]
    s_waitcnt lgkmcnt(15)
    v_mfma_f32_32x32x16_bf16 v[64:79], v[20:23], a[88:91], v[64:79]
    s_waitcnt lgkmcnt(2)
    v_readfirstlane_b32 s56, v18
    s_cmp_ge_u32 s56, s57
    s_cbranch_scc0 spin_g1_kernel_40
back_g1_kernel_41:
    s_add_u32 s18, s18, 36864
    s_cmp_eq_u32 s18, 147456
    s_cselect_b32 s18, 0, s18
    v_add_u32 v3, s18, v16
    s_cmp_ge_u32 s17, 1
    s_cselect_b32 s10, s16, 0
    s_add_u32 s25, s19, s23
    s_add_u32 s27, s20, 1327360
    s_add_u32 s19, s19, 36864
    s_cmp_eq_u32 s19, 147456
    s_cselect_b32 s19, 0, s19
    ds_read_b64_tr_b16 v[144:145], v2 offset:16384
    ds_read_b64_tr_b16 v[146:147], v2 offset:16640
    v_mfma_f32_32x32x16_bf16 v[80:95], v[20:23], a[232:235], v[80:95]
    s_add_u32 m0, s25, 0
    s_nop 0
    buffer_load_dwordx4 v4, s[8:11], s27 offen lds
    v_mfma_f32_32x32x16_bf16 v[96:111], v[24:27], a[88:91], v[96:111]
    ds_read_b64_tr_b16 v[148:149], v2 offset:16896
    ds_read_b64_tr_b16 v[150:151], v2 offset:17152
    v_mfma_f32_32x32x16_bf16 v[112:127], v[24:27], a[232:235], v[112:127]
    v_mfma_f32_32x32x16_bf16 v[64:79], v[28:31], a[92:95], v[64:79]
    ds_read_b64_tr_b16 v[152:153], v3 offset:0
    ds_read_b64_tr_b16 v[154:155], v3 offset:256
    s_add_u32 m0, s25, 1024
    s_nop 0
    buffer_load_dwordx4 v5, s[8:11], s27 offen lds
    v_mfma_f32_32x32x16_bf16 v[80:95], v[28:31], a[236:239], v[80:95]
    v_mfma_f32_32x32x16_bf16 v[96:111], v[32:35], a[92:95], v[96:111]
    ds_read_b64_tr_b16 v[156:157], v3 offset:512
    ds_read_b64_tr_b16 v[158:159], v3 offset:768
    v_mfma_f32_32x32x16_bf16 v[112:127], v[32:35], a[236:239], v[112:127]
    s_add_u32 m0, s25, 2048
    s_nop 0
    buffer_load_dwordx4 v6, s[8:11], s27 offen lds
    v_mfma_f32_32x32x16_bf16 v[64:79], v[128:131], a[96:99], v[64:79]
    ds_read_b64_tr_b16 v[20:21], v3 offset:2048
    ds_read_b64_tr_b16 v[22:23], v3 offset:2304
    v_mfma_f32_32x32x16_bf16 v[80:95], v[128:131], a[240:243], v[80:95]
    v_mfma_f32_32x32x16_bf16 v[96:111], v[132:135], a[96:99], v[96:111]
    ds_read_b64_tr_b16 v[24:25], v3 offset:2560
    ds_read_b64_tr_b16 v[26:27], v3 offset:2816
    s_add_u32 m0, s25, 3072
    s_nop 0
    buffer_load_dwordx4 v7, s[8:11], s27 offen lds
    v_mfma_f32_32x32x16_bf16 v[112:127], v[132:135], a[240:243], v[112:127]
    v_mfma_f32_32x32x16_bf16 v[64:79], v[136:139], a[100:103], v[64:79]
    ds_read_b64_tr_b16 v[28:29], v3 offset:4096
    ds_read_b64_tr_b16 v[30:31], v3 offset:4352
    v_mfma_f32_32x32x16_bf16 v[80:95], v[136:139], a[244:247], v[80:95]
    s_add_u32 m0, s25, 4096
    s_nop 0
    buffer_load_dwordx4 v8, s[8:11], s27 offen lds
    s_waitcnt lgkmcnt(14)
    v_mfma_f32_32x32x16_bf16 v[96:111], v[140:143], a[100:103], v[96:111]
    ds_read_b64_tr_b16 v[32:33], v3 offset:4608
    ds_read_b64_tr_b16 v[34:35], v3 offset:4864
    v_mfma_f32_32x32x16_bf16 v[112:127], v[140:143], a[244:247], v[112:127]
    s_waitcnt lgkmcnt(14)
    v_mfma_f32_32x32x16_bf16 v[64:79], v[144:147], a[104:107], v[64:79]
    ds_read_b64_tr_b16 v[128:129], v3 offset:6144
    ds_read_b64_tr_b16 v[130:131], v3 offset:6400
    s_add_u32 m0, s25, 5120
    s_nop 0
    buffer_load_dwordx4 v9, s[8:11], s27 offen lds
    v_mfma_f32_32x32x16_bf16 v[80:95], v[144:147], a[248:251], v[80:95]
    s_waitcnt lgkmcnt(14)
    v_mfma_f32_32x32x16_bf16 v[96:111], v[148:151], a[104:107], v[96:111]
    ds_read_b64_tr_b16 v[132:133], v3 offset:6656
    ds_read_b64_tr_b16 v[134:135], v3 offset:6912
    v_mfma_f32_32x32x16_bf16 v[112:127], v[148:151], a[248:251], v[112:127]
    s_add_u32 m0, s25, 6144
    s_nop 0
    buffer_load_dwordx4 v10, s[8:11], s27 offen lds
    s_waitcnt lgkmcnt(14)
    v_mfma_f32_32x32x16_bf16 v[64:79], v[152:155], a[108:111], v[64:79]
    s_waitcnt vmcnt(7)
    ds_add_u32 v19, v19
    s_add_u32 s57, s57, 0x98000
    ds_read_b64_tr_b16 v[136:137], v3 offset:8192
    ds_read_b64_tr_b16 v[138:139], v3 offset:8448
    v_mfma_f32_32x32x16_bf16 v[80:95], v[152:155], a[252:255], v[80:95]
    s_waitcnt lgkmcnt(15)
    v_mfma_f32_32x32x16_bf16 v[96:111], v[156:159], a[108:111], v[96:111]
    ds_read_b64_tr_b16 v[140:141], v3 offset:8704
    ds_read_b64_tr_b16 v[142:143], v3 offset:8960
    s_add_u32 m0, s25, 7168
    s_nop 0
    buffer_load_dwordx4 v11, s[8:11], s27 offen lds
    v_mfma_f32_32x32x16_bf16 v[112:127], v[156:159], a[252:255], v[112:127]
    s_waitcnt lgkmcnt(15)
    v_mfma_f32_32x32x16_bf16 v[64:79], v[20:23], a[112:115], v[64:79]
    ds_read_b64_tr_b16 v[144:145], v3 offset:10240
    ds_read_b64_tr_b16 v[146:147], v3 offset:10496
    v_mfma_f32_32x32x16_bf16 v[80:95], v[20:23], v[224:227], v[80:95]
    s_add_u32 m0, s25, 8192
    s_nop 0
    buffer_load_dwordx4 v12, s[8:11], s27 offen lds
    s_waitcnt lgkmcnt(15)
    v_mfma_f32_32x32x16_bf16 v[96:111], v[24:27], a[112:115], v[96:111]
    ds_read_b64_tr_b16 v[148:149], v3 offset:10752
    ds_read_b64_tr_b16 v[150:151], v3 offset:11008
    v_mfma_f32_32x32x16_bf16 v[112:127], v[24:27], v[224:227], v[112:127]
    s_waitcnt lgkmcnt(15)
    v_mfma_f32_32x32x16_bf16 v[64:79], v[28:31], a[116:119], v[64:79]
    ds_read_b64_tr_b16 v[152:153], v3 offset:12288
    ds_read_b64_tr_b16 v[154:155], v3 offset:12544
    v_mfma_f32_32x32x16_bf16 v[80:95], v[28:31], v[228:231], v[80:95]
    s_waitcnt lgkmcnt(15)
    v_mfma_f32_32x32x16_bf16 v[96:111], v[32:35], a[116:119], v[96:111]
    ds_read_b64_tr_b16 v[156:157], v3 offset:12800
    ds_read_b64_tr_b16 v[158:159], v3 offset:13056
    v_mfma_f32_32x32x16_bf16 v[112:127], v[32:35], v[228:231], v[112:127]
    s_waitcnt lgkmcnt(15)
    v_mfma_f32_32x32x16_bf16 v[64:79], v[128:131], a[120:123], v[64:79]
    ds_read_b64_tr_b16 v[20:21], v3 offset:14336
    ds_read_b64_tr_b16 v[22:23], v3 offset:14592
    v_mfma_f32_32x32x16_bf16 v[80:95], v[128:131], v[232:235], v[80:95]
    s_waitcnt lgkmcnt(15)
    v_mfma_f32_32x32x16_bf16 v[96:111], v[132:135], a[120:123], v[96:111]
    ds_read_b32 v18, v19
    ds_read_b64_tr_b16 v[24:25], v3 offset:14848
    ds_read_b64_tr_b16 v[26:27], v3 offset:15104
    v_mfma_f32_32x32x16_bf16 v[112:127], v[132:135], v[232:235], v[112:127]
    s_waitcnt lgkmcnt(15)
    v_mfma_f32_32x32x16_bf16 v[64:79], v[136:139], a[124:127], v[64:79]
    s_waitcnt lgkmcnt(2)
    v_readfirstlane_b32 s56, v18
    s_cmp_ge_u32 s56, s57
    s_cbranch_scc0 spin_g1_kernel_42
back_g1_kernel_43:
    s_add_u32 s18, s18, 36864
    s_cmp_eq_u32 s18, 147456
    s_cselect_b32 s18, 0, s18
    v_add_u32 v2, s18, v16
    s_cmp_ge_u32 s17, 1
    s_cselect_b32 s10, s16, 0
    s_add_u32 s25, s19, s23
    s_add_u32 s27, s20, 2654464
    s_add_u32 s19, s19, 36864
    s_cmp_eq_u32 s19, 147456
    s_cselect_b32 s19, 0, s19
    ds_read_b64_tr_b16 v[28:29], v3 offset:16384
    ds_read_b64_tr_b16 v[30:31], v3 offset:16640
    v_mfma_f32_32x32x16_bf16 v[80:95], v[136:139], v[236:239], v[80:95]
    s_add_u32 m0, s25, 0
    s_nop 0
    buffer_load_dwordx4 v4, s[8:11], s27 offen lds
    v_mfma_f32_32x32x16_bf16 v[96:111], v[140:143], a[124:127], v[96:111]
    ds_read_b64_tr_b16 v[32:33], v3 offset:16896
    ds_read_b64_tr_b16 v[34:35], v3 offset:17152
    v_mfma_f32_32x32x16_bf16 v[112:127], v[140:143], v[236:239], v[112:127]
    v_mfma_f32_32x32x16_bf16 v[64:79], v[144:147], a[128:131], v[64:79]
    ds_read_b64_tr_b16 v[128:129], v2 offset:0
    ds_read_b64_tr_b16 v[130:131], v2 offset:256
    s_add_u32 m0, s25, 1024
    s_nop 0
    buffer_load_dwordx4 v5, s[8:11], s27 offen lds
    v_mfma_f32_32x32x16_bf16 v[80:95], v[144:147], v[240:243], v[80:95]
    v_mfma_f32_32x32x16_bf16 v[96:111], v[148:151], a[128:131], v[96:111]
    ds_read_b64_tr_b16 v[132:133], v2 offset:512
    ds_read_b64_tr_b16 v[134:135], v2 offset:768
    v_mfma_f32_32x32x16_bf16 v[112:127], v[148:151], v[240:243], v[112:127]
    s_add_u32 m0, s25, 2048
    s_nop 0
    buffer_load_dwordx4 v6, s[8:11], s27 offen lds
    v_mfma_f32_32x32x16_bf16 v[64:79], v[152:155], a[132:135], v[64:79]
    ds_read_b64_tr_b16 v[136:137], v2 offset:2048
    ds_read_b64_tr_b16 v[138:139], v2 offset:2304
    v_mfma_f32_32x32x16_bf16 v[80:95], v[152:155], v[244:247], v[80:95]
    v_mfma_f32_32x32x16_bf16 v[96:111], v[156:159], a[132:135], v[96:111]
    ds_read_b64_tr_b16 v[140:141], v2 offset:2560
    ds_read_b64_tr_b16 v[142:143], v2 offset:2816
    s_add_u32 m0, s25, 3072
    s_nop 0
    buffer_load_dwordx4 v7, s[8:11], s27 offen lds
    v_mfma_f32_32x32x16_bf16 v[112:127], v[156:159], v[244:247], v[112:127]
    v_mfma_f32_32x32x16_bf16 v[64:79], v[20:23], a[136:139], v[64:79]
    ds_read_b64_tr_b16 v[144:145], v2 offset:4096
    ds_read_b64_tr_b16 v[146:147], v2 offset:4352
    v_mfma_f32_32x32x16_bf16 v[80:95], v[20:23], v[248:251], v[80:95]
    s_add_u32 m0, s25, 4096
    s_nop 0
    buffer_load_dwordx4 v8, s[8:11], s27 offen lds
    s_waitcnt lgkmcnt(14)
    v_mfma_f32_32x32x16_bf16 v[96:111], v[24:27], a[136:139], v[96:111]
    ds_read_b64_tr_b16 v[148:149], v2 offset:4608
    ds_read_b64_tr_b16 v[150:151], v2 offset:4864
    v_mfma_f32_32x32x16_bf16 v[112:127], v[24:27], v[248:251], v[112:127]
    s_waitcnt lgkmcnt(14)
    v_mfma_f32_32x32x16_bf16 v[64:79], v[28:31], a[140:143], v[64:79]
    ds_read_b64_tr_b16 v[152:153], v2 offset:6144
    ds_read_b64_tr_b16 v[154:155], v2 offset:6400
    s_add_u32 m0, s25, 5120
    s_nop 0
    buffer_load_dwordx4 v9, s[8:11], s27 offen lds
    v_mfma_f32_32x32x16_bf16 v[80:95], v[28:31], v[252:255], v[80:95]
    s_waitcnt lgkmcnt(14)
    v_mfma_f32_32x32x16_bf16 v[96:111], v[32:35], a[140:143], v[96:111]
    ds_read_b64_tr_b16 v[156:157], v2 offset:6656
    ds_read_b64_tr_b16 v[158:159], v2 offset:6912
    v_mfma_f32_32x32x16_bf16 v[112:127], v[32:35], v[252:255], v[112:127]
    s_add_u32 m0, s25, 6144
    s_nop 0
    buffer_load_dwordx4 v10, s[8:11], s27 offen lds
    s_add_u32 s20, s20, 256
    s_cmp_eq_u32 s17, 0
    s_cbranch_scc1 drain0h_g1_kernel_35
    s_sub_u32 s17, s17, 1
looph_g1_kernel_34:
    s_waitcnt lgkmcnt(14)
    v_mfma_f32_32x32x16_bf16 v[160:175], v[128:131], a[0:3], v[176:191]
    s_waitcnt vmcnt(7)
    ds_add_u32 v19, v19
    s_add_u32 s57, s57, 0x98000
    ds_read_b64_tr_b16 v[20:21], v2 offset:8192
    ds_read_b64_tr_b16 v[22:23], v2 offset:8448
    v_mfma_f32_32x32x16_bf16 v[176:191], v[128:131], a[144:147], v[176:191]
    s_waitcnt lgkmcnt(15)
    s_waitcnt lgkmcnt(7)
    v_mfma_f32_32x32x16_bf16 v[192:207], v[132:135], a[0:3], v[208:223]
    ds_read_b64_tr_b16 v[24:25], v2 offset:8704
    ds_read_b64_tr_b16 v[26:27], v2 offset:8960
    s_add_u32 m0, s25, 7168
    s_nop 0
    buffer_load_dwordx4 v11, s[8:11], s27 offen lds
    v_mul_f32 v56, v64, v64
    v_mul_f32 v57, v65, v65
    v_mul_f32 v58, v66, v66
    v_mul_f32 v59, v67, v67
    v_fma_f32 v56, v56, s24, v15
    v_mfma_f32_32x32x16_bf16 v[208:223], v[132:135], a[144:147], v[208:223]
    v_fma_f32 v57, v57, s24, v15
    v_fma_f32 v58, v58, s24, v15
    v_fma_f32 v59, v59, s24, v15
    v_mul_f32 v56, v56, v64
    v_mul_f32 v57, v57, v65
    s_waitcnt lgkmcnt(15)
    v_mfma_f32_32x32x16_bf16 v[160:175], v[136:139], a[4:7], v[160:175]
    ds_read_b64_tr_b16 v[28:29], v2 offset:10240
    ds_read_b64_tr_b16 v[30:31], v2 offset:10496
    v_mul_f32 v58, v58, v66
    v_mul_f32 v59, v59, v67
    v_exp_f32 v56, v56
    v_exp_f32 v57, v57
    v_mfma_f32_32x32x16_bf16 v[176:191], v[136:139], a[148:151], v[176:191]
    s_add_u32 m0, s25, 8192
    s_nop 0
    buffer_load_dwordx4 v12, s[8:11], s27 offen lds
    v_exp_f32 v58, v58
    v_exp_f32 v59, v59
    s_waitcnt lgkmcnt(15)
    v_mfma_f32_32x32x16_bf16 v[192:207], v[140:143], a[4:7], v[192:207]
    ds_read_b64_tr_b16 v[32:33], v2 offset:10752
    ds_read_b64_tr_b16 v[34:35], v2 offset:11008
    v_add_f32 v56, 1.0, v56
    v_add_f32 v57, 1.0, v57
    v_add_f32 v58, 1.0, v58
    v_add_f32 v59, 1.0, v59
    v_mfma_f32_32x32x16_bf16 v[208:223], v[140:143], a[148:151], v[208:223]
    v_rcp_f32 v56, v56
    v_rcp_f32 v57, v57
    v_rcp_f32 v58, v58
    s_waitcnt lgkmcnt(15)
    v_mfma_f32_32x32x16_bf16 v[160:175], v[144:147], a[8:11], v[160:175]
    ds_read_b64_tr_b16 v[128:129], v2 offset:12288
    ds_read_b64_tr_b16 v[130:131], v2 offset:12544
    v_rcp_f32 v59, v59
    v_mul_f32 v52, v64, v56
    v_mfma_f32_32x32x16_bf16 v[176:191], v[144:147], a[152:155], v[176:191]
    v_mul_f32 v53, v65, v57
    v_mul_f32 v54, v66, v58
    v_mul_f32 v55, v67, v59
    v_cvt_pk_bf16_f32 v36, v52, v53
    v_cvt_pk_bf16_f32 v37, v54, v55
    s_waitcnt lgkmcnt(15)
    v_mfma_f32_32x32x16_bf16 v[192:207], v[148:151], a[8:11], v[192:207]
    ds_read_b64_tr_b16 v[132:133], v2 offset:12800
    ds_read_b64_tr_b16 v[134:135], v2 offset:13056
    v_mul_f32 v56, v68, v68
    v_mul_f32 v57, v69, v69
    v_mul_f32 v58, v70, v70
    v_mul_f32 v59, v71, v71
    v_fma_f32 v56, v56, s24, v15
    v_mfma_f32_32x32x16_bf16 v[208:223], v[148:151], a[152:155], v[208:223]
    v_fma_f32 v57, v57, s24, v15
    v_fma_f32 v58, v58, s24, v15
    v_fma_f32 v59, v59, s24, v15
    v_mul_f32 v56, v56, v68
    s_waitcnt lgkmcnt(15)
    v_mfma_f32_32x32x16_bf16 v[160:175], v[152:155], a[12:15], v[160:175]
    ds_read_b64_tr_b16 v[136:137], v2 offset:14336
    ds_read_b64_tr_b16 v[138:139], v2 offset:14592
    v_mul_f32 v57, v57, v69
    v_mul_f32 v58, v58, v70
    v_mul_f32 v59, v59, v71
    v_exp_f32 v56, v56
    v_mfma_f32_32x32x16_bf16 v[176:191], v[152:155], a[156:159], v[176:191]
    v_exp_f32 v57, v57
    v_exp_f32 v58, v58
    v_exp_f32 v59, v59
    s_waitcnt lgkmcnt(15)
    v_mfma_f32_32x32x16_bf16 v[192:207], v[156:159], a[12:15], v[192:207]
    ds_read_b32 v18, v19
    ds_read_b64_tr_b16 v[140:141], v2 offset:14848
    ds_read_b64_tr_b16 v[142:143], v2 offset:15104
    v_add_f32 v56, 1.0, v56
    v_add_f32 v57, 1.0, v57
    v_add_f32 v58, 1.0, v58
    v_mfma_f32_32x32x16_bf16 v[208:223], v[156:159], a[156:159], v[208:223]
    v_add_f32 v59, 1.0, v59
    v_rcp_f32 v56, v56
    v_rcp_f32 v57, v57
    s_waitcnt lgkmcnt(15)
    v_mfma_f32_32x32x16_bf16 v[160:175], v[20:23], a[16:19], v[160:175]
    s_waitcnt lgkmcnt(2)
    v_readfirstlane_b32 s56, v18
    s_cmp_ge_u32 s56, s57
    s_cbranch_scc0 spin_g1_kernel_44
back_g1_kernel_45:
    s_add_u32 s18, s18, 36864
    s_cmp_eq_u32 s18, 147456
    s_cselect_b32 s18, 0, s18
    v_add_u32 v3, s18, v16
    s_cmp_ge_u32 s17, 0
    s_cselect_b32 s10, s16, 0
    s_add_u32 s25, s19, s23
    s_add_u32 s27, s20, 3981312
    s_add_u32 s19, s19, 36864
    s_cmp_eq_u32 s19, 147456
    s_cselect_b32 s19, 0, s19
    ds_read_b64_tr_b16 v[144:145], v2 offset:16384
    ds_read_b64_tr_b16 v[146:147], v2 offset:16640
    v_rcp_f32 v58, v58
    v_rcp_f32 v59, v59
    v_mul_f32 v52, v68, v56
    v_mfma_f32_32x32x16_bf16 v[176:191], v[20:23], a[160:163], v[176:191]
    s_add_u32 m0, s25, 0
    s_nop 0
    buffer_load_dwordx4 v4, s[8:11], s27 offen lds
    v_mul_f32 v53, v69, v57
    v_mul_f32 v54, v70, v58
    v_mul_f32 v55, v71, v59
    v_cvt_pk_bf16_f32 v40, v52, v53
    v_mfma_f32_32x32x16_bf16 v[192:207], v[24:27], a[16:19], v[192:207]
    ds_read_b64_tr_b16 v[148:149], v2 offset:16896
    ds_read_b64_tr_b16 v[150:151], v2 offset:17152
    v_cvt_pk_bf16_f32 v41, v54, v55
    v_mul_f32 v56, v72, v72
    v_mul_f32 v57, v73, v73
    v_mul_f32 v58, v74, v74
    v_mul_f32 v59, v75, v75
    v_mfma_f32_32x32x16_bf16 v[208:223], v[24:27], a[160:163], v[208:223]
    v_fma_f32 v56, v56, s24, v15
    v_fma_f32 v57, v57, s24, v15
    v_fma_f32 v58, v58, s24, v15
    v_fma_f32 v59, v59, s24, v15
    v_mul_f32 v56, v56, v72
    v_mfma_f32_32x32x16_bf16 v[160:175], v[28:31], a[20:23], v[160:175]
    ds_read_b64_tr_b16 v[152:153], v3 offset:0
    ds_read_b64_tr_b16 v[154:155], v3 offset:256
    s_add_u32 m0, s25, 1024
    s_nop 0
    buffer_load_dwordx4 v5, s[8:11], s27 offen lds
    v_mul_f32 v57, v57, v73
    v_mul_f32 v58, v58, v74
    v_mul_f32 v59, v59, v75
    v_exp_f32 v56, v56
    v_mfma_f32_32x32x16_bf16 v[176:191], v[28:31], a[164:167], v[176:191]
    v_exp_f32 v57, v57
    v_exp_f32 v58, v58
    v_mfma_f32_32x32x16_bf16 v[192:207], v[32:35], a[20:23], v[192:207]
    ds_read_b64_tr_b16 v[156:157], v3 offset:512
    ds_read_b64_tr_b16 v[158:159], v3 offset:768
    v_exp_f32 v59, v59
    v_add_f32 v56, 1.0, v56
    v_add_f32 v57, 1.0, v57
    v_add_f32 v58, 1.0, v58
    v_mfma_f32_32x32x16_bf16 v[208:223], v[32:35], a[164:167], v[208:223]
    s_add_u32 m0, s25, 2048
    s_nop 0
    buffer_load_dwordx4 v6, s[8:11], s27 offen lds
    v_add_f32 v59, 1.0, v59
    v_rcp_f32 v56, v56
    v_rcp_f32 v57, v57
    v_mfma_f32_32x32x16_bf16 v[160:175], v[128:131], a[24:27], v[160:175]
    ds_read_b64_tr_b16 v[20:21], v3 offset:2048
    ds_read_b64_tr_b16 v[22:23], v3 offset:2304
    v_rcp_f32 v58, v58
    v_rcp_f32 v59, v59
    v_mfma_f32_32x32x16_bf16 v[176:191], v[128:131], a[168:171], v[176:191]
    v_mul_f32 v52, v72, v56
    v_mul_f32 v53, v73, v57
    v_mul_f32 v54, v74, v58
    v_mul_f32 v55, v75, v59
    v_cvt_pk_bf16_f32 v38, v52, v53
    v_mfma_f32_32x32x16_bf16 v[192:207], v[132:135], a[24:27], v[192:207]
    ds_read_b64_tr_b16 v[24:25], v3 offset:2560
    ds_read_b64_tr_b16 v[26:27], v3 offset:2816
    s_add_u32 m0, s25, 3072
    s_nop 0
    buffer_load_dwordx4 v7, s[8:11], s27 offen lds
    v_cvt_pk_bf16_f32 v39, v54, v55
    v_mul_f32 v56, v76, v76
    v_mul_f32 v57, v77, v77
    v_mul_f32 v58, v78, v78
    v_mfma_f32_32x32x16_bf16 v[208:223], v[132:135], a[168:171], v[208:223]
    v_mul_f32 v59, v79, v79
    v_fma_f32 v56, v56, s24, v15
    v_fma_f32 v57, v57, s24, v15
    v_fma_f32 v58, v58, s24, v15
    v_fma_f32 v59, v59, s24, v15
    v_mfma_f32_32x32x16_bf16 v[160:175], v[136:139], a[28:31], v[160:175]
    ds_read_b64_tr_b16 v[28:29], v3 offset:4096
    ds_read_b64_tr_b16 v[30:31], v3 offset:4352
    v_mul_f32 v56, v56, v76
    v_mul_f32 v57, v57, v77
    v_mul_f32 v58, v58, v78
    v_mul_f32 v59, v59, v79
    v_exp_f32 v56, v56
    v_mfma_f32_32x32x16_bf16 v[176:191], v[136:139], a[172:175], v[176:191]
    s_add_u32 m0, s25, 4096
    s_nop 0
    buffer_load_dwordx4 v8, s[8:11], s27 offen lds
    v_exp_f32 v57, v57
    v_exp_f32 v58, v58
    s_waitcnt lgkmcnt(14)
    v_mfma_f32_32x32x16_bf16 v[192:207], v[140:143], a[28:31], v[192:207]
    ds_read_b64_tr_b16 v[32:33], v3 offset:4608
    ds_read_b64_tr_b16 v[34:35], v3 offset:4864
    v_exp_f32 v59, v59
    v_add_f32 v56, 1.0, v56
    v_add_f32 v57, 1.0, v57
    v_mfma_f32_32x32x16_bf16 v[208:223], v[140:143], a[172:175], v[208:223]
    v_add_f32 v58, 1.0, v58
    v_add_f32 v59, 1.0, v59
    v_rcp_f32 v56, v56
    v_rcp_f32 v57, v57
    s_waitcnt lgkmcnt(14)
    v_mfma_f32_32x32x16_bf16 v[160:175], v[144:147], a[32:35], v[160:175]
    ds_read_b64_tr_b16 v[128:129], v3 offset:6144
    ds_read_b64_tr_b16 v[130:131], v3 offset:6400
    s_add_u32 m0, s25, 5120
    s_nop 0
    buffer_load_dwordx4 v9, s[8:11], s27 offen lds
    v_rcp_f32 v58, v58
    v_rcp_f32 v59, v59
    v_mfma_f32_32x32x16_bf16 v[176:191], v[144:147], a[176:179], v[176:191]
    v_mul_f32 v52, v76, v56
    v_mul_f32 v53, v77, v57
    v_mul_f32 v54, v78, v58
    v_mul_f32 v55, v79, v59
    s_waitcnt lgkmcnt(14)
    v_mfma_f32_32x32x16_bf16 v[192:207], v[148:151], a[32:35], v[192:207]
    ds_read_b64_tr_b16 v[132:133], v3 offset:6656
    ds_read_b64_tr_b16 v[134:135], v3 offset:6912
    v_cvt_pk_bf16_f32 v42, v52, v53
    v_cvt_pk_bf16_f32 v43, v54, v55
    s_nop 1
    v_permlane32_swap_b32 v36, v38
    v_permlane32_swap_b32 v40, v42
    v_mfma_f32_32x32x16_bf16 v[208:223], v[148:151], a[176:179], v[208:223]
    s_add_u32 m0, s25, 6144
    s_nop 0
    buffer_load_dwordx4 v10, s[8:11], s27 offen lds
    v_permlane32_swap_b32 v37, v39
    v_permlane32_swap_b32 v41, v43
    buffer_store_dwordx4 v[36:39], v13, s[12:15], s21 offen offset:0 sc1
    buffer_store_dwordx4 v[40:43], v13, s[12:15], s21 offen offset:512 sc1
    s_waitcnt lgkmcnt(14)
    v_mfma_f32_32x32x16_bf16 v[160:175], v[152:155], a[36:39], v[160:175]
    s_waitcnt vmcnt(9)
    ds_add_u32 v19, v19
    s_add_u32 s57, s57, 0x98000
    ds_read_b64_tr_b16 v[136:137], v3 offset:8192
    ds_read_b64_tr_b16 v[138:139], v3 offset:8448
    v_mul_f32 v56, v80, v80
    v_mul_f32 v57, v81, v81
    v_mul_f32 v58, v82, v82
    v_mfma_f32_32x32x16_bf16 v[176:191], v[152:155], a[180:183], v[176:191]
    v_mul_f32 v59, v83, v83
    v_fma_f32 v56, v56, s24, v15
    v_fma_f32 v57, v57, s24, v15
    v_fma_f32 v58, v58, s24, v15
    v_fma_f32 v59, v59, s24, v15
    s_waitcnt lgkmcnt(15)
    v_mfma_f32_32x32x16_bf16 v[192:207], v[156:159], a[36:39], v[192:207]
    ds_read_b64_tr_b16 v[140:141], v3 offset:8704
    ds_read_b64_tr_b16 v[142:143], v3 offset:8960
    s_add_u32 m0, s25, 7168
    s_nop 0
    buffer_load_dwordx4 v11, s[8:11], s27 offen lds
    v_mul_f32 v56, v56, v80
    v_mul_f32 v57, v57, v81
    v_mul_f32 v58, v58, v82
    v_mul_f32 v59, v59, v83
    v_exp_f32 v56, v56
    v_mfma_f32_32x32x16_bf16 v[208:223], v[156:159], a[180:183], v[208:223]
    v_exp_f32 v57, v57
    v_exp_f32 v58, v58
    s_waitcnt lgkmcnt(15)
    v_mfma_f32_32x32x16_bf16 v[160:175], v[20:23], a[40:43], v[160:175]
    ds_read_b64_tr_b16 v[144:145], v3 offset:10240
    ds_read_b64_tr_b16 v[146:147], v3 offset:10496
    v_exp_f32 v59, v59
    v_add_f32 v56, 1.0, v56
    v_add_f32 v57, 1.0, v57
    v_mfma_f32_32x32x16_bf16 v[176:191], v[20:23], a[184:187], v[176:191]
    s_add_u32 m0, s25, 8192
    s_nop 0
    buffer_load_dwordx4 v12, s[8:11], s27 offen lds
    v_add_f32 v58, 1.0, v58
    v_add_f32 v59, 1.0, v59
    v_rcp_f32 v56, v56
    v_rcp_f32 v57, v57
    s_waitcnt lgkmcnt(15)
    v_mfma_f32_32x32x16_bf16 v[192:207], v[24:27], a[40:43], v[192:207]
    ds_read_b64_tr_b16 v[148:149], v3 offset:10752
    ds_read_b64_tr_b16 v[150:151], v3 offset:11008
    v_rcp_f32 v58, v58
    v_rcp_f32 v59, v59
    v_mfma_f32_32x32x16_bf16 v[208:223], v[24:27], a[184:187], v[208:223]
    v_mul_f32 v52, v80, v56
    v_mul_f32 v53, v81, v57
    v_mul_f32 v54, v82, v58
    v_mul_f32 v55, v83, v59
    s_waitcnt lgkmcnt(15)
    v_mfma_f32_32x32x16_bf16 v[160:175], v[28:31], a[44:47], v[160:175]
    ds_read_b64_tr_b16 v[152:153], v3 offset:12288
    ds_read_b64_tr_b16 v[154:155], v3 offset:12544
    v_cvt_pk_bf16_f32 v44, v52, v53
    v_cvt_pk_bf16_f32 v45, v54, v55
    ds_read_b128 v[80:83], v14 offset:1024
    v_mul_f32 v56, v84, v84
    v_mul_f32 v57, v85, v85
    v_mfma_f32_32x32x16_bf16 v[176:191], v[28:31], a[188:191], v[176:191]
    v_mul_f32 v58, v86, v86
    v_mul_f32 v59, v87, v87
    v_fma_f32 v56, v56, s24, v15
    v_fma_f32 v57, v57, s24, v15
    s_waitcnt lgkmcnt(15)
    v_mfma_f32_32x32x16_bf16 v[192:207], v[32:35], a[44:47], v[192:207]
    ds_read_b64_tr_b16 v[156:157], v3 offset:12800
    ds_read_b64_tr_b16 v[158:159], v3 offset:13056
    v_fma_f32 v58, v58, s24, v15
    v_fma_f32 v59, v59, s24, v15
    v_mul_f32 v56, v56, v84
    v_mul_f32 v57, v57, v85
    v_mul_f32 v58, v58, v86
    v_mfma_f32_32x32x16_bf16 v[208:223], v[32:35], a[188:191], v[208:223]
    v_mul_f32 v59, v59, v87
    v_exp_f32 v56, v56
    v_exp_f32 v57, v57
    s_waitcnt lgkmcnt(15)
    v_mfma_f32_32x32x16_bf16 v[160:175], v[128:131], a[48:51], v[160:175]
    ds_read_b64_tr_b16 v[20:21], v3 offset:14336
    ds_read_b64_tr_b16 v[22:23], v3 offset:14592
    v_exp_f32 v58, v58
    v_exp_f32 v59, v59
    v_mfma_f32_32x32x16_bf16 v[176:191], v[128:131], a[192:195], v[176:191]
    v_add_f32 v56, 1.0, v56
    v_add_f32 v57, 1.0, v57
    v_add_f32 v58, 1.0, v58
    v_add_f32 v59, 1.0, v59
    v_rcp_f32 v56, v56
    s_waitcnt lgkmcnt(15)
    v_mfma_f32_32x32x16_bf16 v[192:207], v[132:135], a[48:51], v[192:207]
    ds_read_b32 v18, v19
    ds_read_b64_tr_b16 v[24:25], v3 offset:14848
    ds_read_b64_tr_b16 v[26:27], v3 offset:15104
    v_rcp_f32 v57, v57
    v_rcp_f32 v58, v58
    v_mfma_f32_32x32x16_bf16 v[208:223], v[132:135], a[192:195], v[208:223]
    v_rcp_f32 v59, v59
    v_mul_f32 v52, v84, v56
    v_mul_f32 v53, v85, v57
    s_waitcnt lgkmcnt(15)
    v_mfma_f32_32x32x16_bf16 v[160:175], v[136:139], a[52:55], v[160:175]
    s_waitcnt lgkmcnt(2)
    v_readfirstlane_b32 s56, v18
    s_cmp_ge_u32 s56, s57
    s_cbranch_scc0 spin_g1_kernel_46
back_g1_kernel_47:
    s_add_u32 s18, s18, 36864
    s_cmp_eq_u32 s18, 147456
    s_cselect_b32 s18, 0, s18
    v_add_u32 v2, s18, v16
    s_cmp_ge_u32 s17, 1
    s_cselect_b32 s10, s16, 0
    s_add_u32 s25, s19, s23
    s_add_u32 s27, s20, 256
    s_add_u32 s19, s19, 36864
    s_cmp_eq_u32 s19, 147456
    s_cselect_b32 s19, 0, s19
    ds_read_b64_tr_b16 v[28:29], v3 offset:16384
    ds_read_b64_tr_b16 v[30:31], v3 offset:16640
    v_mul_f32 v54, v86, v58
    v_mul_f32 v55, v87, v59
    v_cvt_pk_bf16_f32 v48, v52, v53
    v_cvt_pk_bf16_f32 v49, v54, v55
    ds_read_b128 v[84:87], v14 offset:1056
    v_mfma_f32_32x32x16_bf16 v[176:191], v[136:139], a[196:199], v[176:191]
    s_add_u32 m0, s25, 0
    s_nop 0
    buffer_load_dwordx4 v4, s[8:11], s27 offen lds
    v_mul_f32 v56, v88, v88
    v_mul_f32 v57, v89, v89
    v_mul_f32 v58, v90, v90
    v_mul_f32 v59, v91, v91
    v_fma_f32 v56, v56, s24, v15
    v_mfma_f32_32x32x16_bf16 v[192:207], v[140:143], a[52:55], v[192:207]
    ds_read_b64_tr_b16 v[32:33], v3 offset:16896
    ds_read_b64_tr_b16 v[34:35], v3 offset:17152
    v_fma_f32 v57, v57, s24, v15
    v_fma_f32 v58, v58, s24, v15
    v_fma_f32 v59, v59, s24, v15
    v_mul_f32 v56, v56, v88
    v_mfma_f32_32x32x16_bf16 v[208:223], v[140:143], a[196:199], v[208:223]
    v_mul_f32 v57, v57, v89
    v_mul_f32 v58, v58, v90
    v_mul_f32 v59, v59, v91
    v_exp_f32 v56, v56
    v_mfma_f32_32x32x16_bf16 v[160:175], v[144:147], a[56:59], v[160:175]
    ds_read_b64_tr_b16 v[128:129], v2 offset:0
    ds_read_b64_tr_b16 v[130:131], v2 offset:256
    s_add_u32 m0, s25, 1024
    s_nop 0
    buffer_load_dwordx4 v5, s[8:11], s27 offen lds
    v_exp_f32 v57, v57
    v_exp_f32 v58, v58
    v_exp_f32 v59, v59
    v_mfma_f32_32x32x16_bf16 v[176:191], v[144:147], a[200:203], v[176:191]
    v_add_f32 v56, 1.0, v56
    v_add_f32 v57, 1.0, v57
    v_add_f32 v58, 1.0, v58
    v_mfma_f32_32x32x16_bf16 v[192:207], v[148:151], a[56:59], v[192:207]
    ds_read_b64_tr_b16 v[132:133], v2 offset:512
    ds_read_b64_tr_b16 v[134:135], v2 offset:768
    v_add_f32 v59, 1.0, v59
    v_rcp_f32 v56, v56
    v_rcp_f32 v57, v57
    v_mfma_f32_32x32x16_bf16 v[208:223], v[148:151], a[200:203], v[208:223]
    s_add_u32 m0, s25, 2048
    s_nop 0
    buffer_load_dwordx4 v6, s[8:11], s27 offen lds
    v_rcp_f32 v58, v58
    v_rcp_f32 v59, v59
    v_mul_f32 v52, v88, v56
    v_mfma_f32_32x32x16_bf16 v[160:175], v[152:155], a[60:63], v[160:175]
    ds_read_b64_tr_b16 v[136:137], v2 offset:2048
    ds_read_b64_tr_b16 v[138:139], v2 offset:2304
    v_mul_f32 v53, v89, v57
    v_mul_f32 v54, v90, v58
    v_mul_f32 v55, v91, v59
    v_cvt_pk_bf16_f32 v46, v52, v53
    v_cvt_pk_bf16_f32 v47, v54, v55
    v_mfma_f32_32x32x16_bf16 v[176:191], v[152:155], a[204:207], v[176:191]
    ds_read_b128 v[88:91], v14 offset:1088
    v_mul_f32 v56, v92, v92
    v_mul_f32 v57, v93, v93
    v_mul_f32 v58, v94, v94
    v_mfma_f32_32x32x16_bf16 v[192:207], v[156:159], a[60:63], v[192:207]
    ds_read_b64_tr_b16 v[140:141], v2 offset:2560
    ds_read_b64_tr_b16 v[142:143], v2 offset:2816
    s_add_u32 m0, s25, 3072
    s_nop 0
    buffer_load_dwordx4 v7, s[8:11], s27 offen lds
    v_mul_f32 v59, v95, v95
    v_fma_f32 v56, v56, s24, v15
    v_fma_f32 v57, v57, s24, v15
    v_fma_f32 v58, v58, s24, v15
    v_fma_f32 v59, v59, s24, v15
    v_mfma_f32_32x32x16_bf16 v[208:223], v[156:159], a[204:207], v[208:223]
    v_mul_f32 v56, v56, v92
    v_mul_f32 v57, v57, v93
    v_mul_f32 v58, v58, v94
    v_mul_f32 v59, v59, v95
    v_exp_f32 v56, v56
    v_mfma_f32_32x32x16_bf16 v[160:175], v[20:23], a[64:67], v[160:175]
    ds_read_b64_tr_b16 v[144:145], v2 offset:4096
    ds_read_b64_tr_b16 v[146:147], v2 offset:4352
    v_exp_f32 v57, v57
    v_exp_f32 v58, v58
    v_mfma_f32_32x32x16_bf16 v[176:191], v[20:23], a[208:211], v[176:191]
    s_add_u32 m0, s25, 4096
    s_nop 0
    buffer_load_dwordx4 v8, s[8:11], s27 offen lds
    v_exp_f32 v59, v59
    v_add_f32 v56, 1.0, v56
    v_add_f32 v57, 1.0, v57
    s_waitcnt lgkmcnt(15)
    v_mfma_f32_32x32x16_bf16 v[192:207], v[24:27], a[64:67], v[192:207]
    ds_read_b64_tr_b16 v[148:149], v2 offset:4608
    ds_read_b64_tr_b16 v[150:151], v2 offset:4864
    v_add_f32 v58, 1.0, v58
    v_add_f32 v59, 1.0, v59
    v_rcp_f32 v56, v56
    v_rcp_f32 v57, v57
    v_mfma_f32_32x32x16_bf16 v[208:223], v[24:27], a[208:211], v[208:223]
    v_rcp_f32 v58, v58
    v_rcp_f32 v59, v59
    s_waitcnt lgkmcnt(15)
    v_mfma_f32_32x32x16_bf16 v[160:175], v[28:31], a[68:71], v[160:175]
    ds_read_b64_tr_b16 v[152:153], v2 offset:6144
    ds_read_b64_tr_b16 v[154:155], v2 offset:6400
    s_add_u32 m0, s25, 5120
    s_nop 0
    buffer_load_dwordx4 v9, s[8:11], s27 offen lds
    v_mul_f32 v52, v92, v56
    v_mul_f32 v53, v93, v57
    v_mul_f32 v54, v94, v58
    v_mul_f32 v55, v95, v59
    v_mfma_f32_32x32x16_bf16 v[176:191], v[28:31], a[212:215], v[176:191]
    v_cvt_pk_bf16_f32 v50, v52, v53
    v_cvt_pk_bf16_f32 v51, v54, v55
    ds_read_b128 v[92:95], v14 offset:1120
    s_nop 1
    v_permlane32_swap_b32 v44, v46
    s_waitcnt lgkmcnt(15)
    v_mfma_f32_32x32x16_bf16 v[192:207], v[32:35], a[68:71], v[192:207]
    ds_read_b64_tr_b16 v[156:157], v2 offset:6656
    ds_read_b64_tr_b16 v[158:159], v2 offset:6912
    v_permlane32_swap_b32 v48, v50
    v_permlane32_swap_b32 v45, v47
    v_permlane32_swap_b32 v49, v51
    buffer_store_dwordx4 v[44:47], v13, s[12:15], s22 offen offset:0 sc1
    v_mfma_f32_32x32x16_bf16 v[208:223], v[32:35], a[212:215], v[208:223]
    s_add_u32 m0, s25, 6144
    s_nop 0
    buffer_load_dwordx4 v10, s[8:11], s27 offen lds
    buffer_store_dwordx4 v[48:51], v13, s[12:15], s22 offen offset:512 sc1
    v_mul_f32 v56, v96, v96
    v_mul_f32 v57, v97, v97
    s_waitcnt lgkmcnt(15)
    v_mfma_f32_32x32x16_bf16 v[160:175], v[128:131], a[72:75], v[160:175]
    s_waitcnt vmcnt(9)
    ds_add_u32 v19, v19
    s_add_u32 s57, s57, 0x98000
    ds_read_b64_tr_b16 v[20:21], v2 offset:8192
    ds_read_b64_tr_b16 v[22:23], v2 offset:8448
    v_mul_f32 v58, v98, v98
    v_mul_f32 v59, v99, v99
    v_fma_f32 v56, v56, s24, v15
    v_fma_f32 v57, v57, s24, v15
    v_fma_f32 v58, v58, s24, v15
    v_mfma_f32_32x32x16_bf16 v[176:191], v[128:131], a[216:219], v[176:191]
    v_fma_f32 v59, v59, s24, v15
    v_mul_f32 v56, v56, v96
    v_mul_f32 v57, v57, v97
    v_mul_f32 v58, v58, v98
    s_waitcnt lgkmcnt(15)
    v_mfma_f32_32x32x16_bf16 v[192:207], v[132:135], a[72:75], v[192:207]
    ds_read_b64_tr_b16 v[24:25], v2 offset:8704
    ds_read_b64_tr_b16 v[26:27], v2 offset:8960
    s_add_u32 m0, s25, 7168
    s_nop 0
    buffer_load_dwordx4 v11, s[8:11], s27 offen lds
    v_mul_f32 v59, v59, v99
    v_exp_f32 v56, v56
    v_exp_f32 v57, v57
    v_mfma_f32_32x32x16_bf16 v[208:223], v[132:135], a[216:219], v[208:223]
    v_exp_f32 v58, v58
    v_exp_f32 v59, v59
    v_add_f32 v56, 1.0, v56
    v_mfma_f32_32x32x16_bf16 v[160:175], v[136:139], a[76:79], v[160:175]
    ds_read_b64_tr_b16 v[28:29], v2 offset:10240
    ds_read_b64_tr_b16 v[30:31], v2 offset:10496
    v_add_f32 v57, 1.0, v57
    v_add_f32 v58, 1.0, v58
    v_add_f32 v59, 1.0, v59
    v_rcp_f32 v56, v56
    v_mfma_f32_32x32x16_bf16 v[176:191], v[136:139], a[220:223], v[176:191]
    s_add_u32 m0, s25, 8192
    s_nop 0
    buffer_load_dwordx4 v12, s[8:11], s27 offen lds
    v_rcp_f32 v57, v57
    v_rcp_f32 v58, v58
    s_waitcnt lgkmcnt(15)
    v_mfma_f32_32x32x16_bf16 v[192:207], v[140:143], a[76:79], v[192:207]
    ds_read_b64_tr_b16 v[32:33], v2 offset:10752
    ds_read_b64_tr_b16 v[34:35], v2 offset:11008
    v_rcp_f32 v59, v59
    v_mul_f32 v52, v96, v56
    v_mul_f32 v53, v97, v57
    v_mul_f32 v54, v98, v58
    v_mfma_f32_32x32x16_bf16 v[208:223], v[140:143], a[220:223], v[208:223]
    v_mul_f32 v55, v99, v59
    v_cvt_pk_bf16_f32 v36, v52, v53
    v_cvt_pk_bf16_f32 v37, v54, v55
    v_mul_f32 v56, v100, v100
    s_waitcnt lgkmcnt(15)
    v_mfma_f32_32x32x16_bf16 v[160:175], v[144:147], a[80:83], v[160:175]
    ds_read_b64_tr_b16 v[128:129], v2 offset:12288
    ds_read_b64_tr_b16 v[130:131], v2 offset:12544
    v_mul_f32 v57, v101, v101
    v_mul_f32 v58, v102, v102
    v_mul_f32 v59, v103, v103
    v_fma_f32 v56, v56, s24, v15
    v_fma_f32 v57, v57, s24, v15
    v_mfma_f32_32x32x16_bf16 v[176:191], v[144:147], a[224:227], v[176:191]
    v_fma_f32 v58, v58, s24, v15
    v_fma_f32 v59, v59, s24, v15
    v_mul_f32 v56, v56, v100
    v_mul_f32 v57, v57, v101
    v_mul_f32 v58, v58, v102
    s_waitcnt lgkmcnt(15)
    v_mfma_f32_32x32x16_bf16 v[192:207], v[148:151], a[80:83], v[192:207]
    ds_read_b64_tr_b16 v[132:133], v2 offset:12800
    ds_read_b64_tr_b16 v[134:135], v2 offset:13056
    v_mul_f32 v59, v59, v103
    v_exp_f32 v56, v56
    v_exp_f32 v57, v57
    v_mfma_f32_32x32x16_bf16 v[208:223], v[148:151], a[224:227], v[208:223]
    v_exp_f32 v58, v58
    v_exp_f32 v59, v59
    s_waitcnt lgkmcnt(15)
    v_mfma_f32_32x32x16_bf16 v[160:175], v[152:155], a[84:87], v[160:175]
    ds_read_b64_tr_b16 v[136:137], v2 offset:14336
    ds_read_b64_tr_b16 v[138:139], v2 offset:14592
    v_add_f32 v56, 1.0, v56
    v_add_f32 v57, 1.0, v57
    v_add_f32 v58, 1.0, v58
    v_add_f32 v59, 1.0, v59
    v_rcp_f32 v56, v56
    v_mfma_f32_32x32x16_bf16 v[176:191], v[152:155], a[228:231], v[176:191]
    v_rcp_f32 v57, v57
    v_rcp_f32 v58, v58
    s_waitcnt lgkmcnt(15)
    v_mfma_f32_32x32x16_bf16 v[192:207], v[156:159], a[84:87], v[192:207]
    ds_read_b32 v18, v19
    ds_read_b64_tr_b16 v[140:141], v2 offset:14848
    ds_read_b64_tr_b16 v[142:143], v2 offset:15104
    v_rcp_f32 v59, v59
    v_mul_f32 v52, v100, v56
    v_mul_f32 v53, v101, v57
    v_mfma_f32_32x32x16_bf16 v[208:223], v[156:159], a[228:231], v[208:223]
    v_mul_f32 v54, v102, v58
    v_mul_f32 v55, v103, v59
    v_cvt_pk_bf16_f32 v40, v52, v53
    v_cvt_pk_bf16_f32 v41, v54, v55
    v_mul_f32 v56, v104, v104
    s_waitcnt lgkmcnt(15)
    v_mfma_f32_32x32x16_bf16 v[160:175], v[20:23], a[88:91], v[160:175]
    s_waitcnt lgkmcnt(2)
    v_readfirstlane_b32 s56, v18
    s_cmp_ge_u32 s56, s57
    s_cbranch_scc0 spin_g1_kernel_48
back_g1_kernel_49:
    s_add_u32 s18, s18, 36864
    s_cmp_eq_u32 s18, 147456
    s_cselect_b32 s18, 0, s18
    v_add_u32 v3, s18, v16
    s_cmp_ge_u32 s17, 1
    s_cselect_b32 s10, s16, 0
    s_add_u32 s25, s19, s23
    s_add_u32 s27, s20, 1327360
    s_add_u32 s19, s19, 36864
    s_cmp_eq_u32 s19, 147456
    s_cselect_b32 s19, 0, s19
    ds_read_b64_tr_b16 v[144:145], v2 offset:16384
    ds_read_b64_tr_b16 v[146:147], v2 offset:16640
    v_mul_f32 v57, v105, v105
    v_mul_f32 v58, v106, v106
    v_mul_f32 v59, v107, v107
    v_fma_f32 v56, v56, s24, v15
    v_fma_f32 v57, v57, s24, v15
    v_mfma_f32_32x32x16_bf16 v[176:191], v[20:23], a[232:235], v[176:191]
    s_add_u32 m0, s25, 0
    s_nop 0
    buffer_load_dwordx4 v4, s[8:11], s27 offen lds
    v_fma_f32 v58, v58, s24, v15
    v_fma_f32 v59, v59, s24, v15
    v_mul_f32 v56, v56, v104
    v_mul_f32 v57, v57, v105
    v_mfma_f32_32x32x16_bf16 v[192:207], v[24:27], a[88:91], v[192:207]
    ds_read_b64_tr_b16 v[148:149], v2 offset:16896
    ds_read_b64_tr_b16 v[150:151], v2 offset:17152
    v_mul_f32 v58, v58, v106
    v_mul_f32 v59, v59, v107
    v_exp_f32 v56, v56
    v_exp_f32 v57, v57
    v_mfma_f32_32x32x16_bf16 v[208:223], v[24:27], a[232:235], v[208:223]
    v_exp_f32 v58, v58
    v_exp_f32 v59, v59
    v_mfma_f32_32x32x16_bf16 v[160:175], v[28:31], a[92:95], v[160:175]
    ds_read_b64_tr_b16 v[152:153], v3 offset:0
    ds_read_b64_tr_b16 v[154:155], v3 offset:256
    s_add_u32 m0, s25, 1024
    s_nop 0
    buffer_load_dwordx4 v5, s[8:11], s27 offen lds
    v_add_f32 v56, 1.0, v56
    v_add_f32 v57, 1.0, v57
    v_add_f32 v58, 1.0, v58
    v_add_f32 v59, 1.0, v59
    v_mfma_f32_32x32x16_bf16 v[176:191], v[28:31], a[236:239], v[176:191]
    v_rcp_f32 v56, v56
    v_rcp_f32 v57, v57
    v_rcp_f32 v58, v58
    v_mfma_f32_32x32x16_bf16 v[192:207], v[32:35], a[92:95], v[192:207]
    ds_read_b64_tr_b16 v[156:157], v3 offset:512
    ds_read_b64_tr_b16 v[158:159], v3 offset:768
    v_rcp_f32 v59, v59
    v_mul_f32 v52, v104, v56
    v_mul_f32 v53, v105, v57
    v_mfma_f32_32x32x16_bf16 v[208:223], v[32:35], a[236:239], v[208:223]
    s_add_u32 m0, s25, 2048
    s_nop 0
    buffer_load_dwordx4 v6, s[8:11], s27 offen lds
    v_mul_f32 v54, v106, v58
    v_mul_f32 v55, v107, v59
    v_cvt_pk_bf16_f32 v38, v52, v53
    v_cvt_pk_bf16_f32 v39, v54, v55
    v_mfma_f32_32x32x16_bf16 v[160:175], v[128:131], a[96:99], v[160:175]
    ds_read_b64_tr_b16 v[20:21], v3 offset:2048
    ds_read_b64_tr_b16 v[22:23], v3 offset:2304
    v_mul_f32 v56, v108, v108
    v_mul_f32 v57, v109, v109
    v_mul_f32 v58, v110, v110
    v_mul_f32 v59, v111, v111
    v_fma_f32 v56, v56, s24, v15
    v_mfma_f32_32x32x16_bf16 v[176:191], v[128:131], a[240:243], v[176:191]
    v_fma_f32 v57, v57, s24, v15
    v_fma_f32 v58, v58, s24, v15
    v_fma_f32 v59, v59, s24, v15
    v_mul_f32 v56, v56, v108
    v_mul_f32 v57, v57, v109
    v_mfma_f32_32x32x16_bf16 v[192:207], v[132:135], a[96:99], v[192:207]
    ds_read_b64_tr_b16 v[24:25], v3 offset:2560
    ds_read_b64_tr_b16 v[26:27], v3 offset:2816
    s_add_u32 m0, s25, 3072
    s_nop 0
    buffer_load_dwordx4 v7, s[8:11], s27 offen lds
    v_mul_f32 v58, v58, v110
    v_mul_f32 v59, v59, v111
    v_exp_f32 v56, v56
    v_mfma_f32_32x32x16_bf16 v[208:223], v[132:135], a[240:243], v[208:223]
    v_exp_f32 v57, v57
    v_exp_f32 v58, v58
    v_exp_f32 v59, v59
    v_mfma_f32_32x32x16_bf16 v[160:175], v[136:139], a[100:103], v[160:175]
    ds_read_b64_tr_b16 v[28:29], v3 offset:4096
    ds_read_b64_tr_b16 v[30:31], v3 offset:4352
    v_add_f32 v56, 1.0, v56
    v_add_f32 v57, 1.0, v57
    v_add_f32 v58, 1.0, v58
    v_add_f32 v59, 1.0, v59
    v_mfma_f32_32x32x16_bf16 v[176:191], v[136:139], a[244:247], v[176:191]
    s_add_u32 m0, s25, 4096
    s_nop 0
    buffer_load_dwordx4 v8, s[8:11], s27 offen lds
    v_rcp_f32 v56, v56
    v_rcp_f32 v57, v57
    s_waitcnt lgkmcnt(14)
    v_mfma_f32_32x32x16_bf16 v[192:207], v[140:143], a[100:103], v[192:207]
    ds_read_b64_tr_b16 v[32:33], v3 offset:4608
    ds_read_b64_tr_b16 v[34:35], v3 offset:4864
    v_rcp_f32 v58, v58
    v_rcp_f32 v59, v59
    v_mul_f32 v52, v108, v56
    v_mfma_f32_32x32x16_bf16 v[208:223], v[140:143], a[244:247], v[208:223]
    v_mul_f32 v53, v109, v57
    v_mul_f32 v54, v110, v58
    v_mul_f32 v55, v111, v59
    v_cvt_pk_bf16_f32 v42, v52, v53
    v_cvt_pk_bf16_f32 v43, v54, v55
    s_waitcnt lgkmcnt(14)
    v_mfma_f32_32x32x16_bf16 v[160:175], v[144:147], a[104:107], v[160:175]
    ds_read_b64_tr_b16 v[128:129], v3 offset:6144
    ds_read_b64_tr_b16 v[130:131], v3 offset:6400
    s_add_u32 m0, s25, 5120
    s_nop 0
    buffer_load_dwordx4 v9, s[8:11], s27 offen lds
    s_nop 1
    v_permlane32_swap_b32 v36, v38
    v_permlane32_swap_b32 v40, v42
    v_permlane32_swap_b32 v37, v39
    v_mfma_f32_32x32x16_bf16 v[176:191], v[144:147], a[248:251], v[176:191]
    v_permlane32_swap_b32 v41, v43
    buffer_store_dwordx4 v[36:39], v13, s[12:15], s21 offen offset:2048 sc1
    buffer_store_dwordx4 v[40:43], v13, s[12:15], s21 offen offset:2560 sc1
    s_waitcnt lgkmcnt(14)
    v_mfma_f32_32x32x16_bf16 v[192:207], v[148:151], a[104:107], v[192:207]
    ds_read_b64_tr_b16 v[132:133], v3 offset:6656
    ds_read_b64_tr_b16 v[134:135], v3 offset:6912
    v_mul_f32 v56, v112, v112
    v_mul_f32 v57, v113, v113
    v_mul_f32 v58, v114, v114
    v_mul_f32 v59, v115, v115
    v_fma_f32 v56, v56, s24, v15
    v_mfma_f32_32x32x16_bf16 v[208:223], v[148:151], a[248:251], v[208:223]
    s_add_u32 m0, s25, 6144
    s_nop 0
    buffer_load_dwordx4 v10, s[8:11], s27 offen lds
    v_fma_f32 v57, v57, s24, v15
    v_fma_f32 v58, v58, s24, v15
    v_fma_f32 v59, v59, s24, v15
    v_mul_f32 v56, v56, v112
    s_waitcnt lgkmcnt(14)
    v_mfma_f32_32x32x16_bf16 v[160:175], v[152:155], a[108:111], v[160:175]
    s_waitcnt vmcnt(9)
    ds_add_u32 v19, v19
    s_add_u32 s57, s57, 0x98000
    ds_read_b64_tr_b16 v[136:137], v3 offset:8192
    ds_read_b64_tr_b16 v[138:139], v3 offset:8448
    v_mul_f32 v57, v57, v113
    v_mul_f32 v58, v58, v114
    v_mul_f32 v59, v59, v115
    v_exp_f32 v56, v56
    v_mfma_f32_32x32x16_bf16 v[176:191], v[152:155], a[252:255], v[176:191]
    v_exp_f32 v57, v57
    v_exp_f32 v58, v58
    v_exp_f32 v59, v59
    s_waitcnt lgkmcnt(15)
    v_mfma_f32_32x32x16_bf16 v[192:207], v[156:159], a[108:111], v[192:207]
    ds_read_b64_tr_b16 v[140:141], v3 offset:8704
    ds_read_b64_tr_b16 v[142:143], v3 offset:8960
    s_add_u32 m0, s25, 7168
    s_nop 0
    buffer_load_dwordx4 v11, s[8:11], s27 offen lds
    v_add_f32 v56, 1.0, v56
    v_add_f32 v57, 1.0, v57
    v_add_f32 v58, 1.0, v58
    v_mfma_f32_32x32x16_bf16 v[208:223], v[156:159], a[252:255], v[208:223]
    v_add_f32 v59, 1.0, v59
    v_rcp_f32 v56, v56
    v_rcp_f32 v57, v57
    s_waitcnt lgkmcnt(15)
    v_mfma_f32_32x32x16_bf16 v[160:175], v[20:23], a[112:115], v[160:175]
    ds_read_b64_tr_b16 v[144:145], v3 offset:10240
    ds_read_b64_tr_b16 v[146:147], v3 offset:10496
    v_rcp_f32 v58, v58
    v_rcp_f32 v59, v59
    v_mul_f32 v52, v112, v56
    v_mfma_f32_32x32x16_bf16 v[176:191], v[20:23], v[224:227], v[176:191]
    s_add_u32 m0, s25, 8192
    s_nop 0
    buffer_load_dwordx4 v12, s[8:11], s27 offen lds
    v_mul_f32 v53, v113, v57
    v_mul_f32 v54, v114, v58
    v_mul_f32 v55, v115, v59
    v_cvt_pk_bf16_f32 v44, v52, v53
    s_waitcnt lgkmcnt(15)
    v_mfma_f32_32x32x16_bf16 v[192:207], v[24:27], a[112:115], v[192:207]
    ds_read_b64_tr_b16 v[148:149], v3 offset:10752
    ds_read_b64_tr_b16 v[150:151], v3 offset:11008
    v_cvt_pk_bf16_f32 v45, v54, v55
    ds_read_b128 v[112:115], v14 offset:1152
    v_mul_f32 v56, v116, v116
    v_mul_f32 v57, v117, v117
    v_mul_f32 v58, v118, v118
    v_mfma_f32_32x32x16_bf16 v[208:223], v[24:27], v[224:227], v[208:223]
    v_mul_f32 v59, v119, v119
    v_fma_f32 v56, v56, s24, v15
    v_fma_f32 v57, v57, s24, v15
    v_fma_f32 v58, v58, s24, v15
    v_fma_f32 v59, v59, s24, v15
    s_waitcnt lgkmcnt(15)
    v_mfma_f32_32x32x16_bf16 v[160:175], v[28:31], a[116:119], v[160:175]
    ds_read_b64_tr_b16 v[152:153], v3 offset:12288
    ds_read_b64_tr_b16 v[154:155], v3 offset:12544
    v_mul_f32 v56, v56, v116
    v_mul_f32 v57, v57, v117
    v_mul_f32 v58, v58, v118
    v_mul_f32 v59, v59, v119
    v_exp_f32 v56, v56
    v_mfma_f32_32x32x16_bf16 v[176:191], v[28:31], v[228:231], v[176:191]
    v_exp_f32 v57, v57
    v_exp_f32 v58, v58
    s_waitcnt lgkmcnt(15)
    v_mfma_f32_32x32x16_bf16 v[192:207], v[32:35], a[116:119], v[192:207]
    ds_read_b64_tr_b16 v[156:157], v3 offset:12800
    ds_read_b64_tr_b16 v[158:159], v3 offset:13056
    v_exp_f32 v59, v59
    v_add_f32 v56, 1.0, v56
    v_add_f32 v57, 1.0, v57
    v_mfma_f32_32x32x16_bf16 v[208:223], v[32:35], v[228:231], v[208:223]
    v_add_f32 v58, 1.0, v58
    v_add_f32 v59, 1.0, v59
    v_rcp_f32 v56, v56
    v_rcp_f32 v57, v57
    s_waitcnt lgkmcnt(15)
    v_mfma_f32_32x32x16_bf16 v[160:175], v[128:131], a[120:123], v[160:175]
    ds_read_b64_tr_b16 v[20:21], v3 offset:14336
    ds_read_b64_tr_b16 v[22:23], v3 offset:14592
    v_rcp_f32 v58, v58
    v_rcp_f32 v59, v59
    v_mfma_f32_32x32x16_bf16 v[176:191], v[128:131], v[232:235], v[176:191]
    v_mul_f32 v52, v116, v56
    v_mul_f32 v53, v117, v57
    v_mul_f32 v54, v118, v58
    v_mul_f32 v55, v119, v59
    s_waitcnt lgkmcnt(15)
    v_mfma_f32_32x32x16_bf16 v[192:207], v[132:135], a[120:123], v[192:207]
    ds_read_b32 v18, v19
    ds_read_b64_tr_b16 v[24:25], v3 offset:14848
    ds_read_b64_tr_b16 v[26:27], v3 offset:15104
    v_cvt_pk_bf16_f32 v48, v52, v53
    v_cvt_pk_bf16_f32 v49, v54, v55
    ds_read_b128 v[116:119], v14 offset:1184
    v_mul_f32 v56, v120, v120
    v_mul_f32 v57, v121, v121
    v_mfma_f32_32x32x16_bf16 v[208:223], v[132:135], v[232:235], v[208:223]
    v_mul_f32 v58, v122, v122
    v_mul_f32 v59, v123, v123
    v_fma_f32 v56, v56, s24, v15
    v_fma_f32 v57, v57, s24, v15
    s_waitcnt lgkmcnt(15)
    v_mfma_f32_32x32x16_bf16 v[160:175], v[136:139], a[124:127], v[160:175]
    s_waitcnt lgkmcnt(3)
    v_readfirstlane_b32 s56, v18
    s_cmp_ge_u32 s56, s57
    s_cbranch_scc0 spin_g1_kernel_50
back_g1_kernel_51:
    s_add_u32 s18, s18, 36864
    s_cmp_eq_u32 s18, 147456
    s_cselect_b32 s18, 0, s18
    v_add_u32 v2, s18, v16
    s_cmp_ge_u32 s17, 1
    s_cselect_b32 s10, s16, 0
    s_add_u32 s25, s19, s23
    s_add_u32 s27, s20, 2654464
    s_add_u32 s19, s19, 36864
    s_cmp_eq_u32 s19, 147456
    s_cselect_b32 s19, 0, s19
    ds_read_b64_tr_b16 v[28:29], v3 offset:16384
    ds_read_b64_tr_b16 v[30:31], v3 offset:16640
    v_fma_f32 v58, v58, s24, v15
    v_fma_f32 v59, v59, s24, v15
    v_mul_f32 v56, v56, v120
    v_mul_f32 v57, v57, v121
    v_mul_f32 v58, v58, v122
    v_mfma_f32_32x32x16_bf16 v[176:191], v[136:139], v[236:239], v[176:191]
    s_add_u32 m0, s25, 0
    s_nop 0
    buffer_load_dwordx4 v4, s[8:11], s27 offen lds
    v_mul_f32 v59, v59, v123
    v_exp_f32 v56, v56
    v_exp_f32 v57, v57
    v_mfma_f32_32x32x16_bf16 v[192:207], v[140:143], a[124:127], v[192:207]
    ds_read_b64_tr_b16 v[32:33], v3 offset:16896
    ds_read_b64_tr_b16 v[34:35], v3 offset:17152
    v_exp_f32 v58, v58
    v_exp_f32 v59, v59
    v_mfma_f32_32x32x16_bf16 v[208:223], v[140:143], v[236:239], v[208:223]
    v_add_f32 v56, 1.0, v56
    v_add_f32 v57, 1.0, v57
    v_add_f32 v58, 1.0, v58
    v_add_f32 v59, 1.0, v59
    v_rcp_f32 v56, v56
    v_mfma_f32_32x32x16_bf16 v[160:175], v[144:147], a[128:131], v[160:175]
    ds_read_b64_tr_b16 v[128:129], v2 offset:0
    ds_read_b64_tr_b16 v[130:131], v2 offset:256
    s_add_u32 m0, s25, 1024
    s_nop 0
    buffer_load_dwordx4 v5, s[8:11], s27 offen lds
    v_rcp_f32 v57, v57
    v_rcp_f32 v58, v58
    v_mfma_f32_32x32x16_bf16 v[176:191], v[144:147], v[240:243], v[176:191]
    v_rcp_f32 v59, v59
    v_mul_f32 v52, v120, v56
    v_mul_f32 v53, v121, v57
    v_mfma_f32_32x32x16_bf16 v[192:207], v[148:151], a[128:131], v[192:207]
    ds_read_b64_tr_b16 v[132:133], v2 offset:512
    ds_read_b64_tr_b16 v[134:135], v2 offset:768
    v_mul_f32 v54, v122, v58
    v_mul_f32 v55, v123, v59
    v_cvt_pk_bf16_f32 v46, v52, v53
    v_cvt_pk_bf16_f32 v47, v54, v55
    ds_read_b128 v[120:123], v14 offset:1216
    v_mfma_f32_32x32x16_bf16 v[208:223], v[148:151], v[240:243], v[208:223]
    s_add_u32 m0, s25, 2048
    s_nop 0
    buffer_load_dwordx4 v6, s[8:11], s27 offen lds
    v_mul_f32 v56, v124, v124
    v_mul_f32 v57, v125, v125
    v_mul_f32 v58, v126, v126
    v_mul_f32 v59, v127, v127
    v_fma_f32 v56, v56, s24, v15
    v_mfma_f32_32x32x16_bf16 v[160:175], v[152:155], a[132:135], v[160:175]
    ds_read_b64_tr_b16 v[136:137], v2 offset:2048
    ds_read_b64_tr_b16 v[138:139], v2 offset:2304
    v_fma_f32 v57, v57, s24, v15
    v_fma_f32 v58, v58, s24, v15
    v_fma_f32 v59, v59, s24, v15
    v_mul_f32 v56, v56, v124
    v_mfma_f32_32x32x16_bf16 v[176:191], v[152:155], v[244:247], v[176:191]
    v_mul_f32 v57, v57, v125
    v_mul_f32 v58, v58, v126
    v_mul_f32 v59, v59, v127
    v_exp_f32 v56, v56
    v_mfma_f32_32x32x16_bf16 v[192:207], v[156:159], a[132:135], v[192:207]
    ds_read_b64_tr_b16 v[140:141], v2 offset:2560
    ds_read_b64_tr_b16 v[142:143], v2 offset:2816
    s_add_u32 m0, s25, 3072
    s_nop 0
    buffer_load_dwordx4 v7, s[8:11], s27 offen lds
    v_exp_f32 v57, v57
    v_exp_f32 v58, v58
    v_exp_f32 v59, v59
    v_mfma_f32_32x32x16_bf16 v[208:223], v[156:159], v[244:247], v[208:223]
    v_add_f32 v56, 1.0, v56
    v_add_f32 v57, 1.0, v57
    v_add_f32 v58, 1.0, v58
    v_mfma_f32_32x32x16_bf16 v[160:175], v[20:23], a[136:139], v[160:175]
    ds_read_b64_tr_b16 v[144:145], v2 offset:4096
    ds_read_b64_tr_b16 v[146:147], v2 offset:4352
    v_add_f32 v59, 1.0, v59
    v_rcp_f32 v56, v56
    v_rcp_f32 v57, v57
    v_mfma_f32_32x32x16_bf16 v[176:191], v[20:23], v[248:251], v[176:191]
    s_add_u32 m0, s25, 4096
    s_nop 0
    buffer_load_dwordx4 v8, s[8:11], s27 offen lds
    v_rcp_f32 v58, v58
    v_rcp_f32 v59, v59
    v_mul_f32 v52, v124, v56
    s_waitcnt lgkmcnt(15)
    v_mfma_f32_32x32x16_bf16 v[192:207], v[24:27], a[136:139], v[192:207]
    ds_read_b64_tr_b16 v[148:149], v2 offset:4608
    ds_read_b64_tr_b16 v[150:151], v2 offset:4864
    v_mul_f32 v53, v125, v57
    v_mul_f32 v54, v126, v58
    v_mul_f32 v55, v127, v59
    v_cvt_pk_bf16_f32 v50, v52, v53
    v_mfma_f32_32x32x16_bf16 v[208:223], v[24:27], v[248:251], v[208:223]
    v_cvt_pk_bf16_f32 v51, v54, v55
    ds_read_b128 v[124:127], v14 offset:1248
    v_add_u32 v14, 512, v14
    s_nop 1
    v_permlane32_swap_b32 v44, v46
    s_waitcnt lgkmcnt(15)
    v_mfma_f32_32x32x16_bf16 v[160:175], v[28:31], a[140:143], v[160:175]
    ds_read_b64_tr_b16 v[152:153], v2 offset:6144
    ds_read_b64_tr_b16 v[154:155], v2 offset:6400
    s_add_u32 m0, s25, 5120
    s_nop 0
    buffer_load_dwordx4 v9, s[8:11], s27 offen lds
    v_permlane32_swap_b32 v48, v50
    v_permlane32_swap_b32 v45, v47
    v_permlane32_swap_b32 v49, v51
    buffer_store_dwordx4 v[44:47], v13, s[12:15], s22 offen offset:2048 sc1
    v_mfma_f32_32x32x16_bf16 v[176:191], v[28:31], v[252:255], v[176:191]
    buffer_store_dwordx4 v[48:51], v13, s[12:15], s22 offen offset:2560 sc1
    s_add_u32 s21, s21, 8192
    s_add_u32 s22, s22, 8192
    s_waitcnt lgkmcnt(15)
    v_mfma_f32_32x32x16_bf16 v[192:207], v[32:35], a[140:143], v[192:207]
    ds_read_b64_tr_b16 v[156:157], v2 offset:6656
    ds_read_b64_tr_b16 v[158:159], v2 offset:6912
    v_mfma_f32_32x32x16_bf16 v[208:223], v[32:35], v[252:255], v[208:223]
    s_add_u32 m0, s25, 6144
    s_nop 0
    buffer_load_dwordx4 v10, s[8:11], s27 offen lds
    s_add_u32 s20, s20, 256
    s_cmp_eq_u32 s17, 0
    s_cbranch_scc1 drain1h_g1_kernel_36
    s_sub_u32 s17, s17, 1
    s_waitcnt lgkmcnt(15)
    v_mfma_f32_32x32x16_bf16 v[64:79], v[128:131], a[0:3], v[80:95]
    s_waitcnt vmcnt(9)
    ds_add_u32 v19, v19
    s_add_u32 s57, s57, 0x98000
    ds_read_b64_tr_b16 v[20:21], v2 offset:8192
    ds_read_b64_tr_b16 v[22:23], v2 offset:8448
    v_mfma_f32_32x32x16_bf16 v[80:95], v[128:131], a[144:147], v[80:95]
    s_waitcnt lgkmcnt(15)
    s_waitcnt lgkmcnt(7)
    v_mfma_f32_32x32x16_bf16 v[96:111], v[132:135], a[0:3], v[112:127]
    ds_read_b64_tr_b16 v[24:25], v2 offset:8704
    ds_read_b64_tr_b16 v[26:27], v2 offset:8960
    s_add_u32 m0, s25, 7168
    s_nop 0
    buffer_load_dwordx4 v11, s[8:11], s27 offen lds
    v_mul_f32 v56, v160, v160
    v_mul_f32 v57, v161, v161
    v_mul_f32 v58, v162, v162
    v_mul_f32 v59, v163, v163
    v_fma_f32 v56, v56, s24, v15
    v_mfma_f32_32x32x16_bf16 v[112:127], v[132:135], a[144:147], v[112:127]
    v_fma_f32 v57, v57, s24, v15
    v_fma_f32 v58, v58, s24, v15
    v_fma_f32 v59, v59, s24, v15
    v_mul_f32 v56, v56, v160
    v_mul_f32 v57, v57, v161
    v_mfma_f32_32x32x16_bf16 v[64:79], v[136:139], a[4:7], v[64:79]
    ds_read_b64_tr_b16 v[28:29], v2 offset:10240
    ds_read_b64_tr_b16 v[30:31], v2 offset:10496
    v_mul_f32 v58, v58, v162
    v_mul_f32 v59, v59, v163
    v_exp_f32 v56, v56
    v_exp_f32 v57, v57
    v_mfma_f32_32x32x16_bf16 v[80:95], v[136:139], a[148:151], v[80:95]
    s_add_u32 m0, s25, 8192
    s_nop 0
    buffer_load_dwordx4 v12, s[8:11], s27 offen lds
    v_exp_f32 v58, v58
    v_exp_f32 v59, v59
    v_mfma_f32_32x32x16_bf16 v[96:111], v[140:143], a[4:7], v[96:111]
    ds_read_b64_tr_b16 v[32:33], v2 offset:10752
    ds_read_b64_tr_b16 v[34:35], v2 offset:11008
    v_add_f32 v56, 1.0, v56
    v_add_f32 v57, 1.0, v57
    v_add_f32 v58, 1.0, v58
    v_add_f32 v59, 1.0, v59
    v_mfma_f32_32x32x16_bf16 v[112:127], v[140:143], a[148:151], v[112:127]
    v_rcp_f32 v56, v56
    v_rcp_f32 v57, v57
    v_rcp_f32 v58, v58
    v_mfma_f32_32x32x16_bf16 v[64:79], v[144:147], a[8:11], v[64:79]
    ds_read_b64_tr_b16 v[128:129], v2 offset:12288
    ds_read_b64_tr_b16 v[130:131], v2 offset:12544
    v_rcp_f32 v59, v59
    v_mul_f32 v52, v160, v56
    v_mfma_f32_32x32x16_bf16 v[80:95], v[144:147], a[152:155], v[80:95]
    v_mul_f32 v53, v161, v57
    v_mul_f32 v54, v162, v58
    v_mul_f32 v55, v163, v59
    v_cvt_pk_bf16_f32 v36, v52, v53
    v_cvt_pk_bf16_f32 v37, v54, v55
    v_mfma_f32_32x32x16_bf16 v[96:111], v[148:151], a[8:11], v[96:111]
    ds_read_b64_tr_b16 v[132:133], v2 offset:12800
    ds_read_b64_tr_b16 v[134:135], v2 offset:13056
    v_mul_f32 v56, v164, v164
    v_mul_f32 v57, v165, v165
    v_mul_f32 v58, v166, v166
    v_mul_f32 v59, v167, v167
    v_fma_f32 v56, v56, s24, v15
    v_mfma_f32_32x32x16_bf16 v[112:127], v[148:151], a[152:155], v[112:127]
    v_fma_f32 v57, v57, s24, v15
    v_fma_f32 v58, v58, s24, v15
    v_fma_f32 v59, v59, s24, v15
    v_mul_f32 v56, v56, v164
    s_waitcnt lgkmcnt(15)
    v_mfma_f32_32x32x16_bf16 v[64:79], v[152:155], a[12:15], v[64:79]
    ds_read_b64_tr_b16 v[136:137], v2 offset:14336
    ds_read_b64_tr_b16 v[138:139], v2 offset:14592
    v_mul_f32 v57, v57, v165
    v_mul_f32 v58, v58, v166
    v_mul_f32 v59, v59, v167
    v_exp_f32 v56, v56
    v_mfma_f32_32x32x16_bf16 v[80:95], v[152:155], a[156:159], v[80:95]
    v_exp_f32 v57, v57
    v_exp_f32 v58, v58
    v_exp_f32 v59, v59
    s_waitcnt lgkmcnt(15)
    v_mfma_f32_32x32x16_bf16 v[96:111], v[156:159], a[12:15], v[96:111]
    ds_read_b32 v18, v19
    ds_read_b64_tr_b16 v[140:141], v2 offset:14848
    ds_read_b64_tr_b16 v[142:143], v2 offset:15104
    v_add_f32 v56, 1.0, v56
    v_add_f32 v57, 1.0, v57
    v_add_f32 v58, 1.0, v58
    v_mfma_f32_32x32x16_bf16 v[112:127], v[156:159], a[156:159], v[112:127]
    v_add_f32 v59, 1.0, v59
    v_rcp_f32 v56, v56
    v_rcp_f32 v57, v57
    s_waitcnt lgkmcnt(15)
    v_mfma_f32_32x32x16_bf16 v[64:79], v[20:23], a[16:19], v[64:79]
    s_waitcnt lgkmcnt(2)
    v_readfirstlane_b32 s56, v18
    s_cmp_ge_u32 s56, s57
    s_cbranch_scc0 spin_g1_kernel_52
back_g1_kernel_53:
    s_add_u32 s18, s18, 36864
    s_cmp_eq_u32 s18, 147456
    s_cselect_b32 s18, 0, s18
    v_add_u32 v3, s18, v16
    s_cmp_ge_u32 s17, 0
    s_cselect_b32 s10, s16, 0
    s_add_u32 s25, s19, s23
    s_add_u32 s27, s20, 3981312
    s_add_u32 s19, s19, 36864
    s_cmp_eq_u32 s19, 147456
    s_cselect_b32 s19, 0, s19
    ds_read_b64_tr_b16 v[144:145], v2 offset:16384
    ds_read_b64_tr_b16 v[146:147], v2 offset:16640
    v_rcp_f32 v58, v58
    v_rcp_f32 v59, v59
    v_mul_f32 v52, v164, v56
    v_mfma_f32_32x32x16_bf16 v[80:95], v[20:23], a[160:163], v[80:95]
    s_add_u32 m0, s25, 0
    s_nop 0
    buffer_load_dwordx4 v4, s[8:11], s27 offen lds
    v_mul_f32 v53, v165, v57
    v_mul_f32 v54, v166, v58
    v_mul_f32 v55, v167, v59
    v_cvt_pk_bf16_f32 v40, v52, v53
    v_mfma_f32_32x32x16_bf16 v[96:111], v[24:27], a[16:19], v[96:111]
    ds_read_b64_tr_b16 v[148:149], v2 offset:16896
    ds_read_b64_tr_b16 v[150:151], v2 offset:17152
    v_cvt_pk_bf16_f32 v41, v54, v55
    v_mul_f32 v56, v168, v168
    v_mul_f32 v57, v169, v169
    v_mul_f32 v58, v170, v170
    v_mul_f32 v59, v171, v171
    v_mfma_f32_32x32x16_bf16 v[112:127], v[24:27], a[160:163], v[112:127]
    v_fma_f32 v56, v56, s24, v15
    v_fma_f32 v57, v57, s24, v15
    v_fma_f32 v58, v58, s24, v15
    v_fma_f32 v59, v59, s24, v15
    v_mul_f32 v56, v56, v168
    v_mfma_f32_32x32x16_bf16 v[64:79], v[28:31], a[20:23], v[64:79]
    ds_read_b64_tr_b16 v[152:153], v3 offset:0
    ds_read_b64_tr_b16 v[154:155], v3 offset:256
    s_add_u32 m0, s25, 1024
    s_nop 0
    buffer_load_dwordx4 v5, s[8:11], s27 offen lds
    v_mul_f32 v57, v57, v169
    v_mul_f32 v58, v58, v170
    v_mul_f32 v59, v59, v171
    v_exp_f32 v56, v56
    v_mfma_f32_32x32x16_bf16 v[80:95], v[28:31], a[164:167], v[80:95]
    v_exp_f32 v57, v57
    v_exp_f32 v58, v58
    v_mfma_f32_32x32x16_bf16 v[96:111], v[32:35], a[20:23], v[96:111]
    ds_read_b64_tr_b16 v[156:157], v3 offset:512
    ds_read_b64_tr_b16 v[158:159], v3 offset:768
    v_exp_f32 v59, v59
    v_add_f32 v56, 1.0, v56
    v_add_f32 v57, 1.0, v57
    v_add_f32 v58, 1.0, v58
    v_mfma_f32_32x32x16_bf16 v[112:127], v[32:35], a[164:167], v[112:127]
    s_add_u32 m0, s25, 2048
    s_nop 0
    buffer_load_dwordx4 v6, s[8:11], s27 offen lds
    v_add_f32 v59, 1.0, v59
    v_rcp_f32 v56, v56
    v_rcp_f32 v57, v57
    v_mfma_f32_32x32x16_bf16 v[64:79], v[128:131], a[24:27], v[64:79]
    ds_read_b64_tr_b16 v[20:21], v3 offset:2048
    ds_read_b64_tr_b16 v[22:23], v3 offset:2304
    v_rcp_f32 v58, v58
    v_rcp_f32 v59, v59
    v_mfma_f32_32x32x16_bf16 v[80:95], v[128:131], a[168:171], v[80:95]
    v_mul_f32 v52, v168, v56
    v_mul_f32 v53, v169, v57
    v_mul_f32 v54, v170, v58
    v_mul_f32 v55, v171, v59
    v_cvt_pk_bf16_f32 v38, v52, v53
    v_mfma_f32_32x32x16_bf16 v[96:111], v[132:135], a[24:27], v[96:111]
    ds_read_b64_tr_b16 v[24:25], v3 offset:2560
    ds_read_b64_tr_b16 v[26:27], v3 offset:2816
    s_add_u32 m0, s25, 3072
    s_nop 0
    buffer_load_dwordx4 v7, s[8:11], s27 offen lds
    v_cvt_pk_bf16_f32 v39, v54, v55
    v_mul_f32 v56, v172, v172
    v_mul_f32 v57, v173, v173
    v_mul_f32 v58, v174, v174
    v_mfma_f32_32x32x16_bf16 v[112:127], v[132:135], a[168:171], v[112:127]
    v_mul_f32 v59, v175, v175
    v_fma_f32 v56, v56, s24, v15
    v_fma_f32 v57, v57, s24, v15
    v_fma_f32 v58, v58, s24, v15
    v_fma_f32 v59, v59, s24, v15
    v_mfma_f32_32x32x16_bf16 v[64:79], v[136:139], a[28:31], v[64:79]
    ds_read_b64_tr_b16 v[28:29], v3 offset:4096
    ds_read_b64_tr_b16 v[30:31], v3 offset:4352
    v_mul_f32 v56, v56, v172
    v_mul_f32 v57, v57, v173
    v_mul_f32 v58, v58, v174
    v_mul_f32 v59, v59, v175
    v_exp_f32 v56, v56
    v_mfma_f32_32x32x16_bf16 v[80:95], v[136:139], a[172:175], v[80:95]
    s_add_u32 m0, s25, 4096
    s_nop 0
    buffer_load_dwordx4 v8, s[8:11], s27 offen lds
    v_exp_f32 v57, v57
    v_exp_f32 v58, v58
    s_waitcnt lgkmcnt(14)
    v_mfma_f32_32x32x16_bf16 v[96:111], v[140:143], a[28:31], v[96:111]
    ds_read_b64_tr_b16 v[32:33], v3 offset:4608
    ds_read_b64_tr_b16 v[34:35], v3 offset:4864
    v_exp_f32 v59, v59
    v_add_f32 v56, 1.0, v56
    v_add_f32 v57, 1.0, v57
    v_mfma_f32_32x32x16_bf16 v[112:127], v[140:143], a[172:175], v[112:127]
    v_add_f32 v58, 1.0, v58
    v_add_f32 v59, 1.0, v59
    v_rcp_f32 v56, v56
    v_rcp_f32 v57, v57
    s_waitcnt lgkmcnt(14)
    v_mfma_f32_32x32x16_bf16 v[64:79], v[144:147], a[32:35], v[64:79]
    ds_read_b64_tr_b16 v[128:129], v3 offset:6144
    ds_read_b64_tr_b16 v[130:131], v3 offset:6400
    s_add_u32 m0, s25, 5120
    s_nop 0
    buffer_load_dwordx4 v9, s[8:11], s27 offen lds
    v_rcp_f32 v58, v58
    v_rcp_f32 v59, v59
    v_mfma_f32_32x32x16_bf16 v[80:95], v[144:147], a[176:179], v[80:95]
    v_mul_f32 v52, v172, v56
    v_mul_f32 v53, v173, v57
    v_mul_f32 v54, v174, v58
    v_mul_f32 v55, v175, v59
    s_waitcnt lgkmcnt(14)
    v_mfma_f32_32x32x16_bf16 v[96:111], v[148:151], a[32:35], v[96:111]
    ds_read_b64_tr_b16 v[132:133], v3 offset:6656
    ds_read_b64_tr_b16 v[134:135], v3 offset:6912
    v_cvt_pk_bf16_f32 v42, v52, v53
    v_cvt_pk_bf16_f32 v43, v54, v55
    s_nop 1
    v_permlane32_swap_b32 v36, v38
    v_permlane32_swap_b32 v40, v42
    v_mfma_f32_32x32x16_bf16 v[112:127], v[148:151], a[176:179], v[112:127]
    s_add_u32 m0, s25, 6144
    s_nop 0
    buffer_load_dwordx4 v10, s[8:11], s27 offen lds
    v_permlane32_swap_b32 v37, v39
    v_permlane32_swap_b32 v41, v43
    buffer_store_dwordx4 v[36:39], v13, s[12:15], s21 offen offset:0 sc1
    buffer_store_dwordx4 v[40:43], v13, s[12:15], s21 offen offset:512 sc1
    s_waitcnt lgkmcnt(14)
    v_mfma_f32_32x32x16_bf16 v[64:79], v[152:155], a[36:39], v[64:79]
    s_waitcnt vmcnt(9)
    ds_add_u32 v19, v19
    s_add_u32 s57, s57, 0x98000
    ds_read_b64_tr_b16 v[136:137], v3 offset:8192
    ds_read_b64_tr_b16 v[138:139], v3 offset:8448
    v_mul_f32 v56, v176, v176
    v_mul_f32 v57, v177, v177
    v_mul_f32 v58, v178, v178
    v_mfma_f32_32x32x16_bf16 v[80:95], v[152:155], a[180:183], v[80:95]
    v_mul_f32 v59, v179, v179
    v_fma_f32 v56, v56, s24, v15
    v_fma_f32 v57, v57, s24, v15
    v_fma_f32 v58, v58, s24, v15
    v_fma_f32 v59, v59, s24, v15
    s_waitcnt lgkmcnt(15)
    v_mfma_f32_32x32x16_bf16 v[96:111], v[156:159], a[36:39], v[96:111]
    ds_read_b64_tr_b16 v[140:141], v3 offset:8704
    ds_read_b64_tr_b16 v[142:143], v3 offset:8960
    s_add_u32 m0, s25, 7168
    s_nop 0
    buffer_load_dwordx4 v11, s[8:11], s27 offen lds
    v_mul_f32 v56, v56, v176
    v_mul_f32 v57, v57, v177
    v_mul_f32 v58, v58, v178
    v_mul_f32 v59, v59, v179
    v_exp_f32 v56, v56
    v_mfma_f32_32x32x16_bf16 v[112:127], v[156:159], a[180:183], v[112:127]
    v_exp_f32 v57, v57
    v_exp_f32 v58, v58
    s_waitcnt lgkmcnt(15)
    v_mfma_f32_32x32x16_bf16 v[64:79], v[20:23], a[40:43], v[64:79]
    ds_read_b64_tr_b16 v[144:145], v3 offset:10240
    ds_read_b64_tr_b16 v[146:147], v3 offset:10496
    v_exp_f32 v59, v59
    v_add_f32 v56, 1.0, v56
    v_add_f32 v57, 1.0, v57
    v_mfma_f32_32x32x16_bf16 v[80:95], v[20:23], a[184:187], v[80:95]
    s_add_u32 m0, s25, 8192
    s_nop 0
    buffer_load_dwordx4 v12, s[8:11], s27 offen lds
    v_add_f32 v58, 1.0, v58
    v_add_f32 v59, 1.0, v59
    v_rcp_f32 v56, v56
    v_rcp_f32 v57, v57
    s_waitcnt lgkmcnt(15)
    v_mfma_f32_32x32x16_bf16 v[96:111], v[24:27], a[40:43], v[96:111]
    ds_read_b64_tr_b16 v[148:149], v3 offset:10752
    ds_read_b64_tr_b16 v[150:151], v3 offset:11008
    v_rcp_f32 v58, v58
    v_rcp_f32 v59, v59
    v_mfma_f32_32x32x16_bf16 v[112:127], v[24:27], a[184:187], v[112:127]
    v_mul_f32 v52, v176, v56
    v_mul_f32 v53, v177, v57
    v_mul_f32 v54, v178, v58
    v_mul_f32 v55, v179, v59
    s_waitcnt lgkmcnt(15)
    v_mfma_f32_32x32x16_bf16 v[64:79], v[28:31], a[44:47], v[64:79]
    ds_read_b64_tr_b16 v[152:153], v3 offset:12288
    ds_read_b64_tr_b16 v[154:155], v3 offset:12544
    v_cvt_pk_bf16_f32 v44, v52, v53
    v_cvt_pk_bf16_f32 v45, v54, v55
    ds_read_b128 v[176:179], v14 offset:1024
    v_mul_f32 v56, v180, v180
    v_mul_f32 v57, v181, v181
    v_mfma_f32_32x32x16_bf16 v[80:95], v[28:31], a[188:191], v[80:95]
    v_mul_f32 v58, v182, v182
    v_mul_f32 v59, v183, v183
    v_fma_f32 v56, v56, s24, v15
    v_fma_f32 v57, v57, s24, v15
    s_waitcnt lgkmcnt(15)
    v_mfma_f32_32x32x16_bf16 v[96:111], v[32:35], a[44:47], v[96:111]
    ds_read_b64_tr_b16 v[156:157], v3 offset:12800
    ds_read_b64_tr_b16 v[158:159], v3 offset:13056
    v_fma_f32 v58, v58, s24, v15
    v_fma_f32 v59, v59, s24, v15
    v_mul_f32 v56, v56, v180
    v_mul_f32 v57, v57, v181
    v_mul_f32 v58, v58, v182
    v_mfma_f32_32x32x16_bf16 v[112:127], v[32:35], a[188:191], v[112:127]
    v_mul_f32 v59, v59, v183
    v_exp_f32 v56, v56
    v_exp_f32 v57, v57
    s_waitcnt lgkmcnt(15)
    v_mfma_f32_32x32x16_bf16 v[64:79], v[128:131], a[48:51], v[64:79]
    ds_read_b64_tr_b16 v[20:21], v3 offset:14336
    ds_read_b64_tr_b16 v[22:23], v3 offset:14592
    v_exp_f32 v58, v58
    v_exp_f32 v59, v59
    v_mfma_f32_32x32x16_bf16 v[80:95], v[128:131], a[192:195], v[80:95]
    v_add_f32 v56, 1.0, v56
    v_add_f32 v57, 1.0, v57
    v_add_f32 v58, 1.0, v58
    v_add_f32 v59, 1.0, v59
    v_rcp_f32 v56, v56
    s_waitcnt lgkmcnt(15)
    v_mfma_f32_32x32x16_bf16 v[96:111], v[132:135], a[48:51], v[96:111]
    ds_read_b32 v18, v19
    ds_read_b64_tr_b16 v[24:25], v3 offset:14848
    ds_read_b64_tr_b16 v[26:27], v3 offset:15104
    v_rcp_f32 v57, v57
    v_rcp_f32 v58, v58
    v_mfma_f32_32x32x16_bf16 v[112:127], v[132:135], a[192:195], v[112:127]
    v_rcp_f32 v59, v59
    v_mul_f32 v52, v180, v56
    v_mul_f32 v53, v181, v57
    s_waitcnt lgkmcnt(15)
    v_mfma_f32_32x32x16_bf16 v[64:79], v[136:139], a[52:55], v[64:79]
    s_waitcnt lgkmcnt(2)
    v_readfirstlane_b32 s56, v18
    s_cmp_ge_u32 s56, s57
    s_cbranch_scc0 spin_g1_kernel_54
back_g1_kernel_55:
    s_add_u32 s18, s18, 36864
    s_cmp_eq_u32 s18, 147456
    s_cselect_b32 s18, 0, s18
    v_add_u32 v2, s18, v16
    s_cmp_ge_u32 s17, 1
    s_cselect_b32 s10, s16, 0
    s_add_u32 s25, s19, s23
    s_add_u32 s27, s20, 256
    s_add_u32 s19, s19, 36864
    s_cmp_eq_u32 s19, 147456
    s_cselect_b32 s19, 0, s19
    ds_read_b64_tr_b16 v[28:29], v3 offset:16384
    ds_read_b64_tr_b16 v[30:31], v3 offset:16640
    v_mul_f32 v54, v182, v58
    v_mul_f32 v55, v183, v59
    v_cvt_pk_bf16_f32 v48, v52, v53
    v_cvt_pk_bf16_f32 v49, v54, v55
    ds_read_b128 v[180:183], v14 offset:1056
    v_mfma_f32_32x32x16_bf16 v[80:95], v[136:139], a[196:199], v[80:95]
    s_add_u32 m0, s25, 0
    s_nop 0
    buffer_load_dwordx4 v4, s[8:11], s27 offen lds
    v_mul_f32 v56, v184, v184
    v_mul_f32 v57, v185, v185
    v_mul_f32 v58, v186, v186
    v_mul_f32 v59, v187, v187
    v_fma_f32 v56, v56, s24, v15
    v_mfma_f32_32x32x16_bf16 v[96:111], v[140:143], a[52:55], v[96:111]
    ds_read_b64_tr_b16 v[32:33], v3 offset:16896
    ds_read_b64_tr_b16 v[34:35], v3 offset:17152
    v_fma_f32 v57, v57, s24, v15
    v_fma_f32 v58, v58, s24, v15
    v_fma_f32 v59, v59, s24, v15
    v_mul_f32 v56, v56, v184
    v_mfma_f32_32x32x16_bf16 v[112:127], v[140:143], a[196:199], v[112:127]
    v_mul_f32 v57, v57, v185
    v_mul_f32 v58, v58, v186
    v_mul_f32 v59, v59, v187
    v_exp_f32 v56, v56
    v_mfma_f32_32x32x16_bf16 v[64:79], v[144:147], a[56:59], v[64:79]
    ds_read_b64_tr_b16 v[128:129], v2 offset:0
    ds_read_b64_tr_b16 v[130:131], v2 offset:256
    s_add_u32 m0, s25, 1024
    s_nop 0
    buffer_load_dwordx4 v5, s[8:11], s27 offen lds
    v_exp_f32 v57, v57
    v_exp_f32 v58, v58
    v_exp_f32 v59, v59
    v_mfma_f32_32x32x16_bf16 v[80:95], v[144:147], a[200:203], v[80:95]
    v_add_f32 v56, 1.0, v56
    v_add_f32 v57, 1.0, v57
    v_add_f32 v58, 1.0, v58
    v_mfma_f32_32x32x16_bf16 v[96:111], v[148:151], a[56:59], v[96:111]
    ds_read_b64_tr_b16 v[132:133], v2 offset:512
    ds_read_b64_tr_b16 v[134:135], v2 offset:768
    v_add_f32 v59, 1.0, v59
    v_rcp_f32 v56, v56
    v_rcp_f32 v57, v57
    v_mfma_f32_32x32x16_bf16 v[112:127], v[148:151], a[200:203], v[112:127]
    s_add_u32 m0, s25, 2048
    s_nop 0
    buffer_load_dwordx4 v6, s[8:11], s27 offen lds
    v_rcp_f32 v58, v58
    v_rcp_f32 v59, v59
    v_mul_f32 v52, v184, v56
    v_mfma_f32_32x32x16_bf16 v[64:79], v[152:155], a[60:63], v[64:79]
    ds_read_b64_tr_b16 v[136:137], v2 offset:2048
    ds_read_b64_tr_b16 v[138:139], v2 offset:2304
    v_mul_f32 v53, v185, v57
    v_mul_f32 v54, v186, v58
    v_mul_f32 v55, v187, v59
    v_cvt_pk_bf16_f32 v46, v52, v53
    v_cvt_pk_bf16_f32 v47, v54, v55
    v_mfma_f32_32x32x16_bf16 v[80:95], v[152:155], a[204:207], v[80:95]
    ds_read_b128 v[184:187], v14 offset:1088
    v_mul_f32 v56, v188, v188
    v_mul_f32 v57, v189, v189
    v_mul_f32 v58, v190, v190
    v_mfma_f32_32x32x16_bf16 v[96:111], v[156:159], a[60:63], v[96:111]
    ds_read_b64_tr_b16 v[140:141], v2 offset:2560
    ds_read_b64_tr_b16 v[142:143], v2 offset:2816
    s_add_u32 m0, s25, 3072
    s_nop 0
    buffer_load_dwordx4 v7, s[8:11], s27 offen lds
    v_mul_f32 v59, v191, v191
    v_fma_f32 v56, v56, s24, v15
    v_fma_f32 v57, v57, s24, v15
    v_fma_f32 v58, v58, s24, v15
    v_fma_f32 v59, v59, s24, v15
    v_mfma_f32_32x32x16_bf16 v[112:127], v[156:159], a[204:207], v[112:127]
    v_mul_f32 v56, v56, v188
    v_mul_f32 v57, v57, v189
    v_mul_f32 v58, v58, v190
    v_mul_f32 v59, v59, v191
    v_exp_f32 v56, v56
    v_mfma_f32_32x32x16_bf16 v[64:79], v[20:23], a[64:67], v[64:79]
    ds_read_b64_tr_b16 v[144:145], v2 offset:4096
    ds_read_b64_tr_b16 v[146:147], v2 offset:4352
    v_exp_f32 v57, v57
    v_exp_f32 v58, v58
    v_mfma_f32_32x32x16_bf16 v[80:95], v[20:23], a[208:211], v[80:95]
    s_add_u32 m0, s25, 4096
    s_nop 0
    buffer_load_dwordx4 v8, s[8:11], s27 offen lds
    v_exp_f32 v59, v59
    v_add_f32 v56, 1.0, v56
    v_add_f32 v57, 1.0, v57
    s_waitcnt lgkmcnt(15)
    v_mfma_f32_32x32x16_bf16 v[96:111], v[24:27], a[64:67], v[96:111]
    ds_read_b64_tr_b16 v[148:149], v2 offset:4608
    ds_read_b64_tr_b16 v[150:151], v2 offset:4864
    v_add_f32 v58, 1.0, v58
    v_add_f32 v59, 1.0, v59
    v_rcp_f32 v56, v56
    v_rcp_f32 v57, v57
    v_mfma_f32_32x32x16_bf16 v[112:127], v[24:27], a[208:211], v[112:127]
    v_rcp_f32 v58, v58
    v_rcp_f32 v59, v59
    s_waitcnt lgkmcnt(15)
    v_mfma_f32_32x32x16_bf16 v[64:79], v[28:31], a[68:71], v[64:79]
    ds_read_b64_tr_b16 v[152:153], v2 offset:6144
    ds_read_b64_tr_b16 v[154:155], v2 offset:6400
    s_add_u32 m0, s25, 5120
    s_nop 0
    buffer_load_dwordx4 v9, s[8:11], s27 offen lds
    v_mul_f32 v52, v188, v56
    v_mul_f32 v53, v189, v57
    v_mul_f32 v54, v190, v58
    v_mul_f32 v55, v191, v59
    v_mfma_f32_32x32x16_bf16 v[80:95], v[28:31], a[212:215], v[80:95]
    v_cvt_pk_bf16_f32 v50, v52, v53
    v_cvt_pk_bf16_f32 v51, v54, v55
    ds_read_b128 v[188:191], v14 offset:1120
    s_nop 1
    v_permlane32_swap_b32 v44, v46
    s_waitcnt lgkmcnt(15)
    v_mfma_f32_32x32x16_bf16 v[96:111], v[32:35], a[68:71], v[96:111]
    ds_read_b64_tr_b16 v[156:157], v2 offset:6656
    ds_read_b64_tr_b16 v[158:159], v2 offset:6912
    v_permlane32_swap_b32 v48, v50
    v_permlane32_swap_b32 v45, v47
    v_permlane32_swap_b32 v49, v51
    buffer_store_dwordx4 v[44:47], v13, s[12:15], s22 offen offset:0 sc1
    v_mfma_f32_32x32x16_bf16 v[112:127], v[32:35], a[212:215], v[112:127]
    s_add_u32 m0, s25, 6144
    s_nop 0
    buffer_load_dwordx4 v10, s[8:11], s27 offen lds
    buffer_store_dwordx4 v[48:51], v13, s[12:15], s22 offen offset:512 sc1
    v_mul_f32 v56, v192, v192
    v_mul_f32 v57, v193, v193
    s_waitcnt lgkmcnt(15)
    v_mfma_f32_32x32x16_bf16 v[64:79], v[128:131], a[72:75], v[64:79]
    s_waitcnt vmcnt(9)
    ds_add_u32 v19, v19
    s_add_u32 s57, s57, 0x98000
    ds_read_b64_tr_b16 v[20:21], v2 offset:8192
    ds_read_b64_tr_b16 v[22:23], v2 offset:8448
    v_mul_f32 v58, v194, v194
    v_mul_f32 v59, v195, v195
    v_fma_f32 v56, v56, s24, v15
    v_fma_f32 v57, v57, s24, v15
    v_fma_f32 v58, v58, s24, v15
    v_mfma_f32_32x32x16_bf16 v[80:95], v[128:131], a[216:219], v[80:95]
    v_fma_f32 v59, v59, s24, v15
    v_mul_f32 v56, v56, v192
    v_mul_f32 v57, v57, v193
    v_mul_f32 v58, v58, v194
    s_waitcnt lgkmcnt(15)
    v_mfma_f32_32x32x16_bf16 v[96:111], v[132:135], a[72:75], v[96:111]
    ds_read_b64_tr_b16 v[24:25], v2 offset:8704
    ds_read_b64_tr_b16 v[26:27], v2 offset:8960
    s_add_u32 m0, s25, 7168
    s_nop 0
    buffer_load_dwordx4 v11, s[8:11], s27 offen lds
    v_mul_f32 v59, v59, v195
    v_exp_f32 v56, v56
    v_exp_f32 v57, v57
    v_mfma_f32_32x32x16_bf16 v[112:127], v[132:135], a[216:219], v[112:127]
    v_exp_f32 v58, v58
    v_exp_f32 v59, v59
    v_add_f32 v56, 1.0, v56
    v_mfma_f32_32x32x16_bf16 v[64:79], v[136:139], a[76:79], v[64:79]
    ds_read_b64_tr_b16 v[28:29], v2 offset:10240
    ds_read_b64_tr_b16 v[30:31], v2 offset:10496
    v_add_f32 v57, 1.0, v57
    v_add_f32 v58, 1.0, v58
    v_add_f32 v59, 1.0, v59
    v_rcp_f32 v56, v56
    v_mfma_f32_32x32x16_bf16 v[80:95], v[136:139], a[220:223], v[80:95]
    s_add_u32 m0, s25, 8192
    s_nop 0
    buffer_load_dwordx4 v12, s[8:11], s27 offen lds
    v_rcp_f32 v57, v57
    v_rcp_f32 v58, v58
    s_waitcnt lgkmcnt(15)
    v_mfma_f32_32x32x16_bf16 v[96:111], v[140:143], a[76:79], v[96:111]
    ds_read_b64_tr_b16 v[32:33], v2 offset:10752
    ds_read_b64_tr_b16 v[34:35], v2 offset:11008
    v_rcp_f32 v59, v59
    v_mul_f32 v52, v192, v56
    v_mul_f32 v53, v193, v57
    v_mul_f32 v54, v194, v58
    v_mfma_f32_32x32x16_bf16 v[112:127], v[140:143], a[220:223], v[112:127]
    v_mul_f32 v55, v195, v59
    v_cvt_pk_bf16_f32 v36, v52, v53
    v_cvt_pk_bf16_f32 v37, v54, v55
    v_mul_f32 v56, v196, v196
    s_waitcnt lgkmcnt(15)
    v_mfma_f32_32x32x16_bf16 v[64:79], v[144:147], a[80:83], v[64:79]
    ds_read_b64_tr_b16 v[128:129], v2 offset:12288
    ds_read_b64_tr_b16 v[130:131], v2 offset:12544
    v_mul_f32 v57, v197, v197
    v_mul_f32 v58, v198, v198
    v_mul_f32 v59, v199, v199
    v_fma_f32 v56, v56, s24, v15
    v_fma_f32 v57, v57, s24, v15
    v_mfma_f32_32x32x16_bf16 v[80:95], v[144:147], a[224:227], v[80:95]
    v_fma_f32 v58, v58, s24, v15
    v_fma_f32 v59, v59, s24, v15
    v_mul_f32 v56, v56, v196
    v_mul_f32 v57, v57, v197
    v_mul_f32 v58, v58, v198
    s_waitcnt lgkmcnt(15)
    v_mfma_f32_32x32x16_bf16 v[96:111], v[148:151], a[80:83], v[96:111]
    ds_read_b64_tr_b16 v[132:133], v2 offset:12800
    ds_read_b64_tr_b16 v[134:135], v2 offset:13056
    v_mul_f32 v59, v59, v199
    v_exp_f32 v56, v56
    v_exp_f32 v57, v57
    v_mfma_f32_32x32x16_bf16 v[112:127], v[148:151], a[224:227], v[112:127]
    v_exp_f32 v58, v58
    v_exp_f32 v59, v59
    s_waitcnt lgkmcnt(15)
    v_mfma_f32_32x32x16_bf16 v[64:79], v[152:155], a[84:87], v[64:79]
    ds_read_b64_tr_b16 v[136:137], v2 offset:14336
    ds_read_b64_tr_b16 v[138:139], v2 offset:14592
    v_add_f32 v56, 1.0, v56
    v_add_f32 v57, 1.0, v57
    v_add_f32 v58, 1.0, v58
    v_add_f32 v59, 1.0, v59
    v_rcp_f32 v56, v56
    v_mfma_f32_32x32x16_bf16 v[80:95], v[152:155], a[228:231], v[80:95]
    v_rcp_f32 v57, v57
    v_rcp_f32 v58, v58
    s_waitcnt lgkmcnt(15)
    v_mfma_f32_32x32x16_bf16 v[96:111], v[156:159], a[84:87], v[96:111]
    ds_read_b32 v18, v19
    ds_read_b64_tr_b16 v[140:141], v2 offset:14848
    ds_read_b64_tr_b16 v[142:143], v2 offset:15104
    v_rcp_f32 v59, v59
    v_mul_f32 v52, v196, v56
    v_mul_f32 v53, v197, v57
    v_mfma_f32_32x32x16_bf16 v[112:127], v[156:159], a[228:231], v[112:127]
    v_mul_f32 v54, v198, v58
    v_mul_f32 v55, v199, v59
    v_cvt_pk_bf16_f32 v40, v52, v53
    v_cvt_pk_bf16_f32 v41, v54, v55
    v_mul_f32 v56, v200, v200
    s_waitcnt lgkmcnt(15)
    v_mfma_f32_32x32x16_bf16 v[64:79], v[20:23], a[88:91], v[64:79]
    s_waitcnt lgkmcnt(2)
    v_readfirstlane_b32 s56, v18
    s_cmp_ge_u32 s56, s57
    s_cbranch_scc0 spin_g1_kernel_56
back_g1_kernel_57:
    s_add_u32 s18, s18, 36864
    s_cmp_eq_u32 s18, 147456
    s_cselect_b32 s18, 0, s18
    v_add_u32 v3, s18, v16
    s_cmp_ge_u32 s17, 1
    s_cselect_b32 s10, s16, 0
    s_add_u32 s25, s19, s23
    s_add_u32 s27, s20, 1327360
    s_add_u32 s19, s19, 36864
    s_cmp_eq_u32 s19, 147456
    s_cselect_b32 s19, 0, s19
    ds_read_b64_tr_b16 v[144:145], v2 offset:16384
    ds_read_b64_tr_b16 v[146:147], v2 offset:16640
    v_mul_f32 v57, v201, v201
    v_mul_f32 v58, v202, v202
    v_mul_f32 v59, v203, v203
    v_fma_f32 v56, v56, s24, v15
    v_fma_f32 v57, v57, s24, v15
    v_mfma_f32_32x32x16_bf16 v[80:95], v[20:23], a[232:235], v[80:95]
    s_add_u32 m0, s25, 0
    s_nop 0
    buffer_load_dwordx4 v4, s[8:11], s27 offen lds
    v_fma_f32 v58, v58, s24, v15
    v_fma_f32 v59, v59, s24, v15
    v_mul_f32 v56, v56, v200
    v_mul_f32 v57, v57, v201
    v_mfma_f32_32x32x16_bf16 v[96:111], v[24:27], a[88:91], v[96:111]
    ds_read_b64_tr_b16 v[148:149], v2 offset:16896
    ds_read_b64_tr_b16 v[150:151], v2 offset:17152
    v_mul_f32 v58, v58, v202
    v_mul_f32 v59, v59, v203
    v_exp_f32 v56, v56
    v_exp_f32 v57, v57
    v_mfma_f32_32x32x16_bf16 v[112:127], v[24:27], a[232:235], v[112:127]
    v_exp_f32 v58, v58
    v_exp_f32 v59, v59
    v_mfma_f32_32x32x16_bf16 v[64:79], v[28:31], a[92:95], v[64:79]
    ds_read_b64_tr_b16 v[152:153], v3 offset:0
    ds_read_b64_tr_b16 v[154:155], v3 offset:256
    s_add_u32 m0, s25, 1024
    s_nop 0
    buffer_load_dwordx4 v5, s[8:11], s27 offen lds
    v_add_f32 v56, 1.0, v56
    v_add_f32 v57, 1.0, v57
    v_add_f32 v58, 1.0, v58
    v_add_f32 v59, 1.0, v59
    v_mfma_f32_32x32x16_bf16 v[80:95], v[28:31], a[236:239], v[80:95]
    v_rcp_f32 v56, v56
    v_rcp_f32 v57, v57
    v_rcp_f32 v58, v58
    v_mfma_f32_32x32x16_bf16 v[96:111], v[32:35], a[92:95], v[96:111]
    ds_read_b64_tr_b16 v[156:157], v3 offset:512
    ds_read_b64_tr_b16 v[158:159], v3 offset:768
    v_rcp_f32 v59, v59
    v_mul_f32 v52, v200, v56
    v_mul_f32 v53, v201, v57
    v_mfma_f32_32x32x16_bf16 v[112:127], v[32:35], a[236:239], v[112:127]
    s_add_u32 m0, s25, 2048
    s_nop 0
    buffer_load_dwordx4 v6, s[8:11], s27 offen lds
    v_mul_f32 v54, v202, v58
    v_mul_f32 v55, v203, v59
    v_cvt_pk_bf16_f32 v38, v52, v53
    v_cvt_pk_bf16_f32 v39, v54, v55
    v_mfma_f32_32x32x16_bf16 v[64:79], v[128:131], a[96:99], v[64:79]
    ds_read_b64_tr_b16 v[20:21], v3 offset:2048
    ds_read_b64_tr_b16 v[22:23], v3 offset:2304
    v_mul_f32 v56, v204, v204
    v_mul_f32 v57, v205, v205
    v_mul_f32 v58, v206, v206
    v_mul_f32 v59, v207, v207
    v_fma_f32 v56, v56, s24, v15
    v_mfma_f32_32x32x16_bf16 v[80:95], v[128:131], a[240:243], v[80:95]
    v_fma_f32 v57, v57, s24, v15
    v_fma_f32 v58, v58, s24, v15
    v_fma_f32 v59, v59, s24, v15
    v_mul_f32 v56, v56, v204
    v_mul_f32 v57, v57, v205
    v_mfma_f32_32x32x16_bf16 v[96:111], v[132:135], a[96:99], v[96:111]
    ds_read_b64_tr_b16 v[24:25], v3 offset:2560
    ds_read_b64_tr_b16 v[26:27], v3 offset:2816
    s_add_u32 m0, s25, 3072
    s_nop 0
    buffer_load_dwordx4 v7, s[8:11], s27 offen lds
    v_mul_f32 v58, v58, v206
    v_mul_f32 v59, v59, v207
    v_exp_f32 v56, v56
    v_mfma_f32_32x32x16_bf16 v[112:127], v[132:135], a[240:243], v[112:127]
    v_exp_f32 v57, v57
    v_exp_f32 v58, v58
    v_exp_f32 v59, v59
    v_mfma_f32_32x32x16_bf16 v[64:79], v[136:139], a[100:103], v[64:79]
    ds_read_b64_tr_b16 v[28:29], v3 offset:4096
    ds_read_b64_tr_b16 v[30:31], v3 offset:4352
    v_add_f32 v56, 1.0, v56
    v_add_f32 v57, 1.0, v57
    v_add_f32 v58, 1.0, v58
    v_add_f32 v59, 1.0, v59
    v_mfma_f32_32x32x16_bf16 v[80:95], v[136:139], a[244:247], v[80:95]
    s_add_u32 m0, s25, 4096
    s_nop 0
    buffer_load_dwordx4 v8, s[8:11], s27 offen lds
    v_rcp_f32 v56, v56
    v_rcp_f32 v57, v57
    s_waitcnt lgkmcnt(14)
    v_mfma_f32_32x32x16_bf16 v[96:111], v[140:143], a[100:103], v[96:111]
    ds_read_b64_tr_b16 v[32:33], v3 offset:4608
    ds_read_b64_tr_b16 v[34:35], v3 offset:4864
    v_rcp_f32 v58, v58
    v_rcp_f32 v59, v59
    v_mul_f32 v52, v204, v56
    v_mfma_f32_32x32x16_bf16 v[112:127], v[140:143], a[244:247], v[112:127]
    v_mul_f32 v53, v205, v57
    v_mul_f32 v54, v206, v58
    v_mul_f32 v55, v207, v59
    v_cvt_pk_bf16_f32 v42, v52, v53
    v_cvt_pk_bf16_f32 v43, v54, v55
    s_waitcnt lgkmcnt(14)
    v_mfma_f32_32x32x16_bf16 v[64:79], v[144:147], a[104:107], v[64:79]
    ds_read_b64_tr_b16 v[128:129], v3 offset:6144
    ds_read_b64_tr_b16 v[130:131], v3 offset:6400
    s_add_u32 m0, s25, 5120
    s_nop 0
    buffer_load_dwordx4 v9, s[8:11], s27 offen lds
    s_nop 1
    v_permlane32_swap_b32 v36, v38
    v_permlane32_swap_b32 v40, v42
    v_permlane32_swap_b32 v37, v39
    v_mfma_f32_32x32x16_bf16 v[80:95], v[144:147], a[248:251], v[80:95]
    v_permlane32_swap_b32 v41, v43
    buffer_store_dwordx4 v[36:39], v13, s[12:15], s21 offen offset:2048 sc1
    buffer_store_dwordx4 v[40:43], v13, s[12:15], s21 offen offset:2560 sc1
    s_waitcnt lgkmcnt(14)
    v_mfma_f32_32x32x16_bf16 v[96:111], v[148:151], a[104:107], v[96:111]
    ds_read_b64_tr_b16 v[132:133], v3 offset:6656
    ds_read_b64_tr_b16 v[134:135], v3 offset:6912
    v_mul_f32 v56, v208, v208
    v_mul_f32 v57, v209, v209
    v_mul_f32 v58, v210, v210
    v_mul_f32 v59, v211, v211
    v_fma_f32 v56, v56, s24, v15
    v_mfma_f32_32x32x16_bf16 v[112:127], v[148:151], a[248:251], v[112:127]
    s_add_u32 m0, s25, 6144
    s_nop 0
    buffer_load_dwordx4 v10, s[8:11], s27 offen lds
    v_fma_f32 v57, v57, s24, v15
    v_fma_f32 v58, v58, s24, v15
    v_fma_f32 v59, v59, s24, v15
    v_mul_f32 v56, v56, v208
    s_waitcnt lgkmcnt(14)
    v_mfma_f32_32x32x16_bf16 v[64:79], v[152:155], a[108:111], v[64:79]
    s_waitcnt vmcnt(9)
    ds_add_u32 v19, v19
    s_add_u32 s57, s57, 0x98000
    ds_read_b64_tr_b16 v[136:137], v3 offset:8192
    ds_read_b64_tr_b16 v[138:139], v3 offset:8448
    v_mul_f32 v57, v57, v209
    v_mul_f32 v58, v58, v210
    v_mul_f32 v59, v59, v211
    v_exp_f32 v56, v56
    v_mfma_f32_32x32x16_bf16 v[80:95], v[152:155], a[252:255], v[80:95]
    v_exp_f32 v57, v57
    v_exp_f32 v58, v58
    v_exp_f32 v59, v59
    s_waitcnt lgkmcnt(15)
    v_mfma_f32_32x32x16_bf16 v[96:111], v[156:159], a[108:111], v[96:111]
    ds_read_b64_tr_b16 v[140:141], v3 offset:8704
    ds_read_b64_tr_b16 v[142:143], v3 offset:8960
    s_add_u32 m0, s25, 7168
    s_nop 0
    buffer_load_dwordx4 v11, s[8:11], s27 offen lds
    v_add_f32 v56, 1.0, v56
    v_add_f32 v57, 1.0, v57
    v_add_f32 v58, 1.0, v58
    v_mfma_f32_32x32x16_bf16 v[112:127], v[156:159], a[252:255], v[112:127]
    v_add_f32 v59, 1.0, v59
    v_rcp_f32 v56, v56
    v_rcp_f32 v57, v57
    s_waitcnt lgkmcnt(15)
    v_mfma_f32_32x32x16_bf16 v[64:79], v[20:23], a[112:115], v[64:79]
    ds_read_b64_tr_b16 v[144:145], v3 offset:10240
    ds_read_b64_tr_b16 v[146:147], v3 offset:10496
    v_rcp_f32 v58, v58
    v_rcp_f32 v59, v59
    v_mul_f32 v52, v208, v56
    v_mfma_f32_32x32x16_bf16 v[80:95], v[20:23], v[224:227], v[80:95]
    s_add_u32 m0, s25, 8192
    s_nop 0
    buffer_load_dwordx4 v12, s[8:11], s27 offen lds
    v_mul_f32 v53, v209, v57
    v_mul_f32 v54, v210, v58
    v_mul_f32 v55, v211, v59
    v_cvt_pk_bf16_f32 v44, v52, v53
    s_waitcnt lgkmcnt(15)
    v_mfma_f32_32x32x16_bf16 v[96:111], v[24:27], a[112:115], v[96:111]
    ds_read_b64_tr_b16 v[148:149], v3 offset:10752
    ds_read_b64_tr_b16 v[150:151], v3 offset:11008
    v_cvt_pk_bf16_f32 v45, v54, v55
    ds_read_b128 v[208:211], v14 offset:1152
    v_mul_f32 v56, v212, v212
    v_mul_f32 v57, v213, v213
    v_mul_f32 v58, v214, v214
    v_mfma_f32_32x32x16_bf16 v[112:127], v[24:27], v[224:227], v[112:127]
    v_mul_f32 v59, v215, v215
    v_fma_f32 v56, v56, s24, v15
    v_fma_f32 v57, v57, s24, v15
    v_fma_f32 v58, v58, s24, v15
    v_fma_f32 v59, v59, s24, v15
    s_waitcnt lgkmcnt(15)
    v_mfma_f32_32x32x16_bf16 v[64:79], v[28:31], a[116:119], v[64:79]
    ds_read_b64_tr_b16 v[152:153], v3 offset:12288
    ds_read_b64_tr_b16 v[154:155], v3 offset:12544
    v_mul_f32 v56, v56, v212
    v_mul_f32 v57, v57, v213
    v_mul_f32 v58, v58, v214
    v_mul_f32 v59, v59, v215
    v_exp_f32 v56, v56
    v_mfma_f32_32x32x16_bf16 v[80:95], v[28:31], v[228:231], v[80:95]
    v_exp_f32 v57, v57
    v_exp_f32 v58, v58
    s_waitcnt lgkmcnt(15)
    v_mfma_f32_32x32x16_bf16 v[96:111], v[32:35], a[116:119], v[96:111]
    ds_read_b64_tr_b16 v[156:157], v3 offset:12800
    ds_read_b64_tr_b16 v[158:159], v3 offset:13056
    v_exp_f32 v59, v59
    v_add_f32 v56, 1.0, v56
    v_add_f32 v57, 1.0, v57
    v_mfma_f32_32x32x16_bf16 v[112:127], v[32:35], v[228:231], v[112:127]
    v_add_f32 v58, 1.0, v58
    v_add_f32 v59, 1.0, v59
    v_rcp_f32 v56, v56
    v_rcp_f32 v57, v57
    s_waitcnt lgkmcnt(15)
    v_mfma_f32_32x32x16_bf16 v[64:79], v[128:131], a[120:123], v[64:79]
    ds_read_b64_tr_b16 v[20:21], v3 offset:14336
    ds_read_b64_tr_b16 v[22:23], v3 offset:14592
    v_rcp_f32 v58, v58
    v_rcp_f32 v59, v59
    v_mfma_f32_32x32x16_bf16 v[80:95], v[128:131], v[232:235], v[80:95]
    v_mul_f32 v52, v212, v56
    v_mul_f32 v53, v213, v57
    v_mul_f32 v54, v214, v58
    v_mul_f32 v55, v215, v59
    s_waitcnt lgkmcnt(15)
    v_mfma_f32_32x32x16_bf16 v[96:111], v[132:135], a[120:123], v[96:111]
    ds_read_b32 v18, v19
    ds_read_b64_tr_b16 v[24:25], v3 offset:14848
    ds_read_b64_tr_b16 v[26:27], v3 offset:15104
    v_cvt_pk_bf16_f32 v48, v52, v53
    v_cvt_pk_bf16_f32 v49, v54, v55
    ds_read_b128 v[212:215], v14 offset:1184
    v_mul_f32 v56, v216, v216
    v_mul_f32 v57, v217, v217
    v_mfma_f32_32x32x16_bf16 v[112:127], v[132:135], v[232:235], v[112:127]
    v_mul_f32 v58, v218, v218
    v_mul_f32 v59, v219, v219
    v_fma_f32 v56, v56, s24, v15
    v_fma_f32 v57, v57, s24, v15
    s_waitcnt lgkmcnt(15)
    v_mfma_f32_32x32x16_bf16 v[64:79], v[136:139], a[124:127], v[64:79]
    s_waitcnt lgkmcnt(3)
    v_readfirstlane_b32 s56, v18
    s_cmp_ge_u32 s56, s57
    s_cbranch_scc0 spin_g1_kernel_58
back_g1_kernel_59:
    s_add_u32 s18, s18, 36864
    s_cmp_eq_u32 s18, 147456
    s_cselect_b32 s18, 0, s18
    v_add_u32 v2, s18, v16
    s_cmp_ge_u32 s17, 1
    s_cselect_b32 s10, s16, 0
    s_add_u32 s25, s19, s23
    s_add_u32 s27, s20, 2654464
    s_add_u32 s19, s19, 36864
    s_cmp_eq_u32 s19, 147456
    s_cselect_b32 s19, 0, s19
    ds_read_b64_tr_b16 v[28:29], v3 offset:16384
    ds_read_b64_tr_b16 v[30:31], v3 offset:16640
    v_fma_f32 v58, v58, s24, v15
    v_fma_f32 v59, v59, s24, v15
    v_mul_f32 v56, v56, v216
    v_mul_f32 v57, v57, v217
    v_mul_f32 v58, v58, v218
    v_mfma_f32_32x32x16_bf16 v[80:95], v[136:139], v[236:239], v[80:95]
    s_add_u32 m0, s25, 0
    s_nop 0
    buffer_load_dwordx4 v4, s[8:11], s27 offen lds
    v_mul_f32 v59, v59, v219
    v_exp_f32 v56, v56
    v_exp_f32 v57, v57
    v_mfma_f32_32x32x16_bf16 v[96:111], v[140:143], a[124:127], v[96:111]
    ds_read_b64_tr_b16 v[32:33], v3 offset:16896
    ds_read_b64_tr_b16 v[34:35], v3 offset:17152
    v_exp_f32 v58, v58
    v_exp_f32 v59, v59
    v_mfma_f32_32x32x16_bf16 v[112:127], v[140:143], v[236:239], v[112:127]
    v_add_f32 v56, 1.0, v56
    v_add_f32 v57, 1.0, v57
    v_add_f32 v58, 1.0, v58
    v_add_f32 v59, 1.0, v59
    v_rcp_f32 v56, v56
    v_mfma_f32_32x32x16_bf16 v[64:79], v[144:147], a[128:131], v[64:79]
    ds_read_b64_tr_b16 v[128:129], v2 offset:0
    ds_read_b64_tr_b16 v[130:131], v2 offset:256
    s_add_u32 m0, s25, 1024
    s_nop 0
    buffer_load_dwordx4 v5, s[8:11], s27 offen lds
    v_rcp_f32 v57, v57
    v_rcp_f32 v58, v58
    v_mfma_f32_32x32x16_bf16 v[80:95], v[144:147], v[240:243], v[80:95]
    v_rcp_f32 v59, v59
    v_mul_f32 v52, v216, v56
    v_mul_f32 v53, v217, v57
    v_mfma_f32_32x32x16_bf16 v[96:111], v[148:151], a[128:131], v[96:111]
    ds_read_b64_tr_b16 v[132:133], v2 offset:512
    ds_read_b64_tr_b16 v[134:135], v2 offset:768
    v_mul_f32 v54, v218, v58
    v_mul_f32 v55, v219, v59
    v_cvt_pk_bf16_f32 v46, v52, v53
    v_cvt_pk_bf16_f32 v47, v54, v55
    ds_read_b128 v[216:219], v14 offset:1216
    v_mfma_f32_32x32x16_bf16 v[112:127], v[148:151], v[240:243], v[112:127]
    s_add_u32 m0, s25, 2048
    s_nop 0
    buffer_load_dwordx4 v6, s[8:11], s27 offen lds
    v_mul_f32 v56, v220, v220
    v_mul_f32 v57, v221, v221
    v_mul_f32 v58, v222, v222
    v_mul_f32 v59, v223, v223
    v_fma_f32 v56, v56, s24, v15
    v_mfma_f32_32x32x16_bf16 v[64:79], v[152:155], a[132:135], v[64:79]
    ds_read_b64_tr_b16 v[136:137], v2 offset:2048
    ds_read_b64_tr_b16 v[138:139], v2 offset:2304
    v_fma_f32 v57, v57, s24, v15
    v_fma_f32 v58, v58, s24, v15
    v_fma_f32 v59, v59, s24, v15
    v_mul_f32 v56, v56, v220
    v_mfma_f32_32x32x16_bf16 v[80:95], v[152:155], v[244:247], v[80:95]
    v_mul_f32 v57, v57, v221
    v_mul_f32 v58, v58, v222
    v_mul_f32 v59, v59, v223
    v_exp_f32 v56, v56
    v_mfma_f32_32x32x16_bf16 v[96:111], v[156:159], a[132:135], v[96:111]
    ds_read_b64_tr_b16 v[140:141], v2 offset:2560
    ds_read_b64_tr_b16 v[142:143], v2 offset:2816
    s_add_u32 m0, s25, 3072
    s_nop 0
    buffer_load_dwordx4 v7, s[8:11], s27 offen lds
    v_exp_f32 v57, v57
    v_exp_f32 v58, v58
    v_exp_f32 v59, v59
    v_mfma_f32_32x32x16_bf16 v[112:127], v[156:159], v[244:247], v[112:127]
    v_add_f32 v56, 1.0, v56
    v_add_f32 v57, 1.0, v57
    v_add_f32 v58, 1.0, v58
    v_mfma_f32_32x32x16_bf16 v[64:79], v[20:23], a[136:139], v[64:79]
    ds_read_b64_tr_b16 v[144:145], v2 offset:4096
    ds_read_b64_tr_b16 v[146:147], v2 offset:4352
    v_add_f32 v59, 1.0, v59
    v_rcp_f32 v56, v56
    v_rcp_f32 v57, v57
    v_mfma_f32_32x32x16_bf16 v[80:95], v[20:23], v[248:251], v[80:95]
    s_add_u32 m0, s25, 4096
    s_nop 0
    buffer_load_dwordx4 v8, s[8:11], s27 offen lds
    v_rcp_f32 v58, v58
    v_rcp_f32 v59, v59
    v_mul_f32 v52, v220, v56
    s_waitcnt lgkmcnt(15)
    v_mfma_f32_32x32x16_bf16 v[96:111], v[24:27], a[136:139], v[96:111]
    ds_read_b64_tr_b16 v[148:149], v2 offset:4608
    ds_read_b64_tr_b16 v[150:151], v2 offset:4864
    v_mul_f32 v53, v221, v57
    v_mul_f32 v54, v222, v58
    v_mul_f32 v55, v223, v59
    v_cvt_pk_bf16_f32 v50, v52, v53
    v_mfma_f32_32x32x16_bf16 v[112:127], v[24:27], v[248:251], v[112:127]
    v_cvt_pk_bf16_f32 v51, v54, v55
    ds_read_b128 v[220:223], v14 offset:1248
    v_add_u32 v14, 512, v14
    s_nop 1
    v_permlane32_swap_b32 v44, v46
    s_waitcnt lgkmcnt(15)
    v_mfma_f32_32x32x16_bf16 v[64:79], v[28:31], a[140:143], v[64:79]
    ds_read_b64_tr_b16 v[152:153], v2 offset:6144
    ds_read_b64_tr_b16 v[154:155], v2 offset:6400
    s_add_u32 m0, s25, 5120
    s_nop 0
    buffer_load_dwordx4 v9, s[8:11], s27 offen lds
    v_permlane32_swap_b32 v48, v50
    v_permlane32_swap_b32 v45, v47
    v_permlane32_swap_b32 v49, v51
    buffer_store_dwordx4 v[44:47], v13, s[12:15], s22 offen offset:2048 sc1
    v_mfma_f32_32x32x16_bf16 v[80:95], v[28:31], v[252:255], v[80:95]
    buffer_store_dwordx4 v[48:51], v13, s[12:15], s22 offen offset:2560 sc1
    s_add_u32 s21, s21, 8192
    s_add_u32 s22, s22, 8192
    s_waitcnt lgkmcnt(15)
    v_mfma_f32_32x32x16_bf16 v[96:111], v[32:35], a[140:143], v[96:111]
    ds_read_b64_tr_b16 v[156:157], v2 offset:6656
    ds_read_b64_tr_b16 v[158:159], v2 offset:6912
    v_mfma_f32_32x32x16_bf16 v[112:127], v[32:35], v[252:255], v[112:127]
    s_add_u32 m0, s25, 6144
    s_nop 0
    buffer_load_dwordx4 v10, s[8:11], s27 offen lds
    s_add_u32 s20, s20, 256
    s_cmp_eq_u32 s17, 0
    s_cbranch_scc1 drain0h_g1_kernel_35
    s_sub_u32 s17, s17, 1
    s_branch looph_g1_kernel_34
spin_g1_kernel_38:
    ds_read_b32 v18, v19
    s_waitcnt lgkmcnt(0)
    v_readfirstlane_b32 s56, v18
    s_cmp_ge_u32 s56, s57
    s_cbranch_scc0 spin_g1_kernel_38
    s_branch back_g1_kernel_39
spin_g1_kernel_40:
    ds_read_b32 v18, v19
    s_waitcnt lgkmcnt(0)
    v_readfirstlane_b32 s56, v18
    s_cmp_ge_u32 s56, s57
    s_cbranch_scc0 spin_g1_kernel_40
    s_branch back_g1_kernel_41
spin_g1_kernel_42:
    ds_read_b32 v18, v19
    s_waitcnt lgkmcnt(0)
    v_readfirstlane_b32 s56, v18
    s_cmp_ge_u32 s56, s57
    s_cbranch_scc0 spin_g1_kernel_42
    s_branch back_g1_kernel_43
spin_g1_kernel_44:
    ds_read_b32 v18, v19
    s_waitcnt lgkmcnt(0)
    v_readfirstlane_b32 s56, v18
    s_cmp_ge_u32 s56, s57
    s_cbranch_scc0 spin_g1_kernel_44
    s_branch back_g1_kernel_45
spin_g1_kernel_46:
    ds_read_b32 v18, v19
    s_waitcnt lgkmcnt(0)
    v_readfirstlane_b32 s56, v18
    s_cmp_ge_u32 s56, s57
    s_cbranch_scc0 spin_g1_kernel_46
    s_branch back_g1_kernel_47
spin_g1_kernel_48:
    ds_read_b32 v18, v19
    s_waitcnt lgkmcnt(0)
    v_readfirstlane_b32 s56, v18
    s_cmp_ge_u32 s56, s57
    s_cbranch_scc0 spin_g1_kernel_48
    s_branch back_g1_kernel_49
spin_g1_kernel_50:
    ds_read_b32 v18, v19
    s_waitcnt lgkmcnt(0)
    v_readfirstlane_b32 s56, v18
    s_cmp_ge_u32 s56, s57
    s_cbranch_scc0 spin_g1_kernel_50
    s_branch back_g1_kernel_51
spin_g1_kernel_52:
    ds_read_b32 v18, v19
    s_waitcnt lgkmcnt(0)
    v_readfirstlane_b32 s56, v18
    s_cmp_ge_u32 s56, s57
    s_cbranch_scc0 spin_g1_kernel_52
    s_branch back_g1_kernel_53
spin_g1_kernel_54:
    ds_read_b32 v18, v19
    s_waitcnt lgkmcnt(0)
    v_readfirstlane_b32 s56, v18
    s_cmp_ge_u32 s56, s57
    s_cbranch_scc0 spin_g1_kernel_54
    s_branch back_g1_kernel_55
spin_g1_kernel_56:
    ds_read_b32 v18, v19
    s_waitcnt lgkmcnt(0)
    v_readfirstlane_b32 s56, v18
    s_cmp_ge_u32 s56, s57
    s_cbranch_scc0 spin_g1_kernel_56
    s_branch back_g1_kernel_57
spin_g1_kernel_58:
    ds_read_b32 v18, v19
    s_waitcnt lgkmcnt(0)
    v_readfirstlane_b32 s56, v18
    s_cmp_ge_u32 s56, s57
    s_cbranch_scc0 spin_g1_kernel_58
    s_branch back_g1_kernel_59
drain0h_g1_kernel_35:
    s_sub_u32 s89, s2, 64
    s_lshl_b32 s89, s89, 2
    s_add_u32 s89, s89, s26
    v_bfe_u32 v5, v0, 5, 1
    v_mul_u32_u24 v4, 9216, v5
    v_and_b32 v5, 31, v0
    v_lshl_add_u32 v4, v5, 1, v4
    v_lshlrev_b32 v5, 4, v1
    s_mul_i32 s90, s89, 1821
    s_lshr_b32 s90, s90, 16
    s_mul_i32 s91, s90, 36
    s_sub_u32 s91, s89, s91
    s_mul_i32 s91, s91, 18432
    s_lshl_b32 s90, s90, 6
    s_add_u32 s91, s91, s90
    s_cmp_lt_u32 s89, 648
    s_cselect_b32 s82, s82, 0
    s_waitcnt lgkmcnt(0)
    buffer_load_ushort v128, v4, s[80:83], s91 offen offset:0
    buffer_load_ushort v129, v4, s[80:83], s91 offen offset:1152
    buffer_load_ushort v130, v4, s[80:83], s91 offen offset:2304
    s_add_u32 s91, s91, 3456
    buffer_load_ushort v131, v4, s[80:83], s91 offen offset:0
    buffer_load_ushort v132, v4, s[80:83], s91 offen offset:1152
    buffer_load_ushort v133, v4, s[80:83], s91 offen offset:2304
    s_add_u32 s91, s91, 3456
    buffer_load_ushort v134, v4, s[80:83], s91 offen offset:0
    buffer_load_ushort v135, v4, s[80:83], s91 offen offset:1152
    s_nop 15
    v_mul_f32 v56, v64, v64
    v_mul_f32 v57, v65, v65
    v_mul_f32 v58, v66, v66
    v_mul_f32 v59, v67, v67
    v_fma_f32 v56, v56, s24, v15
    v_fma_f32 v57, v57, s24, v15
    v_fma_f32 v58, v58, s24, v15
    v_fma_f32 v59, v59, s24, v15
    v_mul_f32 v56, v56, v64
    v_mul_f32 v57, v57, v65
    v_mul_f32 v58, v58, v66
    v_mul_f32 v59, v59, v67
    v_exp_f32 v56, v56
    v_exp_f32 v57, v57
    v_exp_f32 v58, v58
    v_exp_f32 v59, v59
    v_add_f32 v56, 1.0, v56
    v_add_f32 v57, 1.0, v57
    v_add_f32 v58, 1.0, v58
    v_add_f32 v59, 1.0, v59
    v_rcp_f32 v56, v56
    v_rcp_f32 v57, v57
    v_rcp_f32 v58, v58
    v_rcp_f32 v59, v59
    v_mul_f32 v52, v64, v56
    v_mul_f32 v53, v65, v57
    v_mul_f32 v54, v66, v58
    v_mul_f32 v55, v67, v59
    v_cvt_pk_bf16_f32 v36, v52, v53
    v_cvt_pk_bf16_f32 v37, v54, v55
    v_mul_f32 v56, v68, v68
    v_mul_f32 v57, v69, v69
    v_mul_f32 v58, v70, v70
    v_mul_f32 v59, v71, v71
    v_fma_f32 v56, v56, s24, v15
    v_fma_f32 v57, v57, s24, v15
    v_fma_f32 v58, v58, s24, v15
    v_fma_f32 v59, v59, s24, v15
    v_mul_f32 v56, v56, v68
    v_mul_f32 v57, v57, v69
    v_mul_f32 v58, v58, v70
    v_mul_f32 v59, v59, v71
    v_exp_f32 v56, v56
    v_exp_f32 v57, v57
    v_exp_f32 v58, v58
    v_exp_f32 v59, v59
    v_add_f32 v56, 1.0, v56
    v_add_f32 v57, 1.0, v57
    v_add_f32 v58, 1.0, v58
    v_add_f32 v59, 1.0, v59
    v_rcp_f32 v56, v56
    v_rcp_f32 v57, v57
    v_rcp_f32 v58, v58
    v_rcp_f32 v59, v59
    v_mul_f32 v52, v68, v56
    v_mul_f32 v53, v69, v57
    v_mul_f32 v54, v70, v58
    v_mul_f32 v55, v71, v59
    v_cvt_pk_bf16_f32 v40, v52, v53
    v_cvt_pk_bf16_f32 v41, v54, v55
    v_mul_f32 v56, v72, v72
    v_mul_f32 v57, v73, v73
    v_mul_f32 v58, v74, v74
    v_mul_f32 v59, v75, v75
    v_fma_f32 v56, v56, s24, v15
    v_fma_f32 v57, v57, s24, v15
    v_fma_f32 v58, v58, s24, v15
    v_fma_f32 v59, v59, s24, v15
    v_mul_f32 v56, v56, v72
    v_mul_f32 v57, v57, v73
    v_mul_f32 v58, v58, v74
    v_mul_f32 v59, v59, v75
    v_exp_f32 v56, v56
    v_exp_f32 v57, v57
    v_exp_f32 v58, v58
    v_exp_f32 v59, v59
    v_add_f32 v56, 1.0, v56
    v_add_f32 v57, 1.0, v57
    v_add_f32 v58, 1.0, v58
    v_add_f32 v59, 1.0, v59
    v_rcp_f32 v56, v56
    v_rcp_f32 v57, v57
    v_rcp_f32 v58, v58
    v_rcp_f32 v59, v59
    v_mul_f32 v52, v72, v56
    v_mul_f32 v53, v73, v57
    v_mul_f32 v54, v74, v58
    v_mul_f32 v55, v75, v59
    v_cvt_pk_bf16_f32 v38, v52, v53
    v_cvt_pk_bf16_f32 v39, v54, v55
    v_mul_f32 v56, v76, v76
    v_mul_f32 v57, v77, v77
    v_mul_f32 v58, v78, v78
    v_mul_f32 v59, v79, v79
    v_fma_f32 v56, v56, s24, v15
    v_fma_f32 v57, v57, s24, v15
    v_fma_f32 v58, v58, s24, v15
    v_fma_f32 v59, v59, s24, v15
    v_mul_f32 v56, v56, v76
    v_mul_f32 v57, v57, v77
    v_mul_f32 v58, v58, v78
    v_mul_f32 v59, v59, v79
    v_exp_f32 v56, v56
    v_exp_f32 v57, v57
    v_exp_f32 v58, v58
    v_exp_f32 v59, v59
    v_add_f32 v56, 1.0, v56
    v_add_f32 v57, 1.0, v57
    v_add_f32 v58, 1.0, v58
    v_add_f32 v59, 1.0, v59
    v_rcp_f32 v56, v56
    v_rcp_f32 v57, v57
    v_rcp_f32 v58, v58
    v_rcp_f32 v59, v59
    v_mul_f32 v52, v76, v56
    v_mul_f32 v53, v77, v57
    v_mul_f32 v54, v78, v58
    v_mul_f32 v55, v79, v59
    v_cvt_pk_bf16_f32 v42, v52, v53
    v_cvt_pk_bf16_f32 v43, v54, v55
    s_nop 1
    v_permlane32_swap_b32 v36, v38
    v_permlane32_swap_b32 v40, v42
    v_permlane32_swap_b32 v37, v39
    v_permlane32_swap_b32 v41, v43
    buffer_store_dwordx4 v[36:39], v13, s[12:15], s21 offen offset:0 sc1
    buffer_store_dwordx4 v[40:43], v13, s[12:15], s21 offen offset:512 sc1
    v_mul_f32 v56, v80, v80
    v_mul_f32 v57, v81, v81
    v_mul_f32 v58, v82, v82
    v_mul_f32 v59, v83, v83
    v_fma_f32 v56, v56, s24, v15
    v_fma_f32 v57, v57, s24, v15
    v_fma_f32 v58, v58, s24, v15
    v_fma_f32 v59, v59, s24, v15
    v_mul_f32 v56, v56, v80
    v_mul_f32 v57, v57, v81
    v_mul_f32 v58, v58, v82
    v_mul_f32 v59, v59, v83
    v_exp_f32 v56, v56
    v_exp_f32 v57, v57
    v_exp_f32 v58, v58
    v_exp_f32 v59, v59
    v_add_f32 v56, 1.0, v56
    v_add_f32 v57, 1.0, v57
    v_add_f32 v58, 1.0, v58
    v_add_f32 v59, 1.0, v59
    v_rcp_f32 v56, v56
    v_rcp_f32 v57, v57
    v_rcp_f32 v58, v58
    v_rcp_f32 v59, v59
    v_mul_f32 v52, v80, v56
    v_mul_f32 v53, v81, v57
    v_mul_f32 v54, v82, v58
    v_mul_f32 v55, v83, v59
    v_cvt_pk_bf16_f32 v44, v52, v53
    v_cvt_pk_bf16_f32 v45, v54, v55
    v_mul_f32 v56, v84, v84
    v_mul_f32 v57, v85, v85
    v_mul_f32 v58, v86, v86
    v_mul_f32 v59, v87, v87
    v_fma_f32 v56, v56, s24, v15
    v_fma_f32 v57, v57, s24, v15
    v_fma_f32 v58, v58, s24, v15
    v_fma_f32 v59, v59, s24, v15
    v_mul_f32 v56, v56, v84
    v_mul_f32 v57, v57, v85
    v_mul_f32 v58, v58, v86
    v_mul_f32 v59, v59, v87
    v_exp_f32 v56, v56
    v_exp_f32 v57, v57
    v_exp_f32 v58, v58
    v_exp_f32 v59, v59
    v_add_f32 v56, 1.0, v56
    v_add_f32 v57, 1.0, v57
    v_add_f32 v58, 1.0, v58
    v_add_f32 v59, 1.0, v59
    v_rcp_f32 v56, v56
    v_rcp_f32 v57, v57
    v_rcp_f32 v58, v58
    v_rcp_f32 v59, v59
    v_mul_f32 v52, v84, v56
    v_mul_f32 v53, v85, v57
    v_mul_f32 v54, v86, v58
    v_mul_f32 v55, v87, v59
    v_cvt_pk_bf16_f32 v48, v52, v53
    v_cvt_pk_bf16_f32 v49, v54, v55
    v_mul_f32 v56, v88, v88
    v_mul_f32 v57, v89, v89
    v_mul_f32 v58, v90, v90
    v_mul_f32 v59, v91, v91
    v_fma_f32 v56, v56, s24, v15
    v_fma_f32 v57, v57, s24, v15
    v_fma_f32 v58, v58, s24, v15
    v_fma_f32 v59, v59, s24, v15
    v_mul_f32 v56, v56, v88
    v_mul_f32 v57, v57, v89
    v_mul_f32 v58, v58, v90
    v_mul_f32 v59, v59, v91
    v_exp_f32 v56, v56
    v_exp_f32 v57, v57
    v_exp_f32 v58, v58
    v_exp_f32 v59, v59
    v_add_f32 v56, 1.0, v56
    v_add_f32 v57, 1.0, v57
    v_add_f32 v58, 1.0, v58
    v_add_f32 v59, 1.0, v59
    v_rcp_f32 v56, v56
    v_rcp_f32 v57, v57
    v_rcp_f32 v58, v58
    v_rcp_f32 v59, v59
    v_mul_f32 v52, v88, v56
    v_mul_f32 v53, v89, v57
    v_mul_f32 v54, v90, v58
    v_mul_f32 v55, v91, v59
    v_cvt_pk_bf16_f32 v46, v52, v53
    v_cvt_pk_bf16_f32 v47, v54, v55
    v_mul_f32 v56, v92, v92
    v_mul_f32 v57, v93, v93
    v_mul_f32 v58, v94, v94
    v_mul_f32 v59, v95, v95
    v_fma_f32 v56, v56, s24, v15
    v_fma_f32 v57, v57, s24, v15
    v_fma_f32 v58, v58, s24, v15
    v_fma_f32 v59, v59, s24, v15
    v_mul_f32 v56, v56, v92
    v_mul_f32 v57, v57, v93
    v_mul_f32 v58, v58, v94
    v_mul_f32 v59, v59, v95
    v_exp_f32 v56, v56
    v_exp_f32 v57, v57
    v_exp_f32 v58, v58
    v_exp_f32 v59, v59
    v_add_f32 v56, 1.0, v56
    v_add_f32 v57, 1.0, v57
    v_add_f32 v58, 1.0, v58
    v_add_f32 v59, 1.0, v59
    v_rcp_f32 v56, v56
    v_rcp_f32 v57, v57
    v_rcp_f32 v58, v58
    v_rcp_f32 v59, v59
    v_mul_f32 v52, v92, v56
    v_mul_f32 v53, v93, v57
    v_mul_f32 v54, v94, v58
    v_mul_f32 v55, v95, v59
    v_cvt_pk_bf16_f32 v50, v52, v53
    v_cvt_pk_bf16_f32 v51, v54, v55
    s_nop 1
    v_permlane32_swap_b32 v44, v46
    v_permlane32_swap_b32 v48, v50
    v_permlane32_swap_b32 v45, v47
    v_permlane32_swap_b32 v49, v51
    buffer_store_dwordx4 v[44:47], v13, s[12:15], s22 offen offset:0 sc1
    buffer_store_dwordx4 v[48:51], v13, s[12:15], s22 offen offset:512 sc1
    v_mul_f32 v56, v96, v96
    v_mul_f32 v57, v97, v97
    v_mul_f32 v58, v98, v98
    v_mul_f32 v59, v99, v99
    v_fma_f32 v56, v56, s24, v15
    v_fma_f32 v57, v57, s24, v15
    v_fma_f32 v58, v58, s24, v15
    v_fma_f32 v59, v59, s24, v15
    v_mul_f32 v56, v56, v96
    v_mul_f32 v57, v57, v97
    v_mul_f32 v58, v58, v98
    v_mul_f32 v59, v59, v99
    v_exp_f32 v56, v56
    v_exp_f32 v57, v57
    v_exp_f32 v58, v58
    v_exp_f32 v59, v59
    v_add_f32 v56, 1.0, v56
    v_add_f32 v57, 1.0, v57
    v_add_f32 v58, 1.0, v58
    v_add_f32 v59, 1.0, v59
    v_rcp_f32 v56, v56
    v_rcp_f32 v57, v57
    v_rcp_f32 v58, v58
    v_rcp_f32 v59, v59
    v_mul_f32 v52, v96, v56
    v_mul_f32 v53, v97, v57
    v_mul_f32 v54, v98, v58
    v_mul_f32 v55, v99, v59
    v_cvt_pk_bf16_f32 v36, v52, v53
    v_cvt_pk_bf16_f32 v37, v54, v55
    v_mul_f32 v56, v100, v100
    v_mul_f32 v57, v101, v101
    v_mul_f32 v58, v102, v102
    v_mul_f32 v59, v103, v103
    v_fma_f32 v56, v56, s24, v15
    v_fma_f32 v57, v57, s24, v15
    v_fma_f32 v58, v58, s24, v15
    v_fma_f32 v59, v59, s24, v15
    v_mul_f32 v56, v56, v100
    v_mul_f32 v57, v57, v101
    v_mul_f32 v58, v58, v102
    v_mul_f32 v59, v59, v103
    v_exp_f32 v56, v56
    v_exp_f32 v57, v57
    v_exp_f32 v58, v58
    v_exp_f32 v59, v59
    v_add_f32 v56, 1.0, v56
    v_add_f32 v57, 1.0, v57
    v_add_f32 v58, 1.0, v58
    v_add_f32 v59, 1.0, v59
    v_rcp_f32 v56, v56
    v_rcp_f32 v57, v57
    v_rcp_f32 v58, v58
    v_rcp_f32 v59, v59
    v_mul_f32 v52, v100, v56
    v_mul_f32 v53, v101, v57
    v_mul_f32 v54, v102, v58
    v_mul_f32 v55, v103, v59
    v_cvt_pk_bf16_f32 v40, v52, v53
    v_cvt_pk_bf16_f32 v41, v54, v55
    v_mul_f32 v56, v104, v104
    v_mul_f32 v57, v105, v105
    v_mul_f32 v58, v106, v106
    v_mul_f32 v59, v107, v107
    v_fma_f32 v56, v56, s24, v15
    v_fma_f32 v57, v57, s24, v15
    v_fma_f32 v58, v58, s24, v15
    v_fma_f32 v59, v59, s24, v15
    v_mul_f32 v56, v56, v104
    v_mul_f32 v57, v57, v105
    v_mul_f32 v58, v58, v106
    v_mul_f32 v59, v59, v107
    v_exp_f32 v56, v56
    v_exp_f32 v57, v57
    v_exp_f32 v58, v58
    v_exp_f32 v59, v59
    v_add_f32 v56, 1.0, v56
    v_add_f32 v57, 1.0, v57
    v_add_f32 v58, 1.0, v58
    v_add_f32 v59, 1.0, v59
    v_rcp_f32 v56, v56
    v_rcp_f32 v57, v57
    v_rcp_f32 v58, v58
    v_rcp_f32 v59, v59
    v_mul_f32 v52, v104, v56
    v_mul_f32 v53, v105, v57
    v_mul_f32 v54, v106, v58
    v_mul_f32 v55, v107, v59
    v_cvt_pk_bf16_f32 v38, v52, v53
    v_cvt_pk_bf16_f32 v39, v54, v55
    v_mul_f32 v56, v108, v108
    v_mul_f32 v57, v109, v109
    v_mul_f32 v58, v110, v110
    v_mul_f32 v59, v111, v111
    v_fma_f32 v56, v56, s24, v15
    v_fma_f32 v57, v57, s24, v15
    v_fma_f32 v58, v58, s24, v15
    v_fma_f32 v59, v59, s24, v15
    v_mul_f32 v56, v56, v108
    v_mul_f32 v57, v57, v109
    v_mul_f32 v58, v58, v110
    v_mul_f32 v59, v59, v111
    v_exp_f32 v56, v56
    v_exp_f32 v57, v57
    v_exp_f32 v58, v58
    v_exp_f32 v59, v59
    v_add_f32 v56, 1.0, v56
    v_add_f32 v57, 1.0, v57
    v_add_f32 v58, 1.0, v58
    v_add_f32 v59, 1.0, v59
    v_rcp_f32 v56, v56
    v_rcp_f32 v57, v57
    v_rcp_f32 v58, v58
    v_rcp_f32 v59, v59
    v_mul_f32 v52, v108, v56
    v_mul_f32 v53, v109, v57
    v_mul_f32 v54, v110, v58
    v_mul_f32 v55, v111, v59
    v_cvt_pk_bf16_f32 v42, v52, v53
    v_cvt_pk_bf16_f32 v43, v54, v55
    s_nop 1
    v_permlane32_swap_b32 v36, v38
    v_permlane32_swap_b32 v40, v42
    v_permlane32_swap_b32 v37, v39
    v_permlane32_swap_b32 v41, v43
    buffer_store_dwordx4 v[36:39], v13, s[12:15], s21 offen offset:2048 sc1
    buffer_store_dwordx4 v[40:43], v13, s[12:15], s21 offen offset:2560 sc1
    v_mul_f32 v56, v112, v112
    v_mul_f32 v57, v113, v113
    v_mul_f32 v58, v114, v114
    v_mul_f32 v59, v115, v115
    v_fma_f32 v56, v56, s24, v15
    v_fma_f32 v57, v57, s24, v15
    v_fma_f32 v58, v58, s24, v15
    v_fma_f32 v59, v59, s24, v15
    v_mul_f32 v56, v56, v112
    v_mul_f32 v57, v57, v113
    v_mul_f32 v58, v58, v114
    v_mul_f32 v59, v59, v115
    v_exp_f32 v56, v56
    v_exp_f32 v57, v57
    v_exp_f32 v58, v58
    v_exp_f32 v59, v59
    v_add_f32 v56, 1.0, v56
    v_add_f32 v57, 1.0, v57
    v_add_f32 v58, 1.0, v58
    v_add_f32 v59, 1.0, v59
    v_rcp_f32 v56, v56
    v_rcp_f32 v57, v57
    v_rcp_f32 v58, v58
    v_rcp_f32 v59, v59
    v_mul_f32 v52, v112, v56
    v_mul_f32 v53, v113, v57
    v_mul_f32 v54, v114, v58
    v_mul_f32 v55, v115, v59
    v_cvt_pk_bf16_f32 v44, v52, v53
    v_cvt_pk_bf16_f32 v45, v54, v55
    v_mul_f32 v56, v116, v116
    v_mul_f32 v57, v117, v117
    v_mul_f32 v58, v118, v118
    v_mul_f32 v59, v119, v119
    v_fma_f32 v56, v56, s24, v15
    v_fma_f32 v57, v57, s24, v15
    v_fma_f32 v58, v58, s24, v15
    v_fma_f32 v59, v59, s24, v15
    v_mul_f32 v56, v56, v116
    v_mul_f32 v57, v57, v117
    v_mul_f32 v58, v58, v118
    v_mul_f32 v59, v59, v119
    v_exp_f32 v56, v56
    v_exp_f32 v57, v57
    v_exp_f32 v58, v58
    v_exp_f32 v59, v59
    v_add_f32 v56, 1.0, v56
    v_add_f32 v57, 1.0, v57
    v_add_f32 v58, 1.0, v58
    v_add_f32 v59, 1.0, v59
    v_rcp_f32 v56, v56
    v_rcp_f32 v57, v57
    v_rcp_f32 v58, v58
    v_rcp_f32 v59, v59
    v_mul_f32 v52, v116, v56
    v_mul_f32 v53, v117, v57
    v_mul_f32 v54, v118, v58
    v_mul_f32 v55, v119, v59
    v_cvt_pk_bf16_f32 v48, v52, v53
    v_cvt_pk_bf16_f32 v49, v54, v55
    v_mul_f32 v56, v120, v120
    v_mul_f32 v57, v121, v121
    v_mul_f32 v58, v122, v122
    v_mul_f32 v59, v123, v123
    v_fma_f32 v56, v56, s24, v15
    v_fma_f32 v57, v57, s24, v15
    v_fma_f32 v58, v58, s24, v15
    v_fma_f32 v59, v59, s24, v15
    v_mul_f32 v56, v56, v120
    v_mul_f32 v57, v57, v121
    v_mul_f32 v58, v58, v122
    v_mul_f32 v59, v59, v123
    v_exp_f32 v56, v56
    v_exp_f32 v57, v57
    v_exp_f32 v58, v58
    v_exp_f32 v59, v59
    v_add_f32 v56, 1.0, v56
    v_add_f32 v57, 1.0, v57
    v_add_f32 v58, 1.0, v58
    v_add_f32 v59, 1.0, v59
    v_rcp_f32 v56, v56
    v_rcp_f32 v57, v57
    v_rcp_f32 v58, v58
    v_rcp_f32 v59, v59
    v_mul_f32 v52, v120, v56
    v_mul_f32 v53, v121, v57
    v_mul_f32 v54, v122, v58
    v_mul_f32 v55, v123, v59
    v_cvt_pk_bf16_f32 v46, v52, v53
    v_cvt_pk_bf16_f32 v47, v54, v55
    v_mul_f32 v56, v124, v124
    v_mul_f32 v57, v125, v125
    v_mul_f32 v58, v126, v126
    v_mul_f32 v59, v127, v127
    v_fma_f32 v56, v56, s24, v15
    v_fma_f32 v57, v57, s24, v15
    v_fma_f32 v58, v58, s24, v15
    v_fma_f32 v59, v59, s24, v15
    v_mul_f32 v56, v56, v124
    v_mul_f32 v57, v57, v125
    v_mul_f32 v58, v58, v126
    v_mul_f32 v59, v59, v127
    v_exp_f32 v56, v56
    v_exp_f32 v57, v57
    v_exp_f32 v58, v58
    v_exp_f32 v59, v59
    v_add_f32 v56, 1.0, v56
    v_add_f32 v57, 1.0, v57
    v_add_f32 v58, 1.0, v58
    v_add_f32 v59, 1.0, v59
    v_rcp_f32 v56, v56
    v_rcp_f32 v57, v57
    v_rcp_f32 v58, v58
    v_rcp_f32 v59, v59
    v_mul_f32 v52, v124, v56
    v_mul_f32 v53, v125, v57
    v_mul_f32 v54, v126, v58
    v_mul_f32 v55, v127, v59
    v_cvt_pk_bf16_f32 v50, v52, v53
    v_cvt_pk_bf16_f32 v51, v54, v55
    s_nop 1
    v_permlane32_swap_b32 v44, v46
    v_permlane32_swap_b32 v48, v50
    v_permlane32_swap_b32 v45, v47
    v_permlane32_swap_b32 v49, v51
    buffer_store_dwordx4 v[44:47], v13, s[12:15], s22 offen offset:2048 sc1
    buffer_store_dwordx4 v[48:51], v13, s[12:15], s22 offen offset:2560 sc1
    s_add_u32 s21, s21, 8192
    s_add_u32 s22, s22, 8192
    s_waitcnt vmcnt(8)
    v_lshl_or_b32 v136, v129, 16, v128
    v_lshl_or_b32 v137, v131, 16, v130
    v_lshl_or_b32 v138, v133, 16, v132
    v_lshl_or_b32 v139, v135, 16, v134
    s_lshl_b32 s90, s89, 10
    buffer_store_dwordx4 v[136:139], v5, s[76:79], s90 offen sc1
    s_branch finh_g1_kernel_37
drain1h_g1_kernel_36:
    s_sub_u32 s89, s2, 64
    s_lshl_b32 s89, s89, 2
    s_add_u32 s89, s89, s26
    v_bfe_u32 v5, v0, 5, 1
    v_mul_u32_u24 v4, 9216, v5
    v_and_b32 v5, 31, v0
    v_lshl_add_u32 v4, v5, 1, v4
    v_lshlrev_b32 v5, 4, v1
    s_mul_i32 s90, s89, 1821
    s_lshr_b32 s90, s90, 16
    s_mul_i32 s91, s90, 36
    s_sub_u32 s91, s89, s91
    s_mul_i32 s91, s91, 18432
    s_lshl_b32 s90, s90, 6
    s_add_u32 s91, s91, s90
    s_cmp_lt_u32 s89, 648
    s_cselect_b32 s82, s82, 0
    s_waitcnt lgkmcnt(0)
    buffer_load_ushort v128, v4, s[80:83], s91 offen offset:0
    buffer_load_ushort v129, v4, s[80:83], s91 offen offset:1152
    buffer_load_ushort v130, v4, s[80:83], s91 offen offset:2304
    s_add_u32 s91, s91, 3456
    buffer_load_ushort v131, v4, s[80:83], s91 offen offset:0
    buffer_load_ushort v132, v4, s[80:83], s91 offen offset:1152
    buffer_load_ushort v133, v4, s[80:83], s91 offen offset:2304
    s_add_u32 s91, s91, 3456
    buffer_load_ushort v134, v4, s[80:83], s91 offen offset:0
    buffer_load_ushort v135, v4, s[80:83], s91 offen offset:1152
    s_nop 15
    v_mul_f32 v56, v160, v160
    v_mul_f32 v57, v161, v161
    v_mul_f32 v58, v162, v162
    v_mul_f32 v59, v163, v163
    v_fma_f32 v56, v56, s24, v15
    v_fma_f32 v57, v57, s24, v15
    v_fma_f32 v58, v58, s24, v15
    v_fma_f32 v59, v59, s24, v15
    v_mul_f32 v56, v56, v160
    v_mul_f32 v57, v57, v161
    v_mul_f32 v58, v58, v162
    v_mul_f32 v59, v59, v163
    v_exp_f32 v56, v56
    v_exp_f32 v57, v57
    v_exp_f32 v58, v58
    v_exp_f32 v59, v59
    v_add_f32 v56, 1.0, v56
    v_add_f32 v57, 1.0, v57
    v_add_f32 v58, 1.0, v58
    v_add_f32 v59, 1.0, v59
    v_rcp_f32 v56, v56
    v_rcp_f32 v57, v57
    v_rcp_f32 v58, v58
    v_rcp_f32 v59, v59
    v_mul_f32 v52, v160, v56
    v_mul_f32 v53, v161, v57
    v_mul_f32 v54, v162, v58
    v_mul_f32 v55, v163, v59
    v_cvt_pk_bf16_f32 v36, v52, v53
    v_cvt_pk_bf16_f32 v37, v54, v55
    v_mul_f32 v56, v164, v164
    v_mul_f32 v57, v165, v165
    v_mul_f32 v58, v166, v166
    v_mul_f32 v59, v167, v167
    v_fma_f32 v56, v56, s24, v15
    v_fma_f32 v57, v57, s24, v15
    v_fma_f32 v58, v58, s24, v15
    v_fma_f32 v59, v59, s24, v15
    v_mul_f32 v56, v56, v164
    v_mul_f32 v57, v57, v165
    v_mul_f32 v58, v58, v166
    v_mul_f32 v59, v59, v167
    v_exp_f32 v56, v56
    v_exp_f32 v57, v57
    v_exp_f32 v58, v58
    v_exp_f32 v59, v59
    v_add_f32 v56, 1.0, v56
    v_add_f32 v57, 1.0, v57
    v_add_f32 v58, 1.0, v58
    v_add_f32 v59, 1.0, v59
    v_rcp_f32 v56, v56
    v_rcp_f32 v57, v57
    v_rcp_f32 v58, v58
    v_rcp_f32 v59, v59
    v_mul_f32 v52, v164, v56
    v_mul_f32 v53, v165, v57
    v_mul_f32 v54, v166, v58
    v_mul_f32 v55, v167, v59
    v_cvt_pk_bf16_f32 v40, v52, v53
    v_cvt_pk_bf16_f32 v41, v54, v55
    v_mul_f32 v56, v168, v168
    v_mul_f32 v57, v169, v169
    v_mul_f32 v58, v170, v170
    v_mul_f32 v59, v171, v171
    v_fma_f32 v56, v56, s24, v15
    v_fma_f32 v57, v57, s24, v15
    v_fma_f32 v58, v58, s24, v15
    v_fma_f32 v59, v59, s24, v15
    v_mul_f32 v56, v56, v168
    v_mul_f32 v57, v57, v169
    v_mul_f32 v58, v58, v170
    v_mul_f32 v59, v59, v171
    v_exp_f32 v56, v56
    v_exp_f32 v57, v57
    v_exp_f32 v58, v58
    v_exp_f32 v59, v59
    v_add_f32 v56, 1.0, v56
    v_add_f32 v57, 1.0, v57
    v_add_f32 v58, 1.0, v58
    v_add_f32 v59, 1.0, v59
    v_rcp_f32 v56, v56
    v_rcp_f32 v57, v57
    v_rcp_f32 v58, v58
    v_rcp_f32 v59, v59
    v_mul_f32 v52, v168, v56
    v_mul_f32 v53, v169, v57
    v_mul_f32 v54, v170, v58
    v_mul_f32 v55, v171, v59
    v_cvt_pk_bf16_f32 v38, v52, v53
    v_cvt_pk_bf16_f32 v39, v54, v55
    v_mul_f32 v56, v172, v172
    v_mul_f32 v57, v173, v173
    v_mul_f32 v58, v174, v174
    v_mul_f32 v59, v175, v175
    v_fma_f32 v56, v56, s24, v15
    v_fma_f32 v57, v57, s24, v15
    v_fma_f32 v58, v58, s24, v15
    v_fma_f32 v59, v59, s24, v15
    v_mul_f32 v56, v56, v172
    v_mul_f32 v57, v57, v173
    v_mul_f32 v58, v58, v174
    v_mul_f32 v59, v59, v175
    v_exp_f32 v56, v56
    v_exp_f32 v57, v57
    v_exp_f32 v58, v58
    v_exp_f32 v59, v59
    v_add_f32 v56, 1.0, v56
    v_add_f32 v57, 1.0, v57
    v_add_f32 v58, 1.0, v58
    v_add_f32 v59, 1.0, v59
    v_rcp_f32 v56, v56
    v_rcp_f32 v57, v57
    v_rcp_f32 v58, v58
    v_rcp_f32 v59, v59
    v_mul_f32 v52, v172, v56
    v_mul_f32 v53, v173, v57
    v_mul_f32 v54, v174, v58
    v_mul_f32 v55, v175, v59
    v_cvt_pk_bf16_f32 v42, v52, v53
    v_cvt_pk_bf16_f32 v43, v54, v55
    s_nop 1
    v_permlane32_swap_b32 v36, v38
    v_permlane32_swap_b32 v40, v42
    v_permlane32_swap_b32 v37, v39
    v_permlane32_swap_b32 v41, v43
    buffer_store_dwordx4 v[36:39], v13, s[12:15], s21 offen offset:0 sc1
    buffer_store_dwordx4 v[40:43], v13, s[12:15], s21 offen offset:512 sc1
    v_mul_f32 v56, v176, v176
    v_mul_f32 v57, v177, v177
    v_mul_f32 v58, v178, v178
    v_mul_f32 v59, v179, v179
    v_fma_f32 v56, v56, s24, v15
    v_fma_f32 v57, v57, s24, v15
    v_fma_f32 v58, v58, s24, v15
    v_fma_f32 v59, v59, s24, v15
    v_mul_f32 v56, v56, v176
    v_mul_f32 v57, v57, v177
    v_mul_f32 v58, v58, v178
    v_mul_f32 v59, v59, v179
    v_exp_f32 v56, v56
    v_exp_f32 v57, v57
    v_exp_f32 v58, v58
    v_exp_f32 v59, v59
    v_add_f32 v56, 1.0, v56
    v_add_f32 v57, 1.0, v57
    v_add_f32 v58, 1.0, v58
    v_add_f32 v59, 1.0, v59
    v_rcp_f32 v56, v56
    v_rcp_f32 v57, v57
    v_rcp_f32 v58, v58
    v_rcp_f32 v59, v59
    v_mul_f32 v52, v176, v56
    v_mul_f32 v53, v177, v57
    v_mul_f32 v54, v178, v58
    v_mul_f32 v55, v179, v59
    v_cvt_pk_bf16_f32 v44, v52, v53
    v_cvt_pk_bf16_f32 v45, v54, v55
    v_mul_f32 v56, v180, v180
    v_mul_f32 v57, v181, v181
    v_mul_f32 v58, v182, v182
    v_mul_f32 v59, v183, v183
    v_fma_f32 v56, v56, s24, v15
    v_fma_f32 v57, v57, s24, v15
    v_fma_f32 v58, v58, s24, v15
    v_fma_f32 v59, v59, s24, v15
    v_mul_f32 v56, v56, v180
    v_mul_f32 v57, v57, v181
    v_mul_f32 v58, v58, v182
    v_mul_f32 v59, v59, v183
    v_exp_f32 v56, v56
    v_exp_f32 v57, v57
    v_exp_f32 v58, v58
    v_exp_f32 v59, v59
    v_add_f32 v56, 1.0, v56
    v_add_f32 v57, 1.0, v57
    v_add_f32 v58, 1.0, v58
    v_add_f32 v59, 1.0, v59
    v_rcp_f32 v56, v56
    v_rcp_f32 v57, v57
    v_rcp_f32 v58, v58
    v_rcp_f32 v59, v59
    v_mul_f32 v52, v180, v56
    v_mul_f32 v53, v181, v57
    v_mul_f32 v54, v182, v58
    v_mul_f32 v55, v183, v59
    v_cvt_pk_bf16_f32 v48, v52, v53
    v_cvt_pk_bf16_f32 v49, v54, v55
    v_mul_f32 v56, v184, v184
    v_mul_f32 v57, v185, v185
    v_mul_f32 v58, v186, v186
    v_mul_f32 v59, v187, v187
    v_fma_f32 v56, v56, s24, v15
    v_fma_f32 v57, v57, s24, v15
    v_fma_f32 v58, v58, s24, v15
    v_fma_f32 v59, v59, s24, v15
    v_mul_f32 v56, v56, v184
    v_mul_f32 v57, v57, v185
    v_mul_f32 v58, v58, v186
    v_mul_f32 v59, v59, v187
    v_exp_f32 v56, v56
    v_exp_f32 v57, v57
    v_exp_f32 v58, v58
    v_exp_f32 v59, v59
    v_add_f32 v56, 1.0, v56
    v_add_f32 v57, 1.0, v57
    v_add_f32 v58, 1.0, v58
    v_add_f32 v59, 1.0, v59
    v_rcp_f32 v56, v56
    v_rcp_f32 v57, v57
    v_rcp_f32 v58, v58
    v_rcp_f32 v59, v59
    v_mul_f32 v52, v184, v56
    v_mul_f32 v53, v185, v57
    v_mul_f32 v54, v186, v58
    v_mul_f32 v55, v187, v59
    v_cvt_pk_bf16_f32 v46, v52, v53
    v_cvt_pk_bf16_f32 v47, v54, v55
    v_mul_f32 v56, v188, v188
    v_mul_f32 v57, v189, v189
    v_mul_f32 v58, v190, v190
    v_mul_f32 v59, v191, v191
    v_fma_f32 v56, v56, s24, v15
    v_fma_f32 v57, v57, s24, v15
    v_fma_f32 v58, v58, s24, v15
    v_fma_f32 v59, v59, s24, v15
    v_mul_f32 v56, v56, v188
    v_mul_f32 v57, v57, v189
    v_mul_f32 v58, v58, v190
    v_mul_f32 v59, v59, v191
    v_exp_f32 v56, v56
    v_exp_f32 v57, v57
    v_exp_f32 v58, v58
    v_exp_f32 v59, v59
    v_add_f32 v56, 1.0, v56
    v_add_f32 v57, 1.0, v57
    v_add_f32 v58, 1.0, v58
    v_add_f32 v59, 1.0, v59
    v_rcp_f32 v56, v56
    v_rcp_f32 v57, v57
    v_rcp_f32 v58, v58
    v_rcp_f32 v59, v59
    v_mul_f32 v52, v188, v56
    v_mul_f32 v53, v189, v57
    v_mul_f32 v54, v190, v58
    v_mul_f32 v55, v191, v59
    v_cvt_pk_bf16_f32 v50, v52, v53
    v_cvt_pk_bf16_f32 v51, v54, v55
    s_nop 1
    v_permlane32_swap_b32 v44, v46
    v_permlane32_swap_b32 v48, v50
    v_permlane32_swap_b32 v45, v47
    v_permlane32_swap_b32 v49, v51
    buffer_store_dwordx4 v[44:47], v13, s[12:15], s22 offen offset:0 sc1
    buffer_store_dwordx4 v[48:51], v13, s[12:15], s22 offen offset:512 sc1
    v_mul_f32 v56, v192, v192
    v_mul_f32 v57, v193, v193
    v_mul_f32 v58, v194, v194
    v_mul_f32 v59, v195, v195
    v_fma_f32 v56, v56, s24, v15
    v_fma_f32 v57, v57, s24, v15
    v_fma_f32 v58, v58, s24, v15
    v_fma_f32 v59, v59, s24, v15
    v_mul_f32 v56, v56, v192
    v_mul_f32 v57, v57, v193
    v_mul_f32 v58, v58, v194
    v_mul_f32 v59, v59, v195
    v_exp_f32 v56, v56
    v_exp_f32 v57, v57
    v_exp_f32 v58, v58
    v_exp_f32 v59, v59
    v_add_f32 v56, 1.0, v56
    v_add_f32 v57, 1.0, v57
    v_add_f32 v58, 1.0, v58
    v_add_f32 v59, 1.0, v59
    v_rcp_f32 v56, v56
    v_rcp_f32 v57, v57
    v_rcp_f32 v58, v58
    v_rcp_f32 v59, v59
    v_mul_f32 v52, v192, v56
    v_mul_f32 v53, v193, v57
    v_mul_f32 v54, v194, v58
    v_mul_f32 v55, v195, v59
    v_cvt_pk_bf16_f32 v36, v52, v53
    v_cvt_pk_bf16_f32 v37, v54, v55
    v_mul_f32 v56, v196, v196
    v_mul_f32 v57, v197, v197
    v_mul_f32 v58, v198, v198
    v_mul_f32 v59, v199, v199
    v_fma_f32 v56, v56, s24, v15
    v_fma_f32 v57, v57, s24, v15
    v_fma_f32 v58, v58, s24, v15
    v_fma_f32 v59, v59, s24, v15
    v_mul_f32 v56, v56, v196
    v_mul_f32 v57, v57, v197
    v_mul_f32 v58, v58, v198
    v_mul_f32 v59, v59, v199
    v_exp_f32 v56, v56
    v_exp_f32 v57, v57
    v_exp_f32 v58, v58
    v_exp_f32 v59, v59
    v_add_f32 v56, 1.0, v56
    v_add_f32 v57, 1.0, v57
    v_add_f32 v58, 1.0, v58
    v_add_f32 v59, 1.0, v59
    v_rcp_f32 v56, v56
    v_rcp_f32 v57, v57
    v_rcp_f32 v58, v58
    v_rcp_f32 v59, v59
    v_mul_f32 v52, v196, v56
    v_mul_f32 v53, v197, v57
    v_mul_f32 v54, v198, v58
    v_mul_f32 v55, v199, v59
    v_cvt_pk_bf16_f32 v40, v52, v53
    v_cvt_pk_bf16_f32 v41, v54, v55
    v_mul_f32 v56, v200, v200
    v_mul_f32 v57, v201, v201
    v_mul_f32 v58, v202, v202
    v_mul_f32 v59, v203, v203
    v_fma_f32 v56, v56, s24, v15
    v_fma_f32 v57, v57, s24, v15
    v_fma_f32 v58, v58, s24, v15
    v_fma_f32 v59, v59, s24, v15
    v_mul_f32 v56, v56, v200
    v_mul_f32 v57, v57, v201
    v_mul_f32 v58, v58, v202
    v_mul_f32 v59, v59, v203
    v_exp_f32 v56, v56
    v_exp_f32 v57, v57
    v_exp_f32 v58, v58
    v_exp_f32 v59, v59
    v_add_f32 v56, 1.0, v56
    v_add_f32 v57, 1.0, v57
    v_add_f32 v58, 1.0, v58
    v_add_f32 v59, 1.0, v59
    v_rcp_f32 v56, v56
    v_rcp_f32 v57, v57
    v_rcp_f32 v58, v58
    v_rcp_f32 v59, v59
    v_mul_f32 v52, v200, v56
    v_mul_f32 v53, v201, v57
    v_mul_f32 v54, v202, v58
    v_mul_f32 v55, v203, v59
    v_cvt_pk_bf16_f32 v38, v52, v53
    v_cvt_pk_bf16_f32 v39, v54, v55
    v_mul_f32 v56, v204, v204
    v_mul_f32 v57, v205, v205
    v_mul_f32 v58, v206, v206
    v_mul_f32 v59, v207, v207
    v_fma_f32 v56, v56, s24, v15
    v_fma_f32 v57, v57, s24, v15
    v_fma_f32 v58, v58, s24, v15
    v_fma_f32 v59, v59, s24, v15
    v_mul_f32 v56, v56, v204
    v_mul_f32 v57, v57, v205
    v_mul_f32 v58, v58, v206
    v_mul_f32 v59, v59, v207
    v_exp_f32 v56, v56
    v_exp_f32 v57, v57
    v_exp_f32 v58, v58
    v_exp_f32 v59, v59
    v_add_f32 v56, 1.0, v56
    v_add_f32 v57, 1.0, v57
    v_add_f32 v58, 1.0, v58
    v_add_f32 v59, 1.0, v59
    v_rcp_f32 v56, v56
    v_rcp_f32 v57, v57
    v_rcp_f32 v58, v58
    v_rcp_f32 v59, v59
    v_mul_f32 v52, v204, v56
    v_mul_f32 v53, v205, v57
    v_mul_f32 v54, v206, v58
    v_mul_f32 v55, v207, v59
    v_cvt_pk_bf16_f32 v42, v52, v53
    v_cvt_pk_bf16_f32 v43, v54, v55
    s_nop 1
    v_permlane32_swap_b32 v36, v38
    v_permlane32_swap_b32 v40, v42
    v_permlane32_swap_b32 v37, v39
    v_permlane32_swap_b32 v41, v43
    buffer_store_dwordx4 v[36:39], v13, s[12:15], s21 offen offset:2048 sc1
    buffer_store_dwordx4 v[40:43], v13, s[12:15], s21 offen offset:2560 sc1
    v_mul_f32 v56, v208, v208
    v_mul_f32 v57, v209, v209
    v_mul_f32 v58, v210, v210
    v_mul_f32 v59, v211, v211
    v_fma_f32 v56, v56, s24, v15
    v_fma_f32 v57, v57, s24, v15
    v_fma_f32 v58, v58, s24, v15
    v_fma_f32 v59, v59, s24, v15
    v_mul_f32 v56, v56, v208
    v_mul_f32 v57, v57, v209
    v_mul_f32 v58, v58, v210
    v_mul_f32 v59, v59, v211
    v_exp_f32 v56, v56
    v_exp_f32 v57, v57
    v_exp_f32 v58, v58
    v_exp_f32 v59, v59
    v_add_f32 v56, 1.0, v56
    v_add_f32 v57, 1.0, v57
    v_add_f32 v58, 1.0, v58
    v_add_f32 v59, 1.0, v59
    v_rcp_f32 v56, v56
    v_rcp_f32 v57, v57
    v_rcp_f32 v58, v58
    v_rcp_f32 v59, v59
    v_mul_f32 v52, v208, v56
    v_mul_f32 v53, v209, v57
    v_mul_f32 v54, v210, v58
    v_mul_f32 v55, v211, v59
    v_cvt_pk_bf16_f32 v44, v52, v53
    v_cvt_pk_bf16_f32 v45, v54, v55
    v_mul_f32 v56, v212, v212
    v_mul_f32 v57, v213, v213
    v_mul_f32 v58, v214, v214
    v_mul_f32 v59, v215, v215
    v_fma_f32 v56, v56, s24, v15
    v_fma_f32 v57, v57, s24, v15
    v_fma_f32 v58, v58, s24, v15
    v_fma_f32 v59, v59, s24, v15
    v_mul_f32 v56, v56, v212
    v_mul_f32 v57, v57, v213
    v_mul_f32 v58, v58, v214
    v_mul_f32 v59, v59, v215
    v_exp_f32 v56, v56
    v_exp_f32 v57, v57
    v_exp_f32 v58, v58
    v_exp_f32 v59, v59
    v_add_f32 v56, 1.0, v56
    v_add_f32 v57, 1.0, v57
    v_add_f32 v58, 1.0, v58
    v_add_f32 v59, 1.0, v59
    v_rcp_f32 v56, v56
    v_rcp_f32 v57, v57
    v_rcp_f32 v58, v58
    v_rcp_f32 v59, v59
    v_mul_f32 v52, v212, v56
    v_mul_f32 v53, v213, v57
    v_mul_f32 v54, v214, v58
    v_mul_f32 v55, v215, v59
    v_cvt_pk_bf16_f32 v48, v52, v53
    v_cvt_pk_bf16_f32 v49, v54, v55
    v_mul_f32 v56, v216, v216
    v_mul_f32 v57, v217, v217
    v_mul_f32 v58, v218, v218
    v_mul_f32 v59, v219, v219
    v_fma_f32 v56, v56, s24, v15
    v_fma_f32 v57, v57, s24, v15
    v_fma_f32 v58, v58, s24, v15
    v_fma_f32 v59, v59, s24, v15
    v_mul_f32 v56, v56, v216
    v_mul_f32 v57, v57, v217
    v_mul_f32 v58, v58, v218
    v_mul_f32 v59, v59, v219
    v_exp_f32 v56, v56
    v_exp_f32 v57, v57
    v_exp_f32 v58, v58
    v_exp_f32 v59, v59
    v_add_f32 v56, 1.0, v56
    v_add_f32 v57, 1.0, v57
    v_add_f32 v58, 1.0, v58
    v_add_f32 v59, 1.0, v59
    v_rcp_f32 v56, v56
    v_rcp_f32 v57, v57
    v_rcp_f32 v58, v58
    v_rcp_f32 v59, v59
    v_mul_f32 v52, v216, v56
    v_mul_f32 v53, v217, v57
    v_mul_f32 v54, v218, v58
    v_mul_f32 v55, v219, v59
    v_cvt_pk_bf16_f32 v46, v52, v53
    v_cvt_pk_bf16_f32 v47, v54, v55
    v_mul_f32 v56, v220, v220
    v_mul_f32 v57, v221, v221
    v_mul_f32 v58, v222, v222
    v_mul_f32 v59, v223, v223
    v_fma_f32 v56, v56, s24, v15
    v_fma_f32 v57, v57, s24, v15
    v_fma_f32 v58, v58, s24, v15
    v_fma_f32 v59, v59, s24, v15
    v_mul_f32 v56, v56, v220
    v_mul_f32 v57, v57, v221
    v_mul_f32 v58, v58, v222
    v_mul_f32 v59, v59, v223
    v_exp_f32 v56, v56
    v_exp_f32 v57, v57
    v_exp_f32 v58, v58
    v_exp_f32 v59, v59
    v_add_f32 v56, 1.0, v56
    v_add_f32 v57, 1.0, v57
    v_add_f32 v58, 1.0, v58
    v_add_f32 v59, 1.0, v59
    v_rcp_f32 v56, v56
    v_rcp_f32 v57, v57
    v_rcp_f32 v58, v58
    v_rcp_f32 v59, v59
    v_mul_f32 v52, v220, v56
    v_mul_f32 v53, v221, v57
    v_mul_f32 v54, v222, v58
    v_mul_f32 v55, v223, v59
    v_cvt_pk_bf16_f32 v50, v52, v53
    v_cvt_pk_bf16_f32 v51, v54, v55
    s_nop 1
    v_permlane32_swap_b32 v44, v46
    v_permlane32_swap_b32 v48, v50
    v_permlane32_swap_b32 v45, v47
    v_permlane32_swap_b32 v49, v51
    buffer_store_dwordx4 v[44:47], v13, s[12:15], s22 offen offset:2048 sc1
    buffer_store_dwordx4 v[48:51], v13, s[12:15], s22 offen offset:2560 sc1
    s_add_u32 s21, s21, 8192
    s_add_u32 s22, s22, 8192
    s_waitcnt vmcnt(8)
    v_lshl_or_b32 v136, v129, 16, v128
    v_lshl_or_b32 v137, v131, 16, v130
    v_lshl_or_b32 v138, v133, 16, v132
    v_lshl_or_b32 v139, v135, 16, v134
    s_lshl_b32 s90, s89, 10
    buffer_store_dwordx4 v[136:139], v5, s[76:79], s90 offen sc1
finh_g1_kernel_37:
end_g1_kernel_1:
    s_endpgm
.globl g3_kernel
.p2align 8
.type g3_kernel,@function
g3_kernel:
    s_cmp_ge_u32 s2, 256
    s_cbranch_scc1 end_g3_kernel_1
    s_load_dwordx2 s[40:41], s[0:1], 80
    s_load_dwordx2 s[44:45], s[0:1], 48
    s_load_dwordx2 s[64:65], s[0:1], 0
    s_load_dwordx2 s[96:97], s[0:1], 56
    s_load_dwordx2 s[68:69], s[0:1], 64
    s_getpc_b64 s[82:83]
pc_g3_kernel_3:
    s_sub_u32 s82, s82, pc_g3_kernel_3-g3_kernel
    s_subb_u32 s83, s83, 0
    s_bfe_u32 s84, s2, 0x20003
    s_lshl_b32 s84, s84, 14
    v_lshlrev_b32 v63, 6, v0
    v_add_u32 v63, s84, v63
    v_min_u32 v63, text_end-g3_kernel-4, v63
    global_load_dword v63, v63, s[82:83]
    s_sub_u32 s33, s2, 192
    s_and_b32 s30, s2, 3
    s_bfe_u32 s31, s2, 0x30003
    s_bfe_u32 s32, s2, 0x10002
    s_lshl_b32 s32, s32, 3
    s_add_u32 s31, s31, s32
    s_lshr_b32 s32, s2, 6
    s_mov_b32 s94, 0x3000
    s_mov_b32 s95, 0x00020000
    s_mov_b32 s66, 0x240000
    s_mov_b32 s67, 0x20000
    s_mov_b32 s98, 0x480
    s_mov_b32 s99, 0x20000
    s_cmp_ge_u32 s2, 192
    s_cbranch_scc1 att_g3_kernel_2
    s_mov_b32 s6, 0x1200000
    s_mov_b32 s7, 0x00020000
    s_mul_i32 s28, s31, 1179648
    s_mul_i32 s37, s30, 73728
    s_add_u32 s28, s28, s37
    s_mov_b32 s10, 0x510000
    s_mov_b32 s11, 0x00020000
    s_mov_b32 s16, s10
    s_mul_i32 s20, s30, 1327104
    s_mul_i32 s37, s32, 384
    s_add_u32 s20, s20, s37
    s_mov_b32 s14, 0xd80000
    s_mov_b32 s15, 0x00020000
    s_mul_i32 s29, s30, 2359296
    s_mul_i32 s37, s31, 147456
    s_add_u32 s29, s29, s37
    s_mul_i32 s37, s32, 12288
    s_add_u32 s29, s29, s37
    s_mov_b32 s17, 2
    s_mov_b32 s70, s31
    s_mov_b32 s71, s32
    s_lshl_b32 s72, s30, 2
    v_lshrrev_b32 v17, 6, v0
    v_and_b32 v1, 63, v0
    v_readfirstlane_b32 s26, v17
    v_lshrrev_b32 v18, 5, v1
    v_and_b32 v19, 31, v1
    s_mov_b32 s35, s26
    s_mov_b32 s36, 0
    s_mul_i32 s23, s26, 9216
    s_movk_i32 s27, 1152
    s_mul_i32 s25, s26, 72
    v_bfe_u32 v17, v1, 2, 3
    v_add_u32 v17, s25, v17
    v_mul_lo_u32 v17, v17, s27
    v_lshl_add_u32 v17, v18, 6, v17
    v_and_b32 v4, 3, v1
    v_lshl_add_u32 v4, v4, 4, v17
    v_add_u32 v5, 0x2400, v4
    v_add_u32 v6, 0x2400, v5
    v_add_u32 v7, 0x2400, v6
    v_add_u32 v8, 0x2400, v7
    v_add_u32 v9, 0x2400, v8
    v_add_u32 v10, 0x2400, v9
    v_add_u32 v11, 0x2400, v10
    v_add_u32 v12, 0x2400, v11
    s_cmp_ge_u32 s17, 0
    s_cselect_b32 s10, s16, 0
    s_add_u32 s27, s20, 0
    s_waitcnt lgkmcnt(0)
    s_mov_b32 s8, s44
    s_mov_b32 s9, s45
    s_add_u32 m0, s23, 0
    s_nop 0
    buffer_load_dwordx4 v4, s[8:11], s27 offen lds
    s_add_u32 m0, s23, 1024
    s_nop 0
    buffer_load_dwordx4 v5, s[8:11], s27 offen lds
    s_add_u32 m0, s23, 2048
    s_nop 0
    buffer_load_dwordx4 v6, s[8:11], s27 offen lds
    s_add_u32 m0, s23, 3072
    s_nop 0
    buffer_load_dwordx4 v7, s[8:11], s27 offen lds
    s_add_u32 m0, s23, 4096
    s_nop 0
    buffer_load_dwordx4 v8, s[8:11], s27 offen lds
    s_add_u32 m0, s23, 5120
    s_nop 0
    buffer_load_dwordx4 v9, s[8:11], s27 offen lds
    s_add_u32 m0, s23, 6144
    s_nop 0
    buffer_load_dwordx4 v10, s[8:11], s27 offen lds
    s_add_u32 m0, s23, 7168
    s_nop 0
    buffer_load_dwordx4 v11, s[8:11], s27 offen lds
    s_add_u32 m0, s23, 8192
    s_nop 0
    buffer_load_dwordx4 v12, s[8:11], s27 offen lds
    s_add_u32 s4, s40, 0x1000000
    s_addc_u32 s5, s41, 0
    s_add_u32 s12, s40, 0x3000000
    s_addc_u32 s13, s41, 0
    s_add_u32 s92, s40, 0x28a2000
    s_addc_u32 s93, s41, 0
    s_mul_i32 s25, s35, 294912
    s_add_u32 s38, s25, s28
    s_add_u32 s39, s38, 294912
    v_lshlrev_b32 v17, 4, v1
    buffer_load_dwordx4 a[0:3], v17, s[4:7], s38 offen offset:0
    buffer_load_dwordx4 a[4:7], v17, s[4:7], s38 offen offset:1024
    buffer_load_dwordx4 a[8:11], v17, s[4:7], s38 offen offset:2048
    buffer_load_dwordx4 a[12:15], v17, s[4:7], s38 offen offset:3072
    s_add_u32 s38, s38, 4096
    s_add_u32 s39, s39, 4096
    buffer_load_dwordx4 a[16:19], v17, s[4:7], s38 offen offset:0
    buffer_load_dwordx4 a[20:23], v17, s[4:7], s38 offen offset:1024
    buffer_load_dwordx4 a[24:27], v17, s[4:7], s38 offen offset:2048
    buffer_load_dwordx4 a[28:31], v17, s[4:7], s38 offen offset:3072
    s_add_u32 s38, s38, 4096
    s_add_u32 s39, s39, 4096
    buffer_load_dwordx4 a[32:35], v17, s[4:7], s38 offen offset:0
    buffer_load_dwordx4 a[36:39], v17, s[4:7], s38 offen offset:1024
    buffer_load_dwordx4 a[40:43], v17, s[4:7], s38 offen offset:2048
    buffer_load_dwordx4 a[44:47], v17, s[4:7], s38 offen offset:3072
    s_add_u32 s38, s38, 4096
    s_add_u32 s39, s39, 4096
    buffer_load_dwordx4 a[48:51], v17, s[4:7], s38 offen offset:0
    buffer_load_dwordx4 a[52:55], v17, s[4:7], s38 offen offset:1024
    buffer_load_dwordx4 a[56:59], v17, s[4:7], s38 offen offset:2048
    buffer_load_dwordx4 a[60:63], v17, s[4:7], s38 offen offset:3072
    s_add_u32 s38, s38, 4096
    s_add_u32 s39, s39, 4096
    buffer_load_dwordx4 a[64:67], v17, s[4:7], s38 offen offset:0
    buffer_load_dwordx4 a[68:71], v17, s[4:7], s38 offen offset:1024
    buffer_load_dwordx4 a[72:75], v17, s[4:7], s38 offen offset:2048
    buffer_load_dwordx4 a[76:79], v17, s[4:7], s38 offen offset:3072
    s_mov_b32 s19, 110592
    v_bfe_u32 v54, v1, 2, 2
    v_lshlrev_b32 v16, 6, v54
    v_lshl_add_u32 v16, v18, 10, v16
    v_bfe_u32 v54, v1, 4, 1
    v_lshl_add_u32 v16, v54, 5, v16
    v_and_b32 v54, 3, v1
    v_lshl_add_u32 v16, v54, 3, v16
    v_mov_b32 v2, v16
    s_mov_b32 s18, 0
    v_lshlrev_b32 v13, 4, v1
    v_add_u32 v14, 0x1000, v13
    s_mul_i32 s21, s35, 36864
    s_add_u32 s21, s21, s29
    s_lshl_b32 s27, s36, 12
    s_add_u32 s21, s21, s27
    s_add_u32 s22, s21, 36864
    v_lshlrev_b32 v19, 2, v1
    v_add_u32 v19, 0x26000, v19
    v_mov_b32 v18, 0
    ds_write_b32 v19, v18
    s_mov_b32 s57, 0
    s_waitcnt vmcnt(20)
    s_waitcnt lgkmcnt(0)
    s_barrier
    ds_read_b64_tr_b16 v[128:129], v2 offset:0
    ds_read_b64_tr_b16 v[130:131], v2 offset:256
    ds_read_b64_tr_b16 v[132:133], v2 offset:512
    ds_read_b64_tr_b16 v[134:135], v2 offset:768
    ds_read_b64_tr_b16 v[136:137], v2 offset:2048
    ds_read_b64_tr_b16 v[138:139], v2 offset:2304
    ds_read_b64_tr_b16 v[140:141], v2 offset:2560
    ds_read_b64_tr_b16 v[142:143], v2 offset:2816
    ds_read_b64_tr_b16 v[144:145], v2 offset:4096
    ds_read_b64_tr_b16 v[146:147], v2 offset:4352
    ds_read_b64_tr_b16 v[148:149], v2 offset:4608
    ds_read_b64_tr_b16 v[150:151], v2 offset:4864
    s_waitcnt lgkmcnt(10)
    s_waitcnt vmcnt(19)
    v_mfma_f32_32x32x16_bf16 v[160:175], v[128:131], a[0:3], 0
    s_add_u32 s38, s38, 4096
    s_add_u32 s39, s39, 4096
    buffer_load_dwordx4 a[80:83], v17, s[4:7], s38 offen offset:0
    s_cmp_ge_u32 s17, 0
    s_cselect_b32 s10, s16, 0
    s_add_u32 s27, s20, 331776
    s_add_u32 m0, s23, 36864
    s_nop 0
    buffer_load_dwordx4 v4, s[8:11], s27 offen lds
    s_add_u32 m0, s23, 37888
    s_nop 0
    buffer_load_dwordx4 v5, s[8:11], s27 offen lds
    s_add_u32 m0, s23, 38912
    s_nop 0
    buffer_load_dwordx4 v6, s[8:11], s27 offen lds
    s_add_u32 m0, s23, 39936
    s_nop 0
    buffer_load_dwordx4 v7, s[8:11], s27 offen lds
    s_add_u32 m0, s23, 40960
    s_nop 0
    buffer_load_dwordx4 v8, s[8:11], s27 offen lds
    s_add_u32 m0, s23, 41984
    s_nop 0
    buffer_load_dwordx4 v9, s[8:11], s27 offen lds
    s_add_u32 m0, s23, 43008
    s_nop 0
    buffer_load_dwordx4 v10, s[8:11], s27 offen lds
    s_add_u32 m0, s23, 44032
    s_nop 0
    buffer_load_dwordx4 v11, s[8:11], s27 offen lds
    s_add_u32 m0, s23, 45056
    s_nop 0
    buffer_load_dwordx4 v12, s[8:11], s27 offen lds
    ds_read_b64_tr_b16 v[152:153], v2 offset:6144
    ds_read_b64_tr_b16 v[154:155], v2 offset:6400
    s_waitcnt lgkmcnt(10)
    v_mfma_f32_32x32x16_bf16 v[176:191], v[132:135], a[0:3], 0
    ds_read_b64_tr_b16 v[156:157], v2 offset:6656
    ds_read_b64_tr_b16 v[158:159], v2 offset:6912
    s_waitcnt lgkmcnt(10)
    s_waitcnt vmcnt(28)
    v_mfma_f32_32x32x16_bf16 v[160:175], v[136:139], a[4:7], v[160:175]
    buffer_load_dwordx4 a[84:87], v17, s[4:7], s38 offen offset:1024
    ds_read_b64_tr_b16 v[128:129], v2 offset:8192
    ds_read_b64_tr_b16 v[130:131], v2 offset:8448
    s_waitcnt lgkmcnt(10)
    v_mfma_f32_32x32x16_bf16 v[176:191], v[140:143], a[4:7], v[176:191]
    ds_read_b64_tr_b16 v[132:133], v2 offset:8704
    ds_read_b64_tr_b16 v[134:135], v2 offset:8960
    s_waitcnt lgkmcnt(10)
    s_waitcnt vmcnt(28)
    v_mfma_f32_32x32x16_bf16 v[160:175], v[144:147], a[8:11], v[160:175]
    buffer_load_dwordx4 a[88:91], v17, s[4:7], s38 offen offset:2048
    ds_read_b64_tr_b16 v[136:137], v2 offset:10240
    ds_read_b64_tr_b16 v[138:139], v2 offset:10496
    s_waitcnt lgkmcnt(10)
    v_mfma_f32_32x32x16_bf16 v[176:191], v[148:151], a[8:11], v[176:191]
    ds_read_b64_tr_b16 v[140:141], v2 offset:10752
    ds_read_b64_tr_b16 v[142:143], v2 offset:11008
    s_waitcnt lgkmcnt(10)
    s_waitcnt vmcnt(28)
    v_mfma_f32_32x32x16_bf16 v[160:175], v[152:155], a[12:15], v[160:175]
    buffer_load_dwordx4 a[92:95], v17, s[4:7], s38 offen offset:3072
    ds_read_b64_tr_b16 v[144:145], v2 offset:12288
    ds_read_b64_tr_b16 v[146:147], v2 offset:12544
    s_waitcnt lgkmcnt(10)
    v_mfma_f32_32x32x16_bf16 v[176:191], v[156:159], a[12:15], v[176:191]
    ds_read_b64_tr_b16 v[148:149], v2 offset:12800
    ds_read_b64_tr_b16 v[150:151], v2 offset:13056
    s_waitcnt lgkmcnt(10)
    s_waitcnt vmcnt(28)
    v_mfma_f32_32x32x16_bf16 v[160:175], v[128:131], a[16:19], v[160:175]
    s_add_u32 s38, s38, 4096
    s_add_u32 s39, s39, 4096
    buffer_load_dwordx4 a[96:99], v17, s[4:7], s38 offen offset:0
    ds_read_b64_tr_b16 v[152:153], v2 offset:14336
    ds_read_b64_tr_b16 v[154:155], v2 offset:14592
    s_waitcnt lgkmcnt(10)
    v_mfma_f32_32x32x16_bf16 v[176:191], v[132:135], a[16:19], v[176:191]
    ds_read_b64_tr_b16 v[156:157], v2 offset:14848
    ds_read_b64_tr_b16 v[158:159], v2 offset:15104
    s_waitcnt lgkmcnt(10)
    s_waitcnt vmcnt(28)
    v_mfma_f32_32x32x16_bf16 v[160:175], v[136:139], a[20:23], v[160:175]
    buffer_load_dwordx4 a[100:103], v17, s[4:7], s38 offen offset:1024
    ds_read_b64_tr_b16 v[128:129], v2 offset:16384
    ds_read_b64_tr_b16 v[130:131], v2 offset:16640
    s_waitcnt lgkmcnt(10)
    v_mfma_f32_32x32x16_bf16 v[176:191], v[140:143], a[20:23], v[176:191]
    ds_read_b64_tr_b16 v[132:133], v2 offset:16896
    ds_read_b64_tr_b16 v[134:135], v2 offset:17152
    s_waitcnt lgkmcnt(10)
    s_waitcnt vmcnt(28)
    v_mfma_f32_32x32x16_bf16 v[160:175], v[144:147], a[24:27], v[160:175]
    buffer_load_dwordx4 a[104:107], v17, s[4:7], s38 offen offset:2048
    s_cmp_ge_u32 s17, 0
    s_cselect_b32 s10, s16, 0
    s_add_u32 s27, s20, 663552
    s_add_u32 m0, s23, 73728
    s_nop 0
    buffer_load_dwordx4 v4, s[8:11], s27 offen lds
    s_add_u32 m0, s23, 74752
    s_nop 0
    buffer_load_dwordx4 v5, s[8:11], s27 offen lds
    s_add_u32 m0, s23, 75776
    s_nop 0
    buffer_load_dwordx4 v6, s[8:11], s27 offen lds
    s_add_u32 m0, s23, 76800
    s_nop 0
    buffer_load_dwordx4 v7, s[8:11], s27 offen lds
    s_add_u32 m0, s23, 77824
    s_nop 0
    buffer_load_dwordx4 v8, s[8:11], s27 offen lds
    s_add_u32 m0, s23, 78848
    s_nop 0
    buffer_load_dwordx4 v9, s[8:11], s27 offen lds
    s_add_u32 m0, s23, 79872
    s_nop 0
    buffer_load_dwordx4 v10, s[8:11], s27 offen lds
    s_add_u32 m0, s23, 80896
    s_nop 0
    buffer_load_dwordx4 v11, s[8:11], s27 offen lds
    s_add_u32 m0, s23, 81920
    s_nop 0
    buffer_load_dwordx4 v12, s[8:11], s27 offen lds
    ds_read_b64_tr_b16 v[136:137], v2 offset:18432
    ds_read_b64_tr_b16 v[138:139], v2 offset:18688
    s_waitcnt lgkmcnt(10)
    v_mfma_f32_32x32x16_bf16 v[176:191], v[148:151], a[24:27], v[176:191]
    ds_read_b64_tr_b16 v[140:141], v2 offset:18944
    ds_read_b64_tr_b16 v[142:143], v2 offset:19200
    s_waitcnt lgkmcnt(10)
    s_waitcnt vmcnt(37)
    v_mfma_f32_32x32x16_bf16 v[160:175], v[152:155], a[28:31], v[160:175]
    buffer_load_dwordx4 a[108:111], v17, s[4:7], s38 offen offset:3072
    ds_read_b64_tr_b16 v[144:145], v2 offset:20480
    ds_read_b64_tr_b16 v[146:147], v2 offset:20736
    s_waitcnt lgkmcnt(10)
    v_mfma_f32_32x32x16_bf16 v[176:191], v[156:159], a[28:31], v[176:191]
    ds_read_b64_tr_b16 v[148:149], v2 offset:20992
    ds_read_b64_tr_b16 v[150:151], v2 offset:21248
    s_waitcnt lgkmcnt(10)
    s_waitcnt vmcnt(37)
    v_mfma_f32_32x32x16_bf16 v[160:175], v[128:131], a[32:35], v[160:175]
    s_add_u32 s38, s38, 4096
    s_add_u32 s39, s39, 4096
    buffer_load_dwordx4 a[112:115], v17, s[4:7], s38 offen offset:0
    ds_read_b64_tr_b16 v[152:153], v2 offset:22528
    ds_read_b64_tr_b16 v[154:155], v2 offset:22784
    s_waitcnt lgkmcnt(10)
    v_mfma_f32_32x32x16_bf16 v[176:191], v[132:135], a[32:35], v[176:191]
    ds_read_b64_tr_b16 v[156:157], v2 offset:23040
    ds_read_b64_tr_b16 v[158:159], v2 offset:23296
    s_waitcnt lgkmcnt(10)
    s_waitcnt vmcnt(37)
    v_mfma_f32_32x32x16_bf16 v[160:175], v[136:139], a[36:39], v[160:175]
    buffer_load_dwordx4 a[116:119], v17, s[4:7], s38 offen offset:1024
    ds_read_b64_tr_b16 v[128:129], v2 offset:24576
    ds_read_b64_tr_b16 v[130:131], v2 offset:24832
    s_waitcnt lgkmcnt(10)
    v_mfma_f32_32x32x16_bf16 v[176:191], v[140:143], a[36:39], v[176:191]
    ds_read_b64_tr_b16 v[132:133], v2 offset:25088
    ds_read_b64_tr_b16 v[134:135], v2 offset:25344
    s_waitcnt lgkmcnt(10)
    s_waitcnt vmcnt(37)
    v_mfma_f32_32x32x16_bf16 v[160:175], v[144:147], a[40:43], v[160:175]
    buffer_load_dwordx4 a[120:123], v17, s[4:7], s38 offen offset:2048
    ds_read_b64_tr_b16 v[136:137], v2 offset:26624
    ds_read_b64_tr_b16 v[138:139], v2 offset:26880
    s_waitcnt lgkmcnt(10)
    v_mfma_f32_32x32x16_bf16 v[176:191], v[148:151], a[40:43], v[176:191]
    ds_read_b64_tr_b16 v[140:141], v2 offset:27136
    ds_read_b64_tr_b16 v[142:143], v2 offset:27392
    s_waitcnt lgkmcnt(10)
    s_waitcnt vmcnt(37)
    v_mfma_f32_32x32x16_bf16 v[160:175], v[152:155], a[44:47], v[160:175]
    buffer_load_dwordx4 a[124:127], v17, s[4:7], s38 offen offset:3072
    ds_read_b64_tr_b16 v[144:145], v2 offset:28672
    ds_read_b64_tr_b16 v[146:147], v2 offset:28928
    s_waitcnt lgkmcnt(10)
    v_mfma_f32_32x32x16_bf16 v[176:191], v[156:159], a[44:47], v[176:191]
    ds_read_b64_tr_b16 v[148:149], v2 offset:29184
    ds_read_b64_tr_b16 v[150:151], v2 offset:29440
    s_waitcnt lgkmcnt(10)
    s_waitcnt vmcnt(37)
    v_mfma_f32_32x32x16_bf16 v[160:175], v[128:131], a[48:51], v[160:175]
    s_add_u32 s38, s38, 4096
    s_add_u32 s39, s39, 4096
    buffer_load_dwordx4 a[128:131], v17, s[4:7], s38 offen offset:0
    ds_read_b64_tr_b16 v[152:153], v2 offset:30720
    ds_read_b64_tr_b16 v[154:155], v2 offset:30976
    s_waitcnt lgkmcnt(10)
    v_mfma_f32_32x32x16_bf16 v[176:191], v[132:135], a[48:51], v[176:191]
    ds_read_b64_tr_b16 v[156:157], v2 offset:31232
    ds_read_b64_tr_b16 v[158:159], v2 offset:31488
    s_waitcnt lgkmcnt(10)
    s_waitcnt vmcnt(37)
    v_mfma_f32_32x32x16_bf16 v[160:175], v[136:139], a[52:55], v[160:175]
    buffer_load_dwordx4 a[132:135], v17, s[4:7], s38 offen offset:1024
    ds_read_b64_tr_b16 v[128:129], v2 offset:32768
    ds_read_b64_tr_b16 v[130:131], v2 offset:33024
    s_waitcnt lgkmcnt(10)
    v_mfma_f32_32x32x16_bf16 v[176:191], v[140:143], a[52:55], v[176:191]
    ds_read_b64_tr_b16 v[132:133], v2 offset:33280
    ds_read_b64_tr_b16 v[134:135], v2 offset:33536
    s_waitcnt lgkmcnt(10)
    s_waitcnt vmcnt(37)
    v_mfma_f32_32x32x16_bf16 v[160:175], v[144:147], a[56:59], v[160:175]
    buffer_load_dwordx4 a[136:139], v17, s[4:7], s38 offen offset:2048
    s_waitcnt vmcnt(23)
    s_barrier
    s_add_u32 s18, s18, 36864
    s_cmp_eq_u32 s18, 147456
    s_cselect_b32 s18, 0, s18
    v_add_u32 v3, s18, v16
    s_cmp_ge_u32 s17, 0
    s_cselect_b32 s10, s16, 0
    s_add_u32 s25, s19, s23
    s_add_u32 s27, s20, 995328
    s_add_u32 s19, s19, 36864
    s_cmp_eq_u32 s19, 147456
    s_cselect_b32 s19, 0, s19
    ds_read_b64_tr_b16 v[136:137], v2 offset:34816
    ds_read_b64_tr_b16 v[138:139], v2 offset:35072
    s_waitcnt lgkmcnt(10)
    v_mfma_f32_32x32x16_bf16 v[176:191], v[148:151], a[56:59], v[176:191]
    ds_read_b64_tr_b16 v[140:141], v2 offset:35328
    ds_read_b64_tr_b16 v[142:143], v2 offset:35584
    s_add_u32 m0, s25, 0
    s_nop 0
    buffer_load_dwordx4 v4, s[8:11], s27 offen lds
    s_waitcnt lgkmcnt(10)
    v_mfma_f32_32x32x16_bf16 v[160:175], v[152:155], a[60:63], v[160:175]
    buffer_load_dwordx4 a[140:143], v17, s[4:7], s38 offen offset:3072
    ds_read_b64_tr_b16 v[144:145], v3 offset:0
    ds_read_b64_tr_b16 v[146:147], v3 offset:256
    s_waitcnt lgkmcnt(10)
    v_mfma_f32_32x32x16_bf16 v[176:191], v[156:159], a[60:63], v[176:191]
    ds_read_b64_tr_b16 v[148:149], v3 offset:512
    ds_read_b64_tr_b16 v[150:151], v3 offset:768
    s_waitcnt lgkmcnt(10)
    v_mfma_f32_32x32x16_bf16 v[160:175], v[128:131], a[64:67], v[160:175]
    s_add_u32 s38, s38, 4096
    s_add_u32 s39, s39, 4096
    buffer_load_dwordx4 a[144:147], v17, s[4:7], s38 offen offset:0
    ds_read_b64_tr_b16 v[152:153], v3 offset:2048
    ds_read_b64_tr_b16 v[154:155], v3 offset:2304
    s_add_u32 m0, s25, 1024
    s_nop 0
    buffer_load_dwordx4 v5, s[8:11], s27 offen lds
    s_waitcnt lgkmcnt(10)
    v_mfma_f32_32x32x16_bf16 v[176:191], v[132:135], a[64:67], v[176:191]
    ds_read_b64_tr_b16 v[156:157], v3 offset:2560
    ds_read_b64_tr_b16 v[158:159], v3 offset:2816
    s_waitcnt lgkmcnt(10)
    v_mfma_f32_32x32x16_bf16 v[160:175], v[136:139], a[68:71], v[160:175]
    buffer_load_dwordx4 a[148:151], v17, s[4:7], s38 offen offset:1024
    ds_read_b64_tr_b16 v[128:129], v3 offset:4096
    ds_read_b64_tr_b16 v[130:131], v3 offset:4352
    s_waitcnt lgkmcnt(10)
    v_mfma_f32_32x32x16_bf16 v[176:191], v[140:143], a[68:71], v[176:191]
    ds_read_b64_tr_b16 v[132:133], v3 offset:4608
    ds_read_b64_tr_b16 v[134:135], v3 offset:4864
    s_add_u32 m0, s25, 2048
    s_nop 0
    buffer_load_dwordx4 v6, s[8:11], s27 offen lds
    s_waitcnt lgkmcnt(10)
    v_mfma_f32_32x32x16_bf16 v[160:175], v[144:147], a[72:75], v[160:175]
    buffer_load_dwordx4 a[152:155], v17, s[4:7], s38 offen offset:2048
    ds_read_b64_tr_b16 v[136:137], v3 offset:6144
    ds_read_b64_tr_b16 v[138:139], v3 offset:6400
    s_waitcnt lgkmcnt(10)
    v_mfma_f32_32x32x16_bf16 v[176:191], v[148:151], a[72:75], v[176:191]
    ds_read_b64_tr_b16 v[140:141], v3 offset:6656
    ds_read_b64_tr_b16 v[142:143], v3 offset:6912
    s_waitcnt lgkmcnt(10)
    v_mfma_f32_32x32x16_bf16 v[160:175], v[152:155], a[76:79], v[160:175]
    buffer_load_dwordx4 a[156:159], v17, s[4:7], s38 offen offset:3072
    ds_read_b64_tr_b16 v[144:145], v3 offset:8192
    ds_read_b64_tr_b16 v[146:147], v3 offset:8448
    s_add_u32 m0, s25, 3072
    s_nop 0
    buffer_load_dwordx4 v7, s[8:11], s27 offen lds
    s_waitcnt lgkmcnt(10)
    v_mfma_f32_32x32x16_bf16 v[176:191], v[156:159], a[76:79], v[176:191]
    ds_read_b64_tr_b16 v[148:149], v3 offset:8704
    ds_read_b64_tr_b16 v[150:151], v3 offset:8960
    s_waitcnt lgkmcnt(10)
    v_mfma_f32_32x32x16_bf16 v[160:175], v[128:131], a[80:83], v[160:175]
    s_add_u32 s38, s38, 4096
    s_add_u32 s39, s39, 4096
    buffer_load_dwordx4 a[160:163], v17, s[4:7], s38 offen offset:0
    ds_read_b64_tr_b16 v[152:153], v3 offset:10240
    ds_read_b64_tr_b16 v[154:155], v3 offset:10496
    s_waitcnt lgkmcnt(10)
    v_mfma_f32_32x32x16_bf16 v[176:191], v[132:135], a[80:83], v[176:191]
    ds_read_b64_tr_b16 v[156:157], v3 offset:10752
    ds_read_b64_tr_b16 v[158:159], v3 offset:11008
    s_add_u32 m0, s25, 4096
    s_nop 0
    buffer_load_dwordx4 v8, s[8:11], s27 offen lds
    s_waitcnt lgkmcnt(10)
    s_waitcnt vmcnt(33)
    v_mfma_f32_32x32x16_bf16 v[160:175], v[136:139], a[84:87], v[160:175]
    buffer_load_dwordx4 a[164:167], v17, s[4:7], s38 offen offset:1024
    ds_read_b64_tr_b16 v[128:129], v3 offset:12288
    ds_read_b64_tr_b16 v[130:131], v3 offset:12544
    s_waitcnt lgkmcnt(10)
    v_mfma_f32_32x32x16_bf16 v[176:191], v[140:143], a[84:87], v[176:191]
    ds_read_b64_tr_b16 v[132:133], v3 offset:12800
    ds_read_b64_tr_b16 v[134:135], v3 offset:13056
    s_waitcnt lgkmcnt(10)
    s_waitcnt vmcnt(33)
    v_mfma_f32_32x32x16_bf16 v[160:175], v[144:147], a[88:91], v[160:175]
    buffer_load_dwordx4 a[168:171], v17, s[4:7], s38 offen offset:2048
    ds_read_b64_tr_b16 v[136:137], v3 offset:14336
    ds_read_b64_tr_b16 v[138:139], v3 offset:14592
    s_add_u32 m0, s25, 5120
    s_nop 0
    buffer_load_dwordx4 v9, s[8:11], s27 offen lds
    s_waitcnt lgkmcnt(10)
    v_mfma_f32_32x32x16_bf16 v[176:191], v[148:151], a[88:91], v[176:191]
    ds_read_b64_tr_b16 v[140:141], v3 offset:14848
    ds_read_b64_tr_b16 v[142:143], v3 offset:15104
    s_waitcnt lgkmcnt(10)
    s_waitcnt vmcnt(34)
    v_mfma_f32_32x32x16_bf16 v[160:175], v[152:155], a[92:95], v[160:175]
    buffer_load_dwordx4 a[172:175], v17, s[4:7], s38 offen offset:3072
    ds_read_b64_tr_b16 v[144:145], v3 offset:16384
    ds_read_b64_tr_b16 v[146:147], v3 offset:16640
    s_waitcnt lgkmcnt(10)
    v_mfma_f32_32x32x16_bf16 v[176:191], v[156:159], a[92:95], v[176:191]
    ds_read_b64_tr_b16 v[148:149], v3 offset:16896
    ds_read_b64_tr_b16 v[150:151], v3 offset:17152
    s_add_u32 m0, s25, 6144
    s_nop 0
    buffer_load_dwordx4 v10, s[8:11], s27 offen lds
    s_waitcnt lgkmcnt(10)
    s_waitcnt vmcnt(35)
    v_mfma_f32_32x32x16_bf16 v[160:175], v[128:131], a[96:99], v[160:175]
    s_add_u32 s38, s38, 4096
    s_add_u32 s39, s39, 4096
    buffer_load_dwordx4 a[176:179], v17, s[4:7], s38 offen offset:0
    ds_read_b64_tr_b16 v[152:153], v3 offset:18432
    ds_read_b64_tr_b16 v[154:155], v3 offset:18688
    s_waitcnt lgkmcnt(10)
    v_mfma_f32_32x32x16_bf16 v[176:191], v[132:135], a[96:99], v[176:191]
    ds_read_b64_tr_b16 v[156:157], v3 offset:18944
    ds_read_b64_tr_b16 v[158:159], v3 offset:19200
    s_waitcnt lgkmcnt(10)
    s_waitcnt vmcnt(35)
    v_mfma_f32_32x32x16_bf16 v[160:175], v[136:139], a[100:103], v[160:175]
    buffer_load_dwordx4 a[180:183], v17, s[4:7], s38 offen offset:1024
    ds_read_b64_tr_b16 v[128:129], v3 offset:20480
    ds_read_b64_tr_b16 v[130:131], v3 offset:20736
    s_add_u32 m0, s25, 7168
    s_nop 0
    buffer_load_dwordx4 v11, s[8:11], s27 offen lds
    s_waitcnt lgkmcnt(10)
    v_mfma_f32_32x32x16_bf16 v[176:191], v[140:143], a[100:103], v[176:191]
    ds_read_b64_tr_b16 v[132:133], v3 offset:20992
    ds_read_b64_tr_b16 v[134:135], v3 offset:21248
    s_waitcnt lgkmcnt(10)
    s_waitcnt vmcnt(36)
    v_mfma_f32_32x32x16_bf16 v[160:175], v[144:147], a[104:107], v[160:175]
    buffer_load_dwordx4 a[184:187], v17, s[4:7], s38 offen offset:2048
    s_waitcnt vmcnt(28)
    ds_add_u32 v19, v19
    s_add_u32 s57, s57, 0x98000
    ds_read_b64_tr_b16 v[136:137], v3 offset:22528
    ds_read_b64_tr_b16 v[138:139], v3 offset:22784
    s_waitcnt lgkmcnt(11)
    v_mfma_f32_32x32x16_bf16 v[176:191], v[148:151], a[104:107], v[176:191]
    ds_read_b64_tr_b16 v[140:141], v3 offset:23040
    ds_read_b64_tr_b16 v[142:143], v3 offset:23296
    s_add_u32 m0, s25, 8192
    s_nop 0
    buffer_load_dwordx4 v12, s[8:11], s27 offen lds
    s_waitcnt lgkmcnt(11)
    s_waitcnt vmcnt(28)
    v_mfma_f32_32x32x16_bf16 v[160:175], v[152:155], a[108:111], v[160:175]
    buffer_load_dwordx4 a[188:191], v17, s[4:7], s38 offen offset:3072
    ds_read_b64_tr_b16 v[144:145], v3 offset:24576
    ds_read_b64_tr_b16 v[146:147], v3 offset:24832
    s_waitcnt lgkmcnt(11)
    v_mfma_f32_32x32x16_bf16 v[176:191], v[156:159], a[108:111], v[176:191]
    ds_read_b64_tr_b16 v[148:149], v3 offset:25088
    ds_read_b64_tr_b16 v[150:151], v3 offset:25344
    s_waitcnt lgkmcnt(11)
    s_waitcnt vmcnt(28)
    v_mfma_f32_32x32x16_bf16 v[160:175], v[128:131], a[112:115], v[160:175]
    s_add_u32 s38, s38, 4096
    s_add_u32 s39, s39, 4096
    buffer_load_dwordx4 a[192:195], v17, s[4:7], s38 offen offset:0
    ds_read_b64_tr_b16 v[152:153], v3 offset:26624
    ds_read_b64_tr_b16 v[154:155], v3 offset:26880
    s_waitcnt lgkmcnt(11)
    v_mfma_f32_32x32x16_bf16 v[176:191], v[132:135], a[112:115], v[176:191]
    ds_read_b64_tr_b16 v[156:157], v3 offset:27136
    ds_read_b64_tr_b16 v[158:159], v3 offset:27392
    s_waitcnt lgkmcnt(10)
    s_waitcnt vmcnt(28)
    v_mfma_f32_32x32x16_bf16 v[160:175], v[136:139], a[116:119], v[160:175]
    buffer_load_dwordx4 a[196:199], v17, s[4:7], s38 offen offset:1024
    ds_read_b64_tr_b16 v[128:129], v3 offset:28672
    ds_read_b64_tr_b16 v[130:131], v3 offset:28928
    s_waitcnt lgkmcnt(10)
    v_mfma_f32_32x32x16_bf16 v[176:191], v[140:143], a[116:119], v[176:191]
    ds_read_b64_tr_b16 v[132:133], v3 offset:29184
    ds_read_b64_tr_b16 v[134:135], v3 offset:29440
    s_waitcnt lgkmcnt(10)
    s_waitcnt vmcnt(28)
    v_mfma_f32_32x32x16_bf16 v[160:175], v[144:147], a[120:123], v[160:175]
    buffer_load_dwordx4 a[200:203], v17, s[4:7], s38 offen offset:2048
    ds_read_b64_tr_b16 v[136:137], v3 offset:30720
    ds_read_b64_tr_b16 v[138:139], v3 offset:30976
    s_waitcnt lgkmcnt(10)
    v_mfma_f32_32x32x16_bf16 v[176:191], v[148:151], a[120:123], v[176:191]
    ds_read_b64_tr_b16 v[140:141], v3 offset:31232
    ds_read_b64_tr_b16 v[142:143], v3 offset:31488
    s_waitcnt lgkmcnt(10)
    s_waitcnt vmcnt(28)
    v_mfma_f32_32x32x16_bf16 v[160:175], v[152:155], a[124:127], v[160:175]
    buffer_load_dwordx4 a[204:207], v17, s[4:7], s38 offen offset:3072
    ds_read_b32 v18, v19
    ds_read_b64_tr_b16 v[144:145], v3 offset:32768
    ds_read_b64_tr_b16 v[146:147], v3 offset:33024
    s_waitcnt lgkmcnt(11)
    v_mfma_f32_32x32x16_bf16 v[176:191], v[156:159], a[124:127], v[176:191]
    ds_read_b64_tr_b16 v[148:149], v3 offset:33280
    ds_read_b64_tr_b16 v[150:151], v3 offset:33536
    s_waitcnt lgkmcnt(11)
    s_waitcnt vmcnt(28)
    v_mfma_f32_32x32x16_bf16 v[160:175], v[128:131], a[128:131], v[160:175]
    s_add_u32 s38, s38, 4096
    s_add_u32 s39, s39, 4096
    buffer_load_dwordx4 a[208:211], v17, s[4:7], s38 offen offset:0
    s_waitcnt lgkmcnt(4)
    v_readfirstlane_b32 s56, v18
    s_cmp_ge_u32 s56, s57
    s_cbranch_scc0 spin_g3_kernel_8
back_g3_kernel_9:
    s_add_u32 s18, s18, 36864
    s_cmp_eq_u32 s18, 147456
    s_cselect_b32 s18, 0, s18
    v_add_u32 v2, s18, v16
    s_cmp_ge_u32 s17, 1
    s_cselect_b32 s10, s16, 0
    s_add_u32 s25, s19, s23
    s_add_u32 s27, s20, 128
    s_add_u32 s19, s19, 36864
    s_cmp_eq_u32 s19, 147456
    s_cselect_b32 s19, 0, s19
    ds_read_b64_tr_b16 v[152:153], v3 offset:34816
    ds_read_b64_tr_b16 v[154:155], v3 offset:35072
    v_mfma_f32_32x32x16_bf16 v[176:191], v[132:135], a[128:131], v[176:191]
    ds_read_b64_tr_b16 v[156:157], v3 offset:35328
    ds_read_b64_tr_b16 v[158:159], v3 offset:35584
    s_add_u32 m0, s25, 0
    s_nop 0
    buffer_load_dwordx4 v4, s[8:11], s27 offen lds
    s_waitcnt vmcnt(29)
    v_mfma_f32_32x32x16_bf16 v[160:175], v[136:139], a[132:135], v[160:175]
    buffer_load_dwordx4 a[212:215], v17, s[4:7], s38 offen offset:1024
    ds_read_b64_tr_b16 v[128:129], v2 offset:0
    ds_read_b64_tr_b16 v[130:131], v2 offset:256
    v_mfma_f32_32x32x16_bf16 v[176:191], v[140:143], a[132:135], v[176:191]
    ds_read_b64_tr_b16 v[132:133], v2 offset:512
    ds_read_b64_tr_b16 v[134:135], v2 offset:768
    s_waitcnt lgkmcnt(10)
    s_waitcnt vmcnt(29)
    v_mfma_f32_32x32x16_bf16 v[160:175], v[144:147], a[136:139], v[160:175]
    buffer_load_dwordx4 a[216:219], v17, s[4:7], s38 offen offset:2048
    ds_read_b64_tr_b16 v[136:137], v2 offset:2048
    ds_read_b64_tr_b16 v[138:139], v2 offset:2304
    s_add_u32 m0, s25, 1024
    s_nop 0
    buffer_load_dwordx4 v5, s[8:11], s27 offen lds
    s_waitcnt lgkmcnt(10)
    v_mfma_f32_32x32x16_bf16 v[176:191], v[148:151], a[136:139], v[176:191]
    ds_read_b64_tr_b16 v[140:141], v2 offset:2560
    ds_read_b64_tr_b16 v[142:143], v2 offset:2816
    s_waitcnt lgkmcnt(10)
    s_waitcnt vmcnt(29)
    v_mfma_f32_32x32x16_bf16 v[160:175], v[152:155], a[140:143], v[160:175]
    buffer_load_dwordx4 a[220:223], v17, s[4:7], s38 offen offset:3072
    ds_read_b64_tr_b16 v[144:145], v2 offset:4096
    ds_read_b64_tr_b16 v[146:147], v2 offset:4352
    s_waitcnt lgkmcnt(10)
    v_mfma_f32_32x32x16_bf16 v[176:191], v[156:159], a[140:143], v[176:191]
    ds_read_b64_tr_b16 v[148:149], v2 offset:4608
    ds_read_b64_tr_b16 v[150:151], v2 offset:4864
    s_add_u32 m0, s25, 2048
    s_nop 0
    buffer_load_dwordx4 v6, s[8:11], s27 offen lds
    s_waitcnt lgkmcnt(10)
    s_waitcnt vmcnt(30)
    v_mfma_f32_32x32x16_bf16 v[160:175], v[128:131], a[144:147], v[160:175]
    s_add_u32 s38, s38, 4096
    s_add_u32 s39, s39, 4096
    buffer_load_dwordx4 a[224:227], v17, s[4:7], s38 offen offset:0
    ds_read_b64_tr_b16 v[152:153], v2 offset:6144
    ds_read_b64_tr_b16 v[154:155], v2 offset:6400
    s_waitcnt lgkmcnt(10)
    v_mfma_f32_32x32x16_bf16 v[176:191], v[132:135], a[144:147], v[176:191]
    ds_read_b64_tr_b16 v[156:157], v2 offset:6656
    ds_read_b64_tr_b16 v[158:159], v2 offset:6912
    s_waitcnt lgkmcnt(10)
    s_waitcnt vmcnt(29)
    v_mfma_f32_32x32x16_bf16 v[160:175], v[136:139], a[148:151], v[160:175]
    buffer_load_dwordx4 a[228:231], v17, s[4:7], s38 offen offset:1024
    ds_read_b64_tr_b16 v[128:129], v2 offset:8192
    ds_read_b64_tr_b16 v[130:131], v2 offset:8448
    s_add_u32 m0, s25, 3072
    s_nop 0
    buffer_load_dwordx4 v7, s[8:11], s27 offen lds
    s_waitcnt lgkmcnt(10)
    v_mfma_f32_32x32x16_bf16 v[176:191], v[140:143], a[148:151], v[176:191]
    ds_read_b64_tr_b16 v[132:133], v2 offset:8704
    ds_read_b64_tr_b16 v[134:135], v2 offset:8960
    s_waitcnt lgkmcnt(10)
    s_waitcnt vmcnt(29)
    v_mfma_f32_32x32x16_bf16 v[160:175], v[144:147], a[152:155], v[160:175]
    buffer_load_dwordx4 a[232:235], v17, s[4:7], s38 offen offset:2048
    ds_read_b64_tr_b16 v[136:137], v2 offset:10240
    ds_read_b64_tr_b16 v[138:139], v2 offset:10496
    s_waitcnt lgkmcnt(10)
    v_mfma_f32_32x32x16_bf16 v[176:191], v[148:151], a[152:155], v[176:191]
    ds_read_b64_tr_b16 v[140:141], v2 offset:10752
    ds_read_b64_tr_b16 v[142:143], v2 offset:11008
    s_add_u32 m0, s25, 4096
    s_nop 0
    buffer_load_dwordx4 v8, s[8:11], s27 offen lds
    s_waitcnt lgkmcnt(10)
    s_waitcnt vmcnt(30)
    v_mfma_f32_32x32x16_bf16 v[160:175], v[152:155], a[156:159], v[160:175]
    buffer_load_dwordx4 a[236:239], v17, s[4:7], s38 offen offset:3072
    ds_read_b64_tr_b16 v[144:145], v2 offset:12288
    ds_read_b64_tr_b16 v[146:147], v2 offset:12544
    s_waitcnt lgkmcnt(10)
    v_mfma_f32_32x32x16_bf16 v[176:191], v[156:159], a[156:159], v[176:191]
    ds_read_b64_tr_b16 v[148:149], v2 offset:12800
    ds_read_b64_tr_b16 v[150:151], v2 offset:13056
    s_waitcnt lgkmcnt(10)
    s_waitcnt vmcnt(29)
    v_mfma_f32_32x32x16_bf16 v[160:175], v[128:131], a[160:163], v[160:175]
    s_add_u32 s38, s38, 4096
    s_add_u32 s39, s39, 4096
    buffer_load_dwordx4 a[240:243], v17, s[4:7], s38 offen offset:0
    ds_read_b64_tr_b16 v[152:153], v2 offset:14336
    ds_read_b64_tr_b16 v[154:155], v2 offset:14592
    s_add_u32 m0, s25, 5120
    s_nop 0
    buffer_load_dwordx4 v9, s[8:11], s27 offen lds
    s_waitcnt lgkmcnt(10)
    v_mfma_f32_32x32x16_bf16 v[176:191], v[132:135], a[160:163], v[176:191]
    ds_read_b64_tr_b16 v[156:157], v2 offset:14848
    ds_read_b64_tr_b16 v[158:159], v2 offset:15104
    s_waitcnt lgkmcnt(10)
    s_waitcnt vmcnt(29)
    v_mfma_f32_32x32x16_bf16 v[160:175], v[136:139], a[164:167], v[160:175]
    buffer_load_dwordx4 a[244:247], v17, s[4:7], s38 offen offset:1024
    ds_read_b64_tr_b16 v[128:129], v2 offset:16384
    ds_read_b64_tr_b16 v[130:131], v2 offset:16640
    s_waitcnt lgkmcnt(10)
    v_mfma_f32_32x32x16_bf16 v[176:191], v[140:143], a[164:167], v[176:191]
    ds_read_b64_tr_b16 v[132:133], v2 offset:16896
    ds_read_b64_tr_b16 v[134:135], v2 offset:17152
    s_add_u32 m0, s25, 6144
    s_nop 0
    buffer_load_dwordx4 v10, s[8:11], s27 offen lds
    s_waitcnt lgkmcnt(10)
    s_waitcnt vmcnt(30)
    v_mfma_f32_32x32x16_bf16 v[160:175], v[144:147], a[168:171], v[160:175]
    buffer_load_dwordx4 a[248:251], v17, s[4:7], s38 offen offset:2048
    ds_read_b64_tr_b16 v[136:137], v2 offset:18432
    ds_read_b64_tr_b16 v[138:139], v2 offset:18688
    s_waitcnt lgkmcnt(10)
    v_mfma_f32_32x32x16_bf16 v[176:191], v[148:151], a[168:171], v[176:191]
    ds_read_b64_tr_b16 v[140:141], v2 offset:18944
    ds_read_b64_tr_b16 v[142:143], v2 offset:19200
    s_waitcnt lgkmcnt(10)
    s_waitcnt vmcnt(29)
    v_mfma_f32_32x32x16_bf16 v[160:175], v[152:155], a[172:175], v[160:175]
    buffer_load_dwordx4 a[252:255], v17, s[4:7], s38 offen offset:3072
    ds_read_b64_tr_b16 v[144:145], v2 offset:20480
    ds_read_b64_tr_b16 v[146:147], v2 offset:20736
    s_add_u32 m0, s25, 7168
    s_nop 0
    buffer_load_dwordx4 v11, s[8:11], s27 offen lds
    s_waitcnt lgkmcnt(10)
    v_mfma_f32_32x32x16_bf16 v[176:191], v[156:159], a[172:175], v[176:191]
    ds_read_b64_tr_b16 v[148:149], v2 offset:20992
    ds_read_b64_tr_b16 v[150:151], v2 offset:21248
    s_waitcnt lgkmcnt(10)
    s_waitcnt vmcnt(29)
    v_mfma_f32_32x32x16_bf16 v[160:175], v[128:131], a[176:179], v[160:175]
    s_add_u32 s38, s38, 4096
    s_add_u32 s39, s39, 4096
    buffer_load_dwordx4 v[224:227], v17, s[4:7], s38 offen offset:0
    s_waitcnt vmcnt(26)
    ds_add_u32 v19, v19
    s_add_u32 s57, s57, 0x98000
    ds_read_b64_tr_b16 v[152:153], v2 offset:22528
    ds_read_b64_tr_b16 v[154:155], v2 offset:22784
    s_waitcnt lgkmcnt(11)
    v_mfma_f32_32x32x16_bf16 v[176:191], v[132:135], a[176:179], v[176:191]
    ds_read_b64_tr_b16 v[156:157], v2 offset:23040
    ds_read_b64_tr_b16 v[158:159], v2 offset:23296
    s_add_u32 m0, s25, 8192
    s_nop 0
    buffer_load_dwordx4 v12, s[8:11], s27 offen lds
    s_waitcnt lgkmcnt(11)
    v_mfma_f32_32x32x16_bf16 v[160:175], v[136:139], a[180:183], v[160:175]
    buffer_load_dwordx4 v[228:231], v17, s[4:7], s38 offen offset:1024
    ds_read_b64_tr_b16 v[128:129], v2 offset:24576
    ds_read_b64_tr_b16 v[130:131], v2 offset:24832
    s_waitcnt lgkmcnt(11)
    v_mfma_f32_32x32x16_bf16 v[176:191], v[140:143], a[180:183], v[176:191]
    ds_read_b64_tr_b16 v[132:133], v2 offset:25088
    ds_read_b64_tr_b16 v[134:135], v2 offset:25344
    s_waitcnt lgkmcnt(11)
    v_mfma_f32_32x32x16_bf16 v[160:175], v[144:147], a[184:187], v[160:175]
    buffer_load_dwordx4 v[232:235], v17, s[4:7], s38 offen offset:2048
    ds_read_b64_tr_b16 v[136:137], v2 offset:26624
    ds_read_b64_tr_b16 v[138:139], v2 offset:26880
    s_waitcnt lgkmcnt(11)
    v_mfma_f32_32x32x16_bf16 v[176:191], v[148:151], a[184:187], v[176:191]
    ds_read_b64_tr_b16 v[140:141], v2 offset:27136
    ds_read_b64_tr_b16 v[142:143], v2 offset:27392
    s_waitcnt lgkmcnt(10)
    s_waitcnt vmcnt(28)
    v_mfma_f32_32x32x16_bf16 v[160:175], v[152:155], a[188:191], v[160:175]
    buffer_load_dwordx4 v[236:239], v17, s[4:7], s38 offen offset:3072
    ds_read_b64_tr_b16 v[144:145], v2 offset:28672
    ds_read_b64_tr_b16 v[146:147], v2 offset:28928
    s_waitcnt lgkmcnt(10)
    v_mfma_f32_32x32x16_bf16 v[176:191], v[156:159], a[188:191], v[176:191]
    ds_read_b64_tr_b16 v[148:149], v2 offset:29184
    ds_read_b64_tr_b16 v[150:151], v2 offset:29440
    s_waitcnt lgkmcnt(10)
    s_waitcnt vmcnt(28)
    v_mfma_f32_32x32x16_bf16 v[160:175], v[128:131], a[192:195], v[160:175]
    s_add_u32 s38, s38, 4096
    s_add_u32 s39, s39, 4096
    buffer_load_dwordx4 v[240:243], v17, s[4:7], s38 offen offset:0
    ds_read_b64_tr_b16 v[152:153], v2 offset:30720
    ds_read_b64_tr_b16 v[154:155], v2 offset:30976
    s_waitcnt lgkmcnt(10)
    v_mfma_f32_32x32x16_bf16 v[176:191], v[132:135], a[192:195], v[176:191]
    ds_read_b64_tr_b16 v[156:157], v2 offset:31232
    ds_read_b64_tr_b16 v[158:159], v2 offset:31488
    s_waitcnt lgkmcnt(10)
    s_waitcnt vmcnt(28)
    v_mfma_f32_32x32x16_bf16 v[160:175], v[136:139], a[196:199], v[160:175]
    buffer_load_dwordx4 v[244:247], v17, s[4:7], s38 offen offset:1024
    ds_read_b32 v18, v19
    ds_read_b64_tr_b16 v[128:129], v2 offset:32768
    ds_read_b64_tr_b16 v[130:131], v2 offset:33024
    s_waitcnt lgkmcnt(11)
    v_mfma_f32_32x32x16_bf16 v[176:191], v[140:143], a[196:199], v[176:191]
    ds_read_b64_tr_b16 v[132:133], v2 offset:33280
    ds_read_b64_tr_b16 v[134:135], v2 offset:33536
    s_waitcnt lgkmcnt(11)
    s_waitcnt vmcnt(28)
    v_mfma_f32_32x32x16_bf16 v[160:175], v[144:147], a[200:203], v[160:175]
    buffer_load_dwordx4 v[248:251], v17, s[4:7], s38 offen offset:2048
    s_waitcnt lgkmcnt(4)
    v_readfirstlane_b32 s56, v18
    s_cmp_ge_u32 s56, s57
    s_cbranch_scc0 spin_g3_kernel_10
back_g3_kernel_11:
    s_add_u32 s18, s18, 36864
    s_cmp_eq_u32 s18, 147456
    s_cselect_b32 s18, 0, s18
    v_add_u32 v3, s18, v16
    s_cmp_ge_u32 s17, 1
    s_cselect_b32 s10, s16, 0
    s_add_u32 s25, s19, s23
    s_add_u32 s27, s20, 331904
    s_add_u32 s19, s19, 36864
    s_cmp_eq_u32 s19, 147456
    s_cselect_b32 s19, 0, s19
    ds_read_b64_tr_b16 v[136:137], v2 offset:34816
    ds_read_b64_tr_b16 v[138:139], v2 offset:35072
    v_mfma_f32_32x32x16_bf16 v[176:191], v[148:151], a[200:203], v[176:191]
    ds_read_b64_tr_b16 v[140:141], v2 offset:35328
    ds_read_b64_tr_b16 v[142:143], v2 offset:35584
    s_add_u32 m0, s25, 0
    s_nop 0
    buffer_load_dwordx4 v4, s[8:11], s27 offen lds
    s_waitcnt vmcnt(29)
    v_mfma_f32_32x32x16_bf16 v[160:175], v[152:155], a[204:207], v[160:175]
    buffer_load_dwordx4 v[252:255], v17, s[4:7], s38 offen offset:3072
    ds_read_b64_tr_b16 v[144:145], v3 offset:0
    ds_read_b64_tr_b16 v[146:147], v3 offset:256
    v_mfma_f32_32x32x16_bf16 v[176:191], v[156:159], a[204:207], v[176:191]
    ds_read_b64_tr_b16 v[148:149], v3 offset:512
    ds_read_b64_tr_b16 v[150:151], v3 offset:768
    s_waitcnt lgkmcnt(10)
    s_waitcnt vmcnt(29)
    v_mfma_f32_32x32x16_bf16 v[160:175], v[128:131], a[208:211], v[160:175]
    ds_read_b64_tr_b16 v[152:153], v3 offset:2048
    ds_read_b64_tr_b16 v[154:155], v3 offset:2304
    s_add_u32 m0, s25, 1024
    s_nop 0
    buffer_load_dwordx4 v5, s[8:11], s27 offen lds
    s_waitcnt lgkmcnt(10)
    v_mfma_f32_32x32x16_bf16 v[176:191], v[132:135], a[208:211], v[176:191]
    ds_read_b64_tr_b16 v[156:157], v3 offset:2560
    ds_read_b64_tr_b16 v[158:159], v3 offset:2816
    s_waitcnt lgkmcnt(10)
    s_waitcnt vmcnt(28)
    v_mfma_f32_32x32x16_bf16 v[160:175], v[136:139], a[212:215], v[160:175]
    ds_read_b64_tr_b16 v[128:129], v3 offset:4096
    ds_read_b64_tr_b16 v[130:131], v3 offset:4352
    s_waitcnt lgkmcnt(10)
    v_mfma_f32_32x32x16_bf16 v[176:191], v[140:143], a[212:215], v[176:191]
    ds_read_b64_tr_b16 v[132:133], v3 offset:4608
    ds_read_b64_tr_b16 v[134:135], v3 offset:4864
    s_add_u32 m0, s25, 2048
    s_nop 0
    buffer_load_dwordx4 v6, s[8:11], s27 offen lds
    s_waitcnt lgkmcnt(10)
    s_waitcnt vmcnt(28)
    v_mfma_f32_32x32x16_bf16 v[160:175], v[144:147], a[216:219], v[160:175]
    ds_read_b64_tr_b16 v[136:137], v3 offset:6144
    ds_read_b64_tr_b16 v[138:139], v3 offset:6400
    s_waitcnt lgkmcnt(10)
    v_mfma_f32_32x32x16_bf16 v[176:191], v[148:151], a[216:219], v[176:191]
    ds_read_b64_tr_b16 v[140:141], v3 offset:6656
    ds_read_b64_tr_b16 v[142:143], v3 offset:6912
    s_waitcnt lgkmcnt(10)
    s_waitcnt vmcnt(26)
    v_mfma_f32_32x32x16_bf16 v[160:175], v[152:155], a[220:223], v[160:175]
    ds_read_b64_tr_b16 v[144:145], v3 offset:8192
    ds_read_b64_tr_b16 v[146:147], v3 offset:8448
    s_add_u32 m0, s25, 3072
    s_nop 0
    buffer_load_dwordx4 v7, s[8:11], s27 offen lds
    s_waitcnt lgkmcnt(10)
    v_mfma_f32_32x32x16_bf16 v[176:191], v[156:159], a[220:223], v[176:191]
    ds_read_b64_tr_b16 v[148:149], v3 offset:8704
    ds_read_b64_tr_b16 v[150:151], v3 offset:8960
    s_waitcnt lgkmcnt(10)
    s_waitcnt vmcnt(25)
    v_mfma_f32_32x32x16_bf16 v[160:175], v[128:131], a[224:227], v[160:175]
    ds_read_b64_tr_b16 v[152:153], v3 offset:10240
    ds_read_b64_tr_b16 v[154:155], v3 offset:10496
    s_waitcnt lgkmcnt(10)
    v_mfma_f32_32x32x16_bf16 v[176:191], v[132:135], a[224:227], v[176:191]
    ds_read_b64_tr_b16 v[156:157], v3 offset:10752
    ds_read_b64_tr_b16 v[158:159], v3 offset:11008
    s_add_u32 m0, s25, 4096
    s_nop 0
    buffer_load_dwordx4 v8, s[8:11], s27 offen lds
    s_waitcnt lgkmcnt(10)
    s_waitcnt vmcnt(25)
    v_mfma_f32_32x32x16_bf16 v[160:175], v[136:139], a[228:231], v[160:175]
    ds_read_b64_tr_b16 v[128:129], v3 offset:12288
    ds_read_b64_tr_b16 v[130:131], v3 offset:12544
    s_waitcnt lgkmcnt(10)
    v_mfma_f32_32x32x16_bf16 v[176:191], v[140:143], a[228:231], v[176:191]
    ds_read_b64_tr_b16 v[132:133], v3 offset:12800
    ds_read_b64_tr_b16 v[134:135], v3 offset:13056
    s_waitcnt lgkmcnt(10)
    s_waitcnt vmcnt(23)
    v_mfma_f32_32x32x16_bf16 v[160:175], v[144:147], a[232:235], v[160:175]
    ds_read_b64_tr_b16 v[136:137], v3 offset:14336
    ds_read_b64_tr_b16 v[138:139], v3 offset:14592
    s_add_u32 m0, s25, 5120
    s_nop 0
    buffer_load_dwordx4 v9, s[8:11], s27 offen lds
    s_waitcnt lgkmcnt(10)
    v_mfma_f32_32x32x16_bf16 v[176:191], v[148:151], a[232:235], v[176:191]
    ds_read_b64_tr_b16 v[140:141], v3 offset:14848
    ds_read_b64_tr_b16 v[142:143], v3 offset:15104
    s_waitcnt lgkmcnt(10)
    s_waitcnt vmcnt(22)
    v_mfma_f32_32x32x16_bf16 v[160:175], v[152:155], a[236:239], v[160:175]
    ds_read_b64_tr_b16 v[144:145], v3 offset:16384
    ds_read_b64_tr_b16 v[146:147], v3 offset:16640
    s_waitcnt lgkmcnt(10)
    v_mfma_f32_32x32x16_bf16 v[176:191], v[156:159], a[236:239], v[176:191]
    ds_read_b64_tr_b16 v[148:149], v3 offset:16896
    ds_read_b64_tr_b16 v[150:151], v3 offset:17152
    s_add_u32 m0, s25, 6144
    s_nop 0
    buffer_load_dwordx4 v10, s[8:11], s27 offen lds
    s_waitcnt lgkmcnt(10)
    s_waitcnt vmcnt(22)
    v_mfma_f32_32x32x16_bf16 v[160:175], v[128:131], a[240:243], v[160:175]
    ds_read_b64_tr_b16 v[152:153], v3 offset:18432
    ds_read_b64_tr_b16 v[154:155], v3 offset:18688
    s_waitcnt lgkmcnt(10)
    v_mfma_f32_32x32x16_bf16 v[176:191], v[132:135], a[240:243], v[176:191]
    ds_read_b64_tr_b16 v[156:157], v3 offset:18944
    ds_read_b64_tr_b16 v[158:159], v3 offset:19200
    s_waitcnt lgkmcnt(10)
    s_waitcnt vmcnt(20)
    v_mfma_f32_32x32x16_bf16 v[160:175], v[136:139], a[244:247], v[160:175]
    ds_read_b64_tr_b16 v[128:129], v3 offset:20480
    ds_read_b64_tr_b16 v[130:131], v3 offset:20736
    s_add_u32 m0, s25, 7168
    s_nop 0
    buffer_load_dwordx4 v11, s[8:11], s27 offen lds
    s_waitcnt lgkmcnt(10)
    v_mfma_f32_32x32x16_bf16 v[176:191], v[140:143], a[244:247], v[176:191]
    ds_read_b64_tr_b16 v[132:133], v3 offset:20992
    ds_read_b64_tr_b16 v[134:135], v3 offset:21248
    s_waitcnt lgkmcnt(10)
    s_waitcnt vmcnt(19)
    v_mfma_f32_32x32x16_bf16 v[160:175], v[144:147], a[248:251], v[160:175]
    s_waitcnt vmcnt(15)
    ds_add_u32 v19, v19
    s_add_u32 s57, s57, 0x98000
    ds_read_b64_tr_b16 v[136:137], v3 offset:22528
    ds_read_b64_tr_b16 v[138:139], v3 offset:22784
    s_waitcnt lgkmcnt(11)
    v_mfma_f32_32x32x16_bf16 v[176:191], v[148:151], a[248:251], v[176:191]
    ds_read_b64_tr_b16 v[140:141], v3 offset:23040
    ds_read_b64_tr_b16 v[142:143], v3 offset:23296
    s_add_u32 m0, s25, 8192
    s_nop 0
    buffer_load_dwordx4 v12, s[8:11], s27 offen lds
    s_waitcnt lgkmcnt(11)
    v_mfma_f32_32x32x16_bf16 v[160:175], v[152:155], a[252:255], v[160:175]
    ds_read_b64_tr_b16 v[144:145], v3 offset:24576
    ds_read_b64_tr_b16 v[146:147], v3 offset:24832
    s_waitcnt lgkmcnt(11)
    v_mfma_f32_32x32x16_bf16 v[176:191], v[156:159], a[252:255], v[176:191]
    ds_read_b64_tr_b16 v[148:149], v3 offset:25088
    ds_read_b64_tr_b16 v[150:151], v3 offset:25344
    s_waitcnt lgkmcnt(11)
    v_mfma_f32_32x32x16_bf16 v[160:175], v[128:131], v[224:227], v[160:175]
    ds_read_b64_tr_b16 v[152:153], v3 offset:26624
    ds_read_b64_tr_b16 v[154:155], v3 offset:26880
    s_waitcnt lgkmcnt(11)
    v_mfma_f32_32x32x16_bf16 v[176:191], v[132:135], v[224:227], v[176:191]
    ds_read_b64_tr_b16 v[156:157], v3 offset:27136
    ds_read_b64_tr_b16 v[158:159], v3 offset:27392
    s_waitcnt lgkmcnt(10)
    s_waitcnt vmcnt(15)
    v_mfma_f32_32x32x16_bf16 v[160:175], v[136:139], v[228:231], v[160:175]
    ds_read_b64_tr_b16 v[128:129], v3 offset:28672
    ds_read_b64_tr_b16 v[130:131], v3 offset:28928
    s_waitcnt lgkmcnt(10)
    v_mfma_f32_32x32x16_bf16 v[176:191], v[140:143], v[228:231], v[176:191]
    ds_read_b64_tr_b16 v[132:133], v3 offset:29184
    ds_read_b64_tr_b16 v[134:135], v3 offset:29440
    s_waitcnt lgkmcnt(10)
    s_waitcnt vmcnt(14)
    v_mfma_f32_32x32x16_bf16 v[160:175], v[144:147], v[232:235], v[160:175]
    ds_read_b64_tr_b16 v[136:137], v3 offset:30720
    ds_read_b64_tr_b16 v[138:139], v3 offset:30976
    s_waitcnt lgkmcnt(10)
    v_mfma_f32_32x32x16_bf16 v[176:191], v[148:151], v[232:235], v[176:191]
    ds_read_b64_tr_b16 v[140:141], v3 offset:31232
    ds_read_b64_tr_b16 v[142:143], v3 offset:31488
    s_waitcnt lgkmcnt(10)
    s_waitcnt vmcnt(13)
    v_mfma_f32_32x32x16_bf16 v[160:175], v[152:155], v[236:239], v[160:175]
    ds_read_b32 v18, v19
    ds_read_b64_tr_b16 v[144:145], v3 offset:32768
    ds_read_b64_tr_b16 v[146:147], v3 offset:33024
    s_waitcnt lgkmcnt(11)
    v_mfma_f32_32x32x16_bf16 v[176:191], v[156:159], v[236:239], v[176:191]
    ds_read_b64_tr_b16 v[148:149], v3 offset:33280
    ds_read_b64_tr_b16 v[150:151], v3 offset:33536
    s_waitcnt lgkmcnt(11)
    s_waitcnt vmcnt(12)
    v_mfma_f32_32x32x16_bf16 v[160:175], v[128:131], v[240:243], v[160:175]
    s_waitcnt lgkmcnt(4)
    v_readfirstlane_b32 s56, v18
    s_cmp_ge_u32 s56, s57
    s_cbranch_scc0 spin_g3_kernel_12
back_g3_kernel_13:
    s_add_u32 s18, s18, 36864
    s_cmp_eq_u32 s18, 147456
    s_cselect_b32 s18, 0, s18
    v_add_u32 v2, s18, v16
    s_cmp_ge_u32 s17, 1
    s_cselect_b32 s10, s16, 0
    s_add_u32 s25, s19, s23
    s_add_u32 s27, s20, 663680
    s_add_u32 s19, s19, 36864
    s_cmp_eq_u32 s19, 147456
    s_cselect_b32 s19, 0, s19
    ds_read_b64_tr_b16 v[152:153], v3 offset:34816
    ds_read_b64_tr_b16 v[154:155], v3 offset:35072
    v_mfma_f32_32x32x16_bf16 v[176:191], v[132:135], v[240:243], v[176:191]
    ds_read_b64_tr_b16 v[156:157], v3 offset:35328
    ds_read_b64_tr_b16 v[158:159], v3 offset:35584
    s_add_u32 m0, s25, 0
    s_nop 0
    buffer_load_dwordx4 v4, s[8:11], s27 offen lds
    s_waitcnt vmcnt(12)
    v_mfma_f32_32x32x16_bf16 v[160:175], v[136:139], v[244:247], v[160:175]
    ds_read_b64_tr_b16 v[128:129], v2 offset:0
    ds_read_b64_tr_b16 v[130:131], v2 offset:256
    v_mfma_f32_32x32x16_bf16 v[176:191], v[140:143], v[244:247], v[176:191]
    ds_read_b64_tr_b16 v[132:133], v2 offset:512
    ds_read_b64_tr_b16 v[134:135], v2 offset:768
    s_waitcnt lgkmcnt(10)
    s_waitcnt vmcnt(11)
    v_mfma_f32_32x32x16_bf16 v[160:175], v[144:147], v[248:251], v[160:175]
    ds_read_b64_tr_b16 v[136:137], v2 offset:2048
    ds_read_b64_tr_b16 v[138:139], v2 offset:2304
    s_add_u32 m0, s25, 1024
    s_nop 0
    buffer_load_dwordx4 v5, s[8:11], s27 offen lds
    s_waitcnt lgkmcnt(10)
    v_mfma_f32_32x32x16_bf16 v[176:191], v[148:151], v[248:251], v[176:191]
    ds_read_b64_tr_b16 v[140:141], v2 offset:2560
    ds_read_b64_tr_b16 v[142:143], v2 offset:2816
    s_waitcnt lgkmcnt(10)
    s_waitcnt vmcnt(10)
    v_mfma_f32_32x32x16_bf16 v[160:175], v[152:155], v[252:255], v[160:175]
    ds_read_b64_tr_b16 v[144:145], v2 offset:4096
    ds_read_b64_tr_b16 v[146:147], v2 offset:4352
    s_waitcnt lgkmcnt(10)
    v_mfma_f32_32x32x16_bf16 v[176:191], v[156:159], v[252:255], v[176:191]
    ds_read_b64_tr_b16 v[148:149], v2 offset:4608
    ds_read_b64_tr_b16 v[150:151], v2 offset:4864
    s_add_u32 m0, s25, 2048
    s_nop 0
    buffer_load_dwordx4 v6, s[8:11], s27 offen lds
    s_add_u32 s20, s20, 128
    s_cmp_eq_u32 s17, 0
    s_cbranch_scc1 drain0y_g3_kernel_5
    s_sub_u32 s17, s17, 1
loopy_g3_kernel_4:
    s_waitcnt lgkmcnt(10)
    v_mfma_f32_32x32x16_bf16 v[192:207], v[128:131], a[0:3], 0
    ds_read_b64_tr_b16 v[152:153], v2 offset:6144
    ds_read_b64_tr_b16 v[154:155], v2 offset:6400
    s_waitcnt lgkmcnt(10)
    v_mfma_f32_32x32x16_bf16 v[208:223], v[132:135], a[0:3], 0
    ds_read_b64_tr_b16 v[156:157], v2 offset:6656
    ds_read_b64_tr_b16 v[158:159], v2 offset:6912
    s_waitcnt lgkmcnt(10)
    v_mfma_f32_32x32x16_bf16 v[192:207], v[136:139], a[4:7], v[192:207]
    ds_read_b64_tr_b16 v[128:129], v2 offset:8192
    ds_read_b64_tr_b16 v[130:131], v2 offset:8448
    s_add_u32 m0, s25, 3072
    s_nop 0
    buffer_load_dwordx4 v7, s[8:11], s27 offen lds
    v_cvt_pk_bf16_f32 v36, v160, v161
    v_cvt_pk_bf16_f32 v37, v162, v163
    s_waitcnt lgkmcnt(10)
    v_mfma_f32_32x32x16_bf16 v[208:223], v[140:143], a[4:7], v[208:223]
    ds_read_b64_tr_b16 v[132:133], v2 offset:8704
    ds_read_b64_tr_b16 v[134:135], v2 offset:8960
    v_cvt_pk_bf16_f32 v38, v164, v165
    s_waitcnt lgkmcnt(10)
    v_mfma_f32_32x32x16_bf16 v[192:207], v[144:147], a[8:11], v[192:207]
    ds_read_b64_tr_b16 v[136:137], v2 offset:10240
    ds_read_b64_tr_b16 v[138:139], v2 offset:10496
    v_cvt_pk_bf16_f32 v39, v166, v167
    s_waitcnt lgkmcnt(10)
    v_mfma_f32_32x32x16_bf16 v[208:223], v[148:151], a[8:11], v[208:223]
    ds_read_b64_tr_b16 v[140:141], v2 offset:10752
    ds_read_b64_tr_b16 v[142:143], v2 offset:11008
    s_add_u32 m0, s25, 4096
    s_nop 0
    buffer_load_dwordx4 v8, s[8:11], s27 offen lds
    buffer_store_dwordx4 v[36:39], v13, s[12:15], s21 offen offset:0 sc1
    s_waitcnt lgkmcnt(10)
    v_mfma_f32_32x32x16_bf16 v[192:207], v[152:155], a[12:15], v[192:207]
    ds_read_b64_tr_b16 v[144:145], v2 offset:12288
    ds_read_b64_tr_b16 v[146:147], v2 offset:12544
    s_waitcnt lgkmcnt(10)
    v_mfma_f32_32x32x16_bf16 v[208:223], v[156:159], a[12:15], v[208:223]
    ds_read_b64_tr_b16 v[148:149], v2 offset:12800
    ds_read_b64_tr_b16 v[150:151], v2 offset:13056
    v_cvt_pk_bf16_f32 v40, v168, v169
    s_waitcnt lgkmcnt(10)
    v_mfma_f32_32x32x16_bf16 v[192:207], v[128:131], a[16:19], v[192:207]
    ds_read_b64_tr_b16 v[152:153], v2 offset:14336
    ds_read_b64_tr_b16 v[154:155], v2 offset:14592
    s_add_u32 m0, s25, 5120
    s_nop 0
    buffer_load_dwordx4 v9, s[8:11], s27 offen lds
    v_cvt_pk_bf16_f32 v41, v170, v171
    s_waitcnt lgkmcnt(10)
    v_mfma_f32_32x32x16_bf16 v[208:223], v[132:135], a[16:19], v[208:223]
    ds_read_b64_tr_b16 v[156:157], v2 offset:14848
    ds_read_b64_tr_b16 v[158:159], v2 offset:15104
    v_cvt_pk_bf16_f32 v42, v172, v173
    s_waitcnt lgkmcnt(10)
    v_mfma_f32_32x32x16_bf16 v[192:207], v[136:139], a[20:23], v[192:207]
    ds_read_b64_tr_b16 v[128:129], v2 offset:16384
    ds_read_b64_tr_b16 v[130:131], v2 offset:16640
    v_cvt_pk_bf16_f32 v43, v174, v175
    buffer_store_dwordx4 v[40:43], v13, s[12:15], s21 offen offset:1024 sc1
    s_waitcnt lgkmcnt(10)
    v_mfma_f32_32x32x16_bf16 v[208:223], v[140:143], a[20:23], v[208:223]
    ds_read_b64_tr_b16 v[132:133], v2 offset:16896
    ds_read_b64_tr_b16 v[134:135], v2 offset:17152
    s_add_u32 m0, s25, 6144
    s_nop 0
    buffer_load_dwordx4 v10, s[8:11], s27 offen lds
    s_waitcnt lgkmcnt(10)
    v_mfma_f32_32x32x16_bf16 v[192:207], v[144:147], a[24:27], v[192:207]
    ds_read_b64_tr_b16 v[136:137], v2 offset:18432
    ds_read_b64_tr_b16 v[138:139], v2 offset:18688
    v_cvt_pk_bf16_f32 v44, v176, v177
    s_waitcnt lgkmcnt(10)
    v_mfma_f32_32x32x16_bf16 v[208:223], v[148:151], a[24:27], v[208:223]
    ds_read_b64_tr_b16 v[140:141], v2 offset:18944
    ds_read_b64_tr_b16 v[142:143], v2 offset:19200
    v_cvt_pk_bf16_f32 v45, v178, v179
    s_waitcnt lgkmcnt(10)
    v_mfma_f32_32x32x16_bf16 v[192:207], v[152:155], a[28:31], v[192:207]
    ds_read_b64_tr_b16 v[144:145], v2 offset:20480
    ds_read_b64_tr_b16 v[146:147], v2 offset:20736
    s_add_u32 m0, s25, 7168
    s_nop 0
    buffer_load_dwordx4 v11, s[8:11], s27 offen lds
    v_cvt_pk_bf16_f32 v46, v180, v181
    s_waitcnt lgkmcnt(10)
    v_mfma_f32_32x32x16_bf16 v[208:223], v[156:159], a[28:31], v[208:223]
    ds_read_b64_tr_b16 v[148:149], v2 offset:20992
    ds_read_b64_tr_b16 v[150:151], v2 offset:21248
    v_cvt_pk_bf16_f32 v47, v182, v183
    s_waitcnt lgkmcnt(10)
    v_mfma_f32_32x32x16_bf16 v[192:207], v[128:131], a[32:35], v[192:207]
    s_waitcnt vmcnt(10)
    ds_add_u32 v19, v19
    s_add_u32 s57, s57, 0x98000
    ds_read_b64_tr_b16 v[152:153], v2 offset:22528
    ds_read_b64_tr_b16 v[154:155], v2 offset:22784
    buffer_store_dwordx4 v[44:47], v13, s[12:15], s21 offen offset:2048 sc1
    s_waitcnt lgkmcnt(11)
    v_mfma_f32_32x32x16_bf16 v[208:223], v[132:135], a[32:35], v[208:223]
    ds_read_b64_tr_b16 v[156:157], v2 offset:23040
    ds_read_b64_tr_b16 v[158:159], v2 offset:23296
    s_add_u32 m0, s25, 8192
    s_nop 0
    buffer_load_dwordx4 v12, s[8:11], s27 offen lds
    s_waitcnt lgkmcnt(11)
    v_mfma_f32_32x32x16_bf16 v[192:207], v[136:139], a[36:39], v[192:207]
    ds_read_b64_tr_b16 v[128:129], v2 offset:24576
    ds_read_b64_tr_b16 v[130:131], v2 offset:24832
    v_cvt_pk_bf16_f32 v48, v184, v185
    s_waitcnt lgkmcnt(11)
    v_mfma_f32_32x32x16_bf16 v[208:223], v[140:143], a[36:39], v[208:223]
    ds_read_b64_tr_b16 v[132:133], v2 offset:25088
    ds_read_b64_tr_b16 v[134:135], v2 offset:25344
    v_cvt_pk_bf16_f32 v49, v186, v187
    v_cvt_pk_bf16_f32 v50, v188, v189
    s_waitcnt lgkmcnt(11)
    v_mfma_f32_32x32x16_bf16 v[192:207], v[144:147], a[40:43], v[192:207]
    ds_read_b64_tr_b16 v[136:137], v2 offset:26624
    ds_read_b64_tr_b16 v[138:139], v2 offset:26880
    v_cvt_pk_bf16_f32 v51, v190, v191
    s_waitcnt lgkmcnt(11)
    v_mfma_f32_32x32x16_bf16 v[208:223], v[148:151], a[40:43], v[208:223]
    ds_read_b64_tr_b16 v[140:141], v2 offset:27136
    ds_read_b64_tr_b16 v[142:143], v2 offset:27392
    buffer_store_dwordx4 v[48:51], v13, s[12:15], s21 offen offset:3072 sc1
    s_waitcnt lgkmcnt(10)
    v_mfma_f32_32x32x16_bf16 v[192:207], v[152:155], a[44:47], v[192:207]
    ds_read_b64_tr_b16 v[144:145], v2 offset:28672
    ds_read_b64_tr_b16 v[146:147], v2 offset:28928
    s_waitcnt lgkmcnt(10)
    v_mfma_f32_32x32x16_bf16 v[208:223], v[156:159], a[44:47], v[208:223]
    ds_read_b64_tr_b16 v[148:149], v2 offset:29184
    ds_read_b64_tr_b16 v[150:151], v2 offset:29440
    s_add_u32 s21, s21, 4096
    s_waitcnt lgkmcnt(10)
    v_mfma_f32_32x32x16_bf16 v[192:207], v[128:131], a[48:51], v[192:207]
    ds_read_b64_tr_b16 v[152:153], v2 offset:30720
    ds_read_b64_tr_b16 v[154:155], v2 offset:30976
    s_add_u32 s22, s22, 4096
    s_waitcnt lgkmcnt(10)
    v_mfma_f32_32x32x16_bf16 v[208:223], v[132:135], a[48:51], v[208:223]
    ds_read_b64_tr_b16 v[156:157], v2 offset:31232
    ds_read_b64_tr_b16 v[158:159], v2 offset:31488
    s_waitcnt lgkmcnt(10)
    v_mfma_f32_32x32x16_bf16 v[192:207], v[136:139], a[52:55], v[192:207]
    ds_read_b32 v18, v19
    ds_read_b64_tr_b16 v[128:129], v2 offset:32768
    ds_read_b64_tr_b16 v[130:131], v2 offset:33024
    s_waitcnt lgkmcnt(11)
    v_mfma_f32_32x32x16_bf16 v[208:223], v[140:143], a[52:55], v[208:223]
    ds_read_b64_tr_b16 v[132:133], v2 offset:33280
    ds_read_b64_tr_b16 v[134:135], v2 offset:33536
    s_waitcnt lgkmcnt(11)
    v_mfma_f32_32x32x16_bf16 v[192:207], v[144:147], a[56:59], v[192:207]
    s_waitcnt lgkmcnt(4)
    v_readfirstlane_b32 s56, v18
    s_cmp_ge_u32 s56, s57
    s_cbranch_scc0 spin_g3_kernel_14
back_g3_kernel_15:
    s_add_u32 s18, s18, 36864
    s_cmp_eq_u32 s18, 147456
    s_cselect_b32 s18, 0, s18
    v_add_u32 v3, s18, v16
    s_cmp_ge_u32 s17, 0
    s_cselect_b32 s10, s16, 0
    s_add_u32 s25, s19, s23
    s_add_u32 s27, s20, 995328
    s_add_u32 s19, s19, 36864
    s_cmp_eq_u32 s19, 147456
    s_cselect_b32 s19, 0, s19
    ds_read_b64_tr_b16 v[136:137], v2 offset:34816
    ds_read_b64_tr_b16 v[138:139], v2 offset:35072
    v_mfma_f32_32x32x16_bf16 v[208:223], v[148:151], a[56:59], v[208:223]
    ds_read_b64_tr_b16 v[140:141], v2 offset:35328
    ds_read_b64_tr_b16 v[142:143], v2 offset:35584
    s_add_u32 m0, s25, 0
    s_nop 0
    buffer_load_dwordx4 v4, s[8:11], s27 offen lds
    v_mfma_f32_32x32x16_bf16 v[192:207], v[152:155], a[60:63], v[192:207]
    ds_read_b64_tr_b16 v[144:145], v3 offset:0
    ds_read_b64_tr_b16 v[146:147], v3 offset:256
    v_mfma_f32_32x32x16_bf16 v[208:223], v[156:159], a[60:63], v[208:223]
    ds_read_b64_tr_b16 v[148:149], v3 offset:512
    ds_read_b64_tr_b16 v[150:151], v3 offset:768
    s_waitcnt lgkmcnt(10)
    v_mfma_f32_32x32x16_bf16 v[192:207], v[128:131], a[64:67], v[192:207]
    ds_read_b64_tr_b16 v[152:153], v3 offset:2048
    ds_read_b64_tr_b16 v[154:155], v3 offset:2304
    s_add_u32 m0, s25, 1024
    s_nop 0
    buffer_load_dwordx4 v5, s[8:11], s27 offen lds
    s_waitcnt lgkmcnt(10)
    v_mfma_f32_32x32x16_bf16 v[208:223], v[132:135], a[64:67], v[208:223]
    ds_read_b64_tr_b16 v[156:157], v3 offset:2560
    ds_read_b64_tr_b16 v[158:159], v3 offset:2816
    s_waitcnt lgkmcnt(10)
    v_mfma_f32_32x32x16_bf16 v[192:207], v[136:139], a[68:71], v[192:207]
    ds_read_b64_tr_b16 v[128:129], v3 offset:4096
    ds_read_b64_tr_b16 v[130:131], v3 offset:4352
    s_waitcnt lgkmcnt(10)
    v_mfma_f32_32x32x16_bf16 v[208:223], v[140:143], a[68:71], v[208:223]
    ds_read_b64_tr_b16 v[132:133], v3 offset:4608
    ds_read_b64_tr_b16 v[134:135], v3 offset:4864
    s_add_u32 m0, s25, 2048
    s_nop 0
    buffer_load_dwordx4 v6, s[8:11], s27 offen lds
    s_waitcnt lgkmcnt(10)
    v_mfma_f32_32x32x16_bf16 v[192:207], v[144:147], a[72:75], v[192:207]
    ds_read_b64_tr_b16 v[136:137], v3 offset:6144
    ds_read_b64_tr_b16 v[138:139], v3 offset:6400
    s_waitcnt lgkmcnt(10)
    v_mfma_f32_32x32x16_bf16 v[208:223], v[148:151], a[72:75], v[208:223]
    ds_read_b64_tr_b16 v[140:141], v3 offset:6656
    ds_read_b64_tr_b16 v[142:143], v3 offset:6912
    s_waitcnt lgkmcnt(10)
    v_mfma_f32_32x32x16_bf16 v[192:207], v[152:155], a[76:79], v[192:207]
    ds_read_b64_tr_b16 v[144:145], v3 offset:8192
    ds_read_b64_tr_b16 v[146:147], v3 offset:8448
    s_add_u32 m0, s25, 3072
    s_nop 0
    buffer_load_dwordx4 v7, s[8:11], s27 offen lds
    s_waitcnt lgkmcnt(10)
    v_mfma_f32_32x32x16_bf16 v[208:223], v[156:159], a[76:79], v[208:223]
    ds_read_b64_tr_b16 v[148:149], v3 offset:8704
    ds_read_b64_tr_b16 v[150:151], v3 offset:8960
    s_waitcnt lgkmcnt(10)
    v_mfma_f32_32x32x16_bf16 v[192:207], v[128:131], a[80:83], v[192:207]
    ds_read_b64_tr_b16 v[152:153], v3 offset:10240
    ds_read_b64_tr_b16 v[154:155], v3 offset:10496
    s_waitcnt lgkmcnt(10)
    v_mfma_f32_32x32x16_bf16 v[208:223], v[132:135], a[80:83], v[208:223]
    ds_read_b64_tr_b16 v[156:157], v3 offset:10752
    ds_read_b64_tr_b16 v[158:159], v3 offset:11008
    s_add_u32 m0, s25, 4096
    s_nop 0
    buffer_load_dwordx4 v8, s[8:11], s27 offen lds
    s_waitcnt lgkmcnt(10)
    v_mfma_f32_32x32x16_bf16 v[192:207], v[136:139], a[84:87], v[192:207]
    ds_read_b64_tr_b16 v[128:129], v3 offset:12288
    ds_read_b64_tr_b16 v[130:131], v3 offset:12544
    s_waitcnt lgkmcnt(10)
    v_mfma_f32_32x32x16_bf16 v[208:223], v[140:143], a[84:87], v[208:223]
    ds_read_b64_tr_b16 v[132:133], v3 offset:12800
    ds_read_b64_tr_b16 v[134:135], v3 offset:13056
    s_waitcnt lgkmcnt(10)
    v_mfma_f32_32x32x16_bf16 v[192:207], v[144:147], a[88:91], v[192:207]
    ds_read_b64_tr_b16 v[136:137], v3 offset:14336
    ds_read_b64_tr_b16 v[138:139], v3 offset:14592
    s_add_u32 m0, s25, 5120
    s_nop 0
    buffer_load_dwordx4 v9, s[8:11], s27 offen lds
    s_waitcnt lgkmcnt(10)
    v_mfma_f32_32x32x16_bf16 v[208:223], v[148:151], a[88:91], v[208:223]
    ds_read_b64_tr_b16 v[140:141], v3 offset:14848
    ds_read_b64_tr_b16 v[142:143], v3 offset:15104
    s_waitcnt lgkmcnt(10)
    v_mfma_f32_32x32x16_bf16 v[192:207], v[152:155], a[92:95], v[192:207]
    ds_read_b64_tr_b16 v[144:145], v3 offset:16384
    ds_read_b64_tr_b16 v[146:147], v3 offset:16640
    s_waitcnt lgkmcnt(10)
    v_mfma_f32_32x32x16_bf16 v[208:223], v[156:159], a[92:95], v[208:223]
    ds_read_b64_tr_b16 v[148:149], v3 offset:16896
    ds_read_b64_tr_b16 v[150:151], v3 offset:17152
    s_add_u32 m0, s25, 6144
    s_nop 0
    buffer_load_dwordx4 v10, s[8:11], s27 offen lds
    s_waitcnt lgkmcnt(10)
    v_mfma_f32_32x32x16_bf16 v[192:207], v[128:131], a[96:99], v[192:207]
    ds_read_b64_tr_b16 v[152:153], v3 offset:18432
    ds_read_b64_tr_b16 v[154:155], v3 offset:18688
    s_waitcnt lgkmcnt(10)
    v_mfma_f32_32x32x16_bf16 v[208:223], v[132:135], a[96:99], v[208:223]
    ds_read_b64_tr_b16 v[156:157], v3 offset:18944
    ds_read_b64_tr_b16 v[158:159], v3 offset:19200
    s_waitcnt lgkmcnt(10)
    v_mfma_f32_32x32x16_bf16 v[192:207], v[136:139], a[100:103], v[192:207]
    ds_read_b64_tr_b16 v[128:129], v3 offset:20480
    ds_read_b64_tr_b16 v[130:131], v3 offset:20736
    s_add_u32 m0, s25, 7168
    s_nop 0
    buffer_load_dwordx4 v11, s[8:11], s27 offen lds
    s_waitcnt lgkmcnt(10)
    v_mfma_f32_32x32x16_bf16 v[208:223], v[140:143], a[100:103], v[208:223]
    ds_read_b64_tr_b16 v[132:133], v3 offset:20992
    ds_read_b64_tr_b16 v[134:135], v3 offset:21248
    s_waitcnt lgkmcnt(10)
    v_mfma_f32_32x32x16_bf16 v[192:207], v[144:147], a[104:107], v[192:207]
    s_waitcnt vmcnt(9)
    ds_add_u32 v19, v19
    s_add_u32 s57, s57, 0x98000
    ds_read_b64_tr_b16 v[136:137], v3 offset:22528
    ds_read_b64_tr_b16 v[138:139], v3 offset:22784
    s_waitcnt lgkmcnt(11)
    v_mfma_f32_32x32x16_bf16 v[208:223], v[148:151], a[104:107], v[208:223]
    ds_read_b64_tr_b16 v[140:141], v3 offset:23040
    ds_read_b64_tr_b16 v[142:143], v3 offset:23296
    s_add_u32 m0, s25, 8192
    s_nop 0
    buffer_load_dwordx4 v12, s[8:11], s27 offen lds
    s_waitcnt lgkmcnt(11)
    v_mfma_f32_32x32x16_bf16 v[192:207], v[152:155], a[108:111], v[192:207]
    ds_read_b64_tr_b16 v[144:145], v3 offset:24576
    ds_read_b64_tr_b16 v[146:147], v3 offset:24832
    s_waitcnt lgkmcnt(11)
    v_mfma_f32_32x32x16_bf16 v[208:223], v[156:159], a[108:111], v[208:223]
    ds_read_b64_tr_b16 v[148:149], v3 offset:25088
    ds_read_b64_tr_b16 v[150:151], v3 offset:25344
    s_waitcnt lgkmcnt(11)
    v_mfma_f32_32x32x16_bf16 v[192:207], v[128:131], a[112:115], v[192:207]
    ds_read_b64_tr_b16 v[152:153], v3 offset:26624
    ds_read_b64_tr_b16 v[154:155], v3 offset:26880
    s_waitcnt lgkmcnt(11)
    v_mfma_f32_32x32x16_bf16 v[208:223], v[132:135], a[112:115], v[208:223]
    ds_read_b64_tr_b16 v[156:157], v3 offset:27136
    ds_read_b64_tr_b16 v[158:159], v3 offset:27392
    s_waitcnt lgkmcnt(10)
    v_mfma_f32_32x32x16_bf16 v[192:207], v[136:139], a[116:119], v[192:207]
    ds_read_b64_tr_b16 v[128:129], v3 offset:28672
    ds_read_b64_tr_b16 v[130:131], v3 offset:28928
    s_waitcnt lgkmcnt(10)
    v_mfma_f32_32x32x16_bf16 v[208:223], v[140:143], a[116:119], v[208:223]
    ds_read_b64_tr_b16 v[132:133], v3 offset:29184
    ds_read_b64_tr_b16 v[134:135], v3 offset:29440
    s_waitcnt lgkmcnt(10)
    v_mfma_f32_32x32x16_bf16 v[192:207], v[144:147], a[120:123], v[192:207]
    ds_read_b64_tr_b16 v[136:137], v3 offset:30720
    ds_read_b64_tr_b16 v[138:139], v3 offset:30976
    s_waitcnt lgkmcnt(10)
    v_mfma_f32_32x32x16_bf16 v[208:223], v[148:151], a[120:123], v[208:223]
    ds_read_b64_tr_b16 v[140:141], v3 offset:31232
    ds_read_b64_tr_b16 v[142:143], v3 offset:31488
    s_waitcnt lgkmcnt(10)
    v_mfma_f32_32x32x16_bf16 v[192:207], v[152:155], a[124:127], v[192:207]
    ds_read_b32 v18, v19
    ds_read_b64_tr_b16 v[144:145], v3 offset:32768
    ds_read_b64_tr_b16 v[146:147], v3 offset:33024
    s_waitcnt lgkmcnt(11)
    v_mfma_f32_32x32x16_bf16 v[208:223], v[156:159], a[124:127], v[208:223]
    ds_read_b64_tr_b16 v[148:149], v3 offset:33280
    ds_read_b64_tr_b16 v[150:151], v3 offset:33536
    s_waitcnt lgkmcnt(11)
    v_mfma_f32_32x32x16_bf16 v[192:207], v[128:131], a[128:131], v[192:207]
    s_waitcnt lgkmcnt(4)
    v_readfirstlane_b32 s56, v18
    s_cmp_ge_u32 s56, s57
    s_cbranch_scc0 spin_g3_kernel_16
back_g3_kernel_17:
    s_add_u32 s18, s18, 36864
    s_cmp_eq_u32 s18, 147456
    s_cselect_b32 s18, 0, s18
    v_add_u32 v2, s18, v16
    s_cmp_ge_u32 s17, 1
    s_cselect_b32 s10, s16, 0
    s_add_u32 s25, s19, s23
    s_add_u32 s27, s20, 128
    s_add_u32 s19, s19, 36864
    s_cmp_eq_u32 s19, 147456
    s_cselect_b32 s19, 0, s19
    ds_read_b64_tr_b16 v[152:153], v3 offset:34816
    ds_read_b64_tr_b16 v[154:155], v3 offset:35072
    v_mfma_f32_32x32x16_bf16 v[208:223], v[132:135], a[128:131], v[208:223]
    ds_read_b64_tr_b16 v[156:157], v3 offset:35328
    ds_read_b64_tr_b16 v[158:159], v3 offset:35584
    s_add_u32 m0, s25, 0
    s_nop 0
    buffer_load_dwordx4 v4, s[8:11], s27 offen lds
    v_mfma_f32_32x32x16_bf16 v[192:207], v[136:139], a[132:135], v[192:207]
    ds_read_b64_tr_b16 v[128:129], v2 offset:0
    ds_read_b64_tr_b16 v[130:131], v2 offset:256
    v_mfma_f32_32x32x16_bf16 v[208:223], v[140:143], a[132:135], v[208:223]
    ds_read_b64_tr_b16 v[132:133], v2 offset:512
    ds_read_b64_tr_b16 v[134:135], v2 offset:768
    s_waitcnt lgkmcnt(10)
    v_mfma_f32_32x32x16_bf16 v[192:207], v[144:147], a[136:139], v[192:207]
    ds_read_b64_tr_b16 v[136:137], v2 offset:2048
    ds_read_b64_tr_b16 v[138:139], v2 offset:2304
    s_add_u32 m0, s25, 1024
    s_nop 0
    buffer_load_dwordx4 v5, s[8:11], s27 offen lds
    s_waitcnt lgkmcnt(10)
    v_mfma_f32_32x32x16_bf16 v[208:223], v[148:151], a[136:139], v[208:223]
    ds_read_b64_tr_b16 v[140:141], v2 offset:2560
    ds_read_b64_tr_b16 v[142:143], v2 offset:2816
    s_waitcnt lgkmcnt(10)
    v_mfma_f32_32x32x16_bf16 v[192:207], v[152:155], a[140:143], v[192:207]
    ds_read_b64_tr_b16 v[144:145], v2 offset:4096
    ds_read_b64_tr_b16 v[146:147], v2 offset:4352
    s_waitcnt lgkmcnt(10)
    v_mfma_f32_32x32x16_bf16 v[208:223], v[156:159], a[140:143], v[208:223]
    ds_read_b64_tr_b16 v[148:149], v2 offset:4608
    ds_read_b64_tr_b16 v[150:151], v2 offset:4864
    s_add_u32 m0, s25, 2048
    s_nop 0
    buffer_load_dwordx4 v6, s[8:11], s27 offen lds
    s_waitcnt lgkmcnt(10)
    v_mfma_f32_32x32x16_bf16 v[192:207], v[128:131], a[144:147], v[192:207]
    ds_read_b64_tr_b16 v[152:153], v2 offset:6144
    ds_read_b64_tr_b16 v[154:155], v2 offset:6400
    s_waitcnt lgkmcnt(10)
    v_mfma_f32_32x32x16_bf16 v[208:223], v[132:135], a[144:147], v[208:223]
    ds_read_b64_tr_b16 v[156:157], v2 offset:6656
    ds_read_b64_tr_b16 v[158:159], v2 offset:6912
    s_waitcnt lgkmcnt(10)
    v_mfma_f32_32x32x16_bf16 v[192:207], v[136:139], a[148:151], v[192:207]
    ds_read_b64_tr_b16 v[128:129], v2 offset:8192
    ds_read_b64_tr_b16 v[130:131], v2 offset:8448
    s_add_u32 m0, s25, 3072
    s_nop 0
    buffer_load_dwordx4 v7, s[8:11], s27 offen lds
    s_waitcnt lgkmcnt(10)
    v_mfma_f32_32x32x16_bf16 v[208:223], v[140:143], a[148:151], v[208:223]
    ds_read_b64_tr_b16 v[132:133], v2 offset:8704
    ds_read_b64_tr_b16 v[134:135], v2 offset:8960
    s_waitcnt lgkmcnt(10)
    v_mfma_f32_32x32x16_bf16 v[192:207], v[144:147], a[152:155], v[192:207]
    ds_read_b64_tr_b16 v[136:137], v2 offset:10240
    ds_read_b64_tr_b16 v[138:139], v2 offset:10496
    s_waitcnt lgkmcnt(10)
    v_mfma_f32_32x32x16_bf16 v[208:223], v[148:151], a[152:155], v[208:223]
    ds_read_b64_tr_b16 v[140:141], v2 offset:10752
    ds_read_b64_tr_b16 v[142:143], v2 offset:11008
    s_add_u32 m0, s25, 4096
    s_nop 0
    buffer_load_dwordx4 v8, s[8:11], s27 offen lds
    s_waitcnt lgkmcnt(10)
    v_mfma_f32_32x32x16_bf16 v[192:207], v[152:155], a[156:159], v[192:207]
    ds_read_b64_tr_b16 v[144:145], v2 offset:12288
    ds_read_b64_tr_b16 v[146:147], v2 offset:12544
    s_waitcnt lgkmcnt(10)
    v_mfma_f32_32x32x16_bf16 v[208:223], v[156:159], a[156:159], v[208:223]
    ds_read_b64_tr_b16 v[148:149], v2 offset:12800
    ds_read_b64_tr_b16 v[150:151], v2 offset:13056
    s_waitcnt lgkmcnt(10)
    v_mfma_f32_32x32x16_bf16 v[192:207], v[128:131], a[160:163], v[192:207]
    ds_read_b64_tr_b16 v[152:153], v2 offset:14336
    ds_read_b64_tr_b16 v[154:155], v2 offset:14592
    s_add_u32 m0, s25, 5120
    s_nop 0
    buffer_load_dwordx4 v9, s[8:11], s27 offen lds
    s_waitcnt lgkmcnt(10)
    v_mfma_f32_32x32x16_bf16 v[208:223], v[132:135], a[160:163], v[208:223]
    ds_read_b64_tr_b16 v[156:157], v2 offset:14848
    ds_read_b64_tr_b16 v[158:159], v2 offset:15104
    s_waitcnt lgkmcnt(10)
    v_mfma_f32_32x32x16_bf16 v[192:207], v[136:139], a[164:167], v[192:207]
    ds_read_b64_tr_b16 v[128:129], v2 offset:16384
    ds_read_b64_tr_b16 v[130:131], v2 offset:16640
    s_waitcnt lgkmcnt(10)
    v_mfma_f32_32x32x16_bf16 v[208:223], v[140:143], a[164:167], v[208:223]
    ds_read_b64_tr_b16 v[132:133], v2 offset:16896
    ds_read_b64_tr_b16 v[134:135], v2 offset:17152
    s_add_u32 m0, s25, 6144
    s_nop 0
    buffer_load_dwordx4 v10, s[8:11], s27 offen lds
    s_waitcnt lgkmcnt(10)
    v_mfma_f32_32x32x16_bf16 v[192:207], v[144:147], a[168:171], v[192:207]
    ds_read_b64_tr_b16 v[136:137], v2 offset:18432
    ds_read_b64_tr_b16 v[138:139], v2 offset:18688
    s_waitcnt lgkmcnt(10)
    v_mfma_f32_32x32x16_bf16 v[208:223], v[148:151], a[168:171], v[208:223]
    ds_read_b64_tr_b16 v[140:141], v2 offset:18944
    ds_read_b64_tr_b16 v[142:143], v2 offset:19200
    s_waitcnt lgkmcnt(10)
    v_mfma_f32_32x32x16_bf16 v[192:207], v[152:155], a[172:175], v[192:207]
    ds_read_b64_tr_b16 v[144:145], v2 offset:20480
    ds_read_b64_tr_b16 v[146:147], v2 offset:20736
    s_add_u32 m0, s25, 7168
    s_nop 0
    buffer_load_dwordx4 v11, s[8:11], s27 offen lds
    s_waitcnt lgkmcnt(10)
    v_mfma_f32_32x32x16_bf16 v[208:223], v[156:159], a[172:175], v[208:223]
    ds_read_b64_tr_b16 v[148:149], v2 offset:20992
    ds_read_b64_tr_b16 v[150:151], v2 offset:21248
    s_waitcnt lgkmcnt(10)
    v_mfma_f32_32x32x16_bf16 v[192:207], v[128:131], a[176:179], v[192:207]
    s_waitcnt vmcnt(8)
    ds_add_u32 v19, v19
    s_add_u32 s57, s57, 0x98000
    ds_read_b64_tr_b16 v[152:153], v2 offset:22528
    ds_read_b64_tr_b16 v[154:155], v2 offset:22784
    s_waitcnt lgkmcnt(11)
    v_mfma_f32_32x32x16_bf16 v[208:223], v[132:135], a[176:179], v[208:223]
    ds_read_b64_tr_b16 v[156:157], v2 offset:23040
    ds_read_b64_tr_b16 v[158:159], v2 offset:23296
    s_add_u32 m0, s25, 8192
    s_nop 0
    buffer_load_dwordx4 v12, s[8:11], s27 offen lds
    s_waitcnt lgkmcnt(11)
    v_mfma_f32_32x32x16_bf16 v[192:207], v[136:139], a[180:183], v[192:207]
    ds_read_b64_tr_b16 v[128:129], v2 offset:24576
    ds_read_b64_tr_b16 v[130:131], v2 offset:24832
    s_waitcnt lgkmcnt(11)
    v_mfma_f32_32x32x16_bf16 v[208:223], v[140:143], a[180:183], v[208:223]
    ds_read_b64_tr_b16 v[132:133], v2 offset:25088
    ds_read_b64_tr_b16 v[134:135], v2 offset:25344
    s_waitcnt lgkmcnt(11)
    v_mfma_f32_32x32x16_bf16 v[192:207], v[144:147], a[184:187], v[192:207]
    ds_read_b64_tr_b16 v[136:137], v2 offset:26624
    ds_read_b64_tr_b16 v[138:139], v2 offset:26880
    s_waitcnt lgkmcnt(11)
    v_mfma_f32_32x32x16_bf16 v[208:223], v[148:151], a[184:187], v[208:223]
    ds_read_b64_tr_b16 v[140:141], v2 offset:27136
    ds_read_b64_tr_b16 v[142:143], v2 offset:27392
    s_waitcnt lgkmcnt(10)
    v_mfma_f32_32x32x16_bf16 v[192:207], v[152:155], a[188:191], v[192:207]
    ds_read_b64_tr_b16 v[144:145], v2 offset:28672
    ds_read_b64_tr_b16 v[146:147], v2 offset:28928
    s_waitcnt lgkmcnt(10)
    v_mfma_f32_32x32x16_bf16 v[208:223], v[156:159], a[188:191], v[208:223]
    ds_read_b64_tr_b16 v[148:149], v2 offset:29184
    ds_read_b64_tr_b16 v[150:151], v2 offset:29440
    s_waitcnt lgkmcnt(10)
    v_mfma_f32_32x32x16_bf16 v[192:207], v[128:131], a[192:195], v[192:207]
    ds_read_b64_tr_b16 v[152:153], v2 offset:30720
    ds_read_b64_tr_b16 v[154:155], v2 offset:30976
    s_waitcnt lgkmcnt(10)
    v_mfma_f32_32x32x16_bf16 v[208:223], v[132:135], a[192:195], v[208:223]
    ds_read_b64_tr_b16 v[156:157], v2 offset:31232
    ds_read_b64_tr_b16 v[158:159], v2 offset:31488
    s_waitcnt lgkmcnt(10)
    v_mfma_f32_32x32x16_bf16 v[192:207], v[136:139], a[196:199], v[192:207]
    ds_read_b32 v18, v19
    ds_read_b64_tr_b16 v[128:129], v2 offset:32768
    ds_read_b64_tr_b16 v[130:131], v2 offset:33024
    s_waitcnt lgkmcnt(11)
    v_mfma_f32_32x32x16_bf16 v[208:223], v[140:143], a[196:199], v[208:223]
    ds_read_b64_tr_b16 v[132:133], v2 offset:33280
    ds_read_b64_tr_b16 v[134:135], v2 offset:33536
    s_waitcnt lgkmcnt(11)
    v_mfma_f32_32x32x16_bf16 v[192:207], v[144:147], a[200:203], v[192:207]
    s_waitcnt lgkmcnt(4)
    v_readfirstlane_b32 s56, v18
    s_cmp_ge_u32 s56, s57
    s_cbranch_scc0 spin_g3_kernel_18
back_g3_kernel_19:
    s_add_u32 s18, s18, 36864
    s_cmp_eq_u32 s18, 147456
    s_cselect_b32 s18, 0, s18
    v_add_u32 v3, s18, v16
    s_cmp_ge_u32 s17, 1
    s_cselect_b32 s10, s16, 0
    s_add_u32 s25, s19, s23
    s_add_u32 s27, s20, 331904
    s_add_u32 s19, s19, 36864
    s_cmp_eq_u32 s19, 147456
    s_cselect_b32 s19, 0, s19
    ds_read_b64_tr_b16 v[136:137], v2 offset:34816
    ds_read_b64_tr_b16 v[138:139], v2 offset:35072
    v_mfma_f32_32x32x16_bf16 v[208:223], v[148:151], a[200:203], v[208:223]
    ds_read_b64_tr_b16 v[140:141], v2 offset:35328
    ds_read_b64_tr_b16 v[142:143], v2 offset:35584
    s_add_u32 m0, s25, 0
    s_nop 0
    buffer_load_dwordx4 v4, s[8:11], s27 offen lds
    v_mfma_f32_32x32x16_bf16 v[192:207], v[152:155], a[204:207], v[192:207]
    ds_read_b64_tr_b16 v[144:145], v3 offset:0
    ds_read_b64_tr_b16 v[146:147], v3 offset:256
    v_mfma_f32_32x32x16_bf16 v[208:223], v[156:159], a[204:207], v[208:223]
    ds_read_b64_tr_b16 v[148:149], v3 offset:512
    ds_read_b64_tr_b16 v[150:151], v3 offset:768
    s_waitcnt lgkmcnt(10)
    v_mfma_f32_32x32x16_bf16 v[192:207], v[128:131], a[208:211], v[192:207]
    ds_read_b64_tr_b16 v[152:153], v3 offset:2048
    ds_read_b64_tr_b16 v[154:155], v3 offset:2304
    s_add_u32 m0, s25, 1024
    s_nop 0
    buffer_load_dwordx4 v5, s[8:11], s27 offen lds
    s_waitcnt lgkmcnt(10)
    v_mfma_f32_32x32x16_bf16 v[208:223], v[132:135], a[208:211], v[208:223]
    ds_read_b64_tr_b16 v[156:157], v3 offset:2560
    ds_read_b64_tr_b16 v[158:159], v3 offset:2816
    s_waitcnt lgkmcnt(10)
    v_mfma_f32_32x32x16_bf16 v[192:207], v[136:139], a[212:215], v[192:207]
    ds_read_b64_tr_b16 v[128:129], v3 offset:4096
    ds_read_b64_tr_b16 v[130:131], v3 offset:4352
    s_waitcnt lgkmcnt(10)
    v_mfma_f32_32x32x16_bf16 v[208:223], v[140:143], a[212:215], v[208:223]
    ds_read_b64_tr_b16 v[132:133], v3 offset:4608
    ds_read_b64_tr_b16 v[134:135], v3 offset:4864
    s_add_u32 m0, s25, 2048
    s_nop 0
    buffer_load_dwordx4 v6, s[8:11], s27 offen lds
    s_waitcnt lgkmcnt(10)
    v_mfma_f32_32x32x16_bf16 v[192:207], v[144:147], a[216:219], v[192:207]
    ds_read_b64_tr_b16 v[136:137], v3 offset:6144
    ds_read_b64_tr_b16 v[138:139], v3 offset:6400
    s_waitcnt lgkmcnt(10)
    v_mfma_f32_32x32x16_bf16 v[208:223], v[148:151], a[216:219], v[208:223]
    ds_read_b64_tr_b16 v[140:141], v3 offset:6656
    ds_read_b64_tr_b16 v[142:143], v3 offset:6912
    s_waitcnt lgkmcnt(10)
    v_mfma_f32_32x32x16_bf16 v[192:207], v[152:155], a[220:223], v[192:207]
    ds_read_b64_tr_b16 v[144:145], v3 offset:8192
    ds_read_b64_tr_b16 v[146:147], v3 offset:8448
    s_add_u32 m0, s25, 3072
    s_nop 0
    buffer_load_dwordx4 v7, s[8:11], s27 offen lds
    s_waitcnt lgkmcnt(10)
    v_mfma_f32_32x32x16_bf16 v[208:223], v[156:159], a[220:223], v[208:223]
    ds_read_b64_tr_b16 v[148:149], v3 offset:8704
    ds_read_b64_tr_b16 v[150:151], v3 offset:8960
    s_waitcnt lgkmcnt(10)
    v_mfma_f32_32x32x16_bf16 v[192:207], v[128:131], a[224:227], v[192:207]
    ds_read_b64_tr_b16 v[152:153], v3 offset:10240
    ds_read_b64_tr_b16 v[154:155], v3 offset:10496
    s_waitcnt lgkmcnt(10)
    v_mfma_f32_32x32x16_bf16 v[208:223], v[132:135], a[224:227], v[208:223]
    ds_read_b64_tr_b16 v[156:157], v3 offset:10752
    ds_read_b64_tr_b16 v[158:159], v3 offset:11008
    s_add_u32 m0, s25, 4096
    s_nop 0
    buffer_load_dwordx4 v8, s[8:11], s27 offen lds
    s_waitcnt lgkmcnt(10)
    v_mfma_f32_32x32x16_bf16 v[192:207], v[136:139], a[228:231], v[192:207]
    ds_read_b64_tr_b16 v[128:129], v3 offset:12288
    ds_read_b64_tr_b16 v[130:131], v3 offset:12544
    s_waitcnt lgkmcnt(10)
    v_mfma_f32_32x32x16_bf16 v[208:223], v[140:143], a[228:231], v[208:223]
    ds_read_b64_tr_b16 v[132:133], v3 offset:12800
    ds_read_b64_tr_b16 v[134:135], v3 offset:13056
    s_waitcnt lgkmcnt(10)
    v_mfma_f32_32x32x16_bf16 v[192:207], v[144:147], a[232:235], v[192:207]
    ds_read_b64_tr_b16 v[136:137], v3 offset:14336
    ds_read_b64_tr_b16 v[138:139], v3 offset:14592
    s_add_u32 m0, s25, 5120
    s_nop 0
    buffer_load_dwordx4 v9, s[8:11], s27 offen lds
    s_waitcnt lgkmcnt(10)
    v_mfma_f32_32x32x16_bf16 v[208:223], v[148:151], a[232:235], v[208:223]
    ds_read_b64_tr_b16 v[140:141], v3 offset:14848
    ds_read_b64_tr_b16 v[142:143], v3 offset:15104
    s_waitcnt lgkmcnt(10)
    v_mfma_f32_32x32x16_bf16 v[192:207], v[152:155], a[236:239], v[192:207]
    ds_read_b64_tr_b16 v[144:145], v3 offset:16384
    ds_read_b64_tr_b16 v[146:147], v3 offset:16640
    s_waitcnt lgkmcnt(10)
    v_mfma_f32_32x32x16_bf16 v[208:223], v[156:159], a[236:239], v[208:223]
    ds_read_b64_tr_b16 v[148:149], v3 offset:16896
    ds_read_b64_tr_b16 v[150:151], v3 offset:17152
    s_add_u32 m0, s25, 6144
    s_nop 0
    buffer_load_dwordx4 v10, s[8:11], s27 offen lds
    s_waitcnt lgkmcnt(10)
    v_mfma_f32_32x32x16_bf16 v[192:207], v[128:131], a[240:243], v[192:207]
    ds_read_b64_tr_b16 v[152:153], v3 offset:18432
    ds_read_b64_tr_b16 v[154:155], v3 offset:18688
    s_waitcnt lgkmcnt(10)
    v_mfma_f32_32x32x16_bf16 v[208:223], v[132:135], a[240:243], v[208:223]
    ds_read_b64_tr_b16 v[156:157], v3 offset:18944
    ds_read_b64_tr_b16 v[158:159], v3 offset:19200
    s_waitcnt lgkmcnt(10)
    v_mfma_f32_32x32x16_bf16 v[192:207], v[136:139], a[244:247], v[192:207]
    ds_read_b64_tr_b16 v[128:129], v3 offset:20480
    ds_read_b64_tr_b16 v[130:131], v3 offset:20736
    s_add_u32 m0, s25, 7168
    s_nop 0
    buffer_load_dwordx4 v11, s[8:11], s27 offen lds
    s_waitcnt lgkmcnt(10)
    v_mfma_f32_32x32x16_bf16 v[208:223], v[140:143], a[244:247], v[208:223]
    ds_read_b64_tr_b16 v[132:133], v3 offset:20992
    ds_read_b64_tr_b16 v[134:135], v3 offset:21248
    s_waitcnt lgkmcnt(10)
    v_mfma_f32_32x32x16_bf16 v[192:207], v[144:147], a[248:251], v[192:207]
    s_waitcnt vmcnt(8)
    ds_add_u32 v19, v19
    s_add_u32 s57, s57, 0x98000
    ds_read_b64_tr_b16 v[136:137], v3 offset:22528
    ds_read_b64_tr_b16 v[138:139], v3 offset:22784
    s_waitcnt lgkmcnt(11)
    v_mfma_f32_32x32x16_bf16 v[208:223], v[148:151], a[248:251], v[208:223]
    ds_read_b64_tr_b16 v[140:141], v3 offset:23040
    ds_read_b64_tr_b16 v[142:143], v3 offset:23296
    s_add_u32 m0, s25, 8192
    s_nop 0
    buffer_load_dwordx4 v12, s[8:11], s27 offen lds
    s_waitcnt lgkmcnt(11)
    v_mfma_f32_32x32x16_bf16 v[192:207], v[152:155], a[252:255], v[192:207]
    ds_read_b64_tr_b16 v[144:145], v3 offset:24576
    ds_read_b64_tr_b16 v[146:147], v3 offset:24832
    s_waitcnt lgkmcnt(11)
    v_mfma_f32_32x32x16_bf16 v[208:223], v[156:159], a[252:255], v[208:223]
    ds_read_b64_tr_b16 v[148:149], v3 offset:25088
    ds_read_b64_tr_b16 v[150:151], v3 offset:25344
    s_waitcnt lgkmcnt(11)
    v_mfma_f32_32x32x16_bf16 v[192:207], v[128:131], v[224:227], v[192:207]
    ds_read_b64_tr_b16 v[152:153], v3 offset:26624
    ds_read_b64_tr_b16 v[154:155], v3 offset:26880
    s_waitcnt lgkmcnt(11)
    v_mfma_f32_32x32x16_bf16 v[208:223], v[132:135], v[224:227], v[208:223]
    ds_read_b64_tr_b16 v[156:157], v3 offset:27136
    ds_read_b64_tr_b16 v[158:159], v3 offset:27392
    s_waitcnt lgkmcnt(10)
    v_mfma_f32_32x32x16_bf16 v[192:207], v[136:139], v[228:231], v[192:207]
    ds_read_b64_tr_b16 v[128:129], v3 offset:28672
    ds_read_b64_tr_b16 v[130:131], v3 offset:28928
    s_waitcnt lgkmcnt(10)
    v_mfma_f32_32x32x16_bf16 v[208:223], v[140:143], v[228:231], v[208:223]
    ds_read_b64_tr_b16 v[132:133], v3 offset:29184
    ds_read_b64_tr_b16 v[134:135], v3 offset:29440
    s_waitcnt lgkmcnt(10)
    v_mfma_f32_32x32x16_bf16 v[192:207], v[144:147], v[232:235], v[192:207]
    ds_read_b64_tr_b16 v[136:137], v3 offset:30720
    ds_read_b64_tr_b16 v[138:139], v3 offset:30976
    s_waitcnt lgkmcnt(10)
    v_mfma_f32_32x32x16_bf16 v[208:223], v[148:151], v[232:235], v[208:223]
    ds_read_b64_tr_b16 v[140:141], v3 offset:31232
    ds_read_b64_tr_b16 v[142:143], v3 offset:31488
    s_waitcnt lgkmcnt(10)
    v_mfma_f32_32x32x16_bf16 v[192:207], v[152:155], v[236:239], v[192:207]
    ds_read_b32 v18, v19
    ds_read_b64_tr_b16 v[144:145], v3 offset:32768
    ds_read_b64_tr_b16 v[146:147], v3 offset:33024
    s_waitcnt lgkmcnt(11)
    v_mfma_f32_32x32x16_bf16 v[208:223], v[156:159], v[236:239], v[208:223]
    ds_read_b64_tr_b16 v[148:149], v3 offset:33280
    ds_read_b64_tr_b16 v[150:151], v3 offset:33536
    s_waitcnt lgkmcnt(11)
    v_mfma_f32_32x32x16_bf16 v[192:207], v[128:131], v[240:243], v[192:207]
    s_waitcnt lgkmcnt(4)
    v_readfirstlane_b32 s56, v18
    s_cmp_ge_u32 s56, s57
    s_cbranch_scc0 spin_g3_kernel_20
back_g3_kernel_21:
    s_add_u32 s18, s18, 36864
    s_cmp_eq_u32 s18, 147456
    s_cselect_b32 s18, 0, s18
    v_add_u32 v2, s18, v16
    s_cmp_ge_u32 s17, 1
    s_cselect_b32 s10, s16, 0
    s_add_u32 s25, s19, s23
    s_add_u32 s27, s20, 663680
    s_add_u32 s19, s19, 36864
    s_cmp_eq_u32 s19, 147456
    s_cselect_b32 s19, 0, s19
    ds_read_b64_tr_b16 v[152:153], v3 offset:34816
    ds_read_b64_tr_b16 v[154:155], v3 offset:35072
    v_mfma_f32_32x32x16_bf16 v[208:223], v[132:135], v[240:243], v[208:223]
    ds_read_b64_tr_b16 v[156:157], v3 offset:35328
    ds_read_b64_tr_b16 v[158:159], v3 offset:35584
    s_add_u32 m0, s25, 0
    s_nop 0
    buffer_load_dwordx4 v4, s[8:11], s27 offen lds
    v_mfma_f32_32x32x16_bf16 v[192:207], v[136:139], v[244:247], v[192:207]
    ds_read_b64_tr_b16 v[128:129], v2 offset:0
    ds_read_b64_tr_b16 v[130:131], v2 offset:256
    v_mfma_f32_32x32x16_bf16 v[208:223], v[140:143], v[244:247], v[208:223]
    ds_read_b64_tr_b16 v[132:133], v2 offset:512
    ds_read_b64_tr_b16 v[134:135], v2 offset:768
    s_waitcnt lgkmcnt(10)
    v_mfma_f32_32x32x16_bf16 v[192:207], v[144:147], v[248:251], v[192:207]
    ds_read_b64_tr_b16 v[136:137], v2 offset:2048
    ds_read_b64_tr_b16 v[138:139], v2 offset:2304
    s_add_u32 m0, s25, 1024
    s_nop 0
    buffer_load_dwordx4 v5, s[8:11], s27 offen lds
    s_waitcnt lgkmcnt(10)
    v_mfma_f32_32x32x16_bf16 v[208:223], v[148:151], v[248:251], v[208:223]
    ds_read_b64_tr_b16 v[140:141], v2 offset:2560
    ds_read_b64_tr_b16 v[142:143], v2 offset:2816
    s_waitcnt lgkmcnt(10)
    v_mfma_f32_32x32x16_bf16 v[192:207], v[152:155], v[252:255], v[192:207]
    ds_read_b64_tr_b16 v[144:145], v2 offset:4096
    ds_read_b64_tr_b16 v[146:147], v2 offset:4352
    s_waitcnt lgkmcnt(10)
    v_mfma_f32_32x32x16_bf16 v[208:223], v[156:159], v[252:255], v[208:223]
    ds_read_b64_tr_b16 v[148:149], v2 offset:4608
    ds_read_b64_tr_b16 v[150:151], v2 offset:4864
    s_add_u32 m0, s25, 2048
    s_nop 0
    buffer_load_dwordx4 v6, s[8:11], s27 offen lds
    s_add_u32 s20, s20, 128
    s_cmp_eq_u32 s17, 0
    s_cbranch_scc1 drain1y_g3_kernel_6
    s_sub_u32 s17, s17, 1
    s_waitcnt lgkmcnt(10)
    v_mfma_f32_32x32x16_bf16 v[160:175], v[128:131], a[0:3], 0
    ds_read_b64_tr_b16 v[152:153], v2 offset:6144
    ds_read_b64_tr_b16 v[154:155], v2 offset:6400
    s_waitcnt lgkmcnt(10)
    v_mfma_f32_32x32x16_bf16 v[176:191], v[132:135], a[0:3], 0
    ds_read_b64_tr_b16 v[156:157], v2 offset:6656
    ds_read_b64_tr_b16 v[158:159], v2 offset:6912
    s_waitcnt lgkmcnt(10)
    v_mfma_f32_32x32x16_bf16 v[160:175], v[136:139], a[4:7], v[160:175]
    ds_read_b64_tr_b16 v[128:129], v2 offset:8192
    ds_read_b64_tr_b16 v[130:131], v2 offset:8448
    s_add_u32 m0, s25, 3072
    s_nop 0
    buffer_load_dwordx4 v7, s[8:11], s27 offen lds
    v_cvt_pk_bf16_f32 v36, v192, v193
    v_cvt_pk_bf16_f32 v37, v194, v195
    s_waitcnt lgkmcnt(10)
    v_mfma_f32_32x32x16_bf16 v[176:191], v[140:143], a[4:7], v[176:191]
    ds_read_b64_tr_b16 v[132:133], v2 offset:8704
    ds_read_b64_tr_b16 v[134:135], v2 offset:8960
    v_cvt_pk_bf16_f32 v38, v196, v197
    s_waitcnt lgkmcnt(10)
    v_mfma_f32_32x32x16_bf16 v[160:175], v[144:147], a[8:11], v[160:175]
    ds_read_b64_tr_b16 v[136:137], v2 offset:10240
    ds_read_b64_tr_b16 v[138:139], v2 offset:10496
    v_cvt_pk_bf16_f32 v39, v198, v199
    s_waitcnt lgkmcnt(10)
    v_mfma_f32_32x32x16_bf16 v[176:191], v[148:151], a[8:11], v[176:191]
    ds_read_b64_tr_b16 v[140:141], v2 offset:10752
    ds_read_b64_tr_b16 v[142:143], v2 offset:11008
    s_add_u32 m0, s25, 4096
    s_nop 0
    buffer_load_dwordx4 v8, s[8:11], s27 offen lds
    buffer_store_dwordx4 v[36:39], v13, s[12:15], s21 offen offset:0 sc1
    s_waitcnt lgkmcnt(10)
    v_mfma_f32_32x32x16_bf16 v[160:175], v[152:155], a[12:15], v[160:175]
    ds_read_b64_tr_b16 v[144:145], v2 offset:12288
    ds_read_b64_tr_b16 v[146:147], v2 offset:12544
    s_waitcnt lgkmcnt(10)
    v_mfma_f32_32x32x16_bf16 v[176:191], v[156:159], a[12:15], v[176:191]
    ds_read_b64_tr_b16 v[148:149], v2 offset:12800
    ds_read_b64_tr_b16 v[150:151], v2 offset:13056
    v_cvt_pk_bf16_f32 v40, v200, v201
    s_waitcnt lgkmcnt(10)
    v_mfma_f32_32x32x16_bf16 v[160:175], v[128:131], a[16:19], v[160:175]
    ds_read_b64_tr_b16 v[152:153], v2 offset:14336
    ds_read_b64_tr_b16 v[154:155], v2 offset:14592
    s_add_u32 m0, s25, 5120
    s_nop 0
    buffer_load_dwordx4 v9, s[8:11], s27 offen lds
    v_cvt_pk_bf16_f32 v41, v202, v203
    s_waitcnt lgkmcnt(10)
    v_mfma_f32_32x32x16_bf16 v[176:191], v[132:135], a[16:19], v[176:191]
    ds_read_b64_tr_b16 v[156:157], v2 offset:14848
    ds_read_b64_tr_b16 v[158:159], v2 offset:15104
    v_cvt_pk_bf16_f32 v42, v204, v205
    s_waitcnt lgkmcnt(10)
    v_mfma_f32_32x32x16_bf16 v[160:175], v[136:139], a[20:23], v[160:175]
    ds_read_b64_tr_b16 v[128:129], v2 offset:16384
    ds_read_b64_tr_b16 v[130:131], v2 offset:16640
    v_cvt_pk_bf16_f32 v43, v206, v207
    buffer_store_dwordx4 v[40:43], v13, s[12:15], s21 offen offset:1024 sc1
    s_waitcnt lgkmcnt(10)
    v_mfma_f32_32x32x16_bf16 v[176:191], v[140:143], a[20:23], v[176:191]
    ds_read_b64_tr_b16 v[132:133], v2 offset:16896
    ds_read_b64_tr_b16 v[134:135], v2 offset:17152
    s_add_u32 m0, s25, 6144
    s_nop 0
    buffer_load_dwordx4 v10, s[8:11], s27 offen lds
    s_waitcnt lgkmcnt(10)
    v_mfma_f32_32x32x16_bf16 v[160:175], v[144:147], a[24:27], v[160:175]
    ds_read_b64_tr_b16 v[136:137], v2 offset:18432
    ds_read_b64_tr_b16 v[138:139], v2 offset:18688
    v_cvt_pk_bf16_f32 v44, v208, v209
    s_waitcnt lgkmcnt(10)
    v_mfma_f32_32x32x16_bf16 v[176:191], v[148:151], a[24:27], v[176:191]
    ds_read_b64_tr_b16 v[140:141], v2 offset:18944
    ds_read_b64_tr_b16 v[142:143], v2 offset:19200
    v_cvt_pk_bf16_f32 v45, v210, v211
    s_waitcnt lgkmcnt(10)
    v_mfma_f32_32x32x16_bf16 v[160:175], v[152:155], a[28:31], v[160:175]
    ds_read_b64_tr_b16 v[144:145], v2 offset:20480
    ds_read_b64_tr_b16 v[146:147], v2 offset:20736
    s_add_u32 m0, s25, 7168
    s_nop 0
    buffer_load_dwordx4 v11, s[8:11], s27 offen lds
    v_cvt_pk_bf16_f32 v46, v212, v213
    s_waitcnt lgkmcnt(10)
    v_mfma_f32_32x32x16_bf16 v[176:191], v[156:159], a[28:31], v[176:191]
    ds_read_b64_tr_b16 v[148:149], v2 offset:20992
    ds_read_b64_tr_b16 v[150:151], v2 offset:21248
    v_cvt_pk_bf16_f32 v47, v214, v215
    s_waitcnt lgkmcnt(10)
    v_mfma_f32_32x32x16_bf16 v[160:175], v[128:131], a[32:35], v[160:175]
    s_waitcnt vmcnt(10)
    ds_add_u32 v19, v19
    s_add_u32 s57, s57, 0x98000
    ds_read_b64_tr_b16 v[152:153], v2 offset:22528
    ds_read_b64_tr_b16 v[154:155], v2 offset:22784
    buffer_store_dwordx4 v[44:47], v13, s[12:15], s21 offen offset:2048 sc1
    s_waitcnt lgkmcnt(11)
    v_mfma_f32_32x32x16_bf16 v[176:191], v[132:135], a[32:35], v[176:191]
    ds_read_b64_tr_b16 v[156:157], v2 offset:23040
    ds_read_b64_tr_b16 v[158:159], v2 offset:23296
    s_add_u32 m0, s25, 8192
    s_nop 0
    buffer_load_dwordx4 v12, s[8:11], s27 offen lds
    s_waitcnt lgkmcnt(11)
    v_mfma_f32_32x32x16_bf16 v[160:175], v[136:139], a[36:39], v[160:175]
    ds_read_b64_tr_b16 v[128:129], v2 offset:24576
    ds_read_b64_tr_b16 v[130:131], v2 offset:24832
    v_cvt_pk_bf16_f32 v48, v216, v217
    s_waitcnt lgkmcnt(11)
    v_mfma_f32_32x32x16_bf16 v[176:191], v[140:143], a[36:39], v[176:191]
    ds_read_b64_tr_b16 v[132:133], v2 offset:25088
    ds_read_b64_tr_b16 v[134:135], v2 offset:25344
    v_cvt_pk_bf16_f32 v49, v218, v219
    v_cvt_pk_bf16_f32 v50, v220, v221
    s_waitcnt lgkmcnt(11)
    v_mfma_f32_32x32x16_bf16 v[160:175], v[144:147], a[40:43], v[160:175]
    ds_read_b64_tr_b16 v[136:137], v2 offset:26624
    ds_read_b64_tr_b16 v[138:139], v2 offset:26880
    v_cvt_pk_bf16_f32 v51, v222, v223
    s_waitcnt lgkmcnt(11)
    v_mfma_f32_32x32x16_bf16 v[176:191], v[148:151], a[40:43], v[176:191]
    ds_read_b64_tr_b16 v[140:141], v2 offset:27136
    ds_read_b64_tr_b16 v[142:143], v2 offset:27392
    buffer_store_dwordx4 v[48:51], v13, s[12:15], s21 offen offset:3072 sc1
    s_waitcnt lgkmcnt(10)
    v_mfma_f32_32x32x16_bf16 v[160:175], v[152:155], a[44:47], v[160:175]
    ds_read_b64_tr_b16 v[144:145], v2 offset:28672
    ds_read_b64_tr_b16 v[146:147], v2 offset:28928
    s_waitcnt lgkmcnt(10)
    v_mfma_f32_32x32x16_bf16 v[176:191], v[156:159], a[44:47], v[176:191]
    ds_read_b64_tr_b16 v[148:149], v2 offset:29184
    ds_read_b64_tr_b16 v[150:151], v2 offset:29440
    s_add_u32 s21, s21, 4096
    s_waitcnt lgkmcnt(10)
    v_mfma_f32_32x32x16_bf16 v[160:175], v[128:131], a[48:51], v[160:175]
    ds_read_b64_tr_b16 v[152:153], v2 offset:30720
    ds_read_b64_tr_b16 v[154:155], v2 offset:30976
    s_add_u32 s22, s22, 4096
    s_waitcnt lgkmcnt(10)
    v_mfma_f32_32x32x16_bf16 v[176:191], v[132:135], a[48:51], v[176:191]
    ds_read_b64_tr_b16 v[156:157], v2 offset:31232
    ds_read_b64_tr_b16 v[158:159], v2 offset:31488
    s_waitcnt lgkmcnt(10)
    v_mfma_f32_32x32x16_bf16 v[160:175], v[136:139], a[52:55], v[160:175]
    ds_read_b32 v18, v19
    ds_read_b64_tr_b16 v[128:129], v2 offset:32768
    ds_read_b64_tr_b16 v[130:131], v2 offset:33024
    s_waitcnt lgkmcnt(11)
    v_mfma_f32_32x32x16_bf16 v[176:191], v[140:143], a[52:55], v[176:191]
    ds_read_b64_tr_b16 v[132:133], v2 offset:33280
    ds_read_b64_tr_b16 v[134:135], v2 offset:33536
    s_waitcnt lgkmcnt(11)
    v_mfma_f32_32x32x16_bf16 v[160:175], v[144:147], a[56:59], v[160:175]
    s_waitcnt lgkmcnt(4)
    v_readfirstlane_b32 s56, v18
    s_cmp_ge_u32 s56, s57
    s_cbranch_scc0 spin_g3_kernel_22
back_g3_kernel_23:
    s_add_u32 s18, s18, 36864
    s_cmp_eq_u32 s18, 147456
    s_cselect_b32 s18, 0, s18
    v_add_u32 v3, s18, v16
    s_cmp_ge_u32 s17, 0
    s_cselect_b32 s10, s16, 0
    s_add_u32 s25, s19, s23
    s_add_u32 s27, s20, 995328
    s_add_u32 s19, s19, 36864
    s_cmp_eq_u32 s19, 147456
    s_cselect_b32 s19, 0, s19
    ds_read_b64_tr_b16 v[136:137], v2 offset:34816
    ds_read_b64_tr_b16 v[138:139], v2 offset:35072
    v_mfma_f32_32x32x16_bf16 v[176:191], v[148:151], a[56:59], v[176:191]
    ds_read_b64_tr_b16 v[140:141], v2 offset:35328
    ds_read_b64_tr_b16 v[142:143], v2 offset:35584
    s_add_u32 m0, s25, 0
    s_nop 0
    buffer_load_dwordx4 v4, s[8:11], s27 offen lds
    v_and_b32 v59, 63, v0
    v_lshlrev_b32 v55, 4, v59
    v_lshrrev_b32 v56, 5, v59
    v_mfma_f32_32x32x16_bf16 v[160:175], v[152:155], a[60:63], v[160:175]
    ds_read_b64_tr_b16 v[144:145], v3 offset:0
    ds_read_b64_tr_b16 v[146:147], v3 offset:256
    v_and_b32 v57, 31, v59
    v_mul_u32_u24 v57, 1152, v57
    v_lshlrev_b32 v52, 3, v56
    v_mfma_f32_32x32x16_bf16 v[176:191], v[156:159], a[60:63], v[176:191]
    ds_read_b64_tr_b16 v[148:149], v3 offset:512
    ds_read_b64_tr_b16 v[150:151], v3 offset:768
    v_add_u32 v53, v57, v52
    v_lshl_add_u32 v54, v56, 4, v57
    v_mov_b32 v56, 0x3f80
    s_waitcnt lgkmcnt(10)
    v_mfma_f32_32x32x16_bf16 v[160:175], v[128:131], a[64:67], v[160:175]
    ds_read_b64_tr_b16 v[152:153], v3 offset:2048
    ds_read_b64_tr_b16 v[154:155], v3 offset:2304
    s_add_u32 m0, s25, 1024
    s_nop 0
    buffer_load_dwordx4 v5, s[8:11], s27 offen lds
    v_mov_b32 v57, 0x3f800000
    v_mov_b32 v32, 1
    v_mov_b32 v33, 1
    s_waitcnt lgkmcnt(10)
    v_mfma_f32_32x32x16_bf16 v[176:191], v[132:135], a[64:67], v[176:191]
    ds_read_b64_tr_b16 v[156:157], v3 offset:2560
    ds_read_b64_tr_b16 v[158:159], v3 offset:2816
    v_and_b32 v35, 3, v59
    v_lshlrev_b32 v35, 2, v35
    v_cmp_eq_u32 vcc, 0, v59
    s_waitcnt lgkmcnt(10)
    v_mfma_f32_32x32x16_bf16 v[160:175], v[136:139], a[68:71], v[160:175]
    ds_read_b64_tr_b16 v[128:129], v3 offset:4096
    ds_read_b64_tr_b16 v[130:131], v3 offset:4352
    v_mov_b32 v58, 0x7fff0000
    v_cndmask_b32 v59, v58, v59, vcc
    v_mov_b32 v58, 0x100
    s_waitcnt lgkmcnt(10)
    v_mfma_f32_32x32x16_bf16 v[176:191], v[140:143], a[68:71], v[176:191]
    ds_read_b64_tr_b16 v[132:133], v3 offset:4608
    ds_read_b64_tr_b16 v[134:135], v3 offset:4864
    s_add_u32 m0, s25, 2048
    s_nop 0
    buffer_load_dwordx4 v6, s[8:11], s27 offen lds
    s_mov_b32 s73, 0
    s_mov_b32 s74, 0
    s_add_u32 s72, s72, s35
    s_waitcnt lgkmcnt(10)
    v_mfma_f32_32x32x16_bf16 v[160:175], v[144:147], a[72:75], v[160:175]
    ds_read_b64_tr_b16 v[136:137], v3 offset:6144
    ds_read_b64_tr_b16 v[138:139], v3 offset:6400
    s_mul_i32 s90, s70, 768
    s_lshl_b32 s88, s71, 2
    s_add_u32 s88, s88, s35
    s_waitcnt lgkmcnt(10)
    v_mfma_f32_32x32x16_bf16 v[176:191], v[148:151], a[72:75], v[176:191]
    ds_read_b64_tr_b16 v[140:141], v3 offset:6656
    ds_read_b64_tr_b16 v[142:143], v3 offset:6912
    s_lshl_b32 s88, s88, 6
    s_add_u32 s88, s88, s90
    s_waitcnt lgkmcnt(10)
    v_mfma_f32_32x32x16_bf16 v[160:175], v[152:155], a[76:79], v[160:175]
    ds_read_b64_tr_b16 v[144:145], v3 offset:8192
    ds_read_b64_tr_b16 v[146:147], v3 offset:8448
    s_add_u32 m0, s25, 3072
    s_nop 0
    buffer_load_dwordx4 v7, s[8:11], s27 offen lds
    s_waitcnt lgkmcnt(10)
    v_mfma_f32_32x32x16_bf16 v[176:191], v[156:159], a[76:79], v[176:191]
    ds_read_b64_tr_b16 v[148:149], v3 offset:8704
    ds_read_b64_tr_b16 v[150:151], v3 offset:8960
    s_waitcnt lgkmcnt(10)
    v_mfma_f32_32x32x16_bf16 v[160:175], v[128:131], a[80:83], v[160:175]
    ds_read_b64_tr_b16 v[152:153], v3 offset:10240
    ds_read_b64_tr_b16 v[154:155], v3 offset:10496
    s_waitcnt lgkmcnt(10)
    v_mfma_f32_32x32x16_bf16 v[176:191], v[132:135], a[80:83], v[176:191]
    ds_read_b64_tr_b16 v[156:157], v3 offset:10752
    ds_read_b64_tr_b16 v[158:159], v3 offset:11008
    s_add_u32 m0, s25, 4096
    s_nop 0
    buffer_load_dwordx4 v8, s[8:11], s27 offen lds
    s_waitcnt lgkmcnt(10)
    v_mfma_f32_32x32x16_bf16 v[160:175], v[136:139], a[84:87], v[160:175]
    ds_read_b64_tr_b16 v[128:129], v3 offset:12288
    ds_read_b64_tr_b16 v[130:131], v3 offset:12544
    s_waitcnt lgkmcnt(10)
    v_mfma_f32_32x32x16_bf16 v[176:191], v[140:143], a[84:87], v[176:191]
    ds_read_b64_tr_b16 v[132:133], v3 offset:12800
    ds_read_b64_tr_b16 v[134:135], v3 offset:13056
    s_waitcnt lgkmcnt(10)
    v_mfma_f32_32x32x16_bf16 v[160:175], v[144:147], a[88:91], v[160:175]
    ds_read_b64_tr_b16 v[136:137], v3 offset:14336
    ds_read_b64_tr_b16 v[138:139], v3 offset:14592
    s_add_u32 m0, s25, 5120
    s_nop 0
    buffer_load_dwordx4 v9, s[8:11], s27 offen lds
    s_waitcnt lgkmcnt(10)
    v_mfma_f32_32x32x16_bf16 v[176:191], v[148:151], a[88:91], v[176:191]
    ds_read_b64_tr_b16 v[140:141], v3 offset:14848
    ds_read_b64_tr_b16 v[142:143], v3 offset:15104
    s_waitcnt lgkmcnt(10)
    v_mfma_f32_32x32x16_bf16 v[160:175], v[152:155], a[92:95], v[160:175]
    ds_read_b64_tr_b16 v[144:145], v3 offset:16384
    ds_read_b64_tr_b16 v[146:147], v3 offset:16640
    s_waitcnt lgkmcnt(10)
    v_mfma_f32_32x32x16_bf16 v[176:191], v[156:159], a[92:95], v[176:191]
    ds_read_b64_tr_b16 v[148:149], v3 offset:16896
    ds_read_b64_tr_b16 v[150:151], v3 offset:17152
    s_add_u32 m0, s25, 6144
    s_nop 0
    buffer_load_dwordx4 v10, s[8:11], s27 offen lds
    s_waitcnt lgkmcnt(10)
    v_mfma_f32_32x32x16_bf16 v[160:175], v[128:131], a[96:99], v[160:175]
    ds_read_b64_tr_b16 v[152:153], v3 offset:18432
    ds_read_b64_tr_b16 v[154:155], v3 offset:18688
    s_waitcnt lgkmcnt(10)
    v_mfma_f32_32x32x16_bf16 v[176:191], v[132:135], a[96:99], v[176:191]
    ds_read_b64_tr_b16 v[156:157], v3 offset:18944
    ds_read_b64_tr_b16 v[158:159], v3 offset:19200
    s_waitcnt lgkmcnt(10)
    v_mfma_f32_32x32x16_bf16 v[160:175], v[136:139], a[100:103], v[160:175]
    ds_read_b64_tr_b16 v[128:129], v3 offset:20480
    ds_read_b64_tr_b16 v[130:131], v3 offset:20736
    s_add_u32 m0, s25, 7168
    s_nop 0
    buffer_load_dwordx4 v11, s[8:11], s27 offen lds
    s_waitcnt lgkmcnt(10)
    v_mfma_f32_32x32x16_bf16 v[176:191], v[140:143], a[100:103], v[176:191]
    ds_read_b64_tr_b16 v[132:133], v3 offset:20992
    ds_read_b64_tr_b16 v[134:135], v3 offset:21248
    s_waitcnt lgkmcnt(10)
    v_mfma_f32_32x32x16_bf16 v[160:175], v[144:147], a[104:107], v[160:175]
    s_waitcnt vmcnt(9)
    ds_add_u32 v19, v19
    s_add_u32 s57, s57, 0x98000
    ds_read_b64_tr_b16 v[136:137], v3 offset:22528
    ds_read_b64_tr_b16 v[138:139], v3 offset:22784
    s_waitcnt lgkmcnt(11)
    v_mfma_f32_32x32x16_bf16 v[176:191], v[148:151], a[104:107], v[176:191]
    ds_read_b64_tr_b16 v[140:141], v3 offset:23040
    ds_read_b64_tr_b16 v[142:143], v3 offset:23296
    s_add_u32 m0, s25, 8192
    s_nop 0
    buffer_load_dwordx4 v12, s[8:11], s27 offen lds
    s_waitcnt lgkmcnt(11)
    v_mfma_f32_32x32x16_bf16 v[160:175], v[152:155], a[108:111], v[160:175]
    ds_read_b64_tr_b16 v[144:145], v3 offset:24576
    ds_read_b64_tr_b16 v[146:147], v3 offset:24832
    s_waitcnt lgkmcnt(11)
    v_mfma_f32_32x32x16_bf16 v[176:191], v[156:159], a[108:111], v[176:191]
    ds_read_b64_tr_b16 v[148:149], v3 offset:25088
    ds_read_b64_tr_b16 v[150:151], v3 offset:25344
    s_waitcnt lgkmcnt(11)
    v_mfma_f32_32x32x16_bf16 v[160:175], v[128:131], a[112:115], v[160:175]
    ds_read_b64_tr_b16 v[152:153], v3 offset:26624
    ds_read_b64_tr_b16 v[154:155], v3 offset:26880
    s_waitcnt lgkmcnt(11)
    v_mfma_f32_32x32x16_bf16 v[176:191], v[132:135], a[112:115], v[176:191]
    ds_read_b64_tr_b16 v[156:157], v3 offset:27136
    ds_read_b64_tr_b16 v[158:159], v3 offset:27392
    s_waitcnt lgkmcnt(10)
    v_mfma_f32_32x32x16_bf16 v[160:175], v[136:139], a[116:119], v[160:175]
    ds_read_b64_tr_b16 v[128:129], v3 offset:28672
    ds_read_b64_tr_b16 v[130:131], v3 offset:28928
    s_waitcnt lgkmcnt(10)
    v_mfma_f32_32x32x16_bf16 v[176:191], v[140:143], a[116:119], v[176:191]
    ds_read_b64_tr_b16 v[132:133], v3 offset:29184
    ds_read_b64_tr_b16 v[134:135], v3 offset:29440
    s_waitcnt vmcnt(9)
    buffer_atomic_add v58, v59, s[92:95], s88 offen sc1
    s_waitcnt lgkmcnt(10)
    v_mfma_f32_32x32x16_bf16 v[160:175], v[144:147], a[120:123], v[160:175]
    ds_read_b64_tr_b16 v[136:137], v3 offset:30720
    ds_read_b64_tr_b16 v[138:139], v3 offset:30976
    s_waitcnt lgkmcnt(10)
    v_mfma_f32_32x32x16_bf16 v[176:191], v[148:151], a[120:123], v[176:191]
    ds_read_b64_tr_b16 v[140:141], v3 offset:31232
    ds_read_b64_tr_b16 v[142:143], v3 offset:31488
    s_lshr_b32 s77, s72, 2
    s_and_b32 s78, s72, 3
    s_lshl_b32 s80, s71, 2
    s_waitcnt lgkmcnt(10)
    v_mfma_f32_32x32x16_bf16 v[160:175], v[152:155], a[124:127], v[160:175]
    ds_read_b32 v18, v19
    ds_read_b64_tr_b16 v[144:145], v3 offset:32768
    ds_read_b64_tr_b16 v[146:147], v3 offset:33024
    s_add_u32 s80, s80, s77
    s_lshl_b32 s80, s80, 6
    s_add_u32 s80, s80, s90
    s_waitcnt lgkmcnt(11)
    v_mfma_f32_32x32x16_bf16 v[176:191], v[156:159], a[124:127], v[176:191]
    ds_read_b64_tr_b16 v[148:149], v3 offset:33280
    ds_read_b64_tr_b16 v[150:151], v3 offset:33536
    s_lshl_b32 s79, s70, 2
    s_add_u32 s79, s79, s77
    s_mul_i32 s79, s79, 36864
    s_waitcnt lgkmcnt(11)
    v_mfma_f32_32x32x16_bf16 v[160:175], v[128:131], a[128:131], v[160:175]
    s_waitcnt lgkmcnt(4)
    v_readfirstlane_b32 s56, v18
    s_cmp_ge_u32 s56, s57
    s_cbranch_scc0 spin_g3_kernel_24
back_g3_kernel_25:
    s_add_u32 s18, s18, 36864
    s_cmp_eq_u32 s18, 147456
    s_cselect_b32 s18, 0, s18
    v_add_u32 v2, s18, v16
    ds_read_b64_tr_b16 v[152:153], v3 offset:34816
    ds_read_b64_tr_b16 v[154:155], v3 offset:35072
    s_mul_i32 s77, s71, 12
    s_add_u32 s86, s77, s78
    s_add_u32 s85, s86, s78
    v_mfma_f32_32x32x16_bf16 v[176:191], v[132:135], a[128:131], v[176:191]
    ds_read_b64_tr_b16 v[156:157], v3 offset:35328
    ds_read_b64_tr_b16 v[158:159], v3 offset:35584
    s_add_u32 s86, s86, 8
    s_lshl_b32 s81, s85, 10
    s_lshl_b32 s82, s86, 10
    v_mfma_f32_32x32x16_bf16 v[160:175], v[136:139], a[132:135], v[160:175]
    ds_read_b64_tr_b16 v[128:129], v2 offset:0
    ds_read_b64_tr_b16 v[130:131], v2 offset:256
    s_add_u32 s81, s81, s79
    s_add_u32 s82, s82, s79
    s_lshl_b32 s85, s85, 5
    v_mfma_f32_32x32x16_bf16 v[176:191], v[140:143], a[132:135], v[176:191]
    ds_read_b64_tr_b16 v[132:133], v2 offset:512
    ds_read_b64_tr_b16 v[134:135], v2 offset:768
    s_lshl_b32 s86, s86, 5
    s_add_u32 s83, s85, s79
    s_add_u32 s84, s86, s79
    s_waitcnt lgkmcnt(10)
    v_mfma_f32_32x32x16_bf16 v[160:175], v[144:147], a[136:139], v[160:175]
    ds_read_b64_tr_b16 v[136:137], v2 offset:2048
    ds_read_b64_tr_b16 v[138:139], v2 offset:2304
    s_lshl_b32 s87, s78, 2
    s_add_u32 s87, s87, s80
    s_movk_i32 s75, 96
    s_waitcnt lgkmcnt(10)
    v_mfma_f32_32x32x16_bf16 v[176:191], v[148:151], a[136:139], v[176:191]
    ds_read_b64_tr_b16 v[140:141], v2 offset:2560
    ds_read_b64_tr_b16 v[142:143], v2 offset:2816
    buffer_load_dwordx2 v[112:113], v53, s[64:67], s83 offen offset:0
    s_waitcnt lgkmcnt(10)
    v_mfma_f32_32x32x16_bf16 v[160:175], v[152:155], a[140:143], v[160:175]
    ds_read_b64_tr_b16 v[144:145], v2 offset:4096
    ds_read_b64_tr_b16 v[146:147], v2 offset:4352
    buffer_load_dwordx2 v[20:21], v52, s[96:99], s85 offen offset:0
    s_waitcnt lgkmcnt(10)
    v_mfma_f32_32x32x16_bf16 v[176:191], v[156:159], a[140:143], v[176:191]
    ds_read_b64_tr_b16 v[148:149], v2 offset:4608
    ds_read_b64_tr_b16 v[150:151], v2 offset:4864
    buffer_load_dwordx2 v[114:115], v53, s[64:67], s83 offen offset:16
    s_waitcnt lgkmcnt(10)
    v_mfma_f32_32x32x16_bf16 v[160:175], v[128:131], a[144:147], v[160:175]
    ds_read_b64_tr_b16 v[152:153], v2 offset:6144
    ds_read_b64_tr_b16 v[154:155], v2 offset:6400
    buffer_load_dwordx2 v[22:23], v52, s[96:99], s85 offen offset:16
    s_waitcnt lgkmcnt(10)
    v_mfma_f32_32x32x16_bf16 v[176:191], v[132:135], a[144:147], v[176:191]
    ds_read_b64_tr_b16 v[156:157], v2 offset:6656
    ds_read_b64_tr_b16 v[158:159], v2 offset:6912
    buffer_load_dwordx2 v[116:117], v53, s[64:67], s83 offen offset:32
    s_waitcnt lgkmcnt(10)
    v_mfma_f32_32x32x16_bf16 v[160:175], v[136:139], a[148:151], v[160:175]
    ds_read_b64_tr_b16 v[128:129], v2 offset:8192
    ds_read_b64_tr_b16 v[130:131], v2 offset:8448
    buffer_load_dwordx2 v[24:25], v52, s[96:99], s85 offen offset:32
    s_waitcnt lgkmcnt(10)
    v_mfma_f32_32x32x16_bf16 v[176:191], v[140:143], a[148:151], v[176:191]
    ds_read_b64_tr_b16 v[132:133], v2 offset:8704
    ds_read_b64_tr_b16 v[134:135], v2 offset:8960
    buffer_load_dwordx2 v[118:119], v53, s[64:67], s83 offen offset:48
    s_waitcnt lgkmcnt(10)
    v_mfma_f32_32x32x16_bf16 v[160:175], v[144:147], a[152:155], v[160:175]
    ds_read_b64_tr_b16 v[136:137], v2 offset:10240
    ds_read_b64_tr_b16 v[138:139], v2 offset:10496
    buffer_load_dwordx2 v[26:27], v52, s[96:99], s85 offen offset:48
    s_waitcnt lgkmcnt(10)
    v_mfma_f32_32x32x16_bf16 v[176:191], v[148:151], a[152:155], v[176:191]
    ds_read_b64_tr_b16 v[140:141], v2 offset:10752
    ds_read_b64_tr_b16 v[142:143], v2 offset:11008
    buffer_load_dwordx2 v[120:121], v53, s[64:67], s84 offen offset:0
    s_waitcnt lgkmcnt(10)
    v_mfma_f32_32x32x16_bf16 v[160:175], v[152:155], a[156:159], v[160:175]
    ds_read_b64_tr_b16 v[144:145], v2 offset:12288
    ds_read_b64_tr_b16 v[146:147], v2 offset:12544
    buffer_load_dwordx2 v[28:29], v52, s[96:99], s86 offen offset:0
    s_waitcnt lgkmcnt(10)
    v_mfma_f32_32x32x16_bf16 v[176:191], v[156:159], a[156:159], v[176:191]
    ds_read_b64_tr_b16 v[148:149], v2 offset:12800
    ds_read_b64_tr_b16 v[150:151], v2 offset:13056
    buffer_load_dwordx2 v[122:123], v53, s[64:67], s84 offen offset:16
    s_waitcnt lgkmcnt(10)
    v_mfma_f32_32x32x16_bf16 v[160:175], v[128:131], a[160:163], v[160:175]
    ds_read_b64_tr_b16 v[152:153], v2 offset:14336
    ds_read_b64_tr_b16 v[154:155], v2 offset:14592
    buffer_load_dwordx2 v[30:31], v52, s[96:99], s86 offen offset:16
    s_waitcnt lgkmcnt(10)
    v_mfma_f32_32x32x16_bf16 v[176:191], v[132:135], a[160:163], v[176:191]
    ds_read_b64_tr_b16 v[156:157], v2 offset:14848
    ds_read_b64_tr_b16 v[158:159], v2 offset:15104
    s_waitcnt lgkmcnt(10)
    v_mfma_f32_32x32x16_bf16 v[160:175], v[136:139], a[164:167], v[160:175]
    ds_read_b64_tr_b16 v[128:129], v2 offset:16384
    ds_read_b64_tr_b16 v[130:131], v2 offset:16640
    s_waitcnt lgkmcnt(10)
    v_mfma_f32_32x32x16_bf16 v[176:191], v[140:143], a[164:167], v[176:191]
    ds_read_b64_tr_b16 v[132:133], v2 offset:16896
    ds_read_b64_tr_b16 v[134:135], v2 offset:17152
    s_waitcnt lgkmcnt(10)
    v_mfma_f32_32x32x16_bf16 v[160:175], v[144:147], a[168:171], v[160:175]
    ds_read_b64_tr_b16 v[136:137], v2 offset:18432
    ds_read_b64_tr_b16 v[138:139], v2 offset:18688
    s_waitcnt lgkmcnt(10)
    v_mfma_f32_32x32x16_bf16 v[176:191], v[148:151], a[168:171], v[176:191]
    ds_read_b64_tr_b16 v[140:141], v2 offset:18944
    ds_read_b64_tr_b16 v[142:143], v2 offset:19200
    s_waitcnt lgkmcnt(10)
    v_mfma_f32_32x32x16_bf16 v[160:175], v[152:155], a[172:175], v[160:175]
    ds_read_b64_tr_b16 v[144:145], v2 offset:20480
    ds_read_b64_tr_b16 v[146:147], v2 offset:20736
    s_waitcnt lgkmcnt(10)
    v_mfma_f32_32x32x16_bf16 v[176:191], v[156:159], a[172:175], v[176:191]
    ds_read_b64_tr_b16 v[148:149], v2 offset:20992
    ds_read_b64_tr_b16 v[150:151], v2 offset:21248
    s_waitcnt lgkmcnt(10)
    v_mfma_f32_32x32x16_bf16 v[160:175], v[128:131], a[176:179], v[160:175]
    s_waitcnt vmcnt(13)
    ds_add_u32 v19, v19
    s_add_u32 s57, s57, 0x98000
    ds_read_b64_tr_b16 v[152:153], v2 offset:22528
    ds_read_b64_tr_b16 v[154:155], v2 offset:22784
    s_waitcnt lgkmcnt(11)
    v_mfma_f32_32x32x16_bf16 v[176:191], v[132:135], a[176:179], v[176:191]
    ds_read_b64_tr_b16 v[156:157], v2 offset:23040
    ds_read_b64_tr_b16 v[158:159], v2 offset:23296
    s_waitcnt lgkmcnt(11)
    v_mfma_f32_32x32x16_bf16 v[160:175], v[136:139], a[180:183], v[160:175]
    ds_read_b64_tr_b16 v[128:129], v2 offset:24576
    ds_read_b64_tr_b16 v[130:131], v2 offset:24832
    s_waitcnt lgkmcnt(11)
    v_mfma_f32_32x32x16_bf16 v[176:191], v[140:143], a[180:183], v[176:191]
    ds_read_b64_tr_b16 v[132:133], v2 offset:25088
    ds_read_b64_tr_b16 v[134:135], v2 offset:25344
    s_waitcnt lgkmcnt(11)
    v_mfma_f32_32x32x16_bf16 v[160:175], v[144:147], a[184:187], v[160:175]
    ds_read_b64_tr_b16 v[136:137], v2 offset:26624
    ds_read_b64_tr_b16 v[138:139], v2 offset:26880
    s_waitcnt lgkmcnt(11)
    v_mfma_f32_32x32x16_bf16 v[176:191], v[148:151], a[184:187], v[176:191]
    ds_read_b64_tr_b16 v[140:141], v2 offset:27136
    ds_read_b64_tr_b16 v[142:143], v2 offset:27392
    s_waitcnt lgkmcnt(10)
    v_mfma_f32_32x32x16_bf16 v[160:175], v[152:155], a[188:191], v[160:175]
    ds_read_b64_tr_b16 v[144:145], v2 offset:28672
    ds_read_b64_tr_b16 v[146:147], v2 offset:28928
    s_waitcnt lgkmcnt(10)
    v_mfma_f32_32x32x16_bf16 v[176:191], v[156:159], a[188:191], v[176:191]
    ds_read_b64_tr_b16 v[148:149], v2 offset:29184
    ds_read_b64_tr_b16 v[150:151], v2 offset:29440
    s_waitcnt lgkmcnt(10)
    v_mfma_f32_32x32x16_bf16 v[160:175], v[128:131], a[192:195], v[160:175]
    ds_read_b64_tr_b16 v[152:153], v2 offset:30720
    ds_read_b64_tr_b16 v[154:155], v2 offset:30976
    s_waitcnt lgkmcnt(10)
    v_mfma_f32_32x32x16_bf16 v[176:191], v[132:135], a[192:195], v[176:191]
    ds_read_b64_tr_b16 v[156:157], v2 offset:31232
    ds_read_b64_tr_b16 v[158:159], v2 offset:31488
    s_waitcnt lgkmcnt(10)
    v_mfma_f32_32x32x16_bf16 v[160:175], v[136:139], a[196:199], v[160:175]
    ds_read_b32 v18, v19
    ds_read_b64_tr_b16 v[128:129], v2 offset:32768
    ds_read_b64_tr_b16 v[130:131], v2 offset:33024
    s_waitcnt lgkmcnt(11)
    v_mfma_f32_32x32x16_bf16 v[176:191], v[140:143], a[196:199], v[176:191]
    ds_read_b64_tr_b16 v[132:133], v2 offset:33280
    ds_read_b64_tr_b16 v[134:135], v2 offset:33536
    s_waitcnt lgkmcnt(11)
    v_mfma_f32_32x32x16_bf16 v[160:175], v[144:147], a[200:203], v[160:175]
    s_waitcnt lgkmcnt(4)
    v_readfirstlane_b32 s56, v18
    s_cmp_ge_u32 s56, s57
    s_cbranch_scc0 spin_g3_kernel_26
back_g3_kernel_27:
    s_add_u32 s18, s18, 36864
    s_cmp_eq_u32 s18, 147456
    s_cselect_b32 s18, 0, s18
    v_add_u32 v3, s18, v16
    ds_read_b64_tr_b16 v[136:137], v2 offset:34816
    ds_read_b64_tr_b16 v[138:139], v2 offset:35072
    v_mfma_f32_32x32x16_bf16 v[176:191], v[148:151], a[200:203], v[176:191]
    ds_read_b64_tr_b16 v[140:141], v2 offset:35328
    ds_read_b64_tr_b16 v[142:143], v2 offset:35584
    v_mfma_f32_32x32x16_bf16 v[160:175], v[152:155], a[204:207], v[160:175]
    ds_read_b64_tr_b16 v[144:145], v3 offset:0
    ds_read_b64_tr_b16 v[146:147], v3 offset:256
    v_mfma_f32_32x32x16_bf16 v[176:191], v[156:159], a[204:207], v[176:191]
    ds_read_b64_tr_b16 v[148:149], v3 offset:512
    ds_read_b64_tr_b16 v[150:151], v3 offset:768
    buffer_load_dword v62, v59, s[92:95], s80 offen sc0 sc1
    s_waitcnt lgkmcnt(10)
    v_mfma_f32_32x32x16_bf16 v[160:175], v[128:131], a[208:211], v[160:175]
    ds_read_b64_tr_b16 v[152:153], v3 offset:2048
    ds_read_b64_tr_b16 v[154:155], v3 offset:2304
    s_waitcnt lgkmcnt(10)
    v_mfma_f32_32x32x16_bf16 v[176:191], v[132:135], a[208:211], v[176:191]
    ds_read_b64_tr_b16 v[156:157], v3 offset:2560
    ds_read_b64_tr_b16 v[158:159], v3 offset:2816
    s_waitcnt lgkmcnt(10)
    v_mfma_f32_32x32x16_bf16 v[160:175], v[136:139], a[212:215], v[160:175]
    ds_read_b64_tr_b16 v[128:129], v3 offset:4096
    ds_read_b64_tr_b16 v[130:131], v3 offset:4352
    s_waitcnt lgkmcnt(10)
    v_mfma_f32_32x32x16_bf16 v[176:191], v[140:143], a[212:215], v[176:191]
    ds_read_b64_tr_b16 v[132:133], v3 offset:4608
    ds_read_b64_tr_b16 v[134:135], v3 offset:4864
    s_waitcnt lgkmcnt(10)
    v_mfma_f32_32x32x16_bf16 v[160:175], v[144:147], a[216:219], v[160:175]
    ds_read_b64_tr_b16 v[136:137], v3 offset:6144
    ds_read_b64_tr_b16 v[138:139], v3 offset:6400
    s_waitcnt lgkmcnt(10)
    v_mfma_f32_32x32x16_bf16 v[176:191], v[148:151], a[216:219], v[176:191]
    ds_read_b64_tr_b16 v[140:141], v3 offset:6656
    ds_read_b64_tr_b16 v[142:143], v3 offset:6912
    s_waitcnt lgkmcnt(10)
    v_mfma_f32_32x32x16_bf16 v[160:175], v[152:155], a[220:223], v[160:175]
    ds_read_b64_tr_b16 v[144:145], v3 offset:8192
    ds_read_b64_tr_b16 v[146:147], v3 offset:8448
    s_waitcnt lgkmcnt(10)
    v_mfma_f32_32x32x16_bf16 v[176:191], v[156:159], a[220:223], v[176:191]
    ds_read_b64_tr_b16 v[148:149], v3 offset:8704
    ds_read_b64_tr_b16 v[150:151], v3 offset:8960
    s_waitcnt lgkmcnt(10)
    v_mfma_f32_32x32x16_bf16 v[160:175], v[128:131], a[224:227], v[160:175]
    ds_read_b64_tr_b16 v[152:153], v3 offset:10240
    ds_read_b64_tr_b16 v[154:155], v3 offset:10496
    s_waitcnt lgkmcnt(10)
    v_mfma_f32_32x32x16_bf16 v[176:191], v[132:135], a[224:227], v[176:191]
    ds_read_b64_tr_b16 v[156:157], v3 offset:10752
    ds_read_b64_tr_b16 v[158:159], v3 offset:11008
    s_waitcnt lgkmcnt(10)
    v_mfma_f32_32x32x16_bf16 v[160:175], v[136:139], a[228:231], v[160:175]
    ds_read_b64_tr_b16 v[128:129], v3 offset:12288
    ds_read_b64_tr_b16 v[130:131], v3 offset:12544
    s_waitcnt lgkmcnt(10)
    v_mfma_f32_32x32x16_bf16 v[176:191], v[140:143], a[228:231], v[176:191]
    ds_read_b64_tr_b16 v[132:133], v3 offset:12800
    ds_read_b64_tr_b16 v[134:135], v3 offset:13056
    s_waitcnt lgkmcnt(10)
    v_mfma_f32_32x32x16_bf16 v[160:175], v[144:147], a[232:235], v[160:175]
    ds_read_b64_tr_b16 v[136:137], v3 offset:14336
    ds_read_b64_tr_b16 v[138:139], v3 offset:14592
    s_waitcnt lgkmcnt(10)
    v_mfma_f32_32x32x16_bf16 v[176:191], v[148:151], a[232:235], v[176:191]
    ds_read_b64_tr_b16 v[140:141], v3 offset:14848
    ds_read_b64_tr_b16 v[142:143], v3 offset:15104
    s_waitcnt lgkmcnt(10)
    v_mfma_f32_32x32x16_bf16 v[160:175], v[152:155], a[236:239], v[160:175]
    ds_read_b64_tr_b16 v[144:145], v3 offset:16384
    ds_read_b64_tr_b16 v[146:147], v3 offset:16640
    s_waitcnt lgkmcnt(10)
    v_mfma_f32_32x32x16_bf16 v[176:191], v[156:159], a[236:239], v[176:191]
    ds_read_b64_tr_b16 v[148:149], v3 offset:16896
    ds_read_b64_tr_b16 v[150:151], v3 offset:17152
    s_waitcnt lgkmcnt(10)
    v_mfma_f32_32x32x16_bf16 v[160:175], v[128:131], a[240:243], v[160:175]
    ds_read_b64_tr_b16 v[152:153], v3 offset:18432
    ds_read_b64_tr_b16 v[154:155], v3 offset:18688
    s_waitcnt lgkmcnt(10)
    v_mfma_f32_32x32x16_bf16 v[176:191], v[132:135], a[240:243], v[176:191]
    ds_read_b64_tr_b16 v[156:157], v3 offset:18944
    ds_read_b64_tr_b16 v[158:159], v3 offset:19200
    s_waitcnt lgkmcnt(10)
    v_mfma_f32_32x32x16_bf16 v[160:175], v[136:139], a[244:247], v[160:175]
    ds_read_b64_tr_b16 v[128:129], v3 offset:20480
    ds_read_b64_tr_b16 v[130:131], v3 offset:20736
    s_waitcnt lgkmcnt(10)
    v_mfma_f32_32x32x16_bf16 v[176:191], v[140:143], a[244:247], v[176:191]
    ds_read_b64_tr_b16 v[132:133], v3 offset:20992
    ds_read_b64_tr_b16 v[134:135], v3 offset:21248
    s_waitcnt lgkmcnt(10)
    v_mfma_f32_32x32x16_bf16 v[160:175], v[144:147], a[248:251], v[160:175]
    ds_read_b64_tr_b16 v[136:137], v3 offset:22528
    ds_read_b64_tr_b16 v[138:139], v3 offset:22784
    s_waitcnt lgkmcnt(10)
    v_mfma_f32_32x32x16_bf16 v[176:191], v[148:151], a[248:251], v[176:191]
    ds_read_b64_tr_b16 v[140:141], v3 offset:23040
    ds_read_b64_tr_b16 v[142:143], v3 offset:23296
    s_waitcnt lgkmcnt(10)
    v_mfma_f32_32x32x16_bf16 v[160:175], v[152:155], a[252:255], v[160:175]
    ds_read_b64_tr_b16 v[144:145], v3 offset:24576
    ds_read_b64_tr_b16 v[146:147], v3 offset:24832
    s_waitcnt lgkmcnt(10)
    v_mfma_f32_32x32x16_bf16 v[176:191], v[156:159], a[252:255], v[176:191]
    ds_read_b64_tr_b16 v[148:149], v3 offset:25088
    ds_read_b64_tr_b16 v[150:151], v3 offset:25344
    s_waitcnt vmcnt(0)
    v_readfirstlane_b32 s76, v62
    buffer_load_dwordx4 v[64:67], v55, s[12:15], s81 offen offset:0 sc0 sc1
    s_waitcnt lgkmcnt(10)
    v_mfma_f32_32x32x16_bf16 v[160:175], v[128:131], v[224:227], v[160:175]
    ds_read_b64_tr_b16 v[152:153], v3 offset:26624
    ds_read_b64_tr_b16 v[154:155], v3 offset:26880
    buffer_load_dwordx4 v[80:83], v55, s[12:15], s81 offen offset:1024 sc0 sc1
    s_waitcnt lgkmcnt(10)
    v_mfma_f32_32x32x16_bf16 v[176:191], v[132:135], v[224:227], v[176:191]
    ds_read_b64_tr_b16 v[156:157], v3 offset:27136
    ds_read_b64_tr_b16 v[158:159], v3 offset:27392
    s_add_u32 s81, s81, 2359296
    buffer_load_dwordx4 v[68:71], v55, s[12:15], s81 offen offset:0 sc0 sc1
    s_waitcnt lgkmcnt(10)
    v_mfma_f32_32x32x16_bf16 v[160:175], v[136:139], v[228:231], v[160:175]
    ds_read_b64_tr_b16 v[128:129], v3 offset:28672
    ds_read_b64_tr_b16 v[130:131], v3 offset:28928
    buffer_load_dwordx4 v[84:87], v55, s[12:15], s81 offen offset:1024 sc0 sc1
    s_waitcnt lgkmcnt(10)
    v_mfma_f32_32x32x16_bf16 v[176:191], v[140:143], v[228:231], v[176:191]
    ds_read_b64_tr_b16 v[132:133], v3 offset:29184
    ds_read_b64_tr_b16 v[134:135], v3 offset:29440
    s_add_u32 s81, s81, 2359296
    buffer_load_dwordx4 v[72:75], v55, s[12:15], s81 offen offset:0 sc0 sc1
    s_waitcnt lgkmcnt(10)
    v_mfma_f32_32x32x16_bf16 v[160:175], v[144:147], v[232:235], v[160:175]
    ds_read_b64_tr_b16 v[136:137], v3 offset:30720
    ds_read_b64_tr_b16 v[138:139], v3 offset:30976
    buffer_load_dwordx4 v[88:91], v55, s[12:15], s81 offen offset:1024 sc0 sc1
    s_waitcnt lgkmcnt(10)
    v_mfma_f32_32x32x16_bf16 v[176:191], v[148:151], v[232:235], v[176:191]
    ds_read_b64_tr_b16 v[140:141], v3 offset:31232
    ds_read_b64_tr_b16 v[142:143], v3 offset:31488
    s_add_u32 s81, s81, 2359296
    buffer_load_dwordx4 v[76:79], v55, s[12:15], s81 offen offset:0 sc0 sc1
    s_waitcnt lgkmcnt(10)
    v_mfma_f32_32x32x16_bf16 v[160:175], v[152:155], v[236:239], v[160:175]
    ds_read_b64_tr_b16 v[144:145], v3 offset:32768
    ds_read_b64_tr_b16 v[146:147], v3 offset:33024
    buffer_load_dwordx4 v[92:95], v55, s[12:15], s81 offen offset:1024 sc0 sc1
    s_waitcnt lgkmcnt(10)
    v_mfma_f32_32x32x16_bf16 v[176:191], v[156:159], v[236:239], v[176:191]
    ds_read_b64_tr_b16 v[148:149], v3 offset:33280
    ds_read_b64_tr_b16 v[150:151], v3 offset:33536
    s_add_u32 s81, s81, 2359296
    s_waitcnt lgkmcnt(10)
    v_mfma_f32_32x32x16_bf16 v[160:175], v[128:131], v[240:243], v[160:175]
    ds_read_b64_tr_b16 v[152:153], v3 offset:34816
    ds_read_b64_tr_b16 v[154:155], v3 offset:35072
    s_waitcnt lgkmcnt(10)
    v_mfma_f32_32x32x16_bf16 v[176:191], v[132:135], v[240:243], v[176:191]
    ds_read_b64_tr_b16 v[156:157], v3 offset:35328
    ds_read_b64_tr_b16 v[158:159], v3 offset:35584
    s_waitcnt lgkmcnt(10)
    v_mfma_f32_32x32x16_bf16 v[160:175], v[136:139], v[244:247], v[160:175]
    s_waitcnt lgkmcnt(8)
    v_mfma_f32_32x32x16_bf16 v[176:191], v[140:143], v[244:247], v[176:191]
    s_waitcnt lgkmcnt(6)
    v_mfma_f32_32x32x16_bf16 v[160:175], v[144:147], v[248:251], v[160:175]
    s_waitcnt lgkmcnt(4)
    v_mfma_f32_32x32x16_bf16 v[176:191], v[148:151], v[248:251], v[176:191]
    s_waitcnt lgkmcnt(2)
    v_mfma_f32_32x32x16_bf16 v[160:175], v[152:155], v[252:255], v[160:175]
    s_waitcnt lgkmcnt(0)
    v_mfma_f32_32x32x16_bf16 v[176:191], v[156:159], v[252:255], v[176:191]
    s_add_u32 s20, s20, 128
    s_cmp_eq_u32 s17, 0
    s_cbranch_scc1 drain0y_g3_kernel_5
    s_sub_u32 s17, s17, 1
    s_branch loopy_g3_kernel_4
spin_g3_kernel_8:
    ds_read_b32 v18, v19
    s_waitcnt lgkmcnt(0)
    v_readfirstlane_b32 s56, v18
    s_cmp_ge_u32 s56, s57
    s_cbranch_scc0 spin_g3_kernel_8
    s_branch back_g3_kernel_9
spin_g3_kernel_10:
    ds_read_b32 v18, v19
    s_waitcnt lgkmcnt(0)
    v_readfirstlane_b32 s56, v18
    s_cmp_ge_u32 s56, s57
    s_cbranch_scc0 spin_g3_kernel_10
    s_branch back_g3_kernel_11
spin_g3_kernel_12:
    ds_read_b32 v18, v19
    s_waitcnt lgkmcnt(0)
    v_readfirstlane_b32 s56, v18
    s_cmp_ge_u32 s56, s57
    s_cbranch_scc0 spin_g3_kernel_12
    s_branch back_g3_kernel_13
spin_g3_kernel_14:
    ds_read_b32 v18, v19
    s_waitcnt lgkmcnt(0)
    v_readfirstlane_b32 s56, v18
    s_cmp_ge_u32 s56, s57
    s_cbranch_scc0 spin_g3_kernel_14
    s_branch back_g3_kernel_15
spin_g3_kernel_16:
    ds_read_b32 v18, v19
    s_waitcnt lgkmcnt(0)
    v_readfirstlane_b32 s56, v18
    s_cmp_ge_u32 s56, s57
    s_cbranch_scc0 spin_g3_kernel_16
    s_branch back_g3_kernel_17
spin_g3_kernel_18:
    ds_read_b32 v18, v19
    s_waitcnt lgkmcnt(0)
    v_readfirstlane_b32 s56, v18
    s_cmp_ge_u32 s56, s57
    s_cbranch_scc0 spin_g3_kernel_18
    s_branch back_g3_kernel_19
spin_g3_kernel_20:
    ds_read_b32 v18, v19
    s_waitcnt lgkmcnt(0)
    v_readfirstlane_b32 s56, v18
    s_cmp_ge_u32 s56, s57
    s_cbranch_scc0 spin_g3_kernel_20
    s_branch back_g3_kernel_21
spin_g3_kernel_22:
    ds_read_b32 v18, v19
    s_waitcnt lgkmcnt(0)
    v_readfirstlane_b32 s56, v18
    s_cmp_ge_u32 s56, s57
    s_cbranch_scc0 spin_g3_kernel_22
    s_branch back_g3_kernel_23
spin_g3_kernel_24:
    ds_read_b32 v18, v19
    s_waitcnt lgkmcnt(0)
    v_readfirstlane_b32 s56, v18
    s_cmp_ge_u32 s56, s57
    s_cbranch_scc0 spin_g3_kernel_24
    s_branch back_g3_kernel_25
spin_g3_kernel_26:
    ds_read_b32 v18, v19
    s_waitcnt lgkmcnt(0)
    v_readfirstlane_b32 s56, v18
    s_cmp_ge_u32 s56, s57
    s_cbranch_scc0 spin_g3_kernel_26
    s_branch back_g3_kernel_27
drain0y_g3_kernel_5:
    s_nop 15
    v_cvt_pk_bf16_f32 v36, v160, v161
    v_cvt_pk_bf16_f32 v37, v162, v163
    v_cvt_pk_bf16_f32 v38, v164, v165
    v_cvt_pk_bf16_f32 v39, v166, v167
    buffer_store_dwordx4 v[36:39], v13, s[12:15], s21 offen offset:0 sc1
    v_cvt_pk_bf16_f32 v40, v168, v169
    v_cvt_pk_bf16_f32 v41, v170, v171
    v_cvt_pk_bf16_f32 v42, v172, v173
    v_cvt_pk_bf16_f32 v43, v174, v175
    buffer_store_dwordx4 v[40:43], v13, s[12:15], s21 offen offset:1024 sc1
    v_cvt_pk_bf16_f32 v44, v176, v177
    v_cvt_pk_bf16_f32 v45, v178, v179
    v_cvt_pk_bf16_f32 v46, v180, v181
    v_cvt_pk_bf16_f32 v47, v182, v183
    buffer_store_dwordx4 v[44:47], v13, s[12:15], s21 offen offset:2048 sc1
    v_cvt_pk_bf16_f32 v48, v184, v185
    v_cvt_pk_bf16_f32 v49, v186, v187
    v_cvt_pk_bf16_f32 v50, v188, v189
    v_cvt_pk_bf16_f32 v51, v190, v191
    buffer_store_dwordx4 v[48:51], v13, s[12:15], s21 offen offset:3072 sc1
    s_add_u32 s21, s21, 4096
    s_add_u32 s22, s22, 4096
    s_branch finy_g3_kernel_7
drain1y_g3_kernel_6:
    s_nop 15
    v_cvt_pk_bf16_f32 v36, v192, v193
    v_cvt_pk_bf16_f32 v37, v194, v195
    v_cvt_pk_bf16_f32 v38, v196, v197
    v_cvt_pk_bf16_f32 v39, v198, v199
    buffer_store_dwordx4 v[36:39], v13, s[12:15], s21 offen offset:0 sc1
    v_cvt_pk_bf16_f32 v40, v200, v201
    v_cvt_pk_bf16_f32 v41, v202, v203
    v_cvt_pk_bf16_f32 v42, v204, v205
    v_cvt_pk_bf16_f32 v43, v206, v207
    buffer_store_dwordx4 v[40:43], v13, s[12:15], s21 offen offset:1024 sc1
    v_cvt_pk_bf16_f32 v44, v208, v209
    v_cvt_pk_bf16_f32 v45, v210, v211
    v_cvt_pk_bf16_f32 v46, v212, v213
    v_cvt_pk_bf16_f32 v47, v214, v215
    buffer_store_dwordx4 v[44:47], v13, s[12:15], s21 offen offset:2048 sc1
    v_cvt_pk_bf16_f32 v48, v216, v217
    v_cvt_pk_bf16_f32 v49, v218, v219
    v_cvt_pk_bf16_f32 v50, v220, v221
    v_cvt_pk_bf16_f32 v51, v222, v223
    buffer_store_dwordx4 v[48:51], v13, s[12:15], s21 offen offset:3072 sc1
    s_add_u32 s21, s21, 4096
    s_add_u32 s22, s22, 4096
finy_g3_kernel_7:
    s_mov_b32 s20, s68
    s_mov_b32 s21, s69
    s_mov_b32 s22, 0x240000
    s_mov_b32 s23, 0x00020000
    s_waitcnt lgkmcnt(0)
    s_lshr_b32 s77, s76, 8
    s_cmp_eq_u32 s77, 4
    s_cbranch_scc0 fn0_g3_kernel_30
    v_dot2_f32_bf16 v160, v20, v56, 0
    v_dot2_f32_bf16 v161, v20, v57, 0
    v_dot2_f32_bf16 v162, v21, v56, 0
    v_dot2_f32_bf16 v163, v21, v57, 0
    v_dot2_f32_bf16 v164, v22, v56, 0
    v_dot2_f32_bf16 v165, v22, v57, 0
    v_dot2_f32_bf16 v166, v23, v56, 0
    v_dot2_f32_bf16 v167, v23, v57, 0
    v_dot2_f32_bf16 v168, v24, v56, 0
    v_dot2_f32_bf16 v169, v24, v57, 0
    v_dot2_f32_bf16 v170, v25, v56, 0
    v_dot2_f32_bf16 v171, v25, v57, 0
    v_dot2_f32_bf16 v172, v26, v56, 0
    v_dot2_f32_bf16 v173, v26, v57, 0
    v_dot2_f32_bf16 v174, v27, v56, 0
    v_dot2_f32_bf16 v175, v27, v57, 0
    v_dot2_f32_bf16 v176, v28, v56, 0
    v_dot2_f32_bf16 v177, v28, v57, 0
    v_dot2_f32_bf16 v178, v29, v56, 0
    v_dot2_f32_bf16 v179, v29, v57, 0
    v_dot2_f32_bf16 v180, v30, v56, 0
    v_dot2_f32_bf16 v181, v30, v57, 0
    v_dot2_f32_bf16 v182, v31, v56, 0
    v_dot2_f32_bf16 v183, v31, v57, 0
    v_lshlrev_b32 v184, 16, v112
    v_and_b32 v185, 0xffff0000, v112
    v_lshlrev_b32 v186, 16, v113
    v_and_b32 v187, 0xffff0000, v113
    v_lshlrev_b32 v188, 16, v114
    v_and_b32 v189, 0xffff0000, v114
    v_lshlrev_b32 v190, 16, v115
    v_and_b32 v191, 0xffff0000, v115
    v_lshlrev_b32 v192, 16, v116
    v_and_b32 v193, 0xffff0000, v116
    v_lshlrev_b32 v194, 16, v117
    v_and_b32 v195, 0xffff0000, v117
    v_lshlrev_b32 v196, 16, v118
    v_and_b32 v197, 0xffff0000, v118
    v_lshlrev_b32 v198, 16, v119
    v_and_b32 v199, 0xffff0000, v119
    v_lshlrev_b32 v200, 16, v120
    v_and_b32 v201, 0xffff0000, v120
    v_lshlrev_b32 v202, 16, v121
    v_and_b32 v203, 0xffff0000, v121
    v_lshlrev_b32 v204, 16, v122
    v_and_b32 v205, 0xffff0000, v122
    v_lshlrev_b32 v206, 16, v123
    v_and_b32 v207, 0xffff0000, v123
    s_waitcnt vmcnt(10)
    v_dot2_f32_bf16 v208, v64, v56, 0
    v_dot2_f32_bf16 v209, v64, v57, 0
    v_dot2_f32_bf16 v210, v65, v56, 0
    v_dot2_f32_bf16 v211, v65, v57, 0
    v_dot2_f32_bf16 v212, v66, v56, 0
    v_dot2_f32_bf16 v213, v66, v57, 0
    v_dot2_f32_bf16 v214, v67, v56, 0
    v_dot2_f32_bf16 v215, v67, v57, 0
    v_dot2_f32_bf16 v216, v80, v56, 0
    v_dot2_f32_bf16 v217, v80, v57, 0
    v_dot2_f32_bf16 v218, v81, v56, 0
    v_dot2_f32_bf16 v219, v81, v57, 0
    v_dot2_f32_bf16 v220, v82, v56, 0
    v_dot2_f32_bf16 v221, v82, v57, 0
    v_dot2_f32_bf16 v222, v83, v56, 0
    v_dot2_f32_bf16 v223, v83, v57, 0
    s_waitcnt vmcnt(8)
    v_dot2_f32_bf16 v208, v68, v56, v208
    v_dot2_f32_bf16 v209, v68, v57, v209
    v_dot2_f32_bf16 v210, v69, v56, v210
    v_dot2_f32_bf16 v211, v69, v57, v211
    v_dot2_f32_bf16 v212, v70, v56, v212
    v_dot2_f32_bf16 v213, v70, v57, v213
    v_dot2_f32_bf16 v214, v71, v56, v214
    v_dot2_f32_bf16 v215, v71, v57, v215
    v_dot2_f32_bf16 v216, v84, v56, v216
    v_dot2_f32_bf16 v217, v84, v57, v217
    v_dot2_f32_bf16 v218, v85, v56, v218
    v_dot2_f32_bf16 v219, v85, v57, v219
    v_dot2_f32_bf16 v220, v86, v56, v220
    v_dot2_f32_bf16 v221, v86, v57, v221
    v_dot2_f32_bf16 v222, v87, v56, v222
    v_dot2_f32_bf16 v223, v87, v57, v223
    s_waitcnt vmcnt(6)
    v_dot2_f32_bf16 v208, v72, v56, v208
    v_dot2_f32_bf16 v209, v72, v57, v209
    v_dot2_f32_bf16 v210, v73, v56, v210
    v_dot2_f32_bf16 v211, v73, v57, v211
    v_dot2_f32_bf16 v212, v74, v56, v212
    v_dot2_f32_bf16 v213, v74, v57, v213
    v_dot2_f32_bf16 v214, v75, v56, v214
    v_dot2_f32_bf16 v215, v75, v57, v215
    v_dot2_f32_bf16 v216, v88, v56, v216
    v_dot2_f32_bf16 v217, v88, v57, v217
    v_dot2_f32_bf16 v218, v89, v56, v218
    v_dot2_f32_bf16 v219, v89, v57, v219
    v_dot2_f32_bf16 v220, v90, v56, v220
    v_dot2_f32_bf16 v221, v90, v57, v221
    v_dot2_f32_bf16 v222, v91, v56, v222
    v_dot2_f32_bf16 v223, v91, v57, v223
    s_waitcnt vmcnt(4)
    v_dot2_f32_bf16 v208, v76, v56, v208
    v_dot2_f32_bf16 v209, v76, v57, v209
    v_dot2_f32_bf16 v210, v77, v56, v210
    v_dot2_f32_bf16 v211, v77, v57, v211
    v_dot2_f32_bf16 v212, v78, v56, v212
    v_dot2_f32_bf16 v213, v78, v57, v213
    v_dot2_f32_bf16 v214, v79, v56, v214
    v_dot2_f32_bf16 v215, v79, v57, v215
    v_dot2_f32_bf16 v216, v92, v56, v216
    v_dot2_f32_bf16 v217, v92, v57, v217
    v_dot2_f32_bf16 v218, v93, v56, v218
    v_dot2_f32_bf16 v219, v93, v57, v219
    v_dot2_f32_bf16 v220, v94, v56, v220
    v_dot2_f32_bf16 v221, v94, v57, v221
    v_dot2_f32_bf16 v222, v95, v56, v222
    v_dot2_f32_bf16 v223, v95, v57, v223
    s_waitcnt vmcnt(0)
    buffer_atomic_add v33, v59, s[92:95], s88 offen sc0 sc1
    v_cvt_pk_bf16_f32 v232, v208, v209
    v_cvt_pk_bf16_f32 v233, v210, v211
    v_cvt_pk_bf16_f32 v234, v212, v213
    v_cvt_pk_bf16_f32 v235, v214, v215
    v_cvt_pk_bf16_f32 v236, v216, v217
    v_cvt_pk_bf16_f32 v237, v218, v219
    v_cvt_pk_bf16_f32 v238, v220, v221
    v_cvt_pk_bf16_f32 v239, v222, v223
    v_dot2_f32_bf16 v208, v232, v56, v160
    v_dot2_f32_bf16 v209, v232, v57, v161
    v_dot2_f32_bf16 v210, v233, v56, v162
    v_dot2_f32_bf16 v211, v233, v57, v163
    v_dot2_f32_bf16 v212, v234, v56, v164
    v_dot2_f32_bf16 v213, v234, v57, v165
    v_dot2_f32_bf16 v214, v235, v56, v166
    v_dot2_f32_bf16 v215, v235, v57, v167
    v_dot2_f32_bf16 v216, v236, v56, v168
    v_dot2_f32_bf16 v217, v236, v57, v169
    v_dot2_f32_bf16 v218, v237, v56, v170
    v_dot2_f32_bf16 v219, v237, v57, v171
    v_dot2_f32_bf16 v220, v238, v56, v172
    v_dot2_f32_bf16 v221, v238, v57, v173
    v_dot2_f32_bf16 v222, v239, v56, v174
    v_dot2_f32_bf16 v223, v239, v57, v175
    v_cvt_pk_bf16_f32 v232, v208, v209
    v_cvt_pk_bf16_f32 v233, v210, v211
    v_cvt_pk_bf16_f32 v234, v212, v213
    v_cvt_pk_bf16_f32 v235, v214, v215
    v_cvt_pk_bf16_f32 v236, v216, v217
    v_cvt_pk_bf16_f32 v237, v218, v219
    v_cvt_pk_bf16_f32 v238, v220, v221
    v_cvt_pk_bf16_f32 v239, v222, v223
    v_dot2_f32_bf16 v208, v232, v56, 0
    v_dot2_f32_bf16 v209, v232, v57, 0
    v_dot2_f32_bf16 v210, v233, v56, 0
    v_dot2_f32_bf16 v211, v233, v57, 0
    v_dot2_f32_bf16 v212, v234, v56, 0
    v_dot2_f32_bf16 v213, v234, v57, 0
    v_dot2_f32_bf16 v214, v235, v56, 0
    v_dot2_f32_bf16 v215, v235, v57, 0
    v_dot2_f32_bf16 v216, v236, v56, 0
    v_dot2_f32_bf16 v217, v236, v57, 0
    v_dot2_f32_bf16 v218, v237, v56, 0
    v_dot2_f32_bf16 v219, v237, v57, 0
    v_dot2_f32_bf16 v220, v238, v56, 0
    v_dot2_f32_bf16 v221, v238, v57, 0
    v_dot2_f32_bf16 v222, v239, v56, 0
    v_dot2_f32_bf16 v223, v239, v57, 0
    v_mul_f32 v232, 0xbfb8aa3b, v208
    v_mul_f32 v233, 0xbfb8aa3b, v209
    v_mul_f32 v234, 0xbfb8aa3b, v210
    v_mul_f32 v235, 0xbfb8aa3b, v211
    v_mul_f32 v236, 0xbfb8aa3b, v212
    v_mul_f32 v237, 0xbfb8aa3b, v213
    v_mul_f32 v238, 0xbfb8aa3b, v214
    v_mul_f32 v239, 0xbfb8aa3b, v215
    v_mul_f32 v240, 0xbfb8aa3b, v216
    v_mul_f32 v241, 0xbfb8aa3b, v217
    v_mul_f32 v242, 0xbfb8aa3b, v218
    v_mul_f32 v243, 0xbfb8aa3b, v219
    v_mul_f32 v244, 0xbfb8aa3b, v220
    v_mul_f32 v245, 0xbfb8aa3b, v221
    v_mul_f32 v246, 0xbfb8aa3b, v222
    v_mul_f32 v247, 0xbfb8aa3b, v223
    v_exp_f32 v232, v232
    v_exp_f32 v233, v233
    v_exp_f32 v234, v234
    v_exp_f32 v235, v235
    v_exp_f32 v236, v236
    v_exp_f32 v237, v237
    v_exp_f32 v238, v238
    v_exp_f32 v239, v239
    v_exp_f32 v240, v240
    v_exp_f32 v241, v241
    v_exp_f32 v242, v242
    v_exp_f32 v243, v243
    v_exp_f32 v244, v244
    v_exp_f32 v245, v245
    v_exp_f32 v246, v246
    v_exp_f32 v247, v247
    buffer_load_dword v34, v59, s[92:95], s80 offen sc0 sc1
    v_add_f32 v232, 1.0, v232
    v_add_f32 v233, 1.0, v233
    v_add_f32 v234, 1.0, v234
    v_add_f32 v235, 1.0, v235
    v_add_f32 v236, 1.0, v236
    v_add_f32 v237, 1.0, v237
    v_add_f32 v238, 1.0, v238
    v_add_f32 v239, 1.0, v239
    v_add_f32 v240, 1.0, v240
    v_add_f32 v241, 1.0, v241
    v_add_f32 v242, 1.0, v242
    v_add_f32 v243, 1.0, v243
    v_add_f32 v244, 1.0, v244
    v_add_f32 v245, 1.0, v245
    v_add_f32 v246, 1.0, v246
    v_add_f32 v247, 1.0, v247
    v_rcp_f32 v232, v232
    v_rcp_f32 v233, v233
    v_rcp_f32 v234, v234
    v_rcp_f32 v235, v235
    v_rcp_f32 v236, v236
    v_rcp_f32 v237, v237
    v_rcp_f32 v238, v238
    v_rcp_f32 v239, v239
    v_rcp_f32 v240, v240
    v_rcp_f32 v241, v241
    v_rcp_f32 v242, v242
    v_rcp_f32 v243, v243
    v_rcp_f32 v244, v244
    v_rcp_f32 v245, v245
    v_rcp_f32 v246, v246
    v_rcp_f32 v247, v247
    v_mul_f32 v208, v208, v232
    v_mul_f32 v209, v209, v233
    v_mul_f32 v210, v210, v234
    v_mul_f32 v211, v211, v235
    v_mul_f32 v212, v212, v236
    v_mul_f32 v213, v213, v237
    v_mul_f32 v214, v214, v238
    v_mul_f32 v215, v215, v239
    v_mul_f32 v216, v216, v240
    v_mul_f32 v217, v217, v241
    v_mul_f32 v218, v218, v242
    v_mul_f32 v219, v219, v243
    v_mul_f32 v220, v220, v244
    v_mul_f32 v221, v221, v245
    v_mul_f32 v222, v222, v246
    v_mul_f32 v223, v223, v247
    v_cvt_pk_bf16_f32 v160, v208, 0
    v_cvt_pk_bf16_f32 v161, 0, v209
    v_cvt_pk_bf16_f32 v162, v210, 0
    v_cvt_pk_bf16_f32 v163, 0, v211
    v_cvt_pk_bf16_f32 v164, v212, 0
    v_cvt_pk_bf16_f32 v165, 0, v213
    v_cvt_pk_bf16_f32 v166, v214, 0
    v_cvt_pk_bf16_f32 v167, 0, v215
    v_cvt_pk_bf16_f32 v168, v216, 0
    v_cvt_pk_bf16_f32 v169, 0, v217
    v_cvt_pk_bf16_f32 v170, v218, 0
    v_cvt_pk_bf16_f32 v171, 0, v219
    v_cvt_pk_bf16_f32 v172, v220, 0
    v_cvt_pk_bf16_f32 v173, 0, v221
    v_cvt_pk_bf16_f32 v174, v222, 0
    v_cvt_pk_bf16_f32 v175, 0, v223
    s_waitcnt vmcnt(0)
    s_lshl_b32 s77, s71, 2
    s_add_u32 s77, s77, s35
    s_lshl_b32 s77, 1, s77
    v_readfirstlane_b32 s78, v33
    s_cmp_eq_u32 s78, 0x423
    s_cselect_b32 s74, s77, 0
    v_readfirstlane_b32 s76, v34
fpe_g3_kernel_31:
    s_cmp_eq_u32 s76, 0x424
    s_cbranch_scc1 fge_g3_kernel_32
    s_sub_u32 s75, s75, 1
    s_cmp_eq_u32 s75, 0
    s_cbranch_scc1 fnext_g3_kernel_28
    buffer_load_dword v34, v59, s[92:95], s80 offen sc0 sc1
    s_waitcnt vmcnt(0)
    v_readfirstlane_b32 s76, v34
    s_branch fpe_g3_kernel_31
fge_g3_kernel_32:
    buffer_store_dword v32, v59, s[92:95], s87 offen offset:16 sc0 sc1
    buffer_load_dwordx4 v[96:99], v55, s[12:15], s82 offen offset:0 sc0 sc1
    s_add_u32 s82, s82, 2359296
    buffer_load_dwordx4 v[100:103], v55, s[12:15], s82 offen offset:0 sc0 sc1
    s_add_u32 s82, s82, 2359296
    buffer_load_dwordx4 v[104:107], v55, s[12:15], s82 offen offset:0 sc0 sc1
    s_add_u32 s82, s82, 2359296
    buffer_load_dwordx4 v[108:111], v55, s[12:15], s82 offen offset:0 sc0 sc1
    s_add_u32 s82, s82, 2359296
    buffer_load_dwordx4 v[128:131], v55, s[12:15], s81 offen offset:0 sc0 sc1
    buffer_load_dwordx4 v[136:139], v55, s[12:15], s81 offen offset:1024 sc0 sc1
    buffer_load_dwordx4 v[144:147], v55, s[12:15], s82 offen offset:0 sc0 sc1
    s_add_u32 s81, s81, 2359296
    s_add_u32 s82, s82, 2359296
    buffer_load_dwordx4 v[132:135], v55, s[12:15], s81 offen offset:0 sc0 sc1
    buffer_load_dwordx4 v[140:143], v55, s[12:15], s81 offen offset:1024 sc0 sc1
    buffer_load_dwordx4 v[148:151], v55, s[12:15], s82 offen offset:0 sc0 sc1
    s_add_u32 s81, s81, 2359296
    s_add_u32 s82, s82, 2359296
    s_waitcnt vmcnt(9)
    v_dot2_f32_bf16 v224, v96, v56, 0
    v_dot2_f32_bf16 v225, v96, v57, 0
    v_dot2_f32_bf16 v226, v97, v56, 0
    v_dot2_f32_bf16 v227, v97, v57, 0
    v_dot2_f32_bf16 v228, v98, v56, 0
    v_dot2_f32_bf16 v229, v98, v57, 0
    v_dot2_f32_bf16 v230, v99, v56, 0
    v_dot2_f32_bf16 v231, v99, v57, 0
    s_waitcnt vmcnt(8)
    v_dot2_f32_bf16 v224, v100, v56, v224
    v_dot2_f32_bf16 v225, v100, v57, v225
    v_dot2_f32_bf16 v226, v101, v56, v226
    v_dot2_f32_bf16 v227, v101, v57, v227
    v_dot2_f32_bf16 v228, v102, v56, v228
    v_dot2_f32_bf16 v229, v102, v57, v229
    v_dot2_f32_bf16 v230, v103, v56, v230
    v_dot2_f32_bf16 v231, v103, v57, v231
    s_waitcnt vmcnt(7)
    v_dot2_f32_bf16 v224, v104, v56, v224
    v_dot2_f32_bf16 v225, v104, v57, v225
    v_dot2_f32_bf16 v226, v105, v56, v226
    v_dot2_f32_bf16 v227, v105, v57, v227
    v_dot2_f32_bf16 v228, v106, v56, v228
    v_dot2_f32_bf16 v229, v106, v57, v229
    v_dot2_f32_bf16 v230, v107, v56, v230
    v_dot2_f32_bf16 v231, v107, v57, v231
    s_waitcnt vmcnt(6)
    v_dot2_f32_bf16 v224, v108, v56, v224
    v_dot2_f32_bf16 v225, v108, v57, v225
    v_dot2_f32_bf16 v226, v109, v56, v226
    v_dot2_f32_bf16 v227, v109, v57, v227
    v_dot2_f32_bf16 v228, v110, v56, v228
    v_dot2_f32_bf16 v229, v110, v57, v229
    v_dot2_f32_bf16 v230, v111, v56, v230
    v_dot2_f32_bf16 v231, v111, v57, v231
    s_nop 1
    v_cvt_pk_bf16_f32 v240, v224, v225
    v_cvt_pk_bf16_f32 v241, v226, v227
    v_cvt_pk_bf16_f32 v242, v228, v229
    v_cvt_pk_bf16_f32 v243, v230, v231
    v_dot2_f32_bf16 v224, v240, v56, v176
    v_dot2_f32_bf16 v225, v240, v57, v177
    v_dot2_f32_bf16 v226, v241, v56, v178
    v_dot2_f32_bf16 v227, v241, v57, v179
    v_dot2_f32_bf16 v228, v242, v56, v180
    v_dot2_f32_bf16 v229, v242, v57, v181
    v_dot2_f32_bf16 v230, v243, v56, v182
    v_dot2_f32_bf16 v231, v243, v57, v183
    s_nop 1
    v_cvt_pk_bf16_f32 v240, v224, v225
    v_cvt_pk_bf16_f32 v241, v226, v227
    v_cvt_pk_bf16_f32 v242, v228, v229
    v_cvt_pk_bf16_f32 v243, v230, v231
    v_dot2_f32_bf16 v224, v240, v56, 0
    v_dot2_f32_bf16 v225, v240, v57, 0
    v_dot2_f32_bf16 v226, v241, v56, 0
    v_dot2_f32_bf16 v227, v241, v57, 0
    v_dot2_f32_bf16 v228, v242, v56, 0
    v_dot2_f32_bf16 v229, v242, v57, 0
    v_dot2_f32_bf16 v230, v243, v56, 0
    v_dot2_f32_bf16 v231, v243, v57, 0
    v_mul_f32 v248, 0xbfb8aa3b, v224
    v_mul_f32 v249, 0xbfb8aa3b, v225
    v_mul_f32 v250, 0xbfb8aa3b, v226
    v_mul_f32 v251, 0xbfb8aa3b, v227
    v_mul_f32 v252, 0xbfb8aa3b, v228
    v_mul_f32 v253, 0xbfb8aa3b, v229
    v_mul_f32 v254, 0xbfb8aa3b, v230
    v_mul_f32 v255, 0xbfb8aa3b, v231
    v_exp_f32 v248, v248
    v_exp_f32 v249, v249
    v_exp_f32 v250, v250
    v_exp_f32 v251, v251
    v_exp_f32 v252, v252
    v_exp_f32 v253, v253
    v_exp_f32 v254, v254
    v_exp_f32 v255, v255
    v_add_f32 v248, 1.0, v248
    v_add_f32 v249, 1.0, v249
    v_add_f32 v250, 1.0, v250
    v_add_f32 v251, 1.0, v251
    v_add_f32 v252, 1.0, v252
    v_add_f32 v253, 1.0, v253
    v_add_f32 v254, 1.0, v254
    v_add_f32 v255, 1.0, v255
    v_rcp_f32 v248, v248
    v_rcp_f32 v249, v249
    v_rcp_f32 v250, v250
    v_rcp_f32 v251, v251
    v_rcp_f32 v252, v252
    v_rcp_f32 v253, v253
    v_rcp_f32 v254, v254
    v_rcp_f32 v255, v255
    v_mul_f32 v224, v224, v248
    v_mul_f32 v225, v225, v249
    v_mul_f32 v226, v226, v250
    v_mul_f32 v227, v227, v251
    v_mul_f32 v228, v228, v252
    v_mul_f32 v229, v229, v253
    v_mul_f32 v230, v230, v254
    v_mul_f32 v231, v231, v255
    v_cvt_pk_bf16_f32 v176, v224, 0
    v_cvt_pk_bf16_f32 v177, 0, v225
    v_cvt_pk_bf16_f32 v178, v226, 0
    v_cvt_pk_bf16_f32 v179, 0, v227
    v_cvt_pk_bf16_f32 v180, v228, 0
    v_cvt_pk_bf16_f32 v181, 0, v229
    v_cvt_pk_bf16_f32 v182, v230, 0
    v_cvt_pk_bf16_f32 v183, 0, v231
    s_branch fph2_g3_kernel_35
fn0_g3_kernel_30:
    s_waitcnt vmcnt(0)
    buffer_atomic_add v33, v59, s[92:95], s88 offen sc0 sc1
    s_waitcnt vmcnt(0)
    s_lshl_b32 s77, s71, 2
    s_add_u32 s77, s77, s35
    s_lshl_b32 s77, 1, s77
    v_readfirstlane_b32 s78, v33
    s_cmp_eq_u32 s78, 0x423
    s_cselect_b32 s74, s77, 0
floop_g3_kernel_29:
    s_lshr_b32 s77, s72, 2
    s_and_b32 s78, s72, 3
    s_lshl_b32 s80, s71, 2
    s_add_u32 s80, s80, s77
    s_lshl_b32 s80, s80, 6
    s_add_u32 s80, s80, s90
    s_lshl_b32 s79, s70, 2
    s_add_u32 s79, s79, s77
    s_mul_i32 s79, s79, 36864
    s_mul_i32 s77, s71, 12
    s_add_u32 s86, s77, s78
    s_add_u32 s85, s86, s78
    s_add_u32 s86, s86, 8
    s_lshl_b32 s81, s85, 10
    s_lshl_b32 s82, s86, 10
    s_add_u32 s81, s81, s79
    s_add_u32 s82, s82, s79
    s_lshl_b32 s85, s85, 5
    s_lshl_b32 s86, s86, 5
    s_add_u32 s83, s85, s79
    s_add_u32 s84, s86, s79
    s_lshl_b32 s87, s78, 2
    s_add_u32 s87, s87, s80
    s_movk_i32 s75, 96
    buffer_load_dwordx2 v[112:113], v53, s[64:67], s83 offen offset:0
    buffer_load_dwordx2 v[20:21], v52, s[96:99], s85 offen offset:0
    buffer_load_dwordx2 v[114:115], v53, s[64:67], s83 offen offset:16
    buffer_load_dwordx2 v[22:23], v52, s[96:99], s85 offen offset:16
    buffer_load_dwordx2 v[116:117], v53, s[64:67], s83 offen offset:32
    buffer_load_dwordx2 v[24:25], v52, s[96:99], s85 offen offset:32
    buffer_load_dwordx2 v[118:119], v53, s[64:67], s83 offen offset:48
    buffer_load_dwordx2 v[26:27], v52, s[96:99], s85 offen offset:48
    buffer_load_dwordx2 v[120:121], v53, s[64:67], s84 offen offset:0
    buffer_load_dwordx2 v[28:29], v52, s[96:99], s86 offen offset:0
    buffer_load_dwordx2 v[122:123], v53, s[64:67], s84 offen offset:16
    buffer_load_dwordx2 v[30:31], v52, s[96:99], s86 offen offset:16
fwait_g3_kernel_33:
    s_cmp_eq_u32 s76, 0x424
    s_cbranch_scc1 fgo_g3_kernel_34
    s_sub_u32 s75, s75, 1
    s_cmp_eq_u32 s75, 0
    s_cbranch_scc1 fnext_g3_kernel_28
    buffer_load_dword v34, v59, s[92:95], s80 offen sc0 sc1
    s_waitcnt vmcnt(0)
    v_readfirstlane_b32 s76, v34
    s_branch fwait_g3_kernel_33
fgo_g3_kernel_34:
    buffer_store_dword v32, v59, s[92:95], s87 offen offset:16 sc0 sc1
    buffer_load_dwordx4 v[64:67], v55, s[12:15], s81 offen offset:0 sc0 sc1
    buffer_load_dwordx4 v[80:83], v55, s[12:15], s81 offen offset:1024 sc0 sc1
    buffer_load_dwordx4 v[96:99], v55, s[12:15], s82 offen offset:0 sc0 sc1
    s_add_u32 s81, s81, 2359296
    s_add_u32 s82, s82, 2359296
    buffer_load_dwordx4 v[68:71], v55, s[12:15], s81 offen offset:0 sc0 sc1
    buffer_load_dwordx4 v[84:87], v55, s[12:15], s81 offen offset:1024 sc0 sc1
    buffer_load_dwordx4 v[100:103], v55, s[12:15], s82 offen offset:0 sc0 sc1
    s_add_u32 s81, s81, 2359296
    s_add_u32 s82, s82, 2359296
    buffer_load_dwordx4 v[72:75], v55, s[12:15], s81 offen offset:0 sc0 sc1
    buffer_load_dwordx4 v[88:91], v55, s[12:15], s81 offen offset:1024 sc0 sc1
    buffer_load_dwordx4 v[104:107], v55, s[12:15], s82 offen offset:0 sc0 sc1
    s_add_u32 s81, s81, 2359296
    s_add_u32 s82, s82, 2359296
    buffer_load_dwordx4 v[76:79], v55, s[12:15], s81 offen offset:0 sc0 sc1
    buffer_load_dwordx4 v[92:95], v55, s[12:15], s81 offen offset:1024 sc0 sc1
    buffer_load_dwordx4 v[108:111], v55, s[12:15], s82 offen offset:0 sc0 sc1
    s_add_u32 s81, s81, 2359296
    s_add_u32 s82, s82, 2359296
    buffer_load_dwordx4 v[128:131], v55, s[12:15], s81 offen offset:0 sc0 sc1
    buffer_load_dwordx4 v[136:139], v55, s[12:15], s81 offen offset:1024 sc0 sc1
    buffer_load_dwordx4 v[144:147], v55, s[12:15], s82 offen offset:0 sc0 sc1
    s_add_u32 s81, s81, 2359296
    s_add_u32 s82, s82, 2359296
    buffer_load_dwordx4 v[132:135], v55, s[12:15], s81 offen offset:0 sc0 sc1
    buffer_load_dwordx4 v[140:143], v55, s[12:15], s81 offen offset:1024 sc0 sc1
    buffer_load_dwordx4 v[148:151], v55, s[12:15], s82 offen offset:0 sc0 sc1
    s_add_u32 s81, s81, 2359296
    s_add_u32 s82, s82, 2359296
    s_waitcnt vmcnt(18)
    v_dot2_f32_bf16 v160, v20, v56, 0
    v_dot2_f32_bf16 v161, v20, v57, 0
    v_dot2_f32_bf16 v162, v21, v56, 0
    v_dot2_f32_bf16 v163, v21, v57, 0
    v_dot2_f32_bf16 v164, v22, v56, 0
    v_dot2_f32_bf16 v165, v22, v57, 0
    v_dot2_f32_bf16 v166, v23, v56, 0
    v_dot2_f32_bf16 v167, v23, v57, 0
    v_dot2_f32_bf16 v168, v24, v56, 0
    v_dot2_f32_bf16 v169, v24, v57, 0
    v_dot2_f32_bf16 v170, v25, v56, 0
    v_dot2_f32_bf16 v171, v25, v57, 0
    v_dot2_f32_bf16 v172, v26, v56, 0
    v_dot2_f32_bf16 v173, v26, v57, 0
    v_dot2_f32_bf16 v174, v27, v56, 0
    v_dot2_f32_bf16 v175, v27, v57, 0
    v_dot2_f32_bf16 v176, v28, v56, 0
    v_dot2_f32_bf16 v177, v28, v57, 0
    v_dot2_f32_bf16 v178, v29, v56, 0
    v_dot2_f32_bf16 v179, v29, v57, 0
    v_dot2_f32_bf16 v180, v30, v56, 0
    v_dot2_f32_bf16 v181, v30, v57, 0
    v_dot2_f32_bf16 v182, v31, v56, 0
    v_dot2_f32_bf16 v183, v31, v57, 0
    v_lshlrev_b32 v184, 16, v112
    v_and_b32 v185, 0xffff0000, v112
    v_lshlrev_b32 v186, 16, v113
    v_and_b32 v187, 0xffff0000, v113
    v_lshlrev_b32 v188, 16, v114
    v_and_b32 v189, 0xffff0000, v114
    v_lshlrev_b32 v190, 16, v115
    v_and_b32 v191, 0xffff0000, v115
    v_lshlrev_b32 v192, 16, v116
    v_and_b32 v193, 0xffff0000, v116
    v_lshlrev_b32 v194, 16, v117
    v_and_b32 v195, 0xffff0000, v117
    v_lshlrev_b32 v196, 16, v118
    v_and_b32 v197, 0xffff0000, v118
    v_lshlrev_b32 v198, 16, v119
    v_and_b32 v199, 0xffff0000, v119
    v_lshlrev_b32 v200, 16, v120
    v_and_b32 v201, 0xffff0000, v120
    v_lshlrev_b32 v202, 16, v121
    v_and_b32 v203, 0xffff0000, v121
    v_lshlrev_b32 v204, 16, v122
    v_and_b32 v205, 0xffff0000, v122
    v_lshlrev_b32 v206, 16, v123
    v_and_b32 v207, 0xffff0000, v123
    s_waitcnt vmcnt(15)
    v_dot2_f32_bf16 v208, v64, v56, 0
    v_dot2_f32_bf16 v209, v64, v57, 0
    v_dot2_f32_bf16 v210, v65, v56, 0
    v_dot2_f32_bf16 v211, v65, v57, 0
    v_dot2_f32_bf16 v212, v66, v56, 0
    v_dot2_f32_bf16 v213, v66, v57, 0
    v_dot2_f32_bf16 v214, v67, v56, 0
    v_dot2_f32_bf16 v215, v67, v57, 0
    v_dot2_f32_bf16 v216, v80, v56, 0
    v_dot2_f32_bf16 v217, v80, v57, 0
    v_dot2_f32_bf16 v218, v81, v56, 0
    v_dot2_f32_bf16 v219, v81, v57, 0
    v_dot2_f32_bf16 v220, v82, v56, 0
    v_dot2_f32_bf16 v221, v82, v57, 0
    v_dot2_f32_bf16 v222, v83, v56, 0
    v_dot2_f32_bf16 v223, v83, v57, 0
    v_dot2_f32_bf16 v224, v96, v56, 0
    v_dot2_f32_bf16 v225, v96, v57, 0
    v_dot2_f32_bf16 v226, v97, v56, 0
    v_dot2_f32_bf16 v227, v97, v57, 0
    v_dot2_f32_bf16 v228, v98, v56, 0
    v_dot2_f32_bf16 v229, v98, v57, 0
    v_dot2_f32_bf16 v230, v99, v56, 0
    v_dot2_f32_bf16 v231, v99, v57, 0
    s_waitcnt vmcnt(12)
    v_dot2_f32_bf16 v208, v68, v56, v208
    v_dot2_f32_bf16 v209, v68, v57, v209
    v_dot2_f32_bf16 v210, v69, v56, v210
    v_dot2_f32_bf16 v211, v69, v57, v211
    v_dot2_f32_bf16 v212, v70, v56, v212
    v_dot2_f32_bf16 v213, v70, v57, v213
    v_dot2_f32_bf16 v214, v71, v56, v214
    v_dot2_f32_bf16 v215, v71, v57, v215
    v_dot2_f32_bf16 v216, v84, v56, v216
    v_dot2_f32_bf16 v217, v84, v57, v217
    v_dot2_f32_bf16 v218, v85, v56, v218
    v_dot2_f32_bf16 v219, v85, v57, v219
    v_dot2_f32_bf16 v220, v86, v56, v220
    v_dot2_f32_bf16 v221, v86, v57, v221
    v_dot2_f32_bf16 v222, v87, v56, v222
    v_dot2_f32_bf16 v223, v87, v57, v223
    v_dot2_f32_bf16 v224, v100, v56, v224
    v_dot2_f32_bf16 v225, v100, v57, v225
    v_dot2_f32_bf16 v226, v101, v56, v226
    v_dot2_f32_bf16 v227, v101, v57, v227
    v_dot2_f32_bf16 v228, v102, v56, v228
    v_dot2_f32_bf16 v229, v102, v57, v229
    v_dot2_f32_bf16 v230, v103, v56, v230
    v_dot2_f32_bf16 v231, v103, v57, v231
    s_waitcnt vmcnt(9)
    v_dot2_f32_bf16 v208, v72, v56, v208
    v_dot2_f32_bf16 v209, v72, v57, v209
    v_dot2_f32_bf16 v210, v73, v56, v210
    v_dot2_f32_bf16 v211, v73, v57, v211
    v_dot2_f32_bf16 v212, v74, v56, v212
    v_dot2_f32_bf16 v213, v74, v57, v213
    v_dot2_f32_bf16 v214, v75, v56, v214
    v_dot2_f32_bf16 v215, v75, v57, v215
    v_dot2_f32_bf16 v216, v88, v56, v216
    v_dot2_f32_bf16 v217, v88, v57, v217
    v_dot2_f32_bf16 v218, v89, v56, v218
    v_dot2_f32_bf16 v219, v89, v57, v219
    v_dot2_f32_bf16 v220, v90, v56, v220
    v_dot2_f32_bf16 v221, v90, v57, v221
    v_dot2_f32_bf16 v222, v91, v56, v222
    v_dot2_f32_bf16 v223, v91, v57, v223
    v_dot2_f32_bf16 v224, v104, v56, v224
    v_dot2_f32_bf16 v225, v104, v57, v225
    v_dot2_f32_bf16 v226, v105, v56, v226
    v_dot2_f32_bf16 v227, v105, v57, v227
    v_dot2_f32_bf16 v228, v106, v56, v228
    v_dot2_f32_bf16 v229, v106, v57, v229
    v_dot2_f32_bf16 v230, v107, v56, v230
    v_dot2_f32_bf16 v231, v107, v57, v231
    s_waitcnt vmcnt(6)
    v_dot2_f32_bf16 v208, v76, v56, v208
    v_dot2_f32_bf16 v209, v76, v57, v209
    v_dot2_f32_bf16 v210, v77, v56, v210
    v_dot2_f32_bf16 v211, v77, v57, v211
    v_dot2_f32_bf16 v212, v78, v56, v212
    v_dot2_f32_bf16 v213, v78, v57, v213
    v_dot2_f32_bf16 v214, v79, v56, v214
    v_dot2_f32_bf16 v215, v79, v57, v215
    v_dot2_f32_bf16 v216, v92, v56, v216
    v_dot2_f32_bf16 v217, v92, v57, v217
    v_dot2_f32_bf16 v218, v93, v56, v218
    v_dot2_f32_bf16 v219, v93, v57, v219
    v_dot2_f32_bf16 v220, v94, v56, v220
    v_dot2_f32_bf16 v221, v94, v57, v221
    v_dot2_f32_bf16 v222, v95, v56, v222
    v_dot2_f32_bf16 v223, v95, v57, v223
    v_dot2_f32_bf16 v224, v108, v56, v224
    v_dot2_f32_bf16 v225, v108, v57, v225
    v_dot2_f32_bf16 v226, v109, v56, v226
    v_dot2_f32_bf16 v227, v109, v57, v227
    v_dot2_f32_bf16 v228, v110, v56, v228
    v_dot2_f32_bf16 v229, v110, v57, v229
    v_dot2_f32_bf16 v230, v111, v56, v230
    v_dot2_f32_bf16 v231, v111, v57, v231
    v_cvt_pk_bf16_f32 v232, v208, v209
    v_cvt_pk_bf16_f32 v233, v210, v211
    v_cvt_pk_bf16_f32 v234, v212, v213
    v_cvt_pk_bf16_f32 v235, v214, v215
    v_cvt_pk_bf16_f32 v236, v216, v217
    v_cvt_pk_bf16_f32 v237, v218, v219
    v_cvt_pk_bf16_f32 v238, v220, v221
    v_cvt_pk_bf16_f32 v239, v222, v223
    v_cvt_pk_bf16_f32 v240, v224, v225
    v_cvt_pk_bf16_f32 v241, v226, v227
    v_cvt_pk_bf16_f32 v242, v228, v229
    v_cvt_pk_bf16_f32 v243, v230, v231
    v_dot2_f32_bf16 v208, v232, v56, v160
    v_dot2_f32_bf16 v209, v232, v57, v161
    v_dot2_f32_bf16 v210, v233, v56, v162
    v_dot2_f32_bf16 v211, v233, v57, v163
    v_dot2_f32_bf16 v212, v234, v56, v164
    v_dot2_f32_bf16 v213, v234, v57, v165
    v_dot2_f32_bf16 v214, v235, v56, v166
    v_dot2_f32_bf16 v215, v235, v57, v167
    v_dot2_f32_bf16 v216, v236, v56, v168
    v_dot2_f32_bf16 v217, v236, v57, v169
    v_dot2_f32_bf16 v218, v237, v56, v170
    v_dot2_f32_bf16 v219, v237, v57, v171
    v_dot2_f32_bf16 v220, v238, v56, v172
    v_dot2_f32_bf16 v221, v238, v57, v173
    v_dot2_f32_bf16 v222, v239, v56, v174
    v_dot2_f32_bf16 v223, v239, v57, v175
    v_dot2_f32_bf16 v224, v240, v56, v176
    v_dot2_f32_bf16 v225, v240, v57, v177
    v_dot2_f32_bf16 v226, v241, v56, v178
    v_dot2_f32_bf16 v227, v241, v57, v179
    v_dot2_f32_bf16 v228, v242, v56, v180
    v_dot2_f32_bf16 v229, v242, v57, v181
    v_dot2_f32_bf16 v230, v243, v56, v182
    v_dot2_f32_bf16 v231, v243, v57, v183
    v_cvt_pk_bf16_f32 v232, v208, v209
    v_cvt_pk_bf16_f32 v233, v210, v211
    v_cvt_pk_bf16_f32 v234, v212, v213
    v_cvt_pk_bf16_f32 v235, v214, v215
    v_cvt_pk_bf16_f32 v236, v216, v217
    v_cvt_pk_bf16_f32 v237, v218, v219
    v_cvt_pk_bf16_f32 v238, v220, v221
    v_cvt_pk_bf16_f32 v239, v222, v223
    v_cvt_pk_bf16_f32 v240, v224, v225
    v_cvt_pk_bf16_f32 v241, v226, v227
    v_cvt_pk_bf16_f32 v242, v228, v229
    v_cvt_pk_bf16_f32 v243, v230, v231
    v_dot2_f32_bf16 v208, v232, v56, 0
    v_dot2_f32_bf16 v209, v232, v57, 0
    v_dot2_f32_bf16 v210, v233, v56, 0
    v_dot2_f32_bf16 v211, v233, v57, 0
    v_dot2_f32_bf16 v212, v234, v56, 0
    v_dot2_f32_bf16 v213, v234, v57, 0
    v_dot2_f32_bf16 v214, v235, v56, 0
    v_dot2_f32_bf16 v215, v235, v57, 0
    v_dot2_f32_bf16 v216, v236, v56, 0
    v_dot2_f32_bf16 v217, v236, v57, 0
    v_dot2_f32_bf16 v218, v237, v56, 0
    v_dot2_f32_bf16 v219, v237, v57, 0
    v_dot2_f32_bf16 v220, v238, v56, 0
    v_dot2_f32_bf16 v221, v238, v57, 0
    v_dot2_f32_bf16 v222, v239, v56, 0
    v_dot2_f32_bf16 v223, v239, v57, 0
    v_dot2_f32_bf16 v224, v240, v56, 0
    v_dot2_f32_bf16 v225, v240, v57, 0
    v_dot2_f32_bf16 v226, v241, v56, 0
    v_dot2_f32_bf16 v227, v241, v57, 0
    v_dot2_f32_bf16 v228, v242, v56, 0
    v_dot2_f32_bf16 v229, v242, v57, 0
    v_dot2_f32_bf16 v230, v243, v56, 0
    v_dot2_f32_bf16 v231, v243, v57, 0
    v_mul_f32 v232, 0xbfb8aa3b, v208
    v_mul_f32 v233, 0xbfb8aa3b, v209
    v_mul_f32 v234, 0xbfb8aa3b, v210
    v_mul_f32 v235, 0xbfb8aa3b, v211
    v_mul_f32 v236, 0xbfb8aa3b, v212
    v_mul_f32 v237, 0xbfb8aa3b, v213
    v_mul_f32 v238, 0xbfb8aa3b, v214
    v_mul_f32 v239, 0xbfb8aa3b, v215
    v_mul_f32 v240, 0xbfb8aa3b, v216
    v_mul_f32 v241, 0xbfb8aa3b, v217
    v_mul_f32 v242, 0xbfb8aa3b, v218
    v_mul_f32 v243, 0xbfb8aa3b, v219
    v_mul_f32 v244, 0xbfb8aa3b, v220
    v_mul_f32 v245, 0xbfb8aa3b, v221
    v_mul_f32 v246, 0xbfb8aa3b, v222
    v_mul_f32 v247, 0xbfb8aa3b, v223
    v_mul_f32 v248, 0xbfb8aa3b, v224
    v_mul_f32 v249, 0xbfb8aa3b, v225
    v_mul_f32 v250, 0xbfb8aa3b, v226
    v_mul_f32 v251, 0xbfb8aa3b, v227
    v_mul_f32 v252, 0xbfb8aa3b, v228
    v_mul_f32 v253, 0xbfb8aa3b, v229
    v_mul_f32 v254, 0xbfb8aa3b, v230
    v_mul_f32 v255, 0xbfb8aa3b, v231
    v_exp_f32 v232, v232
    v_exp_f32 v233, v233
    v_exp_f32 v234, v234
    v_exp_f32 v235, v235
    v_exp_f32 v236, v236
    v_exp_f32 v237, v237
    v_exp_f32 v238, v238
    v_exp_f32 v239, v239
    v_exp_f32 v240, v240
    v_exp_f32 v241, v241
    v_exp_f32 v242, v242
    v_exp_f32 v243, v243
    v_exp_f32 v244, v244
    v_exp_f32 v245, v245
    v_exp_f32 v246, v246
    v_exp_f32 v247, v247
    v_exp_f32 v248, v248
    v_exp_f32 v249, v249
    v_exp_f32 v250, v250
    v_exp_f32 v251, v251
    v_exp_f32 v252, v252
    v_exp_f32 v253, v253
    v_exp_f32 v254, v254
    v_exp_f32 v255, v255
    v_add_f32 v232, 1.0, v232
    v_add_f32 v233, 1.0, v233
    v_add_f32 v234, 1.0, v234
    v_add_f32 v235, 1.0, v235
    v_add_f32 v236, 1.0, v236
    v_add_f32 v237, 1.0, v237
    v_add_f32 v238, 1.0, v238
    v_add_f32 v239, 1.0, v239
    v_add_f32 v240, 1.0, v240
    v_add_f32 v241, 1.0, v241
    v_add_f32 v242, 1.0, v242
    v_add_f32 v243, 1.0, v243
    v_add_f32 v244, 1.0, v244
    v_add_f32 v245, 1.0, v245
    v_add_f32 v246, 1.0, v246
    v_add_f32 v247, 1.0, v247
    v_add_f32 v248, 1.0, v248
    v_add_f32 v249, 1.0, v249
    v_add_f32 v250, 1.0, v250
    v_add_f32 v251, 1.0, v251
    v_add_f32 v252, 1.0, v252
    v_add_f32 v253, 1.0, v253
    v_add_f32 v254, 1.0, v254
    v_add_f32 v255, 1.0, v255
    v_rcp_f32 v232, v232
    v_rcp_f32 v233, v233
    v_rcp_f32 v234, v234
    v_rcp_f32 v235, v235
    v_rcp_f32 v236, v236
    v_rcp_f32 v237, v237
    v_rcp_f32 v238, v238
    v_rcp_f32 v239, v239
    v_rcp_f32 v240, v240
    v_rcp_f32 v241, v241
    v_rcp_f32 v242, v242
    v_rcp_f32 v243, v243
    v_rcp_f32 v244, v244
    v_rcp_f32 v245, v245
    v_rcp_f32 v246, v246
    v_rcp_f32 v247, v247
    v_rcp_f32 v248, v248
    v_rcp_f32 v249, v249
    v_rcp_f32 v250, v250
    v_rcp_f32 v251, v251
    v_rcp_f32 v252, v252
    v_rcp_f32 v253, v253
    v_rcp_f32 v254, v254
    v_rcp_f32 v255, v255
    v_mul_f32 v208, v208, v232
    v_mul_f32 v209, v209, v233
    v_mul_f32 v210, v210, v234
    v_mul_f32 v211, v211, v235
    v_mul_f32 v212, v212, v236
    v_mul_f32 v213, v213, v237
    v_mul_f32 v214, v214, v238
    v_mul_f32 v215, v215, v239
    v_mul_f32 v216, v216, v240
    v_mul_f32 v217, v217, v241
    v_mul_f32 v218, v218, v242
    v_mul_f32 v219, v219, v243
    v_mul_f32 v220, v220, v244
    v_mul_f32 v221, v221, v245
    v_mul_f32 v222, v222, v246
    v_mul_f32 v223, v223, v247
    v_mul_f32 v224, v224, v248
    v_mul_f32 v225, v225, v249
    v_mul_f32 v226, v226, v250
    v_mul_f32 v227, v227, v251
    v_mul_f32 v228, v228, v252
    v_mul_f32 v229, v229, v253
    v_mul_f32 v230, v230, v254
    v_mul_f32 v231, v231, v255
    v_cvt_pk_bf16_f32 v160, v208, 0
    v_cvt_pk_bf16_f32 v161, 0, v209
    v_cvt_pk_bf16_f32 v162, v210, 0
    v_cvt_pk_bf16_f32 v163, 0, v211
    v_cvt_pk_bf16_f32 v164, v212, 0
    v_cvt_pk_bf16_f32 v165, 0, v213
    v_cvt_pk_bf16_f32 v166, v214, 0
    v_cvt_pk_bf16_f32 v167, 0, v215
    v_cvt_pk_bf16_f32 v168, v216, 0
    v_cvt_pk_bf16_f32 v169, 0, v217
    v_cvt_pk_bf16_f32 v170, v218, 0
    v_cvt_pk_bf16_f32 v171, 0, v219
    v_cvt_pk_bf16_f32 v172, v220, 0
    v_cvt_pk_bf16_f32 v173, 0, v221
    v_cvt_pk_bf16_f32 v174, v222, 0
    v_cvt_pk_bf16_f32 v175, 0, v223
    v_cvt_pk_bf16_f32 v176, v224, 0
    v_cvt_pk_bf16_f32 v177, 0, v225
    v_cvt_pk_bf16_f32 v178, v226, 0
    v_cvt_pk_bf16_f32 v179, 0, v227
    v_cvt_pk_bf16_f32 v180, v228, 0
    v_cvt_pk_bf16_f32 v181, 0, v229
    v_cvt_pk_bf16_f32 v182, v230, 0
    v_cvt_pk_bf16_f32 v183, 0, v231
fph2_g3_kernel_35:
    s_waitcnt vmcnt(3)
    v_dot2_f32_bf16 v208, v128, v56, 0
    v_dot2_f32_bf16 v209, v128, v57, 0
    v_dot2_f32_bf16 v210, v129, v56, 0
    v_dot2_f32_bf16 v211, v129, v57, 0
    v_dot2_f32_bf16 v212, v130, v56, 0
    v_dot2_f32_bf16 v213, v130, v57, 0
    v_dot2_f32_bf16 v214, v131, v56, 0
    v_dot2_f32_bf16 v215, v131, v57, 0
    v_dot2_f32_bf16 v216, v136, v56, 0
    v_dot2_f32_bf16 v217, v136, v57, 0
    v_dot2_f32_bf16 v218, v137, v56, 0
    v_dot2_f32_bf16 v219, v137, v57, 0
    v_dot2_f32_bf16 v220, v138, v56, 0
    v_dot2_f32_bf16 v221, v138, v57, 0
    v_dot2_f32_bf16 v222, v139, v56, 0
    v_dot2_f32_bf16 v223, v139, v57, 0
    v_dot2_f32_bf16 v224, v144, v56, 0
    v_dot2_f32_bf16 v225, v144, v57, 0
    v_dot2_f32_bf16 v226, v145, v56, 0
    v_dot2_f32_bf16 v227, v145, v57, 0
    v_dot2_f32_bf16 v228, v146, v56, 0
    v_dot2_f32_bf16 v229, v146, v57, 0
    v_dot2_f32_bf16 v230, v147, v56, 0
    v_dot2_f32_bf16 v231, v147, v57, 0
    s_waitcnt vmcnt(0)
    v_dot2_f32_bf16 v208, v132, v56, v208
    v_dot2_f32_bf16 v209, v132, v57, v209
    v_dot2_f32_bf16 v210, v133, v56, v210
    v_dot2_f32_bf16 v211, v133, v57, v211
    v_dot2_f32_bf16 v212, v134, v56, v212
    v_dot2_f32_bf16 v213, v134, v57, v213
    v_dot2_f32_bf16 v214, v135, v56, v214
    v_dot2_f32_bf16 v215, v135, v57, v215
    v_dot2_f32_bf16 v216, v140, v56, v216
    v_dot2_f32_bf16 v217, v140, v57, v217
    v_dot2_f32_bf16 v218, v141, v56, v218
    v_dot2_f32_bf16 v219, v141, v57, v219
    v_dot2_f32_bf16 v220, v142, v56, v220
    v_dot2_f32_bf16 v221, v142, v57, v221
    v_dot2_f32_bf16 v222, v143, v56, v222
    v_dot2_f32_bf16 v223, v143, v57, v223
    v_dot2_f32_bf16 v224, v148, v56, v224
    v_dot2_f32_bf16 v225, v148, v57, v225
    v_dot2_f32_bf16 v226, v149, v56, v226
    v_dot2_f32_bf16 v227, v149, v57, v227
    v_dot2_f32_bf16 v228, v150, v56, v228
    v_dot2_f32_bf16 v229, v150, v57, v229
    v_dot2_f32_bf16 v230, v151, v56, v230
    v_dot2_f32_bf16 v231, v151, v57, v231
    v_cvt_pk_bf16_f32 v232, v208, v209
    v_cvt_pk_bf16_f32 v233, v210, v211
    v_cvt_pk_bf16_f32 v234, v212, v213
    v_cvt_pk_bf16_f32 v235, v214, v215
    v_cvt_pk_bf16_f32 v236, v216, v217
    v_cvt_pk_bf16_f32 v237, v218, v219
    v_cvt_pk_bf16_f32 v238, v220, v221
    v_cvt_pk_bf16_f32 v239, v222, v223
    v_cvt_pk_bf16_f32 v240, v224, v225
    v_cvt_pk_bf16_f32 v241, v226, v227
    v_cvt_pk_bf16_f32 v242, v228, v229
    v_cvt_pk_bf16_f32 v243, v230, v231
    v_dot2_f32_bf16 v208, v232, v160, 0
    v_dot2_f32_bf16 v209, v232, v161, 0
    v_dot2_f32_bf16 v210, v233, v162, 0
    v_dot2_f32_bf16 v211, v233, v163, 0
    v_dot2_f32_bf16 v212, v234, v164, 0
    v_dot2_f32_bf16 v213, v234, v165, 0
    v_dot2_f32_bf16 v214, v235, v166, 0
    v_dot2_f32_bf16 v215, v235, v167, 0
    v_dot2_f32_bf16 v216, v236, v168, 0
    v_dot2_f32_bf16 v217, v236, v169, 0
    v_dot2_f32_bf16 v218, v237, v170, 0
    v_dot2_f32_bf16 v219, v237, v171, 0
    v_dot2_f32_bf16 v220, v238, v172, 0
    v_dot2_f32_bf16 v221, v238, v173, 0
    v_dot2_f32_bf16 v222, v239, v174, 0
    v_dot2_f32_bf16 v223, v239, v175, 0
    v_dot2_f32_bf16 v224, v240, v176, 0
    v_dot2_f32_bf16 v225, v240, v177, 0
    v_dot2_f32_bf16 v226, v241, v178, 0
    v_dot2_f32_bf16 v227, v241, v179, 0
    v_dot2_f32_bf16 v228, v242, v180, 0
    v_dot2_f32_bf16 v229, v242, v181, 0
    v_dot2_f32_bf16 v230, v243, v182, 0
    v_dot2_f32_bf16 v231, v243, v183, 0
    v_cvt_pk_bf16_f32 v232, v208, v209
    v_cvt_pk_bf16_f32 v233, v210, v211
    v_cvt_pk_bf16_f32 v234, v212, v213
    v_cvt_pk_bf16_f32 v235, v214, v215
    v_cvt_pk_bf16_f32 v236, v216, v217
    v_cvt_pk_bf16_f32 v237, v218, v219
    v_cvt_pk_bf16_f32 v238, v220, v221
    v_cvt_pk_bf16_f32 v239, v222, v223
    v_cvt_pk_bf16_f32 v240, v224, v225
    v_cvt_pk_bf16_f32 v241, v226, v227
    v_cvt_pk_bf16_f32 v242, v228, v229
    v_cvt_pk_bf16_f32 v243, v230, v231
    v_dot2_f32_bf16 v208, v232, v56, v184
    v_dot2_f32_bf16 v209, v232, v57, v185
    v_dot2_f32_bf16 v210, v233, v56, v186
    v_dot2_f32_bf16 v211, v233, v57, v187
    v_dot2_f32_bf16 v212, v234, v56, v188
    v_dot2_f32_bf16 v213, v234, v57, v189
    v_dot2_f32_bf16 v214, v235, v56, v190
    v_dot2_f32_bf16 v215, v235, v57, v191
    v_dot2_f32_bf16 v216, v236, v56, v192
    v_dot2_f32_bf16 v217, v236, v57, v193
    v_dot2_f32_bf16 v218, v237, v56, v194
    v_dot2_f32_bf16 v219, v237, v57, v195
    v_dot2_f32_bf16 v220, v238, v56, v196
    v_dot2_f32_bf16 v221, v238, v57, v197
    v_dot2_f32_bf16 v222, v239, v56, v198
    v_dot2_f32_bf16 v223, v239, v57, v199
    v_dot2_f32_bf16 v224, v240, v56, v200
    v_dot2_f32_bf16 v225, v240, v57, v201
    v_dot2_f32_bf16 v226, v241, v56, v202
    v_dot2_f32_bf16 v227, v241, v57, v203
    v_dot2_f32_bf16 v228, v242, v56, v204
    v_dot2_f32_bf16 v229, v242, v57, v205
    v_dot2_f32_bf16 v230, v243, v56, v206
    v_dot2_f32_bf16 v231, v243, v57, v207
    v_cvt_pk_bf16_f32 v232, v208, v209
    v_cvt_pk_bf16_f32 v233, v210, v211
    v_cvt_pk_bf16_f32 v234, v212, v213
    v_cvt_pk_bf16_f32 v235, v214, v215
    v_cvt_pk_bf16_f32 v236, v216, v217
    v_cvt_pk_bf16_f32 v237, v218, v219
    v_cvt_pk_bf16_f32 v238, v220, v221
    v_cvt_pk_bf16_f32 v239, v222, v223
    v_cvt_pk_bf16_f32 v240, v224, v225
    v_cvt_pk_bf16_f32 v241, v226, v227
    v_cvt_pk_bf16_f32 v242, v228, v229
    v_cvt_pk_bf16_f32 v243, v230, v231
    s_nop 1
    v_permlane32_swap_b32 v232, v234
    v_permlane32_swap_b32 v233, v235
    v_permlane32_swap_b32 v236, v238
    v_permlane32_swap_b32 v237, v239
    v_permlane32_swap_b32 v240, v242
    v_permlane32_swap_b32 v241, v243
    s_nop 1
    buffer_store_dwordx4 v[232:235], v54, s[20:23], s83 offen offset:0
    buffer_store_dwordx4 v[236:239], v54, s[20:23], s83 offen offset:32
    buffer_store_dwordx4 v[240:243], v54, s[20:23], s84 offen offset:0
fnext_g3_kernel_28:
    s_movk_i32 s76, 0x424
    s_cmp_eq_u32 s73, 0
    s_cbranch_scc1 fsw_g3_kernel_36
    s_ff1_i32_b32 s72, s73
    s_bitset0_b32 s73, s72
    s_branch floop_g3_kernel_29
fsw_g3_kernel_36:
    s_cmp_eq_u32 s74, 0
    s_cbranch_scc1 end_g3_kernel_1
    s_ff1_i32_b32 s77, s74
    s_bitset0_b32 s74, s77
    s_lshr_b32 s71, s77, 2
    s_lshl_b32 s80, s77, 6
    s_add_u32 s80, s80, s90
    s_and_b32 s77, s77, 3
    s_lshl_b32 s77, s77, 2
    s_movk_i32 s75, 96
ffl_g3_kernel_37:
    buffer_load_dword v34, v35, s[92:95], s80 offen offset:16 sc0 sc1
    s_waitcnt vmcnt(0)
    v_cmp_eq_u32 vcc, 0, v34
    s_and_b32 s73, vcc_lo, 15
    s_lshl_b32 s73, s73, s77
    s_cmp_eq_u32 s73, 0
    s_cbranch_scc1 fsw_g3_kernel_36
    s_sub_u32 s75, s75, 1
    s_cmp_eq_u32 s75, 0
    s_cbranch_scc1 fnext_g3_kernel_28
    s_branch ffl_g3_kernel_37
att_g3_kernel_2:
    s_waitcnt lgkmcnt(0)
    s_add_u32 s92, s40, 0x28a2000
    s_addc_u32 s93, s41, 0
    s_add_u32 s8, s40, 0x400000
    s_addc_u32 s9, s41, 0
    s_mov_b32 s10, 0x6c0000
    s_mov_b32 s11, 0x00020000
    s_add_u32 s12, s40, 0x3900000
    s_addc_u32 s13, s41, 0
    s_mov_b32 s14, 0x480000
    s_mov_b32 s15, 0x00020000
    s_add_u32 s48, s40, 0x2800000
    s_addc_u32 s49, s41, 0
    s_mov_b32 s50, 0xa2000
    s_mov_b32 s51, 0x00020000
    s_and_b32 s30, s33, 1
    s_lshr_b32 s31, s33, 1
    s_lshl_b32 s16, s30, 4
    v_and_b32 v3, 15, v0
    v_add_u32 v3, s16, v3
    v_lshrrev_b32 v2, 6, v0
    s_nop 0
    v_readfirstlane_b32 s35, v2
    v_lshrrev_b32 v2, 5, v0
    v_lshlrev_b32 v2, 3, v2
    v_bfe_u32 v4, v0, 4, 1
    v_add_u32 v2, v2, v4
    s_lshl_b32 s16, s31, 6
    v_add_u32 v5, s16, v2
    v_lshlrev_b32 v18, 4, v3
    v_mul_u32_u24 v19, 12, v3
    s_movk_i32 s17, 3456
    s_mov_b32 s36, 0x05040100
    s_mov_b32 s37, 0x07060302
    v_mul_u32_u24 v18, 36, v3
    v_subrev_u32 v17, 14, v5
    v_max_i32 v17, 0, v17
    v_mul_lo_u32 v6, v17, s17
    v_add_u32 v6, v6, v18
    v_sub_u32 v212, v6, v19
    v_subrev_u32 v17, 12, v5
    v_max_i32 v17, 0, v17
    v_mul_lo_u32 v7, v17, s17
    v_add_u32 v7, v7, v18
    v_sub_u32 v213, v7, v19
    v_subrev_u32 v17, 10, v5
    v_max_i32 v17, 0, v17
    v_mul_lo_u32 v8, v17, s17
    v_add_u32 v8, v8, v18
    v_sub_u32 v214, v8, v19
    v_subrev_u32 v17, 8, v5
    v_max_i32 v17, 0, v17
    v_mul_lo_u32 v9, v17, s17
    v_add_u32 v9, v9, v18
    v_sub_u32 v215, v9, v19
    v_subrev_u32 v17, 6, v5
    v_max_i32 v17, 0, v17
    v_mul_lo_u32 v10, v17, s17
    v_add_u32 v10, v10, v18
    v_sub_u32 v216, v10, v19
    v_subrev_u32 v17, 4, v5
    v_max_i32 v17, 0, v17
    v_mul_lo_u32 v11, v17, s17
    v_add_u32 v11, v11, v18
    v_sub_u32 v217, v11, v19
    v_subrev_u32 v17, 2, v5
    v_max_i32 v17, 0, v17
    v_mul_lo_u32 v12, v17, s17
    v_add_u32 v12, v12, v18
    v_sub_u32 v218, v12, v19
    v_add_u32 v17, 0, v5
    v_mul_lo_u32 v13, v17, s17
    v_add_u32 v13, v13, v18
    v_sub_u32 v219, v13, v19
    v_add_u32 v17, 2, v5
    v_mul_lo_u32 v14, v17, s17
    v_add_u32 v14, v14, v18
    v_sub_u32 v220, v14, v19
    v_add_u32 v17, 4, v5
    v_mul_lo_u32 v15, v17, s17
    v_add_u32 v15, v15, v18
    v_sub_u32 v221, v15, v19
    v_add_u32 v17, 6, v5
    v_mul_lo_u32 v16, v17, s17
    v_add_u32 v16, v16, v18
    v_sub_u32 v222, v16, v19
    buffer_load_dwordx4 v[62:65], v13, s[8:11], 0 offen offset:0
    buffer_load_dwordx4 v[66:69], v13, s[8:11], 0 offen offset:16
    buffer_load_dword v70, v13, s[8:11], 0 offen offset:32
    buffer_load_dwordx4 v[72:75], v14, s[8:11], 0 offen offset:0
    buffer_load_dwordx4 v[76:79], v14, s[8:11], 0 offen offset:16
    buffer_load_dword v80, v14, s[8:11], 0 offen offset:32
    buffer_load_dwordx4 v[82:85], v15, s[8:11], 0 offen offset:0
    buffer_load_dwordx4 v[86:89], v15, s[8:11], 0 offen offset:16
    buffer_load_dword v90, v15, s[8:11], 0 offen offset:32
    buffer_load_dwordx4 v[92:95], v16, s[8:11], 0 offen offset:0
    buffer_load_dwordx4 v[96:99], v16, s[8:11], 0 offen offset:16
    buffer_load_dword v100, v16, s[8:11], 0 offen offset:32
    buffer_load_dwordx4 v[102:105], v6, s[8:11], 0 offen offset:1152
    buffer_load_dwordx4 v[106:109], v6, s[8:11], 0 offen offset:1168
    buffer_load_dword v110, v6, s[8:11], 0 offen offset:1184
    buffer_load_dwordx4 v[112:115], v7, s[8:11], 0 offen offset:1152
    buffer_load_dwordx4 v[116:119], v7, s[8:11], 0 offen offset:1168
    buffer_load_dword v120, v7, s[8:11], 0 offen offset:1184
    buffer_load_dwordx4 v[122:125], v8, s[8:11], 0 offen offset:1152
    buffer_load_dwordx4 v[126:129], v8, s[8:11], 0 offen offset:1168
    buffer_load_dword v130, v8, s[8:11], 0 offen offset:1184
    buffer_load_dwordx4 v[132:135], v9, s[8:11], 0 offen offset:1152
    buffer_load_dwordx4 v[136:139], v9, s[8:11], 0 offen offset:1168
    buffer_load_dword v140, v9, s[8:11], 0 offen offset:1184
    buffer_load_dwordx4 v[142:145], v10, s[8:11], 0 offen offset:1152
    buffer_load_dwordx4 v[146:149], v10, s[8:11], 0 offen offset:1168
    buffer_load_dword v150, v10, s[8:11], 0 offen offset:1184
    buffer_load_dwordx4 v[152:155], v11, s[8:11], 0 offen offset:1152
    buffer_load_dwordx4 v[156:159], v11, s[8:11], 0 offen offset:1168
    buffer_load_dword v160, v11, s[8:11], 0 offen offset:1184
    buffer_load_dwordx4 v[162:165], v12, s[8:11], 0 offen offset:1152
    buffer_load_dwordx4 v[166:169], v12, s[8:11], 0 offen offset:1168
    buffer_load_dword v170, v12, s[8:11], 0 offen offset:1184
    buffer_load_dwordx4 v[172:175], v13, s[8:11], 0 offen offset:1152
    buffer_load_dwordx4 v[176:179], v13, s[8:11], 0 offen offset:1168
    buffer_load_dword v180, v13, s[8:11], 0 offen offset:1184
    buffer_load_dwordx4 v[182:185], v14, s[8:11], 0 offen offset:1152
    buffer_load_dwordx4 v[186:189], v14, s[8:11], 0 offen offset:1168
    buffer_load_dword v190, v14, s[8:11], 0 offen offset:1184
    buffer_load_dwordx4 v[192:195], v15, s[8:11], 0 offen offset:1152
    buffer_load_dwordx4 v[196:199], v15, s[8:11], 0 offen offset:1168
    buffer_load_dword v200, v15, s[8:11], 0 offen offset:1184
    buffer_load_dwordx4 v[202:205], v16, s[8:11], 0 offen offset:1152
    buffer_load_dwordx4 v[206:209], v16, s[8:11], 0 offen offset:1168
    buffer_load_dword v210, v16, s[8:11], 0 offen offset:1184
    buffer_load_dwordx4 a[0:3], v6, s[8:11], 0 offen offset:2304
    buffer_load_dwordx4 a[4:7], v6, s[8:11], 0 offen offset:2320
    buffer_load_dword a8, v6, s[8:11], 0 offen offset:2336
    buffer_load_dwordx4 a[10:13], v7, s[8:11], 0 offen offset:2304
    buffer_load_dwordx4 a[14:17], v7, s[8:11], 0 offen offset:2320
    buffer_load_dword a18, v7, s[8:11], 0 offen offset:2336
    buffer_load_dwordx4 a[20:23], v8, s[8:11], 0 offen offset:2304
    buffer_load_dwordx4 a[24:27], v8, s[8:11], 0 offen offset:2320
    buffer_load_dword a28, v8, s[8:11], 0 offen offset:2336
    buffer_load_dwordx4 a[30:33], v9, s[8:11], 0 offen offset:2304
    buffer_load_dwordx4 a[34:37], v9, s[8:11], 0 offen offset:2320
    buffer_load_dword a38, v9, s[8:11], 0 offen offset:2336
    buffer_load_dwordx4 a[40:43], v10, s[8:11], 0 offen offset:2304
    buffer_load_dwordx4 a[44:47], v10, s[8:11], 0 offen offset:2320
    buffer_load_dword a48, v10, s[8:11], 0 offen offset:2336
    buffer_load_dwordx4 a[50:53], v11, s[8:11], 0 offen offset:2304
    buffer_load_dwordx4 a[54:57], v11, s[8:11], 0 offen offset:2320
    buffer_load_dword a58, v11, s[8:11], 0 offen offset:2336
    buffer_load_dwordx4 a[60:63], v12, s[8:11], 0 offen offset:2304
    buffer_load_dwordx4 a[64:67], v12, s[8:11], 0 offen offset:2320
    buffer_load_dword a68, v12, s[8:11], 0 offen offset:2336
    buffer_load_dwordx4 a[70:73], v13, s[8:11], 0 offen offset:2304
    buffer_load_dwordx4 a[74:77], v13, s[8:11], 0 offen offset:2320
    buffer_load_dword a78, v13, s[8:11], 0 offen offset:2336
    buffer_load_dwordx4 a[80:83], v14, s[8:11], 0 offen offset:2304
    buffer_load_dwordx4 a[84:87], v14, s[8:11], 0 offen offset:2320
    buffer_load_dword a88, v14, s[8:11], 0 offen offset:2336
    buffer_load_dwordx4 a[90:93], v15, s[8:11], 0 offen offset:2304
    buffer_load_dwordx4 a[94:97], v15, s[8:11], 0 offen offset:2320
    buffer_load_dword a98, v15, s[8:11], 0 offen offset:2336
    buffer_load_dwordx4 a[100:103], v16, s[8:11], 0 offen offset:2304
    buffer_load_dwordx4 a[104:107], v16, s[8:11], 0 offen offset:2320
    buffer_load_dword a108, v16, s[8:11], 0 offen offset:2336
    s_lshr_b32 s34, s33, 3
    s_mul_i32 s34, s34, 324
    s_mul_i32 s38, s30, 18432
    v_min_u32 v1, 161, v0
    v_add_u32 v17, s34, v1
    v_mul_u32_u24 v250, 7282, v17
    v_lshrrev_b32 v250, 20, v250
    v_mul_u32_u24 v250, 18432, v250
    v_lshl_add_u32 v17, v17, 7, v250
    s_add_u32 s34, s34, 162
    v_add_u32 v1, s34, v1
    v_mul_u32_u24 v250, 7282, v1
    v_lshrrev_b32 v250, 20, v250
    v_mul_u32_u24 v250, 18432, v250
    v_lshl_add_u32 v1, v1, 7, v250
    s_add_u32 s34, s34, 162
    buffer_load_dword v250, v17, s[48:51], s38 offen
    buffer_load_dword v250, v1, s[48:51], s38 offen
    v_and_b32 v1, 63, v0
    v_lshlrev_b32 v1, 4, v1
    s_mul_i32 s34, s35, 36864
    s_add_u32 s34, s34, s38
    s_mul_i32 s39, s35, 0
    s_add_u32 s39, s39, 37888
    v_add_u32 v251, s39, v1
    s_waitcnt vmcnt(63)
    v_dot2_f32_bf16 v27, v62, v102, 0
    v_dot2_f32_bf16 v27, v63, v103, v27
    v_dot2_f32_bf16 v27, v64, v104, v27
    v_dot2_f32_bf16 v27, v65, v105, v27
    v_dot2_f32_bf16 v27, v66, v106, v27
    v_dot2_f32_bf16 v27, v67, v107, v27
    v_dot2_f32_bf16 v27, v68, v108, v27
    v_dot2_f32_bf16 v27, v69, v109, v27
    v_dot2_f32_bf16 v27, v70, v110, v27
    s_waitcnt vmcnt(62)
    v_dot2_f32_bf16 v26, v62, v112, 0
    v_dot2_f32_bf16 v35, v72, v112, 0
    v_dot2_f32_bf16 v26, v63, v113, v26
    v_dot2_f32_bf16 v35, v73, v113, v35
    v_dot2_f32_bf16 v26, v64, v114, v26
    v_dot2_f32_bf16 v35, v74, v114, v35
    v_dot2_f32_bf16 v26, v65, v115, v26
    v_dot2_f32_bf16 v35, v75, v115, v35
    v_dot2_f32_bf16 v26, v66, v116, v26
    v_dot2_f32_bf16 v35, v76, v116, v35
    v_dot2_f32_bf16 v26, v67, v117, v26
    v_dot2_f32_bf16 v35, v77, v117, v35
    v_dot2_f32_bf16 v26, v68, v118, v26
    v_dot2_f32_bf16 v35, v78, v118, v35
    v_dot2_f32_bf16 v26, v69, v119, v26
    v_dot2_f32_bf16 v35, v79, v119, v35
    v_dot2_f32_bf16 v26, v70, v120, v26
    v_dot2_f32_bf16 v35, v80, v120, v35
    s_waitcnt vmcnt(59)
    v_dot2_f32_bf16 v25, v62, v122, 0
    v_dot2_f32_bf16 v34, v72, v122, 0
    v_dot2_f32_bf16 v43, v82, v122, 0
    v_dot2_f32_bf16 v25, v63, v123, v25
    v_dot2_f32_bf16 v34, v73, v123, v34
    v_dot2_f32_bf16 v43, v83, v123, v43
    v_dot2_f32_bf16 v25, v64, v124, v25
    v_dot2_f32_bf16 v34, v74, v124, v34
    v_dot2_f32_bf16 v43, v84, v124, v43
    v_dot2_f32_bf16 v25, v65, v125, v25
    v_dot2_f32_bf16 v34, v75, v125, v34
    v_dot2_f32_bf16 v43, v85, v125, v43
    v_dot2_f32_bf16 v25, v66, v126, v25
    v_dot2_f32_bf16 v34, v76, v126, v34
    v_dot2_f32_bf16 v43, v86, v126, v43
    v_dot2_f32_bf16 v25, v67, v127, v25
    v_dot2_f32_bf16 v34, v77, v127, v34
    v_dot2_f32_bf16 v43, v87, v127, v43
    v_dot2_f32_bf16 v25, v68, v128, v25
    v_dot2_f32_bf16 v34, v78, v128, v34
    v_dot2_f32_bf16 v43, v88, v128, v43
    v_dot2_f32_bf16 v25, v69, v129, v25
    v_dot2_f32_bf16 v34, v79, v129, v34
    v_dot2_f32_bf16 v43, v89, v129, v43
    v_dot2_f32_bf16 v25, v70, v130, v25
    v_dot2_f32_bf16 v34, v80, v130, v34
    v_dot2_f32_bf16 v43, v90, v130, v43
    s_waitcnt vmcnt(56)
    v_dot2_f32_bf16 v24, v62, v132, 0
    v_dot2_f32_bf16 v33, v72, v132, 0
    v_dot2_f32_bf16 v42, v82, v132, 0
    v_dot2_f32_bf16 v51, v92, v132, 0
    v_dot2_f32_bf16 v24, v63, v133, v24
    v_dot2_f32_bf16 v33, v73, v133, v33
    v_dot2_f32_bf16 v42, v83, v133, v42
    v_dot2_f32_bf16 v51, v93, v133, v51
    v_dot2_f32_bf16 v24, v64, v134, v24
    v_dot2_f32_bf16 v33, v74, v134, v33
    v_dot2_f32_bf16 v42, v84, v134, v42
    v_dot2_f32_bf16 v51, v94, v134, v51
    v_dot2_f32_bf16 v24, v65, v135, v24
    v_dot2_f32_bf16 v33, v75, v135, v33
    v_dot2_f32_bf16 v42, v85, v135, v42
    v_dot2_f32_bf16 v51, v95, v135, v51
    v_dot2_f32_bf16 v24, v66, v136, v24
    v_dot2_f32_bf16 v33, v76, v136, v33
    v_dot2_f32_bf16 v42, v86, v136, v42
    v_dot2_f32_bf16 v51, v96, v136, v51
    v_dot2_f32_bf16 v24, v67, v137, v24
    v_dot2_f32_bf16 v33, v77, v137, v33
    v_dot2_f32_bf16 v42, v87, v137, v42
    v_dot2_f32_bf16 v51, v97, v137, v51
    v_dot2_f32_bf16 v24, v68, v138, v24
    v_dot2_f32_bf16 v33, v78, v138, v33
    v_dot2_f32_bf16 v42, v88, v138, v42
    v_dot2_f32_bf16 v51, v98, v138, v51
    v_dot2_f32_bf16 v24, v69, v139, v24
    v_dot2_f32_bf16 v33, v79, v139, v33
    v_dot2_f32_bf16 v42, v89, v139, v42
    v_dot2_f32_bf16 v51, v99, v139, v51
    v_dot2_f32_bf16 v24, v70, v140, v24
    v_dot2_f32_bf16 v33, v80, v140, v33
    v_dot2_f32_bf16 v42, v90, v140, v42
    v_dot2_f32_bf16 v51, v100, v140, v51
    s_waitcnt vmcnt(53)
    v_dot2_f32_bf16 v23, v62, v142, 0
    v_dot2_f32_bf16 v32, v72, v142, 0
    v_dot2_f32_bf16 v41, v82, v142, 0
    v_dot2_f32_bf16 v50, v92, v142, 0
    v_dot2_f32_bf16 v23, v63, v143, v23
    v_dot2_f32_bf16 v32, v73, v143, v32
    v_dot2_f32_bf16 v41, v83, v143, v41
    v_dot2_f32_bf16 v50, v93, v143, v50
    v_dot2_f32_bf16 v23, v64, v144, v23
    v_dot2_f32_bf16 v32, v74, v144, v32
    v_dot2_f32_bf16 v41, v84, v144, v41
    v_dot2_f32_bf16 v50, v94, v144, v50
    v_dot2_f32_bf16 v23, v65, v145, v23
    v_dot2_f32_bf16 v32, v75, v145, v32
    v_dot2_f32_bf16 v41, v85, v145, v41
    v_dot2_f32_bf16 v50, v95, v145, v50
    v_dot2_f32_bf16 v23, v66, v146, v23
    v_dot2_f32_bf16 v32, v76, v146, v32
    v_dot2_f32_bf16 v41, v86, v146, v41
    v_dot2_f32_bf16 v50, v96, v146, v50
    v_dot2_f32_bf16 v23, v67, v147, v23
    v_dot2_f32_bf16 v32, v77, v147, v32
    v_dot2_f32_bf16 v41, v87, v147, v41
    v_dot2_f32_bf16 v50, v97, v147, v50
    v_dot2_f32_bf16 v23, v68, v148, v23
    v_dot2_f32_bf16 v32, v78, v148, v32
    v_dot2_f32_bf16 v41, v88, v148, v41
    v_dot2_f32_bf16 v50, v98, v148, v50
    v_dot2_f32_bf16 v23, v69, v149, v23
    v_dot2_f32_bf16 v32, v79, v149, v32
    v_dot2_f32_bf16 v41, v89, v149, v41
    v_dot2_f32_bf16 v50, v99, v149, v50
    v_dot2_f32_bf16 v23, v70, v150, v23
    v_dot2_f32_bf16 v32, v80, v150, v32
    v_dot2_f32_bf16 v41, v90, v150, v41
    v_dot2_f32_bf16 v50, v100, v150, v50
    s_waitcnt vmcnt(50)
    v_dot2_f32_bf16 v22, v62, v152, 0
    v_dot2_f32_bf16 v31, v72, v152, 0
    v_dot2_f32_bf16 v40, v82, v152, 0
    v_dot2_f32_bf16 v49, v92, v152, 0
    v_dot2_f32_bf16 v22, v63, v153, v22
    v_dot2_f32_bf16 v31, v73, v153, v31
    v_dot2_f32_bf16 v40, v83, v153, v40
    v_dot2_f32_bf16 v49, v93, v153, v49
    v_dot2_f32_bf16 v22, v64, v154, v22
    v_dot2_f32_bf16 v31, v74, v154, v31
    v_dot2_f32_bf16 v40, v84, v154, v40
    v_dot2_f32_bf16 v49, v94, v154, v49
    v_dot2_f32_bf16 v22, v65, v155, v22
    v_dot2_f32_bf16 v31, v75, v155, v31
    v_dot2_f32_bf16 v40, v85, v155, v40
    v_dot2_f32_bf16 v49, v95, v155, v49
    v_dot2_f32_bf16 v22, v66, v156, v22
    v_dot2_f32_bf16 v31, v76, v156, v31
    v_dot2_f32_bf16 v40, v86, v156, v40
    v_dot2_f32_bf16 v49, v96, v156, v49
    v_dot2_f32_bf16 v22, v67, v157, v22
    v_dot2_f32_bf16 v31, v77, v157, v31
    v_dot2_f32_bf16 v40, v87, v157, v40
    v_dot2_f32_bf16 v49, v97, v157, v49
    v_dot2_f32_bf16 v22, v68, v158, v22
    v_dot2_f32_bf16 v31, v78, v158, v31
    v_dot2_f32_bf16 v40, v88, v158, v40
    v_dot2_f32_bf16 v49, v98, v158, v49
    v_dot2_f32_bf16 v22, v69, v159, v22
    v_dot2_f32_bf16 v31, v79, v159, v31
    v_dot2_f32_bf16 v40, v89, v159, v40
    v_dot2_f32_bf16 v49, v99, v159, v49
    v_dot2_f32_bf16 v22, v70, v160, v22
    v_dot2_f32_bf16 v31, v80, v160, v31
    v_dot2_f32_bf16 v40, v90, v160, v40
    v_dot2_f32_bf16 v49, v100, v160, v49
    s_waitcnt vmcnt(47)
    v_dot2_f32_bf16 v21, v62, v162, 0
    v_dot2_f32_bf16 v30, v72, v162, 0
    v_dot2_f32_bf16 v39, v82, v162, 0
    v_dot2_f32_bf16 v48, v92, v162, 0
    v_dot2_f32_bf16 v21, v63, v163, v21
    v_dot2_f32_bf16 v30, v73, v163, v30
    v_dot2_f32_bf16 v39, v83, v163, v39
    v_dot2_f32_bf16 v48, v93, v163, v48
    v_dot2_f32_bf16 v21, v64, v164, v21
    v_dot2_f32_bf16 v30, v74, v164, v30
    v_dot2_f32_bf16 v39, v84, v164, v39
    v_dot2_f32_bf16 v48, v94, v164, v48
    v_dot2_f32_bf16 v21, v65, v165, v21
    v_dot2_f32_bf16 v30, v75, v165, v30
    v_dot2_f32_bf16 v39, v85, v165, v39
    v_dot2_f32_bf16 v48, v95, v165, v48
    v_dot2_f32_bf16 v21, v66, v166, v21
    v_dot2_f32_bf16 v30, v76, v166, v30
    v_dot2_f32_bf16 v39, v86, v166, v39
    v_dot2_f32_bf16 v48, v96, v166, v48
    v_dot2_f32_bf16 v21, v67, v167, v21
    v_dot2_f32_bf16 v30, v77, v167, v30
    v_dot2_f32_bf16 v39, v87, v167, v39
    v_dot2_f32_bf16 v48, v97, v167, v48
    v_dot2_f32_bf16 v21, v68, v168, v21
    v_dot2_f32_bf16 v30, v78, v168, v30
    v_dot2_f32_bf16 v39, v88, v168, v39
    v_dot2_f32_bf16 v48, v98, v168, v48
    v_dot2_f32_bf16 v21, v69, v169, v21
    v_dot2_f32_bf16 v30, v79, v169, v30
    v_dot2_f32_bf16 v39, v89, v169, v39
    v_dot2_f32_bf16 v48, v99, v169, v48
    v_dot2_f32_bf16 v21, v70, v170, v21
    v_dot2_f32_bf16 v30, v80, v170, v30
    v_dot2_f32_bf16 v39, v90, v170, v39
    v_dot2_f32_bf16 v48, v100, v170, v48
    s_waitcnt vmcnt(44)
    v_dot2_f32_bf16 v20, v62, v172, 0
    v_dot2_f32_bf16 v29, v72, v172, 0
    v_dot2_f32_bf16 v38, v82, v172, 0
    v_dot2_f32_bf16 v47, v92, v172, 0
    v_dot2_f32_bf16 v20, v63, v173, v20
    v_dot2_f32_bf16 v29, v73, v173, v29
    v_dot2_f32_bf16 v38, v83, v173, v38
    v_dot2_f32_bf16 v47, v93, v173, v47
    v_dot2_f32_bf16 v20, v64, v174, v20
    v_dot2_f32_bf16 v29, v74, v174, v29
    v_dot2_f32_bf16 v38, v84, v174, v38
    v_dot2_f32_bf16 v47, v94, v174, v47
    v_dot2_f32_bf16 v20, v65, v175, v20
    v_dot2_f32_bf16 v29, v75, v175, v29
    v_dot2_f32_bf16 v38, v85, v175, v38
    v_dot2_f32_bf16 v47, v95, v175, v47
    v_dot2_f32_bf16 v20, v66, v176, v20
    v_dot2_f32_bf16 v29, v76, v176, v29
    v_dot2_f32_bf16 v38, v86, v176, v38
    v_dot2_f32_bf16 v47, v96, v176, v47
    v_dot2_f32_bf16 v20, v67, v177, v20
    v_dot2_f32_bf16 v29, v77, v177, v29
    v_dot2_f32_bf16 v38, v87, v177, v38
    v_dot2_f32_bf16 v47, v97, v177, v47
    v_dot2_f32_bf16 v20, v68, v178, v20
    v_dot2_f32_bf16 v29, v78, v178, v29
    v_dot2_f32_bf16 v38, v88, v178, v38
    v_dot2_f32_bf16 v47, v98, v178, v47
    v_dot2_f32_bf16 v20, v69, v179, v20
    v_dot2_f32_bf16 v29, v79, v179, v29
    v_dot2_f32_bf16 v38, v89, v179, v38
    v_dot2_f32_bf16 v47, v99, v179, v47
    v_dot2_f32_bf16 v20, v70, v180, v20
    v_dot2_f32_bf16 v29, v80, v180, v29
    v_dot2_f32_bf16 v38, v90, v180, v38
    v_dot2_f32_bf16 v47, v100, v180, v47
    s_waitcnt vmcnt(41)
    v_dot2_f32_bf16 v28, v72, v182, 0
    v_dot2_f32_bf16 v37, v82, v182, 0
    v_dot2_f32_bf16 v46, v92, v182, 0
    v_dot2_f32_bf16 v28, v73, v183, v28
    v_dot2_f32_bf16 v37, v83, v183, v37
    v_dot2_f32_bf16 v46, v93, v183, v46
    v_dot2_f32_bf16 v28, v74, v184, v28
    v_dot2_f32_bf16 v37, v84, v184, v37
    v_dot2_f32_bf16 v46, v94, v184, v46
    v_dot2_f32_bf16 v28, v75, v185, v28
    v_dot2_f32_bf16 v37, v85, v185, v37
    v_dot2_f32_bf16 v46, v95, v185, v46
    v_dot2_f32_bf16 v28, v76, v186, v28
    v_dot2_f32_bf16 v37, v86, v186, v37
    v_dot2_f32_bf16 v46, v96, v186, v46
    v_dot2_f32_bf16 v28, v77, v187, v28
    v_dot2_f32_bf16 v37, v87, v187, v37
    v_dot2_f32_bf16 v46, v97, v187, v46
    v_dot2_f32_bf16 v28, v78, v188, v28
    v_dot2_f32_bf16 v37, v88, v188, v37
    v_dot2_f32_bf16 v46, v98, v188, v46
    v_dot2_f32_bf16 v28, v79, v189, v28
    v_dot2_f32_bf16 v37, v89, v189, v37
    v_dot2_f32_bf16 v46, v99, v189, v46
    v_dot2_f32_bf16 v28, v80, v190, v28
    v_dot2_f32_bf16 v37, v90, v190, v37
    v_dot2_f32_bf16 v46, v100, v190, v46
    s_waitcnt vmcnt(38)
    v_dot2_f32_bf16 v36, v82, v192, 0
    v_dot2_f32_bf16 v45, v92, v192, 0
    v_dot2_f32_bf16 v36, v83, v193, v36
    v_dot2_f32_bf16 v45, v93, v193, v45
    v_dot2_f32_bf16 v36, v84, v194, v36
    v_dot2_f32_bf16 v45, v94, v194, v45
    v_dot2_f32_bf16 v36, v85, v195, v36
    v_dot2_f32_bf16 v45, v95, v195, v45
    v_dot2_f32_bf16 v36, v86, v196, v36
    v_dot2_f32_bf16 v45, v96, v196, v45
    v_dot2_f32_bf16 v36, v87, v197, v36
    v_dot2_f32_bf16 v45, v97, v197, v45
    v_dot2_f32_bf16 v36, v88, v198, v36
    v_dot2_f32_bf16 v45, v98, v198, v45
    v_dot2_f32_bf16 v36, v89, v199, v36
    v_dot2_f32_bf16 v45, v99, v199, v45
    v_dot2_f32_bf16 v36, v90, v200, v36
    v_dot2_f32_bf16 v45, v100, v200, v45
    s_waitcnt vmcnt(35)
    v_dot2_f32_bf16 v44, v92, v202, 0
    v_dot2_f32_bf16 v44, v93, v203, v44
    v_dot2_f32_bf16 v44, v94, v204, v44
    v_dot2_f32_bf16 v44, v95, v205, v44
    v_dot2_f32_bf16 v44, v96, v206, v44
    v_dot2_f32_bf16 v44, v97, v207, v44
    v_dot2_f32_bf16 v44, v98, v208, v44
    v_dot2_f32_bf16 v44, v99, v209, v44
    v_dot2_f32_bf16 v44, v100, v210, v44
    buffer_load_dwordx4 a[112:115], v1, s[48:51], s34 offen offset:0
    buffer_load_dwordx4 a[116:119], v1, s[48:51], s34 offen offset:1024
    buffer_load_dwordx4 a[120:123], v1, s[48:51], s34 offen offset:2048
    buffer_load_dwordx4 a[124:127], v1, s[48:51], s34 offen offset:3072
    s_add_u32 s34, s34, 4096
    buffer_load_dwordx4 a[128:131], v1, s[48:51], s34 offen offset:0
    buffer_load_dwordx4 a[132:135], v1, s[48:51], s34 offen offset:1024
    buffer_load_dwordx4 a[136:139], v1, s[48:51], s34 offen offset:2048
    buffer_load_dwordx4 a[140:143], v1, s[48:51], s34 offen offset:3072
    s_add_u32 s34, s34, 4096
    buffer_load_dwordx4 a[144:147], v1, s[48:51], s34 offen offset:0
    buffer_load_dwordx4 a[148:151], v1, s[48:51], s34 offen offset:1024
    buffer_load_dwordx4 a[152:155], v1, s[48:51], s34 offen offset:2048
    buffer_load_dwordx4 a[156:159], v1, s[48:51], s34 offen offset:3072
    s_add_u32 s34, s34, 4096
    buffer_load_dwordx4 a[160:163], v1, s[48:51], s34 offen offset:0
    buffer_load_dwordx4 a[164:167], v1, s[48:51], s34 offen offset:1024
    buffer_load_dwordx4 a[168:171], v1, s[48:51], s34 offen offset:2048
    buffer_load_dwordx4 a[172:175], v1, s[48:51], s34 offen offset:3072
    s_add_u32 s34, s34, 4096
    buffer_load_dwordx4 a[176:179], v1, s[48:51], s34 offen offset:0
    buffer_load_dwordx4 a[180:183], v1, s[48:51], s34 offen offset:1024
    s_add_u32 s34, s34, 131072
    buffer_load_dwordx4 a[184:187], v1, s[48:51], s34 offen offset:0
    buffer_load_dwordx4 a[188:191], v1, s[48:51], s34 offen offset:1024
    buffer_load_dwordx4 a[192:195], v1, s[48:51], s34 offen offset:2048
    buffer_load_dwordx4 a[196:199], v1, s[48:51], s34 offen offset:3072
    s_add_u32 s34, s34, 4096
    buffer_load_dwordx4 a[200:203], v1, s[48:51], s34 offen offset:0
    buffer_load_dwordx4 a[204:207], v1, s[48:51], s34 offen offset:1024
    buffer_load_dwordx4 a[208:211], v1, s[48:51], s34 offen offset:2048
    buffer_load_dwordx4 a[212:215], v1, s[48:51], s34 offen offset:3072
    s_add_u32 s34, s34, 4096
    buffer_load_dwordx4 a[216:219], v1, s[48:51], s34 offen offset:0
    buffer_load_dwordx4 a[220:223], v1, s[48:51], s34 offen offset:1024
    buffer_load_dwordx4 a[224:227], v1, s[48:51], s34 offen offset:2048
    buffer_load_dwordx4 a[228:231], v1, s[48:51], s34 offen offset:3072
    s_add_u32 s34, s34, 4096
    buffer_load_dwordx4 a[232:235], v1, s[48:51], s34 offen offset:0
    buffer_load_dwordx4 a[236:239], v1, s[48:51], s34 offen offset:1024
    buffer_load_dwordx4 a[240:243], v1, s[48:51], s34 offen offset:2048
    buffer_load_dwordx4 a[244:247], v1, s[48:51], s34 offen offset:3072
    s_add_u32 s34, s34, 4096
    buffer_load_dwordx4 a[248:251], v1, s[48:51], s34 offen offset:0
    buffer_load_dwordx4 a[252:255], v1, s[48:51], s34 offen offset:1024
    v_cvt_pk_bf16_f32 v20, 0, v20
    v_cvt_pk_bf16_f32 v21, 0, v21
    v_cvt_pk_bf16_f32 v22, 0, v22
    v_cvt_pk_bf16_f32 v23, 0, v23
    v_cvt_pk_bf16_f32 v24, 0, v24
    v_cvt_pk_bf16_f32 v25, 0, v25
    v_cvt_pk_bf16_f32 v26, 0, v26
    v_cvt_pk_bf16_f32 v27, 0, v27
    v_cvt_pk_bf16_f32 v28, 0, v28
    v_cvt_pk_bf16_f32 v29, 0, v29
    v_cvt_pk_bf16_f32 v30, 0, v30
    v_cvt_pk_bf16_f32 v31, 0, v31
    v_cvt_pk_bf16_f32 v32, 0, v32
    v_cvt_pk_bf16_f32 v33, 0, v33
    v_cvt_pk_bf16_f32 v34, 0, v34
    v_cvt_pk_bf16_f32 v35, 0, v35
    v_cvt_pk_bf16_f32 v36, 0, v36
    v_cvt_pk_bf16_f32 v37, 0, v37
    v_cvt_pk_bf16_f32 v38, 0, v38
    v_cvt_pk_bf16_f32 v39, 0, v39
    v_cvt_pk_bf16_f32 v40, 0, v40
    v_cvt_pk_bf16_f32 v41, 0, v41
    v_cvt_pk_bf16_f32 v42, 0, v42
    v_cvt_pk_bf16_f32 v43, 0, v43
    v_cvt_pk_bf16_f32 v44, 0, v44
    v_cvt_pk_bf16_f32 v45, 0, v45
    v_cvt_pk_bf16_f32 v46, 0, v46
    v_cvt_pk_bf16_f32 v47, 0, v47
    v_cvt_pk_bf16_f32 v48, 0, v48
    v_cvt_pk_bf16_f32 v49, 0, v49
    v_cvt_pk_bf16_f32 v50, 0, v50
    v_cvt_pk_bf16_f32 v51, 0, v51
    v_mul_f32 v20, 0x3e715bef, v20
    v_mul_f32 v21, 0x3e715bef, v21
    v_mul_f32 v22, 0x3e715bef, v22
    v_mul_f32 v23, 0x3e715bef, v23
    v_mul_f32 v24, 0x3e715bef, v24
    v_mul_f32 v25, 0x3e715bef, v25
    v_mul_f32 v26, 0x3e715bef, v26
    v_mul_f32 v27, 0x3e715bef, v27
    v_mul_f32 v28, 0x3e715bef, v28
    v_mul_f32 v29, 0x3e715bef, v29
    v_mul_f32 v30, 0x3e715bef, v30
    v_mul_f32 v31, 0x3e715bef, v31
    v_mul_f32 v32, 0x3e715bef, v32
    v_mul_f32 v33, 0x3e715bef, v33
    v_mul_f32 v34, 0x3e715bef, v34
    v_mul_f32 v35, 0x3e715bef, v35
    v_mul_f32 v36, 0x3e715bef, v36
    v_mul_f32 v37, 0x3e715bef, v37
    v_mul_f32 v38, 0x3e715bef, v38
    v_mul_f32 v39, 0x3e715bef, v39
    v_mul_f32 v40, 0x3e715bef, v40
    v_mul_f32 v41, 0x3e715bef, v41
    v_mul_f32 v42, 0x3e715bef, v42
    v_mul_f32 v43, 0x3e715bef, v43
    v_mul_f32 v44, 0x3e715bef, v44
    v_mul_f32 v45, 0x3e715bef, v45
    v_mul_f32 v46, 0x3e715bef, v46
    v_mul_f32 v47, 0x3e715bef, v47
    v_mul_f32 v48, 0x3e715bef, v48
    v_mul_f32 v49, 0x3e715bef, v49
    v_mul_f32 v50, 0x3e715bef, v50
    v_mul_f32 v51, 0x3e715bef, v51
    v_cvt_pk_bf16_f32 v20, 0, v20
    v_cvt_pk_bf16_f32 v21, 0, v21
    v_cvt_pk_bf16_f32 v22, 0, v22
    v_cvt_pk_bf16_f32 v23, 0, v23
    v_cvt_pk_bf16_f32 v24, 0, v24
    v_cvt_pk_bf16_f32 v25, 0, v25
    v_cvt_pk_bf16_f32 v26, 0, v26
    v_cvt_pk_bf16_f32 v27, 0, v27
    v_cvt_pk_bf16_f32 v28, 0, v28
    v_cvt_pk_bf16_f32 v29, 0, v29
    v_cvt_pk_bf16_f32 v30, 0, v30
    v_cvt_pk_bf16_f32 v31, 0, v31
    v_cvt_pk_bf16_f32 v32, 0, v32
    v_cvt_pk_bf16_f32 v33, 0, v33
    v_cvt_pk_bf16_f32 v34, 0, v34
    v_cvt_pk_bf16_f32 v35, 0, v35
    v_cvt_pk_bf16_f32 v36, 0, v36
    v_cvt_pk_bf16_f32 v37, 0, v37
    v_cvt_pk_bf16_f32 v38, 0, v38
    v_cvt_pk_bf16_f32 v39, 0, v39
    v_cvt_pk_bf16_f32 v40, 0, v40
    v_cvt_pk_bf16_f32 v41, 0, v41
    v_cvt_pk_bf16_f32 v42, 0, v42
    v_cvt_pk_bf16_f32 v43, 0, v43
    v_cvt_pk_bf16_f32 v44, 0, v44
    v_cvt_pk_bf16_f32 v45, 0, v45
    v_cvt_pk_bf16_f32 v46, 0, v46
    v_cvt_pk_bf16_f32 v47, 0, v47
    v_cvt_pk_bf16_f32 v48, 0, v48
    v_cvt_pk_bf16_f32 v49, 0, v49
    v_cvt_pk_bf16_f32 v50, 0, v50
    v_cvt_pk_bf16_f32 v51, 0, v51
    s_cmp_lg_u32 s31, 0
    s_cbranch_scc1 nomask_g3_kernel_38
    v_mov_b32 v19, 0xce6e0000
    v_cmp_gt_u32 vcc, 2, v5
    v_cndmask_b32 v21, v21, v19, vcc
    v_cmp_gt_u32 vcc, 4, v5
    v_cndmask_b32 v22, v22, v19, vcc
    v_cmp_gt_u32 vcc, 6, v5
    v_cndmask_b32 v23, v23, v19, vcc
    v_cmp_gt_u32 vcc, 8, v5
    v_cndmask_b32 v24, v24, v19, vcc
    v_cmp_gt_u32 vcc, 10, v5
    v_cndmask_b32 v25, v25, v19, vcc
    v_cmp_gt_u32 vcc, 12, v5
    v_cndmask_b32 v26, v26, v19, vcc
    v_cmp_gt_u32 vcc, 14, v5
    v_cndmask_b32 v27, v27, v19, vcc
    v_cmp_gt_u32 vcc, 2, v5
    v_cndmask_b32 v30, v30, v19, vcc
    v_cmp_gt_u32 vcc, 4, v5
    v_cndmask_b32 v31, v31, v19, vcc
    v_cmp_gt_u32 vcc, 6, v5
    v_cndmask_b32 v32, v32, v19, vcc
    v_cmp_gt_u32 vcc, 8, v5
    v_cndmask_b32 v33, v33, v19, vcc
    v_cmp_gt_u32 vcc, 10, v5
    v_cndmask_b32 v34, v34, v19, vcc
    v_cmp_gt_u32 vcc, 12, v5
    v_cndmask_b32 v35, v35, v19, vcc
    v_cmp_gt_u32 vcc, 2, v5
    v_cndmask_b32 v39, v39, v19, vcc
    v_cmp_gt_u32 vcc, 4, v5
    v_cndmask_b32 v40, v40, v19, vcc
    v_cmp_gt_u32 vcc, 6, v5
    v_cndmask_b32 v41, v41, v19, vcc
    v_cmp_gt_u32 vcc, 8, v5
    v_cndmask_b32 v42, v42, v19, vcc
    v_cmp_gt_u32 vcc, 10, v5
    v_cndmask_b32 v43, v43, v19, vcc
    v_cmp_gt_u32 vcc, 2, v5
    v_cndmask_b32 v48, v48, v19, vcc
    v_cmp_gt_u32 vcc, 4, v5
    v_cndmask_b32 v49, v49, v19, vcc
    v_cmp_gt_u32 vcc, 6, v5
    v_cndmask_b32 v50, v50, v19, vcc
    v_cmp_gt_u32 vcc, 8, v5
    v_cndmask_b32 v51, v51, v19, vcc
nomask_g3_kernel_38:
    v_max3_f32 v212, v20, v21, v22
    v_max3_f32 v213, v28, v29, v30
    v_max3_f32 v214, v36, v37, v38
    v_max3_f32 v215, v44, v45, v46
    v_max3_f32 v212, v212, v23, v24
    v_max3_f32 v213, v213, v31, v32
    v_max3_f32 v214, v214, v39, v40
    v_max3_f32 v215, v215, v47, v48
    v_max3_f32 v212, v212, v25, v26
    v_max3_f32 v213, v213, v33, v34
    v_max3_f32 v214, v214, v41, v42
    v_max3_f32 v215, v215, v49, v50
    v_max_f32 v212, v212, v27
    v_max_f32 v213, v213, v35
    v_max_f32 v214, v214, v43
    v_max_f32 v215, v215, v51
    v_sub_f32 v20, v20, v212
    v_sub_f32 v21, v21, v212
    v_sub_f32 v22, v22, v212
    v_sub_f32 v23, v23, v212
    v_sub_f32 v24, v24, v212
    v_sub_f32 v25, v25, v212
    v_sub_f32 v26, v26, v212
    v_sub_f32 v27, v27, v212
    v_sub_f32 v28, v28, v213
    v_sub_f32 v29, v29, v213
    v_sub_f32 v30, v30, v213
    v_sub_f32 v31, v31, v213
    v_sub_f32 v32, v32, v213
    v_sub_f32 v33, v33, v213
    v_sub_f32 v34, v34, v213
    v_sub_f32 v35, v35, v213
    v_sub_f32 v36, v36, v214
    v_sub_f32 v37, v37, v214
    v_sub_f32 v38, v38, v214
    v_sub_f32 v39, v39, v214
    v_sub_f32 v40, v40, v214
    v_sub_f32 v41, v41, v214
    v_sub_f32 v42, v42, v214
    v_sub_f32 v43, v43, v214
    v_sub_f32 v44, v44, v215
    v_sub_f32 v45, v45, v215
    v_sub_f32 v46, v46, v215
    v_sub_f32 v47, v47, v215
    v_sub_f32 v48, v48, v215
    v_sub_f32 v49, v49, v215
    v_sub_f32 v50, v50, v215
    v_sub_f32 v51, v51, v215
    v_mul_f32 v20, 0x3fb8aa3b, v20
    v_mul_f32 v21, 0x3fb8aa3b, v21
    v_mul_f32 v22, 0x3fb8aa3b, v22
    v_mul_f32 v23, 0x3fb8aa3b, v23
    v_mul_f32 v24, 0x3fb8aa3b, v24
    v_mul_f32 v25, 0x3fb8aa3b, v25
    v_mul_f32 v26, 0x3fb8aa3b, v26
    v_mul_f32 v27, 0x3fb8aa3b, v27
    v_mul_f32 v28, 0x3fb8aa3b, v28
    v_mul_f32 v29, 0x3fb8aa3b, v29
    v_mul_f32 v30, 0x3fb8aa3b, v30
    v_mul_f32 v31, 0x3fb8aa3b, v31
    v_mul_f32 v32, 0x3fb8aa3b, v32
    v_mul_f32 v33, 0x3fb8aa3b, v33
    v_mul_f32 v34, 0x3fb8aa3b, v34
    v_mul_f32 v35, 0x3fb8aa3b, v35
    v_mul_f32 v36, 0x3fb8aa3b, v36
    v_mul_f32 v37, 0x3fb8aa3b, v37
    v_mul_f32 v38, 0x3fb8aa3b, v38
    v_mul_f32 v39, 0x3fb8aa3b, v39
    v_mul_f32 v40, 0x3fb8aa3b, v40
    v_mul_f32 v41, 0x3fb8aa3b, v41
    v_mul_f32 v42, 0x3fb8aa3b, v42
    v_mul_f32 v43, 0x3fb8aa3b, v43
    v_mul_f32 v44, 0x3fb8aa3b, v44
    v_mul_f32 v45, 0x3fb8aa3b, v45
    v_mul_f32 v46, 0x3fb8aa3b, v46
    v_mul_f32 v47, 0x3fb8aa3b, v47
    v_mul_f32 v48, 0x3fb8aa3b, v48
    v_mul_f32 v49, 0x3fb8aa3b, v49
    v_mul_f32 v50, 0x3fb8aa3b, v50
    v_mul_f32 v51, 0x3fb8aa3b, v51
    v_exp_f32 v20, v20
    v_exp_f32 v21, v21
    v_exp_f32 v22, v22
    v_exp_f32 v23, v23
    v_exp_f32 v24, v24
    v_exp_f32 v25, v25
    v_exp_f32 v26, v26
    v_exp_f32 v27, v27
    v_exp_f32 v28, v28
    v_exp_f32 v29, v29
    v_exp_f32 v30, v30
    v_exp_f32 v31, v31
    v_exp_f32 v32, v32
    v_exp_f32 v33, v33
    v_exp_f32 v34, v34
    v_exp_f32 v35, v35
    v_exp_f32 v36, v36
    v_exp_f32 v37, v37
    v_exp_f32 v38, v38
    v_exp_f32 v39, v39
    v_exp_f32 v40, v40
    v_exp_f32 v41, v41
    v_exp_f32 v42, v42
    v_exp_f32 v43, v43
    v_exp_f32 v44, v44
    v_exp_f32 v45, v45
    v_exp_f32 v46, v46
    v_exp_f32 v47, v47
    v_exp_f32 v48, v48
    v_exp_f32 v49, v49
    v_exp_f32 v50, v50
    v_exp_f32 v51, v51
    v_add_f32 v212, v20, v21
    v_add_f32 v213, v28, v29
    v_add_f32 v214, v36, v37
    v_add_f32 v215, v44, v45
    v_add_f32 v212, v212, v22
    v_add_f32 v213, v213, v30
    v_add_f32 v214, v214, v38
    v_add_f32 v215, v215, v46
    v_add_f32 v212, v212, v23
    v_add_f32 v213, v213, v31
    v_add_f32 v214, v214, v39
    v_add_f32 v215, v215, v47
    v_add_f32 v212, v212, v24
    v_add_f32 v213, v213, v32
    v_add_f32 v214, v214, v40
    v_add_f32 v215, v215, v48
    v_add_f32 v212, v212, v25
    v_add_f32 v213, v213, v33
    v_add_f32 v214, v214, v41
    v_add_f32 v215, v215, v49
    v_add_f32 v212, v212, v26
    v_add_f32 v213, v213, v34
    v_add_f32 v214, v214, v42
    v_add_f32 v215, v215, v50
    v_add_f32 v212, v212, v27
    v_add_f32 v213, v213, v35
    v_add_f32 v214, v214, v43
    v_add_f32 v215, v215, v51
    v_rcp_f32 v212, v212
    v_rcp_f32 v213, v213
    v_rcp_f32 v214, v214
    v_rcp_f32 v215, v215
    s_nop 0
    v_mul_f32 v20, v20, v212
    v_mul_f32 v21, v21, v212
    v_mul_f32 v22, v22, v212
    v_mul_f32 v23, v23, v212
    v_mul_f32 v24, v24, v212
    v_mul_f32 v25, v25, v212
    v_mul_f32 v26, v26, v212
    v_mul_f32 v27, v27, v212
    v_mul_f32 v28, v28, v213
    v_mul_f32 v29, v29, v213
    v_mul_f32 v30, v30, v213
    v_mul_f32 v31, v31, v213
    v_mul_f32 v32, v32, v213
    v_mul_f32 v33, v33, v213
    v_mul_f32 v34, v34, v213
    v_mul_f32 v35, v35, v213
    v_mul_f32 v36, v36, v214
    v_mul_f32 v37, v37, v214
    v_mul_f32 v38, v38, v214
    v_mul_f32 v39, v39, v214
    v_mul_f32 v40, v40, v214
    v_mul_f32 v41, v41, v214
    v_mul_f32 v42, v42, v214
    v_mul_f32 v43, v43, v214
    v_mul_f32 v44, v44, v215
    v_mul_f32 v45, v45, v215
    v_mul_f32 v46, v46, v215
    v_mul_f32 v47, v47, v215
    v_mul_f32 v48, v48, v215
    v_mul_f32 v49, v49, v215
    v_mul_f32 v50, v50, v215
    v_mul_f32 v51, v51, v215
    v_cvt_pk_bf16_f32 v62, v27, v26
    v_cvt_pk_bf16_f32 v63, v25, v24
    v_cvt_pk_bf16_f32 v64, v23, v22
    v_cvt_pk_bf16_f32 v65, v21, v20
    v_cvt_pk_bf16_f32 v66, 0, v35
    v_cvt_pk_bf16_f32 v67, v34, v33
    v_cvt_pk_bf16_f32 v68, v32, v31
    v_cvt_pk_bf16_f32 v69, v30, v29
    v_cvt_pk_bf16_f32 v70, v28, 0
    v_cvt_pk_bf16_f32 v71, v43, v42
    v_cvt_pk_bf16_f32 v72, v41, v40
    v_cvt_pk_bf16_f32 v73, v39, v38
    v_cvt_pk_bf16_f32 v74, v37, v36
    v_cvt_pk_bf16_f32 v75, 0, v51
    v_cvt_pk_bf16_f32 v76, v50, v49
    v_cvt_pk_bf16_f32 v77, v48, v47
    v_cvt_pk_bf16_f32 v78, v46, v45
    v_cvt_pk_bf16_f32 v79, v44, 0
    v_cvt_pk_bf16_f32 v80, 0, v44
    s_waitcnt vmcnt(63)
    v_accvgpr_read_b32 v212, a0
    v_accvgpr_read_b32 v213, a10
    v_perm_b32 v214, v213, v212, s36
    v_perm_b32 v215, v213, v212, s37
    v_dot2_f32_bf16 v102, v214, v62, 0
    v_dot2_f32_bf16 v103, v215, v62, 0
    v_dot2_f32_bf16 v120, v214, v66, 0
    v_dot2_f32_bf16 v121, v215, v66, 0
    v_accvgpr_read_b32 v216, a1
    v_accvgpr_read_b32 v217, a11
    v_perm_b32 v218, v217, v216, s36
    v_perm_b32 v219, v217, v216, s37
    v_dot2_f32_bf16 v104, v218, v62, 0
    v_dot2_f32_bf16 v105, v219, v62, 0
    v_dot2_f32_bf16 v122, v218, v66, 0
    v_dot2_f32_bf16 v123, v219, v66, 0
    v_accvgpr_read_b32 v212, a2
    v_accvgpr_read_b32 v213, a12
    v_perm_b32 v214, v213, v212, s36
    v_perm_b32 v215, v213, v212, s37
    v_dot2_f32_bf16 v106, v214, v62, 0
    v_dot2_f32_bf16 v107, v215, v62, 0
    v_dot2_f32_bf16 v124, v214, v66, 0
    v_dot2_f32_bf16 v125, v215, v66, 0
    v_accvgpr_read_b32 v216, a3
    v_accvgpr_read_b32 v217, a13
    v_perm_b32 v218, v217, v216, s36
    v_perm_b32 v219, v217, v216, s37
    v_dot2_f32_bf16 v108, v218, v62, 0
    v_dot2_f32_bf16 v109, v219, v62, 0
    v_dot2_f32_bf16 v126, v218, v66, 0
    v_dot2_f32_bf16 v127, v219, v66, 0
    v_accvgpr_read_b32 v212, a4
    v_accvgpr_read_b32 v213, a14
    v_perm_b32 v214, v213, v212, s36
    v_perm_b32 v215, v213, v212, s37
    v_dot2_f32_bf16 v110, v214, v62, 0
    v_dot2_f32_bf16 v111, v215, v62, 0
    v_dot2_f32_bf16 v128, v214, v66, 0
    v_dot2_f32_bf16 v129, v215, v66, 0
    v_accvgpr_read_b32 v216, a5
    v_accvgpr_read_b32 v217, a15
    v_perm_b32 v218, v217, v216, s36
    v_perm_b32 v219, v217, v216, s37
    v_dot2_f32_bf16 v112, v218, v62, 0
    v_dot2_f32_bf16 v113, v219, v62, 0
    v_dot2_f32_bf16 v130, v218, v66, 0
    v_dot2_f32_bf16 v131, v219, v66, 0
    v_accvgpr_read_b32 v212, a6
    v_accvgpr_read_b32 v213, a16
    v_perm_b32 v214, v213, v212, s36
    v_perm_b32 v215, v213, v212, s37
    v_dot2_f32_bf16 v114, v214, v62, 0
    v_dot2_f32_bf16 v115, v215, v62, 0
    v_dot2_f32_bf16 v132, v214, v66, 0
    v_dot2_f32_bf16 v133, v215, v66, 0
    v_accvgpr_read_b32 v216, a7
    v_accvgpr_read_b32 v217, a17
    v_perm_b32 v218, v217, v216, s36
    v_perm_b32 v219, v217, v216, s37
    v_dot2_f32_bf16 v116, v218, v62, 0
    v_dot2_f32_bf16 v117, v219, v62, 0
    v_dot2_f32_bf16 v134, v218, v66, 0
    v_dot2_f32_bf16 v135, v219, v66, 0
    v_accvgpr_read_b32 v212, a8
    v_accvgpr_read_b32 v213, a18
    v_perm_b32 v214, v213, v212, s36
    v_perm_b32 v215, v213, v212, s37
    v_dot2_f32_bf16 v118, v214, v62, 0
    v_dot2_f32_bf16 v119, v215, v62, 0
    v_dot2_f32_bf16 v136, v214, v66, 0
    v_dot2_f32_bf16 v137, v215, v66, 0
    s_waitcnt vmcnt(59)
    v_accvgpr_read_b32 v212, a20
    v_accvgpr_read_b32 v213, a30
    v_perm_b32 v214, v213, v212, s36
    v_perm_b32 v215, v213, v212, s37
    v_dot2_f32_bf16 v102, v214, v63, v102
    v_dot2_f32_bf16 v103, v215, v63, v103
    v_dot2_f32_bf16 v120, v214, v67, v120
    v_dot2_f32_bf16 v121, v215, v67, v121
    v_dot2_f32_bf16 v138, v214, v71, 0
    v_dot2_f32_bf16 v139, v215, v71, 0
    v_dot2_f32_bf16 v156, v214, v75, 0
    v_dot2_f32_bf16 v157, v215, v75, 0
    v_accvgpr_read_b32 v216, a21
    v_accvgpr_read_b32 v217, a31
    v_perm_b32 v218, v217, v216, s36
    v_perm_b32 v219, v217, v216, s37
    v_dot2_f32_bf16 v104, v218, v63, v104
    v_dot2_f32_bf16 v105, v219, v63, v105
    v_dot2_f32_bf16 v122, v218, v67, v122
    v_dot2_f32_bf16 v123, v219, v67, v123
    v_dot2_f32_bf16 v140, v218, v71, 0
    v_dot2_f32_bf16 v141, v219, v71, 0
    v_dot2_f32_bf16 v158, v218, v75, 0
    v_dot2_f32_bf16 v159, v219, v75, 0
    v_accvgpr_read_b32 v212, a22
    v_accvgpr_read_b32 v213, a32
    v_perm_b32 v214, v213, v212, s36
    v_perm_b32 v215, v213, v212, s37
    v_dot2_f32_bf16 v106, v214, v63, v106
    v_dot2_f32_bf16 v107, v215, v63, v107
    v_dot2_f32_bf16 v124, v214, v67, v124
    v_dot2_f32_bf16 v125, v215, v67, v125
    v_dot2_f32_bf16 v142, v214, v71, 0
    v_dot2_f32_bf16 v143, v215, v71, 0
    v_dot2_f32_bf16 v160, v214, v75, 0
    v_dot2_f32_bf16 v161, v215, v75, 0
    v_accvgpr_read_b32 v216, a23
    v_accvgpr_read_b32 v217, a33
    v_perm_b32 v218, v217, v216, s36
    v_perm_b32 v219, v217, v216, s37
    v_dot2_f32_bf16 v108, v218, v63, v108
    v_dot2_f32_bf16 v109, v219, v63, v109
    v_dot2_f32_bf16 v126, v218, v67, v126
    v_dot2_f32_bf16 v127, v219, v67, v127
    v_dot2_f32_bf16 v144, v218, v71, 0
    v_dot2_f32_bf16 v145, v219, v71, 0
    v_dot2_f32_bf16 v162, v218, v75, 0
    v_dot2_f32_bf16 v163, v219, v75, 0
    v_accvgpr_read_b32 v212, a24
    v_accvgpr_read_b32 v213, a34
    v_perm_b32 v214, v213, v212, s36
    v_perm_b32 v215, v213, v212, s37
    v_dot2_f32_bf16 v110, v214, v63, v110
    v_dot2_f32_bf16 v111, v215, v63, v111
    v_dot2_f32_bf16 v128, v214, v67, v128
    v_dot2_f32_bf16 v129, v215, v67, v129
    v_dot2_f32_bf16 v146, v214, v71, 0
    v_dot2_f32_bf16 v147, v215, v71, 0
    v_dot2_f32_bf16 v164, v214, v75, 0
    v_dot2_f32_bf16 v165, v215, v75, 0
    v_accvgpr_read_b32 v216, a25
    v_accvgpr_read_b32 v217, a35
    v_perm_b32 v218, v217, v216, s36
    v_perm_b32 v219, v217, v216, s37
    v_dot2_f32_bf16 v112, v218, v63, v112
    v_dot2_f32_bf16 v113, v219, v63, v113
    v_dot2_f32_bf16 v130, v218, v67, v130
    v_dot2_f32_bf16 v131, v219, v67, v131
    v_dot2_f32_bf16 v148, v218, v71, 0
    v_dot2_f32_bf16 v149, v219, v71, 0
    v_dot2_f32_bf16 v166, v218, v75, 0
    v_dot2_f32_bf16 v167, v219, v75, 0
    v_accvgpr_read_b32 v212, a26
    v_accvgpr_read_b32 v213, a36
    v_perm_b32 v214, v213, v212, s36
    v_perm_b32 v215, v213, v212, s37
    v_dot2_f32_bf16 v114, v214, v63, v114
    v_dot2_f32_bf16 v115, v215, v63, v115
    v_dot2_f32_bf16 v132, v214, v67, v132
    v_dot2_f32_bf16 v133, v215, v67, v133
    v_dot2_f32_bf16 v150, v214, v71, 0
    v_dot2_f32_bf16 v151, v215, v71, 0
    v_dot2_f32_bf16 v168, v214, v75, 0
    v_dot2_f32_bf16 v169, v215, v75, 0
    v_accvgpr_read_b32 v216, a27
    v_accvgpr_read_b32 v217, a37
    v_perm_b32 v218, v217, v216, s36
    v_perm_b32 v219, v217, v216, s37
    v_dot2_f32_bf16 v116, v218, v63, v116
    v_dot2_f32_bf16 v117, v219, v63, v117
    v_dot2_f32_bf16 v134, v218, v67, v134
    v_dot2_f32_bf16 v135, v219, v67, v135
    v_dot2_f32_bf16 v152, v218, v71, 0
    v_dot2_f32_bf16 v153, v219, v71, 0
    v_dot2_f32_bf16 v170, v218, v75, 0
    v_dot2_f32_bf16 v171, v219, v75, 0
    v_accvgpr_read_b32 v212, a28
    v_accvgpr_read_b32 v213, a38
    v_perm_b32 v214, v213, v212, s36
    v_perm_b32 v215, v213, v212, s37
    v_dot2_f32_bf16 v118, v214, v63, v118
    v_dot2_f32_bf16 v119, v215, v63, v119
    v_dot2_f32_bf16 v136, v214, v67, v136
    v_dot2_f32_bf16 v137, v215, v67, v137
    v_dot2_f32_bf16 v154, v214, v71, 0
    v_dot2_f32_bf16 v155, v215, v71, 0
    v_dot2_f32_bf16 v172, v214, v75, 0
    v_dot2_f32_bf16 v173, v215, v75, 0
    s_waitcnt vmcnt(53)
    v_accvgpr_read_b32 v212, a40
    v_accvgpr_read_b32 v213, a50
    v_perm_b32 v214, v213, v212, s36
    v_perm_b32 v215, v213, v212, s37
    v_dot2_f32_bf16 v102, v214, v64, v102
    v_dot2_f32_bf16 v103, v215, v64, v103
    v_dot2_f32_bf16 v120, v214, v68, v120
    v_dot2_f32_bf16 v121, v215, v68, v121
    v_dot2_f32_bf16 v138, v214, v72, v138
    v_dot2_f32_bf16 v139, v215, v72, v139
    v_dot2_f32_bf16 v156, v214, v76, v156
    v_dot2_f32_bf16 v157, v215, v76, v157
    v_accvgpr_read_b32 v216, a41
    v_accvgpr_read_b32 v217, a51
    v_perm_b32 v218, v217, v216, s36
    v_perm_b32 v219, v217, v216, s37
    v_dot2_f32_bf16 v104, v218, v64, v104
    v_dot2_f32_bf16 v105, v219, v64, v105
    v_dot2_f32_bf16 v122, v218, v68, v122
    v_dot2_f32_bf16 v123, v219, v68, v123
    v_dot2_f32_bf16 v140, v218, v72, v140
    v_dot2_f32_bf16 v141, v219, v72, v141
    v_dot2_f32_bf16 v158, v218, v76, v158
    v_dot2_f32_bf16 v159, v219, v76, v159
    v_accvgpr_read_b32 v212, a42
    v_accvgpr_read_b32 v213, a52
    v_perm_b32 v214, v213, v212, s36
    v_perm_b32 v215, v213, v212, s37
    v_dot2_f32_bf16 v106, v214, v64, v106
    v_dot2_f32_bf16 v107, v215, v64, v107
    v_dot2_f32_bf16 v124, v214, v68, v124
    v_dot2_f32_bf16 v125, v215, v68, v125
    v_dot2_f32_bf16 v142, v214, v72, v142
    v_dot2_f32_bf16 v143, v215, v72, v143
    v_dot2_f32_bf16 v160, v214, v76, v160
    v_dot2_f32_bf16 v161, v215, v76, v161
    v_accvgpr_read_b32 v216, a43
    v_accvgpr_read_b32 v217, a53
    v_perm_b32 v218, v217, v216, s36
    v_perm_b32 v219, v217, v216, s37
    v_dot2_f32_bf16 v108, v218, v64, v108
    v_dot2_f32_bf16 v109, v219, v64, v109
    v_dot2_f32_bf16 v126, v218, v68, v126
    v_dot2_f32_bf16 v127, v219, v68, v127
    v_dot2_f32_bf16 v144, v218, v72, v144
    v_dot2_f32_bf16 v145, v219, v72, v145
    v_dot2_f32_bf16 v162, v218, v76, v162
    v_dot2_f32_bf16 v163, v219, v76, v163
    v_accvgpr_read_b32 v212, a44
    v_accvgpr_read_b32 v213, a54
    v_perm_b32 v214, v213, v212, s36
    v_perm_b32 v215, v213, v212, s37
    v_dot2_f32_bf16 v110, v214, v64, v110
    v_dot2_f32_bf16 v111, v215, v64, v111
    v_dot2_f32_bf16 v128, v214, v68, v128
    v_dot2_f32_bf16 v129, v215, v68, v129
    v_dot2_f32_bf16 v146, v214, v72, v146
    v_dot2_f32_bf16 v147, v215, v72, v147
    v_dot2_f32_bf16 v164, v214, v76, v164
    v_dot2_f32_bf16 v165, v215, v76, v165
    v_accvgpr_read_b32 v216, a45
    v_accvgpr_read_b32 v217, a55
    v_perm_b32 v218, v217, v216, s36
    v_perm_b32 v219, v217, v216, s37
    v_dot2_f32_bf16 v112, v218, v64, v112
    v_dot2_f32_bf16 v113, v219, v64, v113
    v_dot2_f32_bf16 v130, v218, v68, v130
    v_dot2_f32_bf16 v131, v219, v68, v131
    v_dot2_f32_bf16 v148, v218, v72, v148
    v_dot2_f32_bf16 v149, v219, v72, v149
    v_dot2_f32_bf16 v166, v218, v76, v166
    v_dot2_f32_bf16 v167, v219, v76, v167
    v_accvgpr_read_b32 v212, a46
    v_accvgpr_read_b32 v213, a56
    v_perm_b32 v214, v213, v212, s36
    v_perm_b32 v215, v213, v212, s37
    v_dot2_f32_bf16 v114, v214, v64, v114
    v_dot2_f32_bf16 v115, v215, v64, v115
    v_dot2_f32_bf16 v132, v214, v68, v132
    v_dot2_f32_bf16 v133, v215, v68, v133
    v_dot2_f32_bf16 v150, v214, v72, v150
    v_dot2_f32_bf16 v151, v215, v72, v151
    v_dot2_f32_bf16 v168, v214, v76, v168
    v_dot2_f32_bf16 v169, v215, v76, v169
    v_accvgpr_read_b32 v216, a47
    v_accvgpr_read_b32 v217, a57
    v_perm_b32 v218, v217, v216, s36
    v_perm_b32 v219, v217, v216, s37
    v_dot2_f32_bf16 v116, v218, v64, v116
    v_dot2_f32_bf16 v117, v219, v64, v117
    v_dot2_f32_bf16 v134, v218, v68, v134
    v_dot2_f32_bf16 v135, v219, v68, v135
    v_dot2_f32_bf16 v152, v218, v72, v152
    v_dot2_f32_bf16 v153, v219, v72, v153
    v_dot2_f32_bf16 v170, v218, v76, v170
    v_dot2_f32_bf16 v171, v219, v76, v171
    v_accvgpr_read_b32 v212, a48
    v_accvgpr_read_b32 v213, a58
    v_perm_b32 v214, v213, v212, s36
    v_perm_b32 v215, v213, v212, s37
    v_dot2_f32_bf16 v118, v214, v64, v118
    v_dot2_f32_bf16 v119, v215, v64, v119
    v_dot2_f32_bf16 v136, v214, v68, v136
    v_dot2_f32_bf16 v137, v215, v68, v137
    v_dot2_f32_bf16 v154, v214, v72, v154
    v_dot2_f32_bf16 v155, v215, v72, v155
    v_dot2_f32_bf16 v172, v214, v76, v172
    v_dot2_f32_bf16 v173, v215, v76, v173
    s_waitcnt vmcnt(47)
    v_accvgpr_read_b32 v212, a60
    v_accvgpr_read_b32 v213, a70
    v_perm_b32 v214, v213, v212, s36
    v_perm_b32 v215, v213, v212, s37
    v_dot2_f32_bf16 v102, v214, v65, v102
    v_dot2_f32_bf16 v103, v215, v65, v103
    v_dot2_f32_bf16 v120, v214, v69, v120
    v_dot2_f32_bf16 v121, v215, v69, v121
    v_dot2_f32_bf16 v138, v214, v73, v138
    v_dot2_f32_bf16 v139, v215, v73, v139
    v_dot2_f32_bf16 v156, v214, v77, v156
    v_dot2_f32_bf16 v157, v215, v77, v157
    v_accvgpr_read_b32 v216, a61
    v_accvgpr_read_b32 v217, a71
    v_perm_b32 v218, v217, v216, s36
    v_perm_b32 v219, v217, v216, s37
    v_dot2_f32_bf16 v104, v218, v65, v104
    v_dot2_f32_bf16 v105, v219, v65, v105
    v_dot2_f32_bf16 v122, v218, v69, v122
    v_dot2_f32_bf16 v123, v219, v69, v123
    v_dot2_f32_bf16 v140, v218, v73, v140
    v_dot2_f32_bf16 v141, v219, v73, v141
    v_dot2_f32_bf16 v158, v218, v77, v158
    v_dot2_f32_bf16 v159, v219, v77, v159
    v_accvgpr_read_b32 v212, a62
    v_accvgpr_read_b32 v213, a72
    v_perm_b32 v214, v213, v212, s36
    v_perm_b32 v215, v213, v212, s37
    v_dot2_f32_bf16 v106, v214, v65, v106
    v_dot2_f32_bf16 v107, v215, v65, v107
    v_dot2_f32_bf16 v124, v214, v69, v124
    v_dot2_f32_bf16 v125, v215, v69, v125
    v_dot2_f32_bf16 v142, v214, v73, v142
    v_dot2_f32_bf16 v143, v215, v73, v143
    v_dot2_f32_bf16 v160, v214, v77, v160
    v_dot2_f32_bf16 v161, v215, v77, v161
    v_accvgpr_read_b32 v216, a63
    v_accvgpr_read_b32 v217, a73
    v_perm_b32 v218, v217, v216, s36
    v_perm_b32 v219, v217, v216, s37
    v_dot2_f32_bf16 v108, v218, v65, v108
    v_dot2_f32_bf16 v109, v219, v65, v109
    v_dot2_f32_bf16 v126, v218, v69, v126
    v_dot2_f32_bf16 v127, v219, v69, v127
    v_dot2_f32_bf16 v144, v218, v73, v144
    v_dot2_f32_bf16 v145, v219, v73, v145
    v_dot2_f32_bf16 v162, v218, v77, v162
    v_dot2_f32_bf16 v163, v219, v77, v163
    v_accvgpr_read_b32 v212, a64
    v_accvgpr_read_b32 v213, a74
    v_perm_b32 v214, v213, v212, s36
    v_perm_b32 v215, v213, v212, s37
    v_dot2_f32_bf16 v110, v214, v65, v110
    v_dot2_f32_bf16 v111, v215, v65, v111
    v_dot2_f32_bf16 v128, v214, v69, v128
    v_dot2_f32_bf16 v129, v215, v69, v129
    v_dot2_f32_bf16 v146, v214, v73, v146
    v_dot2_f32_bf16 v147, v215, v73, v147
    v_dot2_f32_bf16 v164, v214, v77, v164
    v_dot2_f32_bf16 v165, v215, v77, v165
    v_accvgpr_read_b32 v216, a65
    v_accvgpr_read_b32 v217, a75
    v_perm_b32 v218, v217, v216, s36
    v_perm_b32 v219, v217, v216, s37
    v_dot2_f32_bf16 v112, v218, v65, v112
    v_dot2_f32_bf16 v113, v219, v65, v113
    v_dot2_f32_bf16 v130, v218, v69, v130
    v_dot2_f32_bf16 v131, v219, v69, v131
    v_dot2_f32_bf16 v148, v218, v73, v148
    v_dot2_f32_bf16 v149, v219, v73, v149
    v_dot2_f32_bf16 v166, v218, v77, v166
    v_dot2_f32_bf16 v167, v219, v77, v167
    v_accvgpr_read_b32 v212, a66
    v_accvgpr_read_b32 v213, a76
    v_perm_b32 v214, v213, v212, s36
    v_perm_b32 v215, v213, v212, s37
    v_dot2_f32_bf16 v114, v214, v65, v114
    v_dot2_f32_bf16 v115, v215, v65, v115
    v_dot2_f32_bf16 v132, v214, v69, v132
    v_dot2_f32_bf16 v133, v215, v69, v133
    v_dot2_f32_bf16 v150, v214, v73, v150
    v_dot2_f32_bf16 v151, v215, v73, v151
    v_dot2_f32_bf16 v168, v214, v77, v168
    v_dot2_f32_bf16 v169, v215, v77, v169
    v_accvgpr_read_b32 v216, a67
    v_accvgpr_read_b32 v217, a77
    v_perm_b32 v218, v217, v216, s36
    v_perm_b32 v219, v217, v216, s37
    v_dot2_f32_bf16 v116, v218, v65, v116
    v_dot2_f32_bf16 v117, v219, v65, v117
    v_dot2_f32_bf16 v134, v218, v69, v134
    v_dot2_f32_bf16 v135, v219, v69, v135
    v_dot2_f32_bf16 v152, v218, v73, v152
    v_dot2_f32_bf16 v153, v219, v73, v153
    v_dot2_f32_bf16 v170, v218, v77, v170
    v_dot2_f32_bf16 v171, v219, v77, v171
    v_accvgpr_read_b32 v212, a68
    v_accvgpr_read_b32 v213, a78
    v_perm_b32 v214, v213, v212, s36
    v_perm_b32 v215, v213, v212, s37
    v_dot2_f32_bf16 v118, v214, v65, v118
    v_dot2_f32_bf16 v119, v215, v65, v119
    v_dot2_f32_bf16 v136, v214, v69, v136
    v_dot2_f32_bf16 v137, v215, v69, v137
    v_dot2_f32_bf16 v154, v214, v73, v154
    v_dot2_f32_bf16 v155, v215, v73, v155
    v_dot2_f32_bf16 v172, v214, v77, v172
    v_dot2_f32_bf16 v173, v215, v77, v173
    s_waitcnt vmcnt(41)
    v_accvgpr_read_b32 v212, a80
    v_accvgpr_read_b32 v213, a90
    v_perm_b32 v214, v213, v212, s36
    v_perm_b32 v215, v213, v212, s37
    v_dot2_f32_bf16 v120, v214, v70, v120
    v_dot2_f32_bf16 v121, v215, v70, v121
    v_dot2_f32_bf16 v138, v214, v74, v138
    v_dot2_f32_bf16 v139, v215, v74, v139
    v_dot2_f32_bf16 v156, v214, v78, v156
    v_dot2_f32_bf16 v157, v215, v78, v157
    v_accvgpr_read_b32 v216, a81
    v_accvgpr_read_b32 v217, a91
    v_perm_b32 v218, v217, v216, s36
    v_perm_b32 v219, v217, v216, s37
    v_dot2_f32_bf16 v122, v218, v70, v122
    v_dot2_f32_bf16 v123, v219, v70, v123
    v_dot2_f32_bf16 v140, v218, v74, v140
    v_dot2_f32_bf16 v141, v219, v74, v141
    v_dot2_f32_bf16 v158, v218, v78, v158
    v_dot2_f32_bf16 v159, v219, v78, v159
    v_accvgpr_read_b32 v212, a82
    v_accvgpr_read_b32 v213, a92
    v_perm_b32 v214, v213, v212, s36
    v_perm_b32 v215, v213, v212, s37
    v_dot2_f32_bf16 v124, v214, v70, v124
    v_dot2_f32_bf16 v125, v215, v70, v125
    v_dot2_f32_bf16 v142, v214, v74, v142
    v_dot2_f32_bf16 v143, v215, v74, v143
    v_dot2_f32_bf16 v160, v214, v78, v160
    v_dot2_f32_bf16 v161, v215, v78, v161
    v_accvgpr_read_b32 v216, a83
    v_accvgpr_read_b32 v217, a93
    v_perm_b32 v218, v217, v216, s36
    v_perm_b32 v219, v217, v216, s37
    v_dot2_f32_bf16 v126, v218, v70, v126
    v_dot2_f32_bf16 v127, v219, v70, v127
    v_dot2_f32_bf16 v144, v218, v74, v144
    v_dot2_f32_bf16 v145, v219, v74, v145
    v_dot2_f32_bf16 v162, v218, v78, v162
    v_dot2_f32_bf16 v163, v219, v78, v163
    v_accvgpr_read_b32 v212, a84
    v_accvgpr_read_b32 v213, a94
    v_perm_b32 v214, v213, v212, s36
    v_perm_b32 v215, v213, v212, s37
    v_dot2_f32_bf16 v128, v214, v70, v128
    v_dot2_f32_bf16 v129, v215, v70, v129
    v_dot2_f32_bf16 v146, v214, v74, v146
    v_dot2_f32_bf16 v147, v215, v74, v147
    v_dot2_f32_bf16 v164, v214, v78, v164
    v_dot2_f32_bf16 v165, v215, v78, v165
    v_accvgpr_read_b32 v216, a85
    v_accvgpr_read_b32 v217, a95
    v_perm_b32 v218, v217, v216, s36
    v_perm_b32 v219, v217, v216, s37
    v_dot2_f32_bf16 v130, v218, v70, v130
    v_dot2_f32_bf16 v131, v219, v70, v131
    v_dot2_f32_bf16 v148, v218, v74, v148
    v_dot2_f32_bf16 v149, v219, v74, v149
    v_dot2_f32_bf16 v166, v218, v78, v166
    v_dot2_f32_bf16 v167, v219, v78, v167
    v_accvgpr_read_b32 v212, a86
    v_accvgpr_read_b32 v213, a96
    v_perm_b32 v214, v213, v212, s36
    v_perm_b32 v215, v213, v212, s37
    v_dot2_f32_bf16 v132, v214, v70, v132
    v_dot2_f32_bf16 v133, v215, v70, v133
    v_dot2_f32_bf16 v150, v214, v74, v150
    v_dot2_f32_bf16 v151, v215, v74, v151
    v_dot2_f32_bf16 v168, v214, v78, v168
    v_dot2_f32_bf16 v169, v215, v78, v169
    v_accvgpr_read_b32 v216, a87
    v_accvgpr_read_b32 v217, a97
    v_perm_b32 v218, v217, v216, s36
    v_perm_b32 v219, v217, v216, s37
    v_dot2_f32_bf16 v134, v218, v70, v134
    v_dot2_f32_bf16 v135, v219, v70, v135
    v_dot2_f32_bf16 v152, v218, v74, v152
    v_dot2_f32_bf16 v153, v219, v74, v153
    v_dot2_f32_bf16 v170, v218, v78, v170
    v_dot2_f32_bf16 v171, v219, v78, v171
    v_accvgpr_read_b32 v212, a88
    v_accvgpr_read_b32 v213, a98
    v_perm_b32 v214, v213, v212, s36
    v_perm_b32 v215, v213, v212, s37
    v_dot2_f32_bf16 v136, v214, v70, v136
    v_dot2_f32_bf16 v137, v215, v70, v137
    v_dot2_f32_bf16 v154, v214, v74, v154
    v_dot2_f32_bf16 v155, v215, v74, v155
    v_dot2_f32_bf16 v172, v214, v78, v172
    v_dot2_f32_bf16 v173, v215, v78, v173
    s_waitcnt vmcnt(38)
    v_accvgpr_read_b32 v212, a100
    v_dot2_f32_bf16 v156, v212, v79, v156
    v_dot2_f32_bf16 v157, v212, v80, v157
    v_accvgpr_read_b32 v216, a101
    v_dot2_f32_bf16 v158, v216, v79, v158
    v_dot2_f32_bf16 v159, v216, v80, v159
    v_accvgpr_read_b32 v212, a102
    v_dot2_f32_bf16 v160, v212, v79, v160
    v_dot2_f32_bf16 v161, v212, v80, v161
    v_accvgpr_read_b32 v216, a103
    v_dot2_f32_bf16 v162, v216, v79, v162
    v_dot2_f32_bf16 v163, v216, v80, v163
    v_accvgpr_read_b32 v212, a104
    v_dot2_f32_bf16 v164, v212, v79, v164
    v_dot2_f32_bf16 v165, v212, v80, v165
    v_accvgpr_read_b32 v216, a105
    v_dot2_f32_bf16 v166, v216, v79, v166
    v_dot2_f32_bf16 v167, v216, v80, v167
    v_accvgpr_read_b32 v212, a106
    v_dot2_f32_bf16 v168, v212, v79, v168
    v_dot2_f32_bf16 v169, v212, v80, v169
    v_accvgpr_read_b32 v216, a107
    v_dot2_f32_bf16 v170, v216, v79, v170
    v_dot2_f32_bf16 v171, v216, v80, v171
    v_accvgpr_read_b32 v212, a108
    v_dot2_f32_bf16 v172, v212, v79, v172
    v_dot2_f32_bf16 v173, v212, v80, v173
    s_nop 2
    v_and_b32 v3, 15, v3
    v_mul_u32_u24 v4, 36, v3
    v_mul_u32_u24 v17, 592, v2
    v_add_u32 v17, v17, v4
    v_cvt_pk_bf16_f32 v212, v102, v103
    v_cvt_pk_bf16_f32 v213, v104, v105
    v_cvt_pk_bf16_f32 v214, v106, v107
    v_cvt_pk_bf16_f32 v215, v108, v109
    v_cvt_pk_bf16_f32 v216, v110, v111
    v_cvt_pk_bf16_f32 v217, v112, v113
    v_cvt_pk_bf16_f32 v218, v114, v115
    v_cvt_pk_bf16_f32 v219, v116, v117
    v_cvt_pk_bf16_f32 v220, v118, v119
    ds_write_b32 v17, v212 offset:0
    ds_write_b32 v17, v213 offset:4
    ds_write_b32 v17, v214 offset:8
    ds_write_b32 v17, v215 offset:12
    ds_write_b32 v17, v216 offset:16
    ds_write_b32 v17, v217 offset:20
    ds_write_b32 v17, v218 offset:24
    ds_write_b32 v17, v219 offset:28
    ds_write_b32 v17, v220 offset:32
    v_cvt_pk_bf16_f32 v212, v120, v121
    v_cvt_pk_bf16_f32 v213, v122, v123
    v_cvt_pk_bf16_f32 v214, v124, v125
    v_cvt_pk_bf16_f32 v215, v126, v127
    v_cvt_pk_bf16_f32 v216, v128, v129
    v_cvt_pk_bf16_f32 v217, v130, v131
    v_cvt_pk_bf16_f32 v218, v132, v133
    v_cvt_pk_bf16_f32 v219, v134, v135
    v_cvt_pk_bf16_f32 v220, v136, v137
    ds_write_b32 v17, v212 offset:1184
    ds_write_b32 v17, v213 offset:1188
    ds_write_b32 v17, v214 offset:1192
    ds_write_b32 v17, v215 offset:1196
    ds_write_b32 v17, v216 offset:1200
    ds_write_b32 v17, v217 offset:1204
    ds_write_b32 v17, v218 offset:1208
    ds_write_b32 v17, v219 offset:1212
    ds_write_b32 v17, v220 offset:1216
    v_cvt_pk_bf16_f32 v212, v138, v139
    v_cvt_pk_bf16_f32 v213, v140, v141
    v_cvt_pk_bf16_f32 v214, v142, v143
    v_cvt_pk_bf16_f32 v215, v144, v145
    v_cvt_pk_bf16_f32 v216, v146, v147
    v_cvt_pk_bf16_f32 v217, v148, v149
    v_cvt_pk_bf16_f32 v218, v150, v151
    v_cvt_pk_bf16_f32 v219, v152, v153
    v_cvt_pk_bf16_f32 v220, v154, v155
    ds_write_b32 v17, v212 offset:2368
    ds_write_b32 v17, v213 offset:2372
    ds_write_b32 v17, v214 offset:2376
    ds_write_b32 v17, v215 offset:2380
    ds_write_b32 v17, v216 offset:2384
    ds_write_b32 v17, v217 offset:2388
    ds_write_b32 v17, v218 offset:2392
    ds_write_b32 v17, v219 offset:2396
    ds_write_b32 v17, v220 offset:2400
    v_cvt_pk_bf16_f32 v212, v156, v157
    v_cvt_pk_bf16_f32 v213, v158, v159
    v_cvt_pk_bf16_f32 v214, v160, v161
    v_cvt_pk_bf16_f32 v215, v162, v163
    v_cvt_pk_bf16_f32 v216, v164, v165
    v_cvt_pk_bf16_f32 v217, v166, v167
    v_cvt_pk_bf16_f32 v218, v168, v169
    v_cvt_pk_bf16_f32 v219, v170, v171
    v_cvt_pk_bf16_f32 v220, v172, v173
    ds_write_b32 v17, v212 offset:3552
    ds_write_b32 v17, v213 offset:3556
    ds_write_b32 v17, v214 offset:3560
    ds_write_b32 v17, v215 offset:3564
    ds_write_b32 v17, v216 offset:3568
    ds_write_b32 v17, v217 offset:3572
    ds_write_b32 v17, v218 offset:3576
    ds_write_b32 v17, v219 offset:3580
    ds_write_b32 v17, v220 offset:3584
    s_waitcnt lgkmcnt(0)
    s_barrier
    v_bfe_u32 v6, v0, 5, 1
    v_and_b32 v3, 31, v0
    v_mul_u32_u24 v7, 592, v3
    v_lshl_add_u32 v7, v6, 4, v7
    s_mul_i32 s16, s31, 73728
    s_lshl_b32 s17, s35, 11
    s_add_u32 s16, s16, s17
    s_mul_i32 s17, s30, 2359296
    s_add_u32 s16, s16, s17
    s_add_u32 s17, s16, 36864
    ds_read_b128 v[100:103], v7 offset:0
    ds_read_b128 v[104:107], v7 offset:18944
    ds_read_b128 v[108:111], v7 offset:32
    ds_read_b128 v[112:115], v7 offset:18976
    ds_read_b128 v[116:119], v7 offset:64
    ds_read_b128 v[120:123], v7 offset:19008
    ds_read_b128 v[124:127], v7 offset:96
    ds_read_b128 v[128:131], v7 offset:19040
    ds_read_b128 v[132:135], v7 offset:128
    ds_read_b128 v[136:139], v7 offset:19072
    ds_read_b128 v[140:143], v7 offset:160
    ds_read_b128 v[144:147], v7 offset:19104
    ds_read_b128 v[148:151], v7 offset:192
    ds_read_b128 v[152:155], v7 offset:19136
    ds_read_b128 v[156:159], v7 offset:224
    ds_read_b128 v[160:163], v7 offset:19168
    ds_read_b128 v[164:167], v7 offset:256
    ds_read_b128 v[168:171], v7 offset:19200
    ds_read_b128 v[172:175], v7 offset:288
    ds_read_b128 v[176:179], v7 offset:19232
    ds_read_b128 v[180:183], v7 offset:320
    ds_read_b128 v[184:187], v7 offset:19264
    ds_read_b128 v[188:191], v7 offset:352
    ds_read_b128 v[192:195], v7 offset:19296
    ds_read_b128 v[196:199], v7 offset:384
    ds_read_b128 v[200:203], v7 offset:19328
    ds_read_b128 v[204:207], v7 offset:416
    ds_read_b128 v[208:211], v7 offset:19360
    ds_read_b128 v[212:215], v7 offset:448
    ds_read_b128 v[216:219], v7 offset:19392
    ds_read_b128 v[220:223], v7 offset:480
    ds_read_b128 v[224:227], v7 offset:19424
    ds_read_b128 v[228:231], v7 offset:512
    ds_read_b128 v[232:235], v7 offset:19456
    ds_read_b128 v[236:239], v7 offset:544
    ds_read_b128 v[240:243], v7 offset:19488
    s_waitcnt vmcnt(35)
    s_waitcnt lgkmcnt(15)
    v_mfma_f32_32x32x16_bf16 v[20:35], a[112:115], v[100:103], 0
    s_waitcnt lgkmcnt(15)
    v_mfma_f32_32x32x16_bf16 v[36:51], a[112:115], v[104:107], 0
    s_add_u32 s34, s34, 131072
    buffer_load_dwordx4 a[112:115], v1, s[48:51], s34 offen offset:0
    s_waitcnt vmcnt(35)
    s_waitcnt lgkmcnt(15)
    v_mfma_f32_32x32x16_bf16 v[20:35], a[116:119], v[108:111], v[20:35]
    s_waitcnt lgkmcnt(15)
    v_mfma_f32_32x32x16_bf16 v[36:51], a[116:119], v[112:115], v[36:51]
    buffer_load_dwordx4 a[116:119], v1, s[48:51], s34 offen offset:1024
    s_waitcnt vmcnt(35)
    s_waitcnt lgkmcnt(15)
    v_mfma_f32_32x32x16_bf16 v[20:35], a[120:123], v[116:119], v[20:35]
    s_waitcnt lgkmcnt(15)
    v_mfma_f32_32x32x16_bf16 v[36:51], a[120:123], v[120:123], v[36:51]
    buffer_load_dwordx4 a[120:123], v1, s[48:51], s34 offen offset:2048
    s_waitcnt vmcnt(35)
    s_waitcnt lgkmcnt(15)
    v_mfma_f32_32x32x16_bf16 v[20:35], a[124:127], v[124:127], v[20:35]
    s_waitcnt lgkmcnt(15)
    v_mfma_f32_32x32x16_bf16 v[36:51], a[124:127], v[128:131], v[36:51]
    buffer_load_dwordx4 a[124:127], v1, s[48:51], s34 offen offset:3072
    s_waitcnt vmcnt(35)
    s_waitcnt lgkmcnt(15)
    v_mfma_f32_32x32x16_bf16 v[20:35], a[128:131], v[132:135], v[20:35]
    s_waitcnt lgkmcnt(15)
    v_mfma_f32_32x32x16_bf16 v[36:51], a[128:131], v[136:139], v[36:51]
    s_add_u32 s34, s34, 4096
    buffer_load_dwordx4 a[128:131], v1, s[48:51], s34 offen offset:0
    s_waitcnt vmcnt(35)
    s_waitcnt lgkmcnt(15)
    v_mfma_f32_32x32x16_bf16 v[20:35], a[132:135], v[140:143], v[20:35]
    s_waitcnt lgkmcnt(15)
    v_mfma_f32_32x32x16_bf16 v[36:51], a[132:135], v[144:147], v[36:51]
    buffer_load_dwordx4 a[132:135], v1, s[48:51], s34 offen offset:1024
    s_waitcnt vmcnt(35)
    s_waitcnt lgkmcnt(15)
    v_mfma_f32_32x32x16_bf16 v[20:35], a[136:139], v[148:151], v[20:35]
    s_waitcnt lgkmcnt(15)
    v_mfma_f32_32x32x16_bf16 v[36:51], a[136:139], v[152:155], v[36:51]
    buffer_load_dwordx4 a[136:139], v1, s[48:51], s34 offen offset:2048
    s_waitcnt vmcnt(35)
    s_waitcnt lgkmcnt(15)
    v_mfma_f32_32x32x16_bf16 v[20:35], a[140:143], v[156:159], v[20:35]
    s_waitcnt lgkmcnt(15)
    v_mfma_f32_32x32x16_bf16 v[36:51], a[140:143], v[160:163], v[36:51]
    buffer_load_dwordx4 a[140:143], v1, s[48:51], s34 offen offset:3072
    s_waitcnt vmcnt(35)
    s_waitcnt lgkmcnt(15)
    v_mfma_f32_32x32x16_bf16 v[20:35], a[144:147], v[164:167], v[20:35]
    s_waitcnt lgkmcnt(15)
    v_mfma_f32_32x32x16_bf16 v[36:51], a[144:147], v[168:171], v[36:51]
    s_add_u32 s34, s34, 4096
    buffer_load_dwordx4 a[144:147], v1, s[48:51], s34 offen offset:0
    s_waitcnt vmcnt(35)
    s_waitcnt lgkmcnt(15)
    v_mfma_f32_32x32x16_bf16 v[20:35], a[148:151], v[172:175], v[20:35]
    s_waitcnt lgkmcnt(15)
    v_mfma_f32_32x32x16_bf16 v[36:51], a[148:151], v[176:179], v[36:51]
    buffer_load_dwordx4 a[148:151], v1, s[48:51], s34 offen offset:1024
    s_waitcnt vmcnt(35)
    s_waitcnt lgkmcnt(15)
    v_mfma_f32_32x32x16_bf16 v[20:35], a[152:155], v[180:183], v[20:35]
    s_waitcnt lgkmcnt(14)
    v_mfma_f32_32x32x16_bf16 v[36:51], a[152:155], v[184:187], v[36:51]
    buffer_load_dwordx4 a[152:155], v1, s[48:51], s34 offen offset:2048
    s_waitcnt vmcnt(35)
    s_waitcnt lgkmcnt(13)
    v_mfma_f32_32x32x16_bf16 v[20:35], a[156:159], v[188:191], v[20:35]
    s_waitcnt lgkmcnt(12)
    v_mfma_f32_32x32x16_bf16 v[36:51], a[156:159], v[192:195], v[36:51]
    buffer_load_dwordx4 a[156:159], v1, s[48:51], s34 offen offset:3072
    s_waitcnt vmcnt(35)
    s_waitcnt lgkmcnt(11)
    v_mfma_f32_32x32x16_bf16 v[20:35], a[160:163], v[196:199], v[20:35]
    s_waitcnt lgkmcnt(10)
    v_mfma_f32_32x32x16_bf16 v[36:51], a[160:163], v[200:203], v[36:51]
    s_add_u32 s34, s34, 4096
    buffer_load_dwordx4 a[160:163], v1, s[48:51], s34 offen offset:0
    s_waitcnt vmcnt(35)
    s_waitcnt lgkmcnt(9)
    v_mfma_f32_32x32x16_bf16 v[20:35], a[164:167], v[204:207], v[20:35]
    s_waitcnt lgkmcnt(8)
    v_mfma_f32_32x32x16_bf16 v[36:51], a[164:167], v[208:211], v[36:51]
    buffer_load_dwordx4 a[164:167], v1, s[48:51], s34 offen offset:1024
    s_waitcnt vmcnt(35)
    s_waitcnt lgkmcnt(7)
    v_mfma_f32_32x32x16_bf16 v[20:35], a[168:171], v[212:215], v[20:35]
    s_waitcnt lgkmcnt(6)
    v_mfma_f32_32x32x16_bf16 v[36:51], a[168:171], v[216:219], v[36:51]
    buffer_load_dwordx4 a[168:171], v1, s[48:51], s34 offen offset:2048
    s_waitcnt vmcnt(35)
    s_waitcnt lgkmcnt(5)
    v_mfma_f32_32x32x16_bf16 v[20:35], a[172:175], v[220:223], v[20:35]
    s_waitcnt lgkmcnt(4)
    v_mfma_f32_32x32x16_bf16 v[36:51], a[172:175], v[224:227], v[36:51]
    buffer_load_dwordx4 a[172:175], v1, s[48:51], s34 offen offset:3072
    s_waitcnt vmcnt(35)
    s_waitcnt lgkmcnt(3)
    v_mfma_f32_32x32x16_bf16 v[20:35], a[176:179], v[228:231], v[20:35]
    s_waitcnt lgkmcnt(2)
    v_mfma_f32_32x32x16_bf16 v[36:51], a[176:179], v[232:235], v[36:51]
    s_add_u32 s34, s34, 4096
    buffer_load_dwordx4 a[176:179], v1, s[48:51], s34 offen offset:0
    s_waitcnt vmcnt(35)
    s_waitcnt lgkmcnt(1)
    v_mfma_f32_32x32x16_bf16 v[20:35], a[180:183], v[236:239], v[20:35]
    s_waitcnt lgkmcnt(0)
    v_mfma_f32_32x32x16_bf16 v[36:51], a[180:183], v[240:243], v[36:51]
    buffer_load_dwordx4 a[180:183], v1, s[48:51], s34 offen offset:1024
    s_waitcnt vmcnt(35)
    v_mfma_f32_32x32x16_bf16 v[52:67], a[184:187], v[100:103], 0
    v_mfma_f32_32x32x16_bf16 v[68:83], a[184:187], v[104:107], 0
    s_add_u32 s34, s34, 131072
    buffer_load_dwordx4 a[184:187], v1, s[48:51], s34 offen offset:0
    s_waitcnt vmcnt(35)
    v_mfma_f32_32x32x16_bf16 v[52:67], a[188:191], v[108:111], v[52:67]
    v_mfma_f32_32x32x16_bf16 v[68:83], a[188:191], v[112:115], v[68:83]
    buffer_load_dwordx4 a[188:191], v1, s[48:51], s34 offen offset:1024
    v_cvt_pk_bf16_f32 v84, v20, v21
    v_cvt_pk_bf16_f32 v85, v22, v23
    v_cvt_pk_bf16_f32 v86, v24, v25
    v_cvt_pk_bf16_f32 v87, v26, v27
    v_cvt_pk_bf16_f32 v88, v28, v29
    v_cvt_pk_bf16_f32 v89, v30, v31
    v_cvt_pk_bf16_f32 v90, v32, v33
    v_cvt_pk_bf16_f32 v91, v34, v35
    buffer_store_dwordx4 v[84:87], v1, s[12:15], s16 offen sc1
    buffer_store_dwordx4 v[88:91], v1, s[12:15], s16 offen offset:1024 sc1
    s_add_u32 s16, s16, 8192
    s_waitcnt vmcnt(37)
    v_mfma_f32_32x32x16_bf16 v[52:67], a[192:195], v[116:119], v[52:67]
    v_mfma_f32_32x32x16_bf16 v[68:83], a[192:195], v[120:123], v[68:83]
    buffer_load_dwordx4 a[192:195], v1, s[48:51], s34 offen offset:2048
    v_cvt_pk_bf16_f32 v92, v36, v37
    v_cvt_pk_bf16_f32 v93, v38, v39
    v_cvt_pk_bf16_f32 v94, v40, v41
    v_cvt_pk_bf16_f32 v95, v42, v43
    v_cvt_pk_bf16_f32 v96, v44, v45
    v_cvt_pk_bf16_f32 v97, v46, v47
    v_cvt_pk_bf16_f32 v98, v48, v49
    v_cvt_pk_bf16_f32 v99, v50, v51
    buffer_store_dwordx4 v[92:95], v1, s[12:15], s17 offen sc1
    buffer_store_dwordx4 v[96:99], v1, s[12:15], s17 offen offset:1024 sc1
    s_add_u32 s17, s17, 8192
    s_waitcnt vmcnt(39)
    v_mfma_f32_32x32x16_bf16 v[52:67], a[196:199], v[124:127], v[52:67]
    v_mfma_f32_32x32x16_bf16 v[68:83], a[196:199], v[128:131], v[68:83]
    buffer_load_dwordx4 a[196:199], v1, s[48:51], s34 offen offset:3072
    s_waitcnt vmcnt(39)
    v_mfma_f32_32x32x16_bf16 v[52:67], a[200:203], v[132:135], v[52:67]
    v_mfma_f32_32x32x16_bf16 v[68:83], a[200:203], v[136:139], v[68:83]
    s_add_u32 s34, s34, 4096
    buffer_load_dwordx4 a[200:203], v1, s[48:51], s34 offen offset:0
    s_waitcnt vmcnt(39)
    v_mfma_f32_32x32x16_bf16 v[52:67], a[204:207], v[140:143], v[52:67]
    v_mfma_f32_32x32x16_bf16 v[68:83], a[204:207], v[144:147], v[68:83]
    buffer_load_dwordx4 a[204:207], v1, s[48:51], s34 offen offset:1024
    s_waitcnt vmcnt(39)
    v_mfma_f32_32x32x16_bf16 v[52:67], a[208:211], v[148:151], v[52:67]
    v_mfma_f32_32x32x16_bf16 v[68:83], a[208:211], v[152:155], v[68:83]
    buffer_load_dwordx4 a[208:211], v1, s[48:51], s34 offen offset:2048
    s_waitcnt vmcnt(39)
    v_mfma_f32_32x32x16_bf16 v[52:67], a[212:215], v[156:159], v[52:67]
    v_mfma_f32_32x32x16_bf16 v[68:83], a[212:215], v[160:163], v[68:83]
    buffer_load_dwordx4 a[212:215], v1, s[48:51], s34 offen offset:3072
    s_waitcnt vmcnt(39)
    v_mfma_f32_32x32x16_bf16 v[52:67], a[216:219], v[164:167], v[52:67]
    v_mfma_f32_32x32x16_bf16 v[68:83], a[216:219], v[168:171], v[68:83]
    s_add_u32 s34, s34, 4096
    buffer_load_dwordx4 a[216:219], v1, s[48:51], s34 offen offset:0
    s_waitcnt vmcnt(39)
    v_mfma_f32_32x32x16_bf16 v[52:67], a[220:223], v[172:175], v[52:67]
    v_mfma_f32_32x32x16_bf16 v[68:83], a[220:223], v[176:179], v[68:83]
    buffer_load_dwordx4 a[220:223], v1, s[48:51], s34 offen offset:1024
    s_waitcnt vmcnt(39)
    v_mfma_f32_32x32x16_bf16 v[52:67], a[224:227], v[180:183], v[52:67]
    v_mfma_f32_32x32x16_bf16 v[68:83], a[224:227], v[184:187], v[68:83]
    buffer_load_dwordx4 a[224:227], v1, s[48:51], s34 offen offset:2048
    s_waitcnt vmcnt(39)
    v_mfma_f32_32x32x16_bf16 v[52:67], a[228:231], v[188:191], v[52:67]
    v_mfma_f32_32x32x16_bf16 v[68:83], a[228:231], v[192:195], v[68:83]
    buffer_load_dwordx4 a[228:231], v1, s[48:51], s34 offen offset:3072
    s_waitcnt vmcnt(39)
    v_mfma_f32_32x32x16_bf16 v[52:67], a[232:235], v[196:199], v[52:67]
    v_mfma_f32_32x32x16_bf16 v[68:83], a[232:235], v[200:203], v[68:83]
    s_add_u32 s34, s34, 4096
    buffer_load_dwordx4 a[232:235], v1, s[48:51], s34 offen offset:0
    s_waitcnt vmcnt(39)
    v_mfma_f32_32x32x16_bf16 v[52:67], a[236:239], v[204:207], v[52:67]
    v_mfma_f32_32x32x16_bf16 v[68:83], a[236:239], v[208:211], v[68:83]
    buffer_load_dwordx4 a[236:239], v1, s[48:51], s34 offen offset:1024
    s_waitcnt vmcnt(39)
    v_mfma_f32_32x32x16_bf16 v[52:67], a[240:243], v[212:215], v[52:67]
    v_mfma_f32_32x32x16_bf16 v[68:83], a[240:243], v[216:219], v[68:83]
    buffer_load_dwordx4 a[240:243], v1, s[48:51], s34 offen offset:2048
    s_waitcnt vmcnt(39)
    v_mfma_f32_32x32x16_bf16 v[52:67], a[244:247], v[220:223], v[52:67]
    v_mfma_f32_32x32x16_bf16 v[68:83], a[244:247], v[224:227], v[68:83]
    buffer_load_dwordx4 a[244:247], v1, s[48:51], s34 offen offset:3072
    s_waitcnt vmcnt(39)
    v_mfma_f32_32x32x16_bf16 v[52:67], a[248:251], v[228:231], v[52:67]
    v_mfma_f32_32x32x16_bf16 v[68:83], a[248:251], v[232:235], v[68:83]
    s_add_u32 s34, s34, 4096
    buffer_load_dwordx4 a[248:251], v1, s[48:51], s34 offen offset:0
    s_waitcnt vmcnt(39)
    v_mfma_f32_32x32x16_bf16 v[52:67], a[252:255], v[236:239], v[52:67]
    v_mfma_f32_32x32x16_bf16 v[68:83], a[252:255], v[240:243], v[68:83]
    buffer_load_dwordx4 a[252:255], v1, s[48:51], s34 offen offset:1024
    s_waitcnt vmcnt(39)
    v_mfma_f32_32x32x16_bf16 v[20:35], a[112:115], v[100:103], 0
    v_mfma_f32_32x32x16_bf16 v[36:51], a[112:115], v[104:107], 0
    s_add_u32 s34, s34, 131072
    buffer_load_dwordx4 a[112:115], v1, s[48:51], s34 offen offset:0
    s_waitcnt vmcnt(39)
    v_mfma_f32_32x32x16_bf16 v[20:35], a[116:119], v[108:111], v[20:35]
    v_mfma_f32_32x32x16_bf16 v[36:51], a[116:119], v[112:115], v[36:51]
    buffer_load_dwordx4 a[116:119], v1, s[48:51], s34 offen offset:1024
    v_cvt_pk_bf16_f32 v84, v52, v53
    v_cvt_pk_bf16_f32 v85, v54, v55
    v_cvt_pk_bf16_f32 v86, v56, v57
    v_cvt_pk_bf16_f32 v87, v58, v59
    v_cvt_pk_bf16_f32 v88, v60, v61
    v_cvt_pk_bf16_f32 v89, v62, v63
    v_cvt_pk_bf16_f32 v90, v64, v65
    v_cvt_pk_bf16_f32 v91, v66, v67
    buffer_store_dwordx4 v[84:87], v1, s[12:15], s16 offen sc1
    buffer_store_dwordx4 v[88:91], v1, s[12:15], s16 offen offset:1024 sc1
    s_add_u32 s16, s16, 8192
    s_waitcnt vmcnt(41)
    v_mfma_f32_32x32x16_bf16 v[20:35], a[120:123], v[116:119], v[20:35]
    v_mfma_f32_32x32x16_bf16 v[36:51], a[120:123], v[120:123], v[36:51]
    buffer_load_dwordx4 a[120:123], v1, s[48:51], s34 offen offset:2048
    v_cvt_pk_bf16_f32 v92, v68, v69
    v_cvt_pk_bf16_f32 v93, v70, v71
    v_cvt_pk_bf16_f32 v94, v72, v73
    v_cvt_pk_bf16_f32 v95, v74, v75
    v_cvt_pk_bf16_f32 v96, v76, v77
    v_cvt_pk_bf16_f32 v97, v78, v79
    v_cvt_pk_bf16_f32 v98, v80, v81
    v_cvt_pk_bf16_f32 v99, v82, v83
    buffer_store_dwordx4 v[92:95], v1, s[12:15], s17 offen sc1
    buffer_store_dwordx4 v[96:99], v1, s[12:15], s17 offen offset:1024 sc1
    s_add_u32 s17, s17, 8192
    s_waitcnt vmcnt(43)
    v_mfma_f32_32x32x16_bf16 v[20:35], a[124:127], v[124:127], v[20:35]
    v_mfma_f32_32x32x16_bf16 v[36:51], a[124:127], v[128:131], v[36:51]
    buffer_load_dwordx4 a[124:127], v1, s[48:51], s34 offen offset:3072
    s_waitcnt vmcnt(43)
    v_mfma_f32_32x32x16_bf16 v[20:35], a[128:131], v[132:135], v[20:35]
    v_mfma_f32_32x32x16_bf16 v[36:51], a[128:131], v[136:139], v[36:51]
    s_add_u32 s34, s34, 4096
    buffer_load_dwordx4 a[128:131], v1, s[48:51], s34 offen offset:0
    s_waitcnt vmcnt(43)
    v_mfma_f32_32x32x16_bf16 v[20:35], a[132:135], v[140:143], v[20:35]
    v_mfma_f32_32x32x16_bf16 v[36:51], a[132:135], v[144:147], v[36:51]
    buffer_load_dwordx4 a[132:135], v1, s[48:51], s34 offen offset:1024
    s_waitcnt vmcnt(43)
    v_mfma_f32_32x32x16_bf16 v[20:35], a[136:139], v[148:151], v[20:35]
    v_mfma_f32_32x32x16_bf16 v[36:51], a[136:139], v[152:155], v[36:51]
    buffer_load_dwordx4 a[136:139], v1, s[48:51], s34 offen offset:2048
    s_waitcnt vmcnt(43)
    v_mfma_f32_32x32x16_bf16 v[20:35], a[140:143], v[156:159], v[20:35]
    v_mfma_f32_32x32x16_bf16 v[36:51], a[140:143], v[160:163], v[36:51]
    buffer_load_dwordx4 a[140:143], v1, s[48:51], s34 offen offset:3072
    s_waitcnt vmcnt(43)
    v_mfma_f32_32x32x16_bf16 v[20:35], a[144:147], v[164:167], v[20:35]
    v_mfma_f32_32x32x16_bf16 v[36:51], a[144:147], v[168:171], v[36:51]
    s_add_u32 s34, s34, 4096
    buffer_load_dwordx4 a[144:147], v1, s[48:51], s34 offen offset:0
    s_waitcnt vmcnt(43)
    v_mfma_f32_32x32x16_bf16 v[20:35], a[148:151], v[172:175], v[20:35]
    v_mfma_f32_32x32x16_bf16 v[36:51], a[148:151], v[176:179], v[36:51]
    buffer_load_dwordx4 a[148:151], v1, s[48:51], s34 offen offset:1024
    s_waitcnt vmcnt(43)
    v_mfma_f32_32x32x16_bf16 v[20:35], a[152:155], v[180:183], v[20:35]
    v_mfma_f32_32x32x16_bf16 v[36:51], a[152:155], v[184:187], v[36:51]
    buffer_load_dwordx4 a[152:155], v1, s[48:51], s34 offen offset:2048
    s_waitcnt vmcnt(43)
    v_mfma_f32_32x32x16_bf16 v[20:35], a[156:159], v[188:191], v[20:35]
    v_mfma_f32_32x32x16_bf16 v[36:51], a[156:159], v[192:195], v[36:51]
    buffer_load_dwordx4 a[156:159], v1, s[48:51], s34 offen offset:3072
    s_waitcnt vmcnt(43)
    v_mfma_f32_32x32x16_bf16 v[20:35], a[160:163], v[196:199], v[20:35]
    v_mfma_f32_32x32x16_bf16 v[36:51], a[160:163], v[200:203], v[36:51]
    s_add_u32 s34, s34, 4096
    buffer_load_dwordx4 a[160:163], v1, s[48:51], s34 offen offset:0
    s_waitcnt vmcnt(43)
    v_mfma_f32_32x32x16_bf16 v[20:35], a[164:167], v[204:207], v[20:35]
    v_mfma_f32_32x32x16_bf16 v[36:51], a[164:167], v[208:211], v[36:51]
    buffer_load_dwordx4 a[164:167], v1, s[48:51], s34 offen offset:1024
    s_waitcnt vmcnt(43)
    v_mfma_f32_32x32x16_bf16 v[20:35], a[168:171], v[212:215], v[20:35]
    v_mfma_f32_32x32x16_bf16 v[36:51], a[168:171], v[216:219], v[36:51]
    buffer_load_dwordx4 a[168:171], v1, s[48:51], s34 offen offset:2048
    s_waitcnt vmcnt(43)
    v_mfma_f32_32x32x16_bf16 v[20:35], a[172:175], v[220:223], v[20:35]
    v_mfma_f32_32x32x16_bf16 v[36:51], a[172:175], v[224:227], v[36:51]
    buffer_load_dwordx4 a[172:175], v1, s[48:51], s34 offen offset:3072
    s_waitcnt vmcnt(43)
    v_mfma_f32_32x32x16_bf16 v[20:35], a[176:179], v[228:231], v[20:35]
    v_mfma_f32_32x32x16_bf16 v[36:51], a[176:179], v[232:235], v[36:51]
    s_add_u32 s34, s34, 4096
    buffer_load_dwordx4 a[176:179], v1, s[48:51], s34 offen offset:0
    s_waitcnt vmcnt(43)
    v_mfma_f32_32x32x16_bf16 v[20:35], a[180:183], v[236:239], v[20:35]
    v_mfma_f32_32x32x16_bf16 v[36:51], a[180:183], v[240:243], v[36:51]
    buffer_load_dwordx4 a[180:183], v1, s[48:51], s34 offen offset:1024
    s_waitcnt vmcnt(43)
    v_mfma_f32_32x32x16_bf16 v[52:67], a[184:187], v[100:103], 0
    v_mfma_f32_32x32x16_bf16 v[68:83], a[184:187], v[104:107], 0
    s_waitcnt vmcnt(42)
    v_mfma_f32_32x32x16_bf16 v[52:67], a[188:191], v[108:111], v[52:67]
    v_mfma_f32_32x32x16_bf16 v[68:83], a[188:191], v[112:115], v[68:83]
    v_cvt_pk_bf16_f32 v84, v20, v21
    v_cvt_pk_bf16_f32 v85, v22, v23
    v_cvt_pk_bf16_f32 v86, v24, v25
    v_cvt_pk_bf16_f32 v87, v26, v27
    v_cvt_pk_bf16_f32 v88, v28, v29
    v_cvt_pk_bf16_f32 v89, v30, v31
    v_cvt_pk_bf16_f32 v90, v32, v33
    v_cvt_pk_bf16_f32 v91, v34, v35
    buffer_store_dwordx4 v[84:87], v1, s[12:15], s16 offen sc1
    buffer_store_dwordx4 v[88:91], v1, s[12:15], s16 offen offset:1024 sc1
    s_add_u32 s16, s16, 8192
    s_waitcnt vmcnt(41)
    v_mfma_f32_32x32x16_bf16 v[52:67], a[192:195], v[116:119], v[52:67]
    v_mfma_f32_32x32x16_bf16 v[68:83], a[192:195], v[120:123], v[68:83]
    v_cvt_pk_bf16_f32 v92, v36, v37
    v_cvt_pk_bf16_f32 v93, v38, v39
    v_cvt_pk_bf16_f32 v94, v40, v41
    v_cvt_pk_bf16_f32 v95, v42, v43
    v_cvt_pk_bf16_f32 v96, v44, v45
    v_cvt_pk_bf16_f32 v97, v46, v47
    v_cvt_pk_bf16_f32 v98, v48, v49
    v_cvt_pk_bf16_f32 v99, v50, v51
    buffer_store_dwordx4 v[92:95], v1, s[12:15], s17 offen sc1
    buffer_store_dwordx4 v[96:99], v1, s[12:15], s17 offen offset:1024 sc1
    s_add_u32 s17, s17, 8192
    s_waitcnt vmcnt(40)
    v_mfma_f32_32x32x16_bf16 v[52:67], a[196:199], v[124:127], v[52:67]
    v_mfma_f32_32x32x16_bf16 v[68:83], a[196:199], v[128:131], v[68:83]
    s_waitcnt vmcnt(39)
    v_mfma_f32_32x32x16_bf16 v[52:67], a[200:203], v[132:135], v[52:67]
    v_mfma_f32_32x32x16_bf16 v[68:83], a[200:203], v[136:139], v[68:83]
    s_waitcnt vmcnt(38)
    v_mfma_f32_32x32x16_bf16 v[52:67], a[204:207], v[140:143], v[52:67]
    v_mfma_f32_32x32x16_bf16 v[68:83], a[204:207], v[144:147], v[68:83]
    s_waitcnt vmcnt(37)
    v_mfma_f32_32x32x16_bf16 v[52:67], a[208:211], v[148:151], v[52:67]
    v_mfma_f32_32x32x16_bf16 v[68:83], a[208:211], v[152:155], v[68:83]
    s_waitcnt vmcnt(36)
    v_mfma_f32_32x32x16_bf16 v[52:67], a[212:215], v[156:159], v[52:67]
    v_mfma_f32_32x32x16_bf16 v[68:83], a[212:215], v[160:163], v[68:83]
    s_waitcnt vmcnt(35)
    v_mfma_f32_32x32x16_bf16 v[52:67], a[216:219], v[164:167], v[52:67]
    v_mfma_f32_32x32x16_bf16 v[68:83], a[216:219], v[168:171], v[68:83]
    s_waitcnt vmcnt(34)
    v_mfma_f32_32x32x16_bf16 v[52:67], a[220:223], v[172:175], v[52:67]
    v_mfma_f32_32x32x16_bf16 v[68:83], a[220:223], v[176:179], v[68:83]
    s_waitcnt vmcnt(33)
    v_mfma_f32_32x32x16_bf16 v[52:67], a[224:227], v[180:183], v[52:67]
    v_mfma_f32_32x32x16_bf16 v[68:83], a[224:227], v[184:187], v[68:83]
    s_waitcnt vmcnt(32)
    v_mfma_f32_32x32x16_bf16 v[52:67], a[228:231], v[188:191], v[52:67]
    v_mfma_f32_32x32x16_bf16 v[68:83], a[228:231], v[192:195], v[68:83]
    s_waitcnt vmcnt(31)
    v_mfma_f32_32x32x16_bf16 v[52:67], a[232:235], v[196:199], v[52:67]
    v_mfma_f32_32x32x16_bf16 v[68:83], a[232:235], v[200:203], v[68:83]
    s_waitcnt vmcnt(30)
    v_mfma_f32_32x32x16_bf16 v[52:67], a[236:239], v[204:207], v[52:67]
    v_mfma_f32_32x32x16_bf16 v[68:83], a[236:239], v[208:211], v[68:83]
    s_waitcnt vmcnt(29)
    v_mfma_f32_32x32x16_bf16 v[52:67], a[240:243], v[212:215], v[52:67]
    v_mfma_f32_32x32x16_bf16 v[68:83], a[240:243], v[216:219], v[68:83]
    s_waitcnt vmcnt(28)
    v_mfma_f32_32x32x16_bf16 v[52:67], a[244:247], v[220:223], v[52:67]
    v_mfma_f32_32x32x16_bf16 v[68:83], a[244:247], v[224:227], v[68:83]
    s_waitcnt vmcnt(27)
    v_mfma_f32_32x32x16_bf16 v[52:67], a[248:251], v[228:231], v[52:67]
    v_mfma_f32_32x32x16_bf16 v[68:83], a[248:251], v[232:235], v[68:83]
    s_waitcnt vmcnt(26)
    v_mfma_f32_32x32x16_bf16 v[52:67], a[252:255], v[236:239], v[52:67]
    v_mfma_f32_32x32x16_bf16 v[68:83], a[252:255], v[240:243], v[68:83]
    s_cmp_ge_u32 s35, 2
    s_cbranch_scc1 g2end_g3_kernel_39
    s_waitcnt vmcnt(25)
    v_mfma_f32_32x32x16_bf16 v[20:35], a[112:115], v[100:103], 0
    v_mfma_f32_32x32x16_bf16 v[36:51], a[112:115], v[104:107], 0
    s_waitcnt vmcnt(24)
    v_mfma_f32_32x32x16_bf16 v[20:35], a[116:119], v[108:111], v[20:35]
    v_mfma_f32_32x32x16_bf16 v[36:51], a[116:119], v[112:115], v[36:51]
    v_cvt_pk_bf16_f32 v84, v52, v53
    v_cvt_pk_bf16_f32 v85, v54, v55
    v_cvt_pk_bf16_f32 v86, v56, v57
    v_cvt_pk_bf16_f32 v87, v58, v59
    v_cvt_pk_bf16_f32 v88, v60, v61
    v_cvt_pk_bf16_f32 v89, v62, v63
    v_cvt_pk_bf16_f32 v90, v64, v65
    v_cvt_pk_bf16_f32 v91, v66, v67
    buffer_store_dwordx4 v[84:87], v1, s[12:15], s16 offen sc1
    buffer_store_dwordx4 v[88:91], v1, s[12:15], s16 offen offset:1024 sc1
    s_add_u32 s16, s16, 8192
    s_waitcnt vmcnt(23)
    v_mfma_f32_32x32x16_bf16 v[20:35], a[120:123], v[116:119], v[20:35]
    v_mfma_f32_32x32x16_bf16 v[36:51], a[120:123], v[120:123], v[36:51]
    v_cvt_pk_bf16_f32 v92, v68, v69
    v_cvt_pk_bf16_f32 v93, v70, v71
    v_cvt_pk_bf16_f32 v94, v72, v73
    v_cvt_pk_bf16_f32 v95, v74, v75
    v_cvt_pk_bf16_f32 v96, v76, v77
    v_cvt_pk_bf16_f32 v97, v78, v79
    v_cvt_pk_bf16_f32 v98, v80, v81
    v_cvt_pk_bf16_f32 v99, v82, v83
    buffer_store_dwordx4 v[92:95], v1, s[12:15], s17 offen sc1
    buffer_store_dwordx4 v[96:99], v1, s[12:15], s17 offen offset:1024 sc1
    s_add_u32 s17, s17, 8192
    s_waitcnt vmcnt(22)
    v_mfma_f32_32x32x16_bf16 v[20:35], a[124:127], v[124:127], v[20:35]
    v_mfma_f32_32x32x16_bf16 v[36:51], a[124:127], v[128:131], v[36:51]
    s_waitcnt vmcnt(21)
    v_mfma_f32_32x32x16_bf16 v[20:35], a[128:131], v[132:135], v[20:35]
    v_mfma_f32_32x32x16_bf16 v[36:51], a[128:131], v[136:139], v[36:51]
    s_waitcnt vmcnt(20)
    v_mfma_f32_32x32x16_bf16 v[20:35], a[132:135], v[140:143], v[20:35]
    v_mfma_f32_32x32x16_bf16 v[36:51], a[132:135], v[144:147], v[36:51]
    s_waitcnt vmcnt(19)
    v_mfma_f32_32x32x16_bf16 v[20:35], a[136:139], v[148:151], v[20:35]
    v_mfma_f32_32x32x16_bf16 v[36:51], a[136:139], v[152:155], v[36:51]
    s_waitcnt vmcnt(18)
    v_mfma_f32_32x32x16_bf16 v[20:35], a[140:143], v[156:159], v[20:35]
    v_mfma_f32_32x32x16_bf16 v[36:51], a[140:143], v[160:163], v[36:51]
    s_waitcnt vmcnt(17)
    v_mfma_f32_32x32x16_bf16 v[20:35], a[144:147], v[164:167], v[20:35]
    v_mfma_f32_32x32x16_bf16 v[36:51], a[144:147], v[168:171], v[36:51]
    s_waitcnt vmcnt(16)
    v_mfma_f32_32x32x16_bf16 v[20:35], a[148:151], v[172:175], v[20:35]
    v_mfma_f32_32x32x16_bf16 v[36:51], a[148:151], v[176:179], v[36:51]
    s_waitcnt vmcnt(15)
    v_mfma_f32_32x32x16_bf16 v[20:35], a[152:155], v[180:183], v[20:35]
    v_mfma_f32_32x32x16_bf16 v[36:51], a[152:155], v[184:187], v[36:51]
    s_waitcnt vmcnt(14)
    v_mfma_f32_32x32x16_bf16 v[20:35], a[156:159], v[188:191], v[20:35]
    v_mfma_f32_32x32x16_bf16 v[36:51], a[156:159], v[192:195], v[36:51]
    s_waitcnt vmcnt(13)
    v_mfma_f32_32x32x16_bf16 v[20:35], a[160:163], v[196:199], v[20:35]
    v_mfma_f32_32x32x16_bf16 v[36:51], a[160:163], v[200:203], v[36:51]
    s_waitcnt vmcnt(12)
    v_mfma_f32_32x32x16_bf16 v[20:35], a[164:167], v[204:207], v[20:35]
    v_mfma_f32_32x32x16_bf16 v[36:51], a[164:167], v[208:211], v[36:51]
    s_waitcnt vmcnt(11)
    v_mfma_f32_32x32x16_bf16 v[20:35], a[168:171], v[212:215], v[20:35]
    v_mfma_f32_32x32x16_bf16 v[36:51], a[168:171], v[216:219], v[36:51]
    s_waitcnt vmcnt(10)
    v_mfma_f32_32x32x16_bf16 v[20:35], a[172:175], v[220:223], v[20:35]
    v_mfma_f32_32x32x16_bf16 v[36:51], a[172:175], v[224:227], v[36:51]
    s_waitcnt vmcnt(9)
    v_mfma_f32_32x32x16_bf16 v[20:35], a[176:179], v[228:231], v[20:35]
    v_mfma_f32_32x32x16_bf16 v[36:51], a[176:179], v[232:235], v[36:51]
    s_waitcnt vmcnt(8)
    v_mfma_f32_32x32x16_bf16 v[20:35], a[180:183], v[236:239], v[20:35]
    v_mfma_f32_32x32x16_bf16 v[36:51], a[180:183], v[240:243], v[36:51]
    s_nop 15
    v_cvt_pk_bf16_f32 v84, v20, v21
    v_cvt_pk_bf16_f32 v85, v22, v23
    v_cvt_pk_bf16_f32 v86, v24, v25
    v_cvt_pk_bf16_f32 v87, v26, v27
    v_cvt_pk_bf16_f32 v88, v28, v29
    v_cvt_pk_bf16_f32 v89, v30, v31
    v_cvt_pk_bf16_f32 v90, v32, v33
    v_cvt_pk_bf16_f32 v91, v34, v35
    buffer_store_dwordx4 v[84:87], v1, s[12:15], s16 offen sc1
    buffer_store_dwordx4 v[88:91], v1, s[12:15], s16 offen offset:1024 sc1
    s_add_u32 s16, s16, 8192
    v_cvt_pk_bf16_f32 v92, v36, v37
    v_cvt_pk_bf16_f32 v93, v38, v39
    v_cvt_pk_bf16_f32 v94, v40, v41
    v_cvt_pk_bf16_f32 v95, v42, v43
    v_cvt_pk_bf16_f32 v96, v44, v45
    v_cvt_pk_bf16_f32 v97, v46, v47
    v_cvt_pk_bf16_f32 v98, v48, v49
    v_cvt_pk_bf16_f32 v99, v50, v51
    buffer_store_dwordx4 v[92:95], v1, s[12:15], s17 offen sc1
    buffer_store_dwordx4 v[96:99], v1, s[12:15], s17 offen offset:1024 sc1
    s_add_u32 s17, s17, 8192
    s_waitcnt vmcnt(0)
    s_branch g2join_g3_kernel_40
g2end_g3_kernel_39:
    s_nop 15
    v_cvt_pk_bf16_f32 v84, v52, v53
    v_cvt_pk_bf16_f32 v85, v54, v55
    v_cvt_pk_bf16_f32 v86, v56, v57
    v_cvt_pk_bf16_f32 v87, v58, v59
    v_cvt_pk_bf16_f32 v88, v60, v61
    v_cvt_pk_bf16_f32 v89, v62, v63
    v_cvt_pk_bf16_f32 v90, v64, v65
    v_cvt_pk_bf16_f32 v91, v66, v67
    buffer_store_dwordx4 v[84:87], v1, s[12:15], s16 offen sc1
    buffer_store_dwordx4 v[88:91], v1, s[12:15], s16 offen offset:1024 sc1
    s_add_u32 s16, s16, 8192
    v_cvt_pk_bf16_f32 v92, v68, v69
    v_cvt_pk_bf16_f32 v93, v70, v71
    v_cvt_pk_bf16_f32 v94, v72, v73
    v_cvt_pk_bf16_f32 v95, v74, v75
    v_cvt_pk_bf16_f32 v96, v76, v77
    v_cvt_pk_bf16_f32 v97, v78, v79
    v_cvt_pk_bf16_f32 v98, v80, v81
    v_cvt_pk_bf16_f32 v99, v82, v83
    buffer_store_dwordx4 v[92:95], v1, s[12:15], s17 offen sc1
    buffer_store_dwordx4 v[96:99], v1, s[12:15], s17 offen offset:1024 sc1
    s_add_u32 s17, s17, 8192
    s_waitcnt vmcnt(0)
g2join_g3_kernel_40:
    s_barrier
    s_cmp_lg_u32 s35, 0
    s_cbranch_scc1 end_g3_kernel_1
    s_sub_u32 s70, s2, 192
    s_and_b32 s77, s70, 2
    s_lshr_b32 s70, s70, 2
    s_mul_i32 s90, s70, 768
    s_lshl_b32 s78, 0x333, s77
    s_mov_b32 s79, 0
    v_mov_b32 v9, 16
    v_lshlrev_b32 v3, 6, v0
    s_mov_b64 exec, s[78:79]
    buffer_atomic_add v9, v3, s[92:95], s90 offen sc0 sc1
    s_mov_b64 exec, -1
    s_mov_b32 s71, 0
    s_mov_b32 s72, 0
    v_and_b32 v59, 63, v0
    v_lshlrev_b32 v55, 4, v59
    v_lshrrev_b32 v56, 5, v59
    v_and_b32 v57, 31, v59
    v_mul_u32_u24 v57, 1152, v57
    v_lshlrev_b32 v52, 3, v56
    v_add_u32 v53, v57, v52
    v_lshl_add_u32 v54, v56, 4, v57
    v_mov_b32 v56, 0x3f80
    v_mov_b32 v57, 0x3f800000
    v_mov_b32 v32, 1
    v_mov_b32 v33, 1
    v_and_b32 v35, 3, v59
    v_lshlrev_b32 v35, 2, v35
    v_cmp_eq_u32 vcc, 0, v59
    v_mov_b32 v58, 0x7fff0000
    v_cndmask_b32 v59, v58, v59, vcc
    v_mov_b32 v58, 0x100
    s_mov_b32 s73, 0
    s_mov_b32 s74, 0
    s_add_u32 s12, s40, 0x3000000
    s_addc_u32 s13, s41, 0
    s_mov_b32 s14, 0xd80000
    s_mov_b32 s15, 0x00020000
    s_mov_b32 s20, s68
    s_mov_b32 s21, s69
    s_mov_b32 s22, 0x240000
    s_mov_b32 s23, 0x00020000
    s_movk_i32 s77, 0x414
    s_waitcnt vmcnt(0)
    v_cmp_eq_u32 vcc, s77, v9
    s_and_b32 s74, vcc_lo, s78
    s_branch fnext_g3_kernel_28
end_g3_kernel_1:
    s_endpgm
text_end:
.section .rodata,"a"
.p2align 6
.amdhsa_kernel g1_kernel
  .amdhsa_next_free_vgpr 512
  .amdhsa_next_free_sgpr 96
  .amdhsa_accum_offset 256
  .amdhsa_group_segment_fixed_size 0
  .amdhsa_kernarg_size 88
  .amdhsa_user_sgpr_count 2
  .amdhsa_user_sgpr_kernarg_segment_ptr 1
  .amdhsa_system_sgpr_workgroup_id_x 1
.end_amdhsa_kernel
.p2align 6
.amdhsa_kernel g3_kernel
  .amdhsa_next_free_vgpr 512
  .amdhsa_next_free_sgpr 100
  .amdhsa_accum_offset 256
  .amdhsa_group_segment_fixed_size 0
  .amdhsa_kernarg_size 88
  .amdhsa_user_sgpr_count 2
  .amdhsa_user_sgpr_kernarg_segment_ptr 1
  .amdhsa_system_sgpr_workgroup_id_x 1
.end_amdhsa_kernel
```
